```python
import torch

def _softmax(x, axis=-1):
    return torch.softmax(x, dim=axis)
def _gelu(x):
    return torch.nn.functional.gelu(x, approximate="tanh")
def _silu(x):
    return torch.nn.functional.silu(x)
def _sigmoid(x):
    return torch.sigmoid(x)
def _layernorm(x, axis=-1, eps=1e-5):
    m = x.mean(dim=axis, keepdim=True)
    v = x.var(dim=axis, keepdim=True, unbiased=False)
    return (x - m) / torch.sqrt(v + eps)
def _scatter_add(tgt, idx, src, axis=0):
    return tgt.clone().index_add_(axis, idx, src)
def _segment_sum(src, seg, n):
    out = torch.zeros((n,) + src.shape[1:], dtype=src.dtype)
    return out.index_add_(0, seg, src)
def _pad(x, pw):
    flat = tuple(v for pair in reversed(pw) for v in pair)
    return torch.nn.functional.pad(x, flat)

kernel_name = 'sequential_preLN__sliding_block__mixer_s_mlp__prompt'

def setup_inputs():

    _w = (lambda a: (lambda t: t.to(torch.bfloat16) if t.is_floating_point() else t)(torch.as_tensor(a)))
    def _A_setup():
        B, S, D = 1, 2048, 576
        return {
            "x": _w((lambda *s: torch.randn(*s, dtype=torch.bfloat16) * 0.05)(B, S, D)),
            "wqkv": _w((lambda *s: torch.randn(*s, dtype=torch.bfloat16) * 0.05)(D, 3 * D)),
            "wo": _w((lambda *s: torch.randn(*s, dtype=torch.bfloat16) * 0.05)(D, D)),
        }
    _A_in = _A_setup()

    def _B_setup():
        B, S, D, F = 1, 2048, 576, 4608
        return {
            "x":  _w((lambda *s: torch.randn(*s, dtype=torch.bfloat16) * 0.05)(B, S, D)),
            "w1": _w((lambda *s: torch.randn(*s, dtype=torch.bfloat16) * 3.2)(D, D) * (D ** -0.5)),
            "w2": _w((lambda *s: torch.randn(*s, dtype=torch.bfloat16) * 3.2)(D, D) * (D ** -0.5)),
            "w3": _w((lambda *s: torch.randn(*s, dtype=torch.bfloat16) * 3.2)(D, F) * (D ** -0.5)),
            "w4": _w((lambda *s: torch.randn(*s, dtype=torch.bfloat16) * 3.2)(F, D) * (F ** -0.5)),
        }
    _B_in = _B_setup()

    return {
        "A_x": _A_in["x"],
        "A_wqkv": _A_in["wqkv"],
        "A_wo": _A_in["wo"],
        "B_x": _B_in["x"],
        "B_w1": _B_in["w1"],
        "B_w2": _B_in["w2"],
        "B_w3": _B_in["w3"],
        "B_w4": _B_in["w4"],
    }

def reference(A_x, A_wqkv, A_wo, B_x, B_w1, B_w2, B_w3, B_w4):
    def _A_ref(x, wqkv, wo):
        B, S, D = x.shape
        H = 32; Dh = D // H; W = 256
        qkv = (lambda x, *d: x.permute(*d))((x @ wqkv).reshape(B, S, 3, H, Dh), 2, 0, 3, 1, 4)
        q, k, v = qkv[0], qkv[1], qkv[2]
        scores = torch.einsum("bhqd,bhkd->bhqk", q, k) * (Dh ** -0.5)
        idx = torch.arange(S)
        mask = (idx[:, None] - idx[None, :] >= 0) & (idx[:, None] - idx[None, :] < W)
        scores = torch.where(mask[None, None], scores, -1e9)
        p = _softmax(scores, axis=-1)
        o = torch.einsum("bhqk,bhkd->bhqd", p, v)
        return (lambda x, *d: x.permute(*d))(o, 0, 2, 1, 3).reshape(B, S, D) @ wo

    def _B_ref(x, w1, w2, w3, w4):
        B, S, D = x.shape
        h = _gelu(_layernorm(x, axis=-1) @ w1)
        c = D // 4
        g0 = _pad(h[:, :, 0*c:1*c], ((0, 0), (1, 0), (0, 0)))[:, :S, :]
        g1 = _pad(h[:, :, 1*c:2*c], ((0, 0), (0, 1), (0, 0)))[:, 1:, :]
        g2 = _pad(h[:, :, 2*c:3*c], ((0, 0), (2, 0), (0, 0)))[:, :S, :]
        g3 = _pad(h[:, :, 3*c:   ], ((0, 0), (0, 2), (0, 0)))[:, 2:, :]
        hs = torch.concatenate([g0, g1, g2, g3], axis=-1) @ w2
        x1 = x + hs
        h2 = _gelu(_layernorm(x1, axis=-1) @ w3) @ w4
        return x1 + h2

    x = A_x
    h = x + _A_ref(_layernorm(x, axis=-1), A_wqkv, A_wo)
    h2 = h + _B_ref(_layernorm(h, axis=-1), B_w1, B_w2, B_w3, B_w4)
    return h2
```

```asm
; @launch grid=(256,1,1) block=(256,1,1) lds=163840
.amdgcn_target "amdgcn-amd-amdhsa--gfx950"
.text
.globl sequential_preLN__sliding_block__mixer_s_mlp__prompt_kernel
.p2align 8
.type sequential_preLN__sliding_block__mixer_s_mlp__prompt_kernel,@function
sequential_preLN__sliding_block__mixer_s_mlp__prompt_kernel:
    s_cmp_ge_u32 s2, 256
    s_cbranch_scc1 L_end
    s_load_dwordx16 s[4:19], s[0:1], 0
    s_load_dwordx4 s[20:23], s[0:1], 64
    s_load_dwordx2 s[24:25], s[0:1], 80
    s_getpc_b64 s[26:27]
L_pc_1:
    s_lshr_b32 s3, s2, 3
    v_and_b32 v126, 31, v0
    v_lshl_add_u32 v126, v126, 5, s3
    v_cmp_gt_u32 vcc, 128, v0
    s_sub_u32 s26, s26, L_pc_1-sequential_preLN__sliding_block__mixer_s_mlp__prompt_kernel
    s_subb_u32 s27, s27, 0
    v_cndmask_b32 v126, v126, v0, vcc
    v_lshlrev_b32 v126, 7, v126
    v_min_u32 v126, L_end-sequential_preLN__sliding_block__mixer_s_mlp__prompt_kernel, v126
    global_load_dword v127, v126, s[26:27]
    v_and_b32 v1, 63, v0
    v_lshrrev_b32 v2, 6, v0
    s_and_b32 s44, s2, 7
    v_readfirstlane_b32 s46, v2
    s_lshr_b32 s45, s2, 3
    s_mov_b32 s47, 0x3f803f80
    s_and_b32 s53, s45, 3
    s_lshr_b32 s54, s45, 2
    s_and_b32 s48, s44, 3
    s_lshl_b32 s48, s48, 2
    s_add_u32 s48, s48, s53
    s_lshr_b32 s49, s44, 2
    s_mul_i32 s49, s49, 7
    s_add_u32 s49, s49, s54
    s_lshl_b32 s54, s54, 2
    s_mul_i32 s53, s53, 7
    s_add_u32 s50, s53, s54
    s_add_u32 s50, s50, s44
    s_mul_i32 s53, s50, 57
    s_lshr_b32 s53, s53, 9
    s_mul_i32 s53, s53, 9
    s_sub_u32 s50, s50, s53
    s_lshl_b32 s51, s48, 2
    s_add_u32 s51, s51, s46
    s_mul_i32 s51, s51, 36864
    s_mul_i32 s52, s46, 55296
    s_lshl_b32 s53, s49, 8
    s_add_u32 s52, s52, s53
    s_lshl_b32 s55, s46, 12
    v_lshrrev_b32 v115, 3, v1
    v_mul_u32_u24 v115, 1152, v115
    v_lshrrev_b32 v116, 4, v1
    v_and_b32 v117, 7, v1
    v_xor_b32 v117, v117, v116
    v_lshl_add_u32 v96, v117, 4, v115
    v_xor_b32 v117, 4, v117
    v_lshl_add_u32 v97, v117, 4, v115
    v_add_u32 v98, 16384, v96
    v_add_u32 v99, 24576, v97
    v_add_u32 v97, 8192, v97
    v_bfe_u32 v117, v1, 2, 2
    v_xor_b32 v117, v117, v116
    v_mul_u32_u24 v116, 3456, v116
    v_lshl_add_u32 v116, v117, 6, v116
    v_and_b32 v117, 3, v1
    v_lshl_add_u32 v100, v117, 4, v116
    v_add_u32 v101, 12800, v100
    v_add_u32 v102, 25600, v100
    v_add_u32 v103, 38400, v100
    s_waitcnt lgkmcnt(0)
    s_mov_b32 s36, s4
    s_mov_b32 s37, s5
    s_mov_b32 s38, 0x240000
    s_mov_b32 s39, 0x20000
    s_mov_b32 s32, s6
    s_mov_b32 s33, s7
    s_mov_b32 s34, 0x1e6000
    s_mov_b32 s35, 0x20000
    s_cmp_ge_u32 s45, 28
    s_cbranch_scc1 L_idle
    s_lshl_b32 s53, s50, 7
    s_add_u32 s53, s53, s51
    s_add_u32 m0, s55, 0
    s_mul_i32 s54, s50, 221184
    buffer_load_dwordx4 v96, s[36:39], s53 offen offset:0 lds
    buffer_load_dwordx4 v97, s[36:39], s53 offen offset:1024 lds
    buffer_load_dwordx4 v98, s[36:39], s53 offen offset:2048 lds
    buffer_load_dwordx4 v99, s[36:39], s53 offen offset:3072 lds
    s_add_u32 m0, s55, 16384
    s_add_u32 s54, s54, s52
    buffer_load_dwordx4 v100, s[32:35], s54 offen offset:0 lds
    buffer_load_dwordx4 v101, s[32:35], s54 offen offset:1024 lds
    buffer_load_dwordx4 v102, s[32:35], s54 offen offset:2048 lds
    buffer_load_dwordx4 v103, s[32:35], s54 offen offset:3072 lds
    s_add_u32 s50, s50, 1
    s_cmp_eq_u32 s50, 9
    s_cselect_b32 s50, 0, s50
    s_and_b32 s57, s45, 3
    s_lshl_b32 s53, s44, 2
    s_add_u32 s57, s57, s53
    s_lshr_b32 s58, s45, 2
    s_lshl_b32 s59, s58, 2
    s_add_u32 s59, s59, s46
    s_mul_i32 s60, s59, 18
    s_lshr_b32 s60, s60, 3
    s_and_b32 s61, s59, 3
    v_lshlrev_b32 v2, 4, v1
    s_lshr_b32 s65, s45, 2
    s_lshl_b32 s53, s44, 3
    s_add_u32 s65, s65, s53
    s_and_b32 s66, s45, 3
    s_lshl_b32 s67, s66, 2
    s_add_u32 s67, s67, s46
    s_mul_i32 s67, s67, 46080
    s_add_u32 s67, s67, 0x1700000
    s_mov_b32 s28, s24
    s_mov_b32 s29, s25
    s_mov_b32 s30, 0x8000000
    s_mov_b32 s31, 0x20000
    s_mov_b32 s40, s22
    s_mov_b32 s41, s23
    s_mov_b32 s42, 0x100
    s_mov_b32 s43, 0x20000
    s_lshl_b32 s53, s50, 7
    s_add_u32 s53, s53, s51
    s_add_u32 m0, s55, 32768
    s_mul_i32 s54, s50, 221184
    buffer_load_dwordx4 v96, s[36:39], s53 offen offset:0 lds
    buffer_load_dwordx4 v97, s[36:39], s53 offen offset:1024 lds
    buffer_load_dwordx4 v98, s[36:39], s53 offen offset:2048 lds
    buffer_load_dwordx4 v99, s[36:39], s53 offen offset:3072 lds
    s_add_u32 m0, s55, 49152
    s_add_u32 s54, s54, s52
    buffer_load_dwordx4 v100, s[32:35], s54 offen offset:0 lds
    buffer_load_dwordx4 v101, s[32:35], s54 offen offset:1024 lds
    buffer_load_dwordx4 v102, s[32:35], s54 offen offset:2048 lds
    buffer_load_dwordx4 v103, s[32:35], s54 offen offset:3072 lds
    s_add_u32 s50, s50, 1
    s_cmp_eq_u32 s50, 9
    s_cselect_b32 s50, 0, s50
    s_branch L_act
L_idle:
    s_and_b32 s57, s45, 3
    s_lshl_b32 s53, s44, 2
    s_add_u32 s57, s57, s53
    s_lshr_b32 s58, s45, 2
    s_lshl_b32 s59, s58, 2
    s_add_u32 s59, s59, s46
    s_mul_i32 s60, s59, 18
    s_lshr_b32 s60, s60, 3
    s_and_b32 s61, s59, 3
    v_lshlrev_b32 v2, 4, v1
    s_lshr_b32 s65, s45, 2
    s_lshl_b32 s53, s44, 3
    s_add_u32 s65, s65, s53
    s_and_b32 s66, s45, 3
    s_lshl_b32 s67, s66, 2
    s_add_u32 s67, s67, s46
    s_mul_i32 s67, s67, 46080
    s_add_u32 s67, s67, 0x1700000
    s_mov_b32 s28, s24
    s_mov_b32 s29, s25
    s_mov_b32 s30, 0x8000000
    s_mov_b32 s31, 0x20000
    s_mov_b32 s40, s22
    s_mov_b32 s41, s23
    s_mov_b32 s42, 0x100
    s_mov_b32 s43, 0x20000
    s_sub_u32 s48, s45, 28
    s_lshl_b32 s48, s48, 3
    s_add_u32 s48, s48, s44
    s_cmp_ge_u32 s48, 27
    s_cbranch_scc1 L_common
    s_mul_i32 s49, s48, 57
    s_lshr_b32 s49, s49, 9
    s_mul_i32 s51, s49, 9
    s_sub_u32 s51, s48, s51
    s_cmp_eq_u32 s49, 1
    s_cselect_b32 s32, s12, s14
    s_cselect_b32 s33, s13, s15
    s_cmp_eq_u32 s49, 0
    s_cselect_b32 s32, s8, s32
    s_cselect_b32 s33, s9, s33
    s_mov_b32 s34, 663552
    s_mov_b32 s35, 0x20000
    s_cselect_b32 s53, 18, 16
    s_lshl_b32 s54, s51, 2
    s_add_u32 s54, s54, s46
    s_mul_i32 s52, s54, s53
    s_mul_i32 s53, s46, 144
    s_add_u32 s53, s53, 16
    s_cmp_eq_u32 s48, 8
    s_cselect_b32 s52, s53, s52
    s_cselect_b32 s55, 18432, 0
    s_mul_i32 s52, s52, 1152
    s_mul_i32 s56, s46, 18432
    v_lshlrev_b32 v234, 4, v1
    v_add_u32 v232, 0, v1
    v_mul_u32_u24 v232, 3641, v232
    v_lshrrev_b32 v232, 19, v232
    s_add_u32 m0, s56, 0
    v_mul_u32_u24 v232, s55, v232
    v_add3_u32 v232, v232, v234, s52
    buffer_load_dwordx4 v232, s[32:35], 0 offen lds
    s_add_u32 s52, s52, 1024
    v_add_u32 v232, 64, v1
    v_mul_u32_u24 v232, 3641, v232
    v_lshrrev_b32 v232, 19, v232
    s_add_u32 m0, s56, 1024
    v_mul_u32_u24 v232, s55, v232
    v_add3_u32 v232, v232, v234, s52
    buffer_load_dwordx4 v232, s[32:35], 0 offen lds
    s_add_u32 s52, s52, 1024
    v_add_u32 v232, 128, v1
    v_mul_u32_u24 v232, 3641, v232
    v_lshrrev_b32 v232, 19, v232
    s_add_u32 m0, s56, 2048
    v_mul_u32_u24 v232, s55, v232
    v_add3_u32 v232, v232, v234, s52
    buffer_load_dwordx4 v232, s[32:35], 0 offen lds
    s_add_u32 s52, s52, 1024
    v_add_u32 v232, 192, v1
    v_mul_u32_u24 v232, 3641, v232
    v_lshrrev_b32 v232, 19, v232
    s_add_u32 m0, s56, 3072
    v_mul_u32_u24 v232, s55, v232
    v_add3_u32 v232, v232, v234, s52
    buffer_load_dwordx4 v232, s[32:35], 0 offen lds
    s_add_u32 s52, s52, 1024
    v_add_u32 v232, 256, v1
    v_mul_u32_u24 v232, 3641, v232
    v_lshrrev_b32 v232, 19, v232
    s_add_u32 m0, s56, 4096
    v_mul_u32_u24 v232, s55, v232
    v_add3_u32 v232, v232, v234, s52
    buffer_load_dwordx4 v232, s[32:35], 0 offen lds
    s_add_u32 s52, s52, 1024
    v_add_u32 v232, 320, v1
    v_mul_u32_u24 v232, 3641, v232
    v_lshrrev_b32 v232, 19, v232
    s_add_u32 m0, s56, 5120
    v_mul_u32_u24 v232, s55, v232
    v_add3_u32 v232, v232, v234, s52
    buffer_load_dwordx4 v232, s[32:35], 0 offen lds
    s_add_u32 s52, s52, 1024
    v_add_u32 v232, 384, v1
    v_mul_u32_u24 v232, 3641, v232
    v_lshrrev_b32 v232, 19, v232
    s_add_u32 m0, s56, 6144
    v_mul_u32_u24 v232, s55, v232
    v_add3_u32 v232, v232, v234, s52
    buffer_load_dwordx4 v232, s[32:35], 0 offen lds
    s_add_u32 s52, s52, 1024
    v_add_u32 v232, 448, v1
    v_mul_u32_u24 v232, 3641, v232
    v_lshrrev_b32 v232, 19, v232
    s_add_u32 m0, s56, 7168
    v_mul_u32_u24 v232, s55, v232
    v_add3_u32 v232, v232, v234, s52
    buffer_load_dwordx4 v232, s[32:35], 0 offen lds
    s_add_u32 s52, s52, 1024
    v_add_u32 v232, 512, v1
    v_mul_u32_u24 v232, 3641, v232
    v_lshrrev_b32 v232, 19, v232
    s_add_u32 m0, s56, 8192
    v_mul_u32_u24 v232, s55, v232
    v_add3_u32 v232, v232, v234, s52
    buffer_load_dwordx4 v232, s[32:35], 0 offen lds
    s_add_u32 s52, s52, 1024
    v_add_u32 v232, 576, v1
    v_mul_u32_u24 v232, 3641, v232
    v_lshrrev_b32 v232, 19, v232
    s_add_u32 m0, s56, 9216
    v_mul_u32_u24 v232, s55, v232
    v_add3_u32 v232, v232, v234, s52
    buffer_load_dwordx4 v232, s[32:35], 0 offen lds
    s_add_u32 s52, s52, 1024
    v_add_u32 v232, 640, v1
    v_mul_u32_u24 v232, 3641, v232
    v_lshrrev_b32 v232, 19, v232
    s_add_u32 m0, s56, 10240
    v_mul_u32_u24 v232, s55, v232
    v_add3_u32 v232, v232, v234, s52
    buffer_load_dwordx4 v232, s[32:35], 0 offen lds
    s_add_u32 s52, s52, 1024
    v_add_u32 v232, 704, v1
    v_mul_u32_u24 v232, 3641, v232
    v_lshrrev_b32 v232, 19, v232
    s_add_u32 m0, s56, 11264
    v_mul_u32_u24 v232, s55, v232
    v_add3_u32 v232, v232, v234, s52
    buffer_load_dwordx4 v232, s[32:35], 0 offen lds
    s_add_u32 s52, s52, 1024
    v_add_u32 v232, 768, v1
    v_mul_u32_u24 v232, 3641, v232
    v_lshrrev_b32 v232, 19, v232
    s_add_u32 m0, s56, 12288
    v_mul_u32_u24 v232, s55, v232
    v_add3_u32 v232, v232, v234, s52
    buffer_load_dwordx4 v232, s[32:35], 0 offen lds
    s_add_u32 s52, s52, 1024
    v_add_u32 v232, 832, v1
    v_mul_u32_u24 v232, 3641, v232
    v_lshrrev_b32 v232, 19, v232
    s_add_u32 m0, s56, 13312
    v_mul_u32_u24 v232, s55, v232
    v_add3_u32 v232, v232, v234, s52
    buffer_load_dwordx4 v232, s[32:35], 0 offen lds
    s_add_u32 s52, s52, 1024
    v_add_u32 v232, 896, v1
    v_mul_u32_u24 v232, 3641, v232
    v_lshrrev_b32 v232, 19, v232
    s_add_u32 m0, s56, 14336
    v_mul_u32_u24 v232, s55, v232
    v_add3_u32 v232, v232, v234, s52
    buffer_load_dwordx4 v232, s[32:35], 0 offen lds
    s_add_u32 s52, s52, 1024
    v_add_u32 v232, 960, v1
    v_mul_u32_u24 v232, 3641, v232
    v_lshrrev_b32 v232, 19, v232
    s_add_u32 m0, s56, 15360
    v_mul_u32_u24 v232, s55, v232
    v_add3_u32 v232, v232, v234, s52
    buffer_load_dwordx4 v232, s[32:35], 0 offen lds
    s_add_u32 s52, s52, 1024
    v_add_u32 v232, 1024, v1
    v_mul_u32_u24 v232, 3641, v232
    v_lshrrev_b32 v232, 19, v232
    s_add_u32 m0, s56, 16384
    v_mul_u32_u24 v232, s55, v232
    v_add3_u32 v232, v232, v234, s52
    buffer_load_dwordx4 v232, s[32:35], 0 offen lds
    s_add_u32 s52, s52, 1024
    v_add_u32 v232, 1088, v1
    v_mul_u32_u24 v232, 3641, v232
    v_lshrrev_b32 v232, 19, v232
    s_add_u32 m0, s56, 17408
    v_mul_u32_u24 v232, s55, v232
    v_add3_u32 v232, v232, v234, s52
    buffer_load_dwordx4 v232, s[32:35], 0 offen lds
    s_add_u32 s52, s52, 1024
L_common:
    s_cmp_ge_u32 s48, 27
    s_cbranch_scc1 L_free_2
    s_mul_i32 s56, s48, 8
    s_mov_b32 s32, s16
    s_mov_b32 s33, s17
    s_mov_b32 s34, 0x510000
    s_mov_b32 s35, 0x20000
    v_bfe_u32 v96, v0, 2, 3
    v_mul_u32_u24 v96, 9, v96
    v_and_b32 v97, 3, v0
    v_lshlrev_b32 v97, 2, v97
    s_mov_b32 s53, 0x1540
    v_lshrrev_b32 v97, v97, s53
    v_and_b32 v97, 15, v97
    v_add_u32 v96, v96, v97
    v_lshlrev_b32 v96, 7, v96
    v_lshrrev_b32 v97, 5, v0
    v_mul_u32_u24 v97, 9216, v97
    v_add_u32 v96, v96, v97
    v_and_b32 v97, 3, v0
    v_cmp_eq_u32 vcc, 3, v97
    s_mul_i32 s53, s56, 9216
    v_bfe_u32 v119, v0, 5, 1
    v_mul_u32_u24 v119, 640, v119
    v_lshrrev_b32 v120, 5, v0
    v_add_u32 v121, s56, v120
    v_add_u32 v121, 1, v121
    v_lshrrev_b32 v121, 1, v121
    v_mul_u32_u24 v121, 9216, v121
    v_sub_u32 v121, v119, v121
    v_cndmask_b32 v121, 0, v121, vcc
    v_add3_u32 v121, v121, v96, s53
    buffer_load_dword v248, v121, s[32:35], 0 offen
    s_add_u32 s53, s53, 73728
    s_branch L_warmed
L_free_2:
    s_sub_u32 s56, s48, 27
    s_mul_i32 s56, s56, 16
    s_add_u32 s56, s56, 216
    s_mov_b32 s32, s16
    s_mov_b32 s33, s17
    s_mov_b32 s34, 0x510000
    s_mov_b32 s35, 0x20000
    v_bfe_u32 v96, v0, 2, 3
    v_mul_u32_u24 v96, 9, v96
    v_and_b32 v97, 3, v0
    v_lshlrev_b32 v97, 2, v97
    s_mov_b32 s53, 0x1540
    v_lshrrev_b32 v97, v97, s53
    v_and_b32 v97, 15, v97
    v_add_u32 v96, v96, v97
    v_lshlrev_b32 v96, 7, v96
    v_lshrrev_b32 v97, 5, v0
    v_mul_u32_u24 v97, 9216, v97
    v_add_u32 v96, v96, v97
    v_and_b32 v97, 3, v0
    v_cmp_eq_u32 vcc, 3, v97
    s_mul_i32 s53, s56, 9216
    v_bfe_u32 v119, v0, 5, 1
    v_mul_u32_u24 v119, 640, v119
    v_lshrrev_b32 v120, 5, v0
    v_add_u32 v121, s56, v120
    v_add_u32 v121, 1, v121
    v_lshrrev_b32 v121, 1, v121
    v_mul_u32_u24 v121, 9216, v121
    v_sub_u32 v121, v119, v121
    v_cndmask_b32 v121, 0, v121, vcc
    v_add3_u32 v121, v121, v96, s53
    s_waitcnt vmcnt(0)
    buffer_load_dword v248, v121, s[32:35], 0 offen
    s_add_u32 s53, s53, 73728
    v_add_u32 v121, s56, v120
    v_add_u32 v121, 9, v121
    v_lshrrev_b32 v121, 1, v121
    v_mul_u32_u24 v121, 9216, v121
    v_sub_u32 v121, v119, v121
    v_cndmask_b32 v121, 0, v121, vcc
    v_add3_u32 v121, v121, v96, s53
    buffer_load_dword v249, v121, s[32:35], 0 offen
    s_add_u32 s53, s53, 73728
L_warmed:
    v_and_b32 v6, 0x13, v1
    v_bfe_u32 v7, v1, 2, 1
    v_lshl_add_u32 v6, v7, 3, v6
    v_bfe_u32 v7, v1, 3, 1
    v_lshl_add_u32 v6, v7, 2, v6
    v_lshrrev_b32 v7, 5, v1
    v_lshlrev_b32 v8, 4, v7
    v_lshl_add_u32 v3, v6, 5, v8
    v_add_u32 v4, 18432, v3
    v_and_b32 v6, 31, v1
    v_lshlrev_b32 v7, 2, v7
    v_sub_u32 v6, v6, v7
    v_mov_b32 v8, 0xff800000
    v_mov_b32 v9, 0
    v_cmp_le_i32 vcc, 0, v6
    s_nop 1
    v_cndmask_b32 v32, v8, v9, vcc
    v_cndmask_b32 v48, v9, v8, vcc
    v_cmp_le_i32 vcc, 1, v6
    s_nop 1
    v_cndmask_b32 v33, v8, v9, vcc
    v_cndmask_b32 v49, v9, v8, vcc
    v_cmp_le_i32 vcc, 2, v6
    s_nop 1
    v_cndmask_b32 v34, v8, v9, vcc
    v_cndmask_b32 v50, v9, v8, vcc
    v_cmp_le_i32 vcc, 3, v6
    s_nop 1
    v_cndmask_b32 v35, v8, v9, vcc
    v_cndmask_b32 v51, v9, v8, vcc
    v_cmp_le_i32 vcc, 8, v6
    s_nop 1
    v_cndmask_b32 v36, v8, v9, vcc
    v_cndmask_b32 v52, v9, v8, vcc
    v_cmp_le_i32 vcc, 9, v6
    s_nop 1
    v_cndmask_b32 v37, v8, v9, vcc
    v_cndmask_b32 v53, v9, v8, vcc
    v_cmp_le_i32 vcc, 10, v6
    s_nop 1
    v_cndmask_b32 v38, v8, v9, vcc
    v_cndmask_b32 v54, v9, v8, vcc
    v_cmp_le_i32 vcc, 11, v6
    s_nop 1
    v_cndmask_b32 v39, v8, v9, vcc
    v_cndmask_b32 v55, v9, v8, vcc
    v_cmp_le_i32 vcc, 16, v6
    s_nop 1
    v_cndmask_b32 v40, v8, v9, vcc
    v_cndmask_b32 v56, v9, v8, vcc
    v_cmp_le_i32 vcc, 17, v6
    s_nop 1
    v_cndmask_b32 v41, v8, v9, vcc
    v_cndmask_b32 v57, v9, v8, vcc
    v_cmp_le_i32 vcc, 18, v6
    s_nop 1
    v_cndmask_b32 v42, v8, v9, vcc
    v_cndmask_b32 v58, v9, v8, vcc
    v_cmp_le_i32 vcc, 19, v6
    s_nop 1
    v_cndmask_b32 v43, v8, v9, vcc
    v_cndmask_b32 v59, v9, v8, vcc
    v_cmp_le_i32 vcc, 24, v6
    s_nop 1
    v_cndmask_b32 v44, v8, v9, vcc
    v_cndmask_b32 v60, v9, v8, vcc
    v_cmp_le_i32 vcc, 25, v6
    s_nop 1
    v_cndmask_b32 v45, v8, v9, vcc
    v_cndmask_b32 v61, v9, v8, vcc
    v_cmp_le_i32 vcc, 26, v6
    s_nop 1
    v_cndmask_b32 v46, v8, v9, vcc
    v_cndmask_b32 v62, v9, v8, vcc
    v_cmp_le_i32 vcc, 27, v6
    s_nop 1
    v_cndmask_b32 v47, v8, v9, vcc
    v_cndmask_b32 v63, v9, v8, vcc
    v_and_b32 v6, 27, v1
    v_cmp_eq_u32 vcc, 18, v6
    v_mov_b32 v7, s47
    s_nop 0
    v_cndmask_b32 v6, 0, v7, vcc
    s_mov_b32 exec_lo, 0xfffc0000
    s_mov_b32 exec_hi, 0xfffc0000
    v_accvgpr_write_b32 a80, v6
    v_accvgpr_write_b32 a81, v6
    v_accvgpr_write_b32 a82, v6
    v_accvgpr_write_b32 a83, v6
    v_accvgpr_write_b32 a84, v6
    v_accvgpr_write_b32 a85, v6
    v_accvgpr_write_b32 a86, v6
    v_accvgpr_write_b32 a87, v6
    v_accvgpr_write_b32 a88, v6
    v_accvgpr_write_b32 a89, v6
    v_accvgpr_write_b32 a90, v6
    v_accvgpr_write_b32 a91, v6
    v_accvgpr_write_b32 a92, v6
    v_accvgpr_write_b32 a93, v6
    v_accvgpr_write_b32 a94, v6
    v_accvgpr_write_b32 a95, v6
    v_accvgpr_write_b32 a96, v6
    v_accvgpr_write_b32 a97, v6
    v_accvgpr_write_b32 a98, v6
    v_accvgpr_write_b32 a99, v6
    v_accvgpr_write_b32 a100, v6
    v_accvgpr_write_b32 a101, v6
    v_accvgpr_write_b32 a102, v6
    v_accvgpr_write_b32 a103, v6
    v_accvgpr_write_b32 a104, v6
    v_accvgpr_write_b32 a105, v6
    v_accvgpr_write_b32 a106, v6
    v_accvgpr_write_b32 a107, v6
    v_accvgpr_write_b32 a108, v6
    v_accvgpr_write_b32 a109, v6
    v_accvgpr_write_b32 a110, v6
    v_accvgpr_write_b32 a111, v6
    v_accvgpr_write_b32 a112, v6
    v_accvgpr_write_b32 a113, v6
    v_accvgpr_write_b32 a114, v6
    v_accvgpr_write_b32 a115, v6
    v_accvgpr_write_b32 a116, v6
    v_accvgpr_write_b32 a117, v6
    v_accvgpr_write_b32 a118, v6
    v_accvgpr_write_b32 a119, v6
    v_accvgpr_write_b32 a120, v6
    v_accvgpr_write_b32 a121, v6
    v_accvgpr_write_b32 a122, v6
    v_accvgpr_write_b32 a123, v6
    v_accvgpr_write_b32 a124, v6
    v_accvgpr_write_b32 a125, v6
    v_accvgpr_write_b32 a126, v6
    v_accvgpr_write_b32 a127, v6
    v_accvgpr_write_b32 a128, v6
    v_accvgpr_write_b32 a129, v6
    v_accvgpr_write_b32 a130, v6
    v_accvgpr_write_b32 a131, v6
    v_accvgpr_write_b32 a132, v6
    v_accvgpr_write_b32 a133, v6
    v_accvgpr_write_b32 a134, v6
    v_accvgpr_write_b32 a135, v6
    v_accvgpr_write_b32 a136, v6
    v_accvgpr_write_b32 a137, v6
    v_accvgpr_write_b32 a138, v6
    v_accvgpr_write_b32 a139, v6
    v_accvgpr_write_b32 a140, v6
    v_accvgpr_write_b32 a141, v6
    v_accvgpr_write_b32 a142, v6
    v_accvgpr_write_b32 a143, v6
    v_accvgpr_write_b32 a144, v6
    v_accvgpr_write_b32 a145, v6
    v_accvgpr_write_b32 a146, v6
    v_accvgpr_write_b32 a147, v6
    v_accvgpr_write_b32 a148, v6
    v_accvgpr_write_b32 a149, v6
    v_accvgpr_write_b32 a150, v6
    v_accvgpr_write_b32 a151, v6
    v_accvgpr_write_b32 a152, v6
    v_accvgpr_write_b32 a153, v6
    v_accvgpr_write_b32 a154, v6
    v_accvgpr_write_b32 a155, v6
    v_accvgpr_write_b32 a156, v6
    v_accvgpr_write_b32 a157, v6
    v_accvgpr_write_b32 a158, v6
    v_accvgpr_write_b32 a159, v6
    s_mov_b64 exec, -1
    s_mov_b32 exec_lo, 0
    s_lshl_b32 s53, s57, 1
    s_cmp_ge_u32 s53, 8
    s_cselect_b32 s54, 0x3f800000, 0x3f80ff80
    v_accvgpr_write_b32 a4, s54
    v_accvgpr_write_b32 a5, s47
    v_accvgpr_write_b32 a6, 0
    v_accvgpr_write_b32 a7, 0
    s_cmp_ge_u32 s53, 7
    s_cselect_b32 s54, 0x3f800000, 0x3f80ff80
    v_accvgpr_write_b32 a12, s54
    v_accvgpr_write_b32 a13, s47
    v_accvgpr_write_b32 a14, 0
    v_accvgpr_write_b32 a15, 0
    s_cmp_ge_u32 s53, 6
    s_cselect_b32 s54, 0x3f800000, 0x3f80ff80
    v_accvgpr_write_b32 a20, s54
    v_accvgpr_write_b32 a21, s47
    v_accvgpr_write_b32 a22, 0
    v_accvgpr_write_b32 a23, 0
    s_cmp_ge_u32 s53, 5
    s_cselect_b32 s54, 0x3f800000, 0x3f80ff80
    v_accvgpr_write_b32 a28, s54
    v_accvgpr_write_b32 a29, s47
    v_accvgpr_write_b32 a30, 0
    v_accvgpr_write_b32 a31, 0
    s_cmp_ge_u32 s53, 4
    s_cselect_b32 s54, 0x3f800000, 0x3f80ff80
    v_accvgpr_write_b32 a36, s54
    v_accvgpr_write_b32 a37, s47
    v_accvgpr_write_b32 a38, 0
    v_accvgpr_write_b32 a39, 0
    s_cmp_ge_u32 s53, 3
    s_cselect_b32 s54, 0x3f800000, 0x3f80ff80
    v_accvgpr_write_b32 a44, s54
    v_accvgpr_write_b32 a45, s47
    v_accvgpr_write_b32 a46, 0
    v_accvgpr_write_b32 a47, 0
    s_cmp_ge_u32 s53, 2
    s_cselect_b32 s54, 0x3f800000, 0x3f80ff80
    v_accvgpr_write_b32 a52, s54
    v_accvgpr_write_b32 a53, s47
    v_accvgpr_write_b32 a54, 0
    v_accvgpr_write_b32 a55, 0
    s_cmp_ge_u32 s53, 1
    s_cselect_b32 s54, 0x3f800000, 0x3f80ff80
    v_accvgpr_write_b32 a60, s54
    v_accvgpr_write_b32 a61, s47
    v_accvgpr_write_b32 a62, 0
    v_accvgpr_write_b32 a63, 0
    s_cmp_ge_u32 s53, 0
    s_cselect_b32 s54, 0x3f800000, 0x3f80ff80
    v_accvgpr_write_b32 a68, s54
    v_accvgpr_write_b32 a69, s47
    v_accvgpr_write_b32 a70, 0
    v_accvgpr_write_b32 a71, 0
    s_cmp_ge_u32 s53, 0
    s_cselect_b32 s54, 0x3f800000, 0x3f80ff80
    v_accvgpr_write_b32 a76, s54
    v_accvgpr_write_b32 a77, s47
    v_accvgpr_write_b32 a78, 0
    v_accvgpr_write_b32 a79, 0
    v_mov_b32 v20, 0x3f80
    v_mov_b32 v21, 0
    v_mov_b32 v22, 0
    v_mov_b32 v23, 0
    v_mov_b32 v28, 0x3f80
    v_mov_b32 v29, 0
    v_mov_b32 v30, 0
    v_mov_b32 v31, 0
    s_mov_b64 exec, -1
    v_mul_u32_u24 v6, 43, v1
    v_lshrrev_b32 v6, 8, v6
    v_mul_u32_u24 v7, 6, v6
    v_sub_u32 v7, v1, v7
    s_lshr_b32 s53, s57, 1
    v_sub_u32 v6, s53, v6
    v_max_i32 v6, 0, v6
    v_lshrrev_b32 v8, 1, v7
    v_mul_u32_u24 v8, 576, v8
    v_and_b32 v7, 1, v7
    v_mul_u32_u24 v7, 71, v7
    s_mul_i32 s53, s58, 72
    v_add3_u32 v7, v7, v8, s53
    v_lshrrev_b32 v7, 7, v7
    v_lshlrev_b32 v7, 3, v7
    v_mul_u32_u24 v6, 1152, v6
    s_mov_b32 s53, 0x1a00000
    v_add3_u32 v5, v6, v7, s53
    s_branch L_idle2
L_act:
    s_cmp_ge_u32 s49, 9
    s_cbranch_scc1 L_p1v
    v_and_b32 v115, 31, v1
    v_lshlrev_b32 v115, 7, v115
    v_add_u32 v115, s55, v115
    v_bfe_u32 v116, v1, 1, 3
    v_lshrrev_b32 v117, 5, v1
    v_xor_b32 v116, v116, v117
    v_xor_b32 v118, 0, v116
    v_lshl_add_u32 v104, v118, 4, v115
    v_xor_b32 v118, 2, v116
    v_lshl_add_u32 v105, v118, 4, v115
    v_xor_b32 v118, 4, v116
    v_lshl_add_u32 v106, v118, 4, v115
    v_xor_b32 v118, 6, v116
    v_lshl_add_u32 v107, v118, 4, v115
    v_bfe_u32 v115, v1, 2, 2
    v_lshl_add_u32 v116, v117, 3, v115
    v_lshlrev_b32 v116, 8, v116
    v_bfe_u32 v118, v1, 4, 1
    v_lshl_add_u32 v116, v118, 5, v116
    v_and_b32 v118, 1, v1
    v_lshl_add_u32 v116, v118, 4, v116
    v_bfe_u32 v118, v1, 1, 1
    v_lshl_add_u32 v116, v118, 3, v116
    s_add_u32 s53, s46, 0
    s_and_b32 s53, s53, 3
    v_xor_b32 v118, s53, v115
    v_lshl_add_u32 v108, v118, 6, v116
    s_add_u32 s53, s46, 1
    s_and_b32 s53, s53, 3
    v_xor_b32 v118, s53, v115
    v_lshl_add_u32 v109, v118, 6, v116
    s_add_u32 s53, s46, 2
    s_and_b32 s53, s53, 3
    v_xor_b32 v118, s53, v115
    v_lshl_add_u32 v110, v118, 6, v116
    s_add_u32 s53, s46, 3
    s_and_b32 s53, s53, 3
    v_xor_b32 v118, s53, v115
    v_lshl_add_u32 v111, v118, 6, v116
    v_mov_b32 v112, 0
    v_mov_b32 v113, 0
    v_mov_b32 v114, 0
    s_waitcnt vmcnt(8)
    s_barrier
    ds_read_b128 v[152:155], v104 offset:0
    ds_read_b64_tr_b16 v[240:241], v108 offset:16384
    ds_read_b64_tr_b16 v[242:243], v108 offset:17408
    ds_read_b64_tr_b16 a[232:233], v109 offset:16384
    ds_read_b64_tr_b16 a[234:235], v109 offset:17408
    ds_read_b64_tr_b16 a[236:237], v110 offset:16384
    ds_read_b64_tr_b16 a[238:239], v110 offset:17408
    ds_read_b64_tr_b16 a[240:241], v111 offset:16384
    ds_read_b64_tr_b16 a[242:243], v111 offset:17408
    s_waitcnt lgkmcnt(4)
    v_mfma_f32_32x32x16_bf16 v[176:191], v[240:243], v[152:155], 0
    ds_read_b128 v[156:159], v105 offset:0
    ds_read_b64_tr_b16 v[244:245], v108 offset:20480
    ds_read_b64_tr_b16 v[246:247], v108 offset:21504
    s_lshl_b32 s53, s50, 7
    s_add_u32 s53, s53, s51
    s_add_u32 m0, s55, 65536
    s_mul_i32 s54, s50, 221184
    buffer_load_dwordx4 v96, s[36:39], s53 offen offset:0 lds
    buffer_load_dwordx4 v97, s[36:39], s53 offen offset:1024 lds
    v_mfma_f32_32x32x16_bf16 v[192:207], a[232:235], v[152:155], 0
    ds_read_b64_tr_b16 a[244:245], v109 offset:20480
    ds_read_b64_tr_b16 a[246:247], v109 offset:21504
    buffer_load_dwordx4 v98, s[36:39], s53 offen offset:2048 lds
    buffer_load_dwordx4 v99, s[36:39], s53 offen offset:3072 lds
    s_add_u32 m0, s55, 81920
    s_waitcnt lgkmcnt(5)
    v_mfma_f32_32x32x16_bf16 v[208:223], a[236:239], v[152:155], 0
    ds_read_b64_tr_b16 a[248:249], v110 offset:20480
    ds_read_b64_tr_b16 a[250:251], v110 offset:21504
    s_add_u32 s54, s54, s52
    buffer_load_dwordx4 v100, s[32:35], s54 offen offset:0 lds
    buffer_load_dwordx4 v101, s[32:35], s54 offen offset:1024 lds
    v_mfma_f32_32x32x16_bf16 v[224:239], a[240:243], v[152:155], 0
    ds_read_b64_tr_b16 a[252:253], v111 offset:20480
    ds_read_b64_tr_b16 a[254:255], v111 offset:21504
    buffer_load_dwordx4 v102, s[32:35], s54 offen offset:2048 lds
    buffer_load_dwordx4 v103, s[32:35], s54 offen offset:3072 lds
    s_add_u32 s50, s50, 1
    s_cmp_eq_u32 s50, 9
    s_cselect_b32 s50, 0, s50
    s_waitcnt lgkmcnt(4)
    v_mfma_f32_32x32x16_bf16 v[176:191], v[244:247], v[156:159], v[176:191]
    ds_read_b128 v[160:163], v106 offset:0
    ds_read_b64_tr_b16 v[248:249], v108 offset:24576
    ds_read_b64_tr_b16 v[250:251], v108 offset:25600
    s_lshl_b32 s53, s50, 7
    s_add_u32 s53, s53, s51
    s_add_u32 m0, s55, 98304
    s_mul_i32 s54, s50, 221184
    buffer_load_dwordx4 v96, s[36:39], s53 offen offset:0 lds
    buffer_load_dwordx4 v97, s[36:39], s53 offen offset:1024 lds
    v_mfma_f32_32x32x16_bf16 v[192:207], a[244:247], v[156:159], v[192:207]
    ds_read_b64_tr_b16 a[232:233], v109 offset:24576
    ds_read_b64_tr_b16 a[234:235], v109 offset:25600
    buffer_load_dwordx4 v98, s[36:39], s53 offen offset:2048 lds
    buffer_load_dwordx4 v99, s[36:39], s53 offen offset:3072 lds
    s_add_u32 m0, s55, 114688
    s_waitcnt lgkmcnt(5)
    v_mfma_f32_32x32x16_bf16 v[208:223], a[248:251], v[156:159], v[208:223]
    ds_read_b64_tr_b16 a[236:237], v110 offset:24576
    ds_read_b64_tr_b16 a[238:239], v110 offset:25600
    s_add_u32 s54, s54, s52
    buffer_load_dwordx4 v100, s[32:35], s54 offen offset:0 lds
    buffer_load_dwordx4 v101, s[32:35], s54 offen offset:1024 lds
    v_mfma_f32_32x32x16_bf16 v[224:239], a[252:255], v[156:159], v[224:239]
    ds_read_b64_tr_b16 a[240:241], v111 offset:24576
    ds_read_b64_tr_b16 a[242:243], v111 offset:25600
    buffer_load_dwordx4 v102, s[32:35], s54 offen offset:2048 lds
    buffer_load_dwordx4 v103, s[32:35], s54 offen offset:3072 lds
    s_add_u32 s50, s50, 1
    s_cmp_eq_u32 s50, 9
    s_cselect_b32 s50, 0, s50
    s_waitcnt lgkmcnt(4)
    v_mfma_f32_32x32x16_bf16 v[176:191], v[248:251], v[160:163], v[176:191]
    ds_read_b128 v[164:167], v107 offset:0
    ds_read_b64_tr_b16 v[252:253], v108 offset:28672
    ds_read_b64_tr_b16 v[254:255], v108 offset:29696
    s_lshl_b32 s53, s50, 7
    s_add_u32 s53, s53, s51
    s_add_u32 m0, s55, 131072
    s_mul_i32 s54, s50, 221184
    buffer_load_dwordx4 v96, s[36:39], s53 offen offset:0 lds
    buffer_load_dwordx4 v97, s[36:39], s53 offen offset:1024 lds
    v_mfma_f32_32x32x16_bf16 v[192:207], a[232:235], v[160:163], v[192:207]
    ds_read_b64_tr_b16 a[244:245], v109 offset:28672
    ds_read_b64_tr_b16 a[246:247], v109 offset:29696
    buffer_load_dwordx4 v98, s[36:39], s53 offen offset:2048 lds
    buffer_load_dwordx4 v99, s[36:39], s53 offen offset:3072 lds
    s_add_u32 m0, s55, 147456
    s_waitcnt lgkmcnt(5)
    v_mfma_f32_32x32x16_bf16 v[208:223], a[236:239], v[160:163], v[208:223]
    ds_read_b64_tr_b16 a[248:249], v110 offset:28672
    ds_read_b64_tr_b16 a[250:251], v110 offset:29696
    s_add_u32 s54, s54, s52
    buffer_load_dwordx4 v100, s[32:35], s54 offen offset:0 lds
    buffer_load_dwordx4 v101, s[32:35], s54 offen offset:1024 lds
    v_mfma_f32_32x32x16_bf16 v[224:239], a[240:243], v[160:163], v[224:239]
    ds_read_b64_tr_b16 a[252:253], v111 offset:28672
    ds_read_b64_tr_b16 a[254:255], v111 offset:29696
    buffer_load_dwordx4 v102, s[32:35], s54 offen offset:2048 lds
    buffer_load_dwordx4 v103, s[32:35], s54 offen offset:3072 lds
    s_add_u32 s50, s50, 1
    s_cmp_eq_u32 s50, 9
    s_cselect_b32 s50, 0, s50
    s_waitcnt lgkmcnt(0)
    v_dot2c_f32_bf16 v112, s47, v152
    v_dot2c_f32_bf16 v113, v152, v152
    v_dot2c_f32_bf16 v114, s47, v240
    v_dot2c_f32_bf16 v112, s47, v153
    v_dot2c_f32_bf16 v113, v153, v153
    v_dot2c_f32_bf16 v114, s47, v241
    v_dot2c_f32_bf16 v112, s47, v154
    v_dot2c_f32_bf16 v113, v154, v154
    v_dot2c_f32_bf16 v114, s47, v242
    v_dot2c_f32_bf16 v112, s47, v155
    v_dot2c_f32_bf16 v113, v155, v155
    v_dot2c_f32_bf16 v114, s47, v243
    v_dot2c_f32_bf16 v112, s47, v156
    v_dot2c_f32_bf16 v113, v156, v156
    v_dot2c_f32_bf16 v114, s47, v244
    v_dot2c_f32_bf16 v112, s47, v157
    v_dot2c_f32_bf16 v113, v157, v157
    v_dot2c_f32_bf16 v114, s47, v245
    v_dot2c_f32_bf16 v112, s47, v158
    v_dot2c_f32_bf16 v113, v158, v158
    v_dot2c_f32_bf16 v114, s47, v246
    v_dot2c_f32_bf16 v112, s47, v159
    v_dot2c_f32_bf16 v113, v159, v159
    v_dot2c_f32_bf16 v114, s47, v247
    v_dot2c_f32_bf16 v112, s47, v160
    v_dot2c_f32_bf16 v113, v160, v160
    v_dot2c_f32_bf16 v114, s47, v248
    v_dot2c_f32_bf16 v112, s47, v161
    v_dot2c_f32_bf16 v113, v161, v161
    v_dot2c_f32_bf16 v114, s47, v249
    v_dot2c_f32_bf16 v112, s47, v162
    v_dot2c_f32_bf16 v113, v162, v162
    v_dot2c_f32_bf16 v114, s47, v250
    v_dot2c_f32_bf16 v112, s47, v163
    v_dot2c_f32_bf16 v113, v163, v163
    v_dot2c_f32_bf16 v114, s47, v251
    v_dot2c_f32_bf16 v112, s47, v164
    v_dot2c_f32_bf16 v113, v164, v164
    v_dot2c_f32_bf16 v114, s47, v252
    v_dot2c_f32_bf16 v112, s47, v165
    v_dot2c_f32_bf16 v113, v165, v165
    v_dot2c_f32_bf16 v114, s47, v253
    v_dot2c_f32_bf16 v112, s47, v166
    v_dot2c_f32_bf16 v113, v166, v166
    v_dot2c_f32_bf16 v114, s47, v254
    v_dot2c_f32_bf16 v112, s47, v167
    v_dot2c_f32_bf16 v113, v167, v167
    v_dot2c_f32_bf16 v114, s47, v255
    v_mfma_f32_32x32x16_bf16 v[176:191], v[252:255], v[164:167], v[176:191]
    s_waitcnt vmcnt(24)
    s_barrier
    ds_read_b128 v[152:155], v104 offset:32768
    ds_read_b64_tr_b16 v[240:241], v108 offset:49152
    ds_read_b64_tr_b16 v[242:243], v108 offset:50176
    s_lshl_b32 s53, s50, 7
    s_add_u32 s53, s53, s51
    s_add_u32 m0, s55, 0
    s_mul_i32 s54, s50, 221184
    v_mfma_f32_32x32x16_bf16 v[192:207], a[244:247], v[164:167], v[192:207]
    ds_read_b64_tr_b16 a[232:233], v109 offset:49152
    ds_read_b64_tr_b16 a[234:235], v109 offset:50176
    buffer_load_dwordx4 v96, s[36:39], s53 offen offset:0 lds
    v_mfma_f32_32x32x16_bf16 v[208:223], a[248:251], v[164:167], v[208:223]
    ds_read_b64_tr_b16 a[236:237], v110 offset:49152
    ds_read_b64_tr_b16 a[238:239], v110 offset:50176
    v_mfma_f32_32x32x16_bf16 v[224:239], a[252:255], v[164:167], v[224:239]
    ds_read_b64_tr_b16 a[240:241], v111 offset:49152
    ds_read_b64_tr_b16 a[242:243], v111 offset:50176
    buffer_load_dwordx4 v97, s[36:39], s53 offen offset:1024 lds
    s_waitcnt lgkmcnt(4)
    v_mfma_f32_32x32x16_bf16 v[176:191], v[240:243], v[152:155], v[176:191]
    ds_read_b128 v[156:159], v105 offset:32768
    ds_read_b64_tr_b16 v[244:245], v108 offset:53248
    ds_read_b64_tr_b16 v[246:247], v108 offset:54272
    buffer_load_dwordx4 v98, s[36:39], s53 offen offset:2048 lds
    v_mfma_f32_32x32x16_bf16 v[192:207], a[232:235], v[152:155], v[192:207]
    ds_read_b64_tr_b16 a[244:245], v109 offset:53248
    ds_read_b64_tr_b16 a[246:247], v109 offset:54272
    buffer_load_dwordx4 v99, s[36:39], s53 offen offset:3072 lds
    s_waitcnt lgkmcnt(5)
    v_mfma_f32_32x32x16_bf16 v[208:223], a[236:239], v[152:155], v[208:223]
    ds_read_b64_tr_b16 a[248:249], v110 offset:53248
    ds_read_b64_tr_b16 a[250:251], v110 offset:54272
    s_add_u32 m0, s55, 16384
    s_add_u32 s54, s54, s52
    v_mfma_f32_32x32x16_bf16 v[224:239], a[240:243], v[152:155], v[224:239]
    ds_read_b64_tr_b16 a[252:253], v111 offset:53248
    ds_read_b64_tr_b16 a[254:255], v111 offset:54272
    buffer_load_dwordx4 v100, s[32:35], s54 offen offset:0 lds
    s_waitcnt lgkmcnt(4)
    v_mfma_f32_32x32x16_bf16 v[176:191], v[244:247], v[156:159], v[176:191]
    ds_read_b128 v[160:163], v106 offset:32768
    ds_read_b64_tr_b16 v[248:249], v108 offset:57344
    ds_read_b64_tr_b16 v[250:251], v108 offset:58368
    buffer_load_dwordx4 v101, s[32:35], s54 offen offset:1024 lds
    v_mfma_f32_32x32x16_bf16 v[192:207], a[244:247], v[156:159], v[192:207]
    ds_read_b64_tr_b16 a[232:233], v109 offset:57344
    ds_read_b64_tr_b16 a[234:235], v109 offset:58368
    s_waitcnt lgkmcnt(5)
    v_mfma_f32_32x32x16_bf16 v[208:223], a[248:251], v[156:159], v[208:223]
    ds_read_b64_tr_b16 a[236:237], v110 offset:57344
    ds_read_b64_tr_b16 a[238:239], v110 offset:58368
    buffer_load_dwordx4 v102, s[32:35], s54 offen offset:2048 lds
    v_mfma_f32_32x32x16_bf16 v[224:239], a[252:255], v[156:159], v[224:239]
    ds_read_b64_tr_b16 a[240:241], v111 offset:57344
    ds_read_b64_tr_b16 a[242:243], v111 offset:58368
    buffer_load_dwordx4 v103, s[32:35], s54 offen offset:3072 lds
    s_waitcnt lgkmcnt(4)
    v_mfma_f32_32x32x16_bf16 v[176:191], v[248:251], v[160:163], v[176:191]
    ds_read_b128 v[164:167], v107 offset:32768
    ds_read_b64_tr_b16 v[252:253], v108 offset:61440
    ds_read_b64_tr_b16 v[254:255], v108 offset:62464
    s_add_u32 s50, s50, 1
    s_cmp_eq_u32 s50, 9
    s_cselect_b32 s50, 0, s50
    v_mfma_f32_32x32x16_bf16 v[192:207], a[232:235], v[160:163], v[192:207]
    ds_read_b64_tr_b16 a[244:245], v109 offset:61440
    ds_read_b64_tr_b16 a[246:247], v109 offset:62464
    s_waitcnt lgkmcnt(5)
    v_mfma_f32_32x32x16_bf16 v[208:223], a[236:239], v[160:163], v[208:223]
    ds_read_b64_tr_b16 a[248:249], v110 offset:61440
    ds_read_b64_tr_b16 a[250:251], v110 offset:62464
    v_mfma_f32_32x32x16_bf16 v[224:239], a[240:243], v[160:163], v[224:239]
    ds_read_b64_tr_b16 a[252:253], v111 offset:61440
    ds_read_b64_tr_b16 a[254:255], v111 offset:62464
    s_waitcnt lgkmcnt(0)
    v_dot2c_f32_bf16 v112, s47, v152
    v_dot2c_f32_bf16 v113, v152, v152
    v_dot2c_f32_bf16 v114, s47, v240
    v_dot2c_f32_bf16 v112, s47, v153
    v_dot2c_f32_bf16 v113, v153, v153
    v_dot2c_f32_bf16 v114, s47, v241
    v_dot2c_f32_bf16 v112, s47, v154
    v_dot2c_f32_bf16 v113, v154, v154
    v_dot2c_f32_bf16 v114, s47, v242
    v_dot2c_f32_bf16 v112, s47, v155
    v_dot2c_f32_bf16 v113, v155, v155
    v_dot2c_f32_bf16 v114, s47, v243
    v_dot2c_f32_bf16 v112, s47, v156
    v_dot2c_f32_bf16 v113, v156, v156
    v_dot2c_f32_bf16 v114, s47, v244
    v_dot2c_f32_bf16 v112, s47, v157
    v_dot2c_f32_bf16 v113, v157, v157
    v_dot2c_f32_bf16 v114, s47, v245
    v_dot2c_f32_bf16 v112, s47, v158
    v_dot2c_f32_bf16 v113, v158, v158
    v_dot2c_f32_bf16 v114, s47, v246
    v_dot2c_f32_bf16 v112, s47, v159
    v_dot2c_f32_bf16 v113, v159, v159
    v_dot2c_f32_bf16 v114, s47, v247
    v_dot2c_f32_bf16 v112, s47, v160
    v_dot2c_f32_bf16 v113, v160, v160
    v_dot2c_f32_bf16 v114, s47, v248
    v_dot2c_f32_bf16 v112, s47, v161
    v_dot2c_f32_bf16 v113, v161, v161
    v_dot2c_f32_bf16 v114, s47, v249
    v_dot2c_f32_bf16 v112, s47, v162
    v_dot2c_f32_bf16 v113, v162, v162
    v_dot2c_f32_bf16 v114, s47, v250
    v_dot2c_f32_bf16 v112, s47, v163
    v_dot2c_f32_bf16 v113, v163, v163
    v_dot2c_f32_bf16 v114, s47, v251
    v_dot2c_f32_bf16 v112, s47, v164
    v_dot2c_f32_bf16 v113, v164, v164
    v_dot2c_f32_bf16 v114, s47, v252
    v_dot2c_f32_bf16 v112, s47, v165
    v_dot2c_f32_bf16 v113, v165, v165
    v_dot2c_f32_bf16 v114, s47, v253
    v_dot2c_f32_bf16 v112, s47, v166
    v_dot2c_f32_bf16 v113, v166, v166
    v_dot2c_f32_bf16 v114, s47, v254
    v_dot2c_f32_bf16 v112, s47, v167
    v_dot2c_f32_bf16 v113, v167, v167
    v_dot2c_f32_bf16 v114, s47, v255
    v_mfma_f32_32x32x16_bf16 v[176:191], v[252:255], v[164:167], v[176:191]
    s_waitcnt vmcnt(24)
    s_barrier
    v_add_u32 v104, 0x10000, v104
    v_add_u32 v105, 0x10000, v105
    v_add_u32 v106, 0x10000, v106
    v_add_u32 v107, 0x10000, v107
    v_add_u32 v108, 0x10000, v108
    v_add_u32 v109, 0x10000, v109
    v_add_u32 v110, 0x10000, v110
    v_add_u32 v111, 0x10000, v111
    ds_read_b128 v[152:155], v104 offset:0
    ds_read_b64_tr_b16 v[240:241], v108 offset:16384
    ds_read_b64_tr_b16 v[242:243], v108 offset:17408
    s_lshl_b32 s53, s50, 7
    s_add_u32 s53, s53, s51
    s_add_u32 m0, s55, 32768
    s_mul_i32 s54, s50, 221184
    v_mfma_f32_32x32x16_bf16 v[192:207], a[244:247], v[164:167], v[192:207]
    ds_read_b64_tr_b16 a[232:233], v109 offset:16384
    ds_read_b64_tr_b16 a[234:235], v109 offset:17408
    buffer_load_dwordx4 v96, s[36:39], s53 offen offset:0 lds
    v_mfma_f32_32x32x16_bf16 v[208:223], a[248:251], v[164:167], v[208:223]
    ds_read_b64_tr_b16 a[236:237], v110 offset:16384
    ds_read_b64_tr_b16 a[238:239], v110 offset:17408
    v_mfma_f32_32x32x16_bf16 v[224:239], a[252:255], v[164:167], v[224:239]
    ds_read_b64_tr_b16 a[240:241], v111 offset:16384
    ds_read_b64_tr_b16 a[242:243], v111 offset:17408
    buffer_load_dwordx4 v97, s[36:39], s53 offen offset:1024 lds
    s_waitcnt lgkmcnt(4)
    v_mfma_f32_32x32x16_bf16 v[176:191], v[240:243], v[152:155], v[176:191]
    ds_read_b128 v[156:159], v105 offset:0
    ds_read_b64_tr_b16 v[244:245], v108 offset:20480
    ds_read_b64_tr_b16 v[246:247], v108 offset:21504
    buffer_load_dwordx4 v98, s[36:39], s53 offen offset:2048 lds
    v_mfma_f32_32x32x16_bf16 v[192:207], a[232:235], v[152:155], v[192:207]
    ds_read_b64_tr_b16 a[244:245], v109 offset:20480
    ds_read_b64_tr_b16 a[246:247], v109 offset:21504
    buffer_load_dwordx4 v99, s[36:39], s53 offen offset:3072 lds
    s_waitcnt lgkmcnt(5)
    v_mfma_f32_32x32x16_bf16 v[208:223], a[236:239], v[152:155], v[208:223]
    ds_read_b64_tr_b16 a[248:249], v110 offset:20480
    ds_read_b64_tr_b16 a[250:251], v110 offset:21504
    s_add_u32 m0, s55, 49152
    s_add_u32 s54, s54, s52
    v_mfma_f32_32x32x16_bf16 v[224:239], a[240:243], v[152:155], v[224:239]
    ds_read_b64_tr_b16 a[252:253], v111 offset:20480
    ds_read_b64_tr_b16 a[254:255], v111 offset:21504
    buffer_load_dwordx4 v100, s[32:35], s54 offen offset:0 lds
    s_waitcnt lgkmcnt(4)
    v_mfma_f32_32x32x16_bf16 v[176:191], v[244:247], v[156:159], v[176:191]
    ds_read_b128 v[160:163], v106 offset:0
    ds_read_b64_tr_b16 v[248:249], v108 offset:24576
    ds_read_b64_tr_b16 v[250:251], v108 offset:25600
    buffer_load_dwordx4 v101, s[32:35], s54 offen offset:1024 lds
    v_mfma_f32_32x32x16_bf16 v[192:207], a[244:247], v[156:159], v[192:207]
    ds_read_b64_tr_b16 a[232:233], v109 offset:24576
    ds_read_b64_tr_b16 a[234:235], v109 offset:25600
    s_waitcnt lgkmcnt(5)
    v_mfma_f32_32x32x16_bf16 v[208:223], a[248:251], v[156:159], v[208:223]
    ds_read_b64_tr_b16 a[236:237], v110 offset:24576
    ds_read_b64_tr_b16 a[238:239], v110 offset:25600
    buffer_load_dwordx4 v102, s[32:35], s54 offen offset:2048 lds
    v_mfma_f32_32x32x16_bf16 v[224:239], a[252:255], v[156:159], v[224:239]
    ds_read_b64_tr_b16 a[240:241], v111 offset:24576
    ds_read_b64_tr_b16 a[242:243], v111 offset:25600
    buffer_load_dwordx4 v103, s[32:35], s54 offen offset:3072 lds
    s_waitcnt lgkmcnt(4)
    v_mfma_f32_32x32x16_bf16 v[176:191], v[248:251], v[160:163], v[176:191]
    ds_read_b128 v[164:167], v107 offset:0
    ds_read_b64_tr_b16 v[252:253], v108 offset:28672
    ds_read_b64_tr_b16 v[254:255], v108 offset:29696
    s_add_u32 s50, s50, 1
    s_cmp_eq_u32 s50, 9
    s_cselect_b32 s50, 0, s50
    v_mfma_f32_32x32x16_bf16 v[192:207], a[232:235], v[160:163], v[192:207]
    ds_read_b64_tr_b16 a[244:245], v109 offset:28672
    ds_read_b64_tr_b16 a[246:247], v109 offset:29696
    s_waitcnt lgkmcnt(5)
    v_mfma_f32_32x32x16_bf16 v[208:223], a[236:239], v[160:163], v[208:223]
    ds_read_b64_tr_b16 a[248:249], v110 offset:28672
    ds_read_b64_tr_b16 a[250:251], v110 offset:29696
    v_mfma_f32_32x32x16_bf16 v[224:239], a[240:243], v[160:163], v[224:239]
    ds_read_b64_tr_b16 a[252:253], v111 offset:28672
    ds_read_b64_tr_b16 a[254:255], v111 offset:29696
    s_waitcnt lgkmcnt(0)
    v_dot2c_f32_bf16 v112, s47, v152
    v_dot2c_f32_bf16 v113, v152, v152
    v_dot2c_f32_bf16 v114, s47, v240
    v_dot2c_f32_bf16 v112, s47, v153
    v_dot2c_f32_bf16 v113, v153, v153
    v_dot2c_f32_bf16 v114, s47, v241
    v_dot2c_f32_bf16 v112, s47, v154
    v_dot2c_f32_bf16 v113, v154, v154
    v_dot2c_f32_bf16 v114, s47, v242
    v_dot2c_f32_bf16 v112, s47, v155
    v_dot2c_f32_bf16 v113, v155, v155
    v_dot2c_f32_bf16 v114, s47, v243
    v_dot2c_f32_bf16 v112, s47, v156
    v_dot2c_f32_bf16 v113, v156, v156
    v_dot2c_f32_bf16 v114, s47, v244
    v_dot2c_f32_bf16 v112, s47, v157
    v_dot2c_f32_bf16 v113, v157, v157
    v_dot2c_f32_bf16 v114, s47, v245
    v_dot2c_f32_bf16 v112, s47, v158
    v_dot2c_f32_bf16 v113, v158, v158
    v_dot2c_f32_bf16 v114, s47, v246
    v_dot2c_f32_bf16 v112, s47, v159
    v_dot2c_f32_bf16 v113, v159, v159
    v_dot2c_f32_bf16 v114, s47, v247
    v_dot2c_f32_bf16 v112, s47, v160
    v_dot2c_f32_bf16 v113, v160, v160
    v_dot2c_f32_bf16 v114, s47, v248
    v_dot2c_f32_bf16 v112, s47, v161
    v_dot2c_f32_bf16 v113, v161, v161
    v_dot2c_f32_bf16 v114, s47, v249
    v_dot2c_f32_bf16 v112, s47, v162
    v_dot2c_f32_bf16 v113, v162, v162
    v_dot2c_f32_bf16 v114, s47, v250
    v_dot2c_f32_bf16 v112, s47, v163
    v_dot2c_f32_bf16 v113, v163, v163
    v_dot2c_f32_bf16 v114, s47, v251
    v_dot2c_f32_bf16 v112, s47, v164
    v_dot2c_f32_bf16 v113, v164, v164
    v_dot2c_f32_bf16 v114, s47, v252
    v_dot2c_f32_bf16 v112, s47, v165
    v_dot2c_f32_bf16 v113, v165, v165
    v_dot2c_f32_bf16 v114, s47, v253
    v_dot2c_f32_bf16 v112, s47, v166
    v_dot2c_f32_bf16 v113, v166, v166
    v_dot2c_f32_bf16 v114, s47, v254
    v_dot2c_f32_bf16 v112, s47, v167
    v_dot2c_f32_bf16 v113, v167, v167
    v_dot2c_f32_bf16 v114, s47, v255
    v_mfma_f32_32x32x16_bf16 v[176:191], v[252:255], v[164:167], v[176:191]
    s_waitcnt vmcnt(24)
    s_barrier
    ds_read_b128 v[152:155], v104 offset:32768
    ds_read_b64_tr_b16 v[240:241], v108 offset:49152
    ds_read_b64_tr_b16 v[242:243], v108 offset:50176
    s_lshl_b32 s53, s50, 7
    s_add_u32 s53, s53, s51
    s_add_u32 m0, s55, 65536
    s_mul_i32 s54, s50, 221184
    v_mfma_f32_32x32x16_bf16 v[192:207], a[244:247], v[164:167], v[192:207]
    ds_read_b64_tr_b16 a[232:233], v109 offset:49152
    ds_read_b64_tr_b16 a[234:235], v109 offset:50176
    buffer_load_dwordx4 v96, s[36:39], s53 offen offset:0 lds
    v_mfma_f32_32x32x16_bf16 v[208:223], a[248:251], v[164:167], v[208:223]
    ds_read_b64_tr_b16 a[236:237], v110 offset:49152
    ds_read_b64_tr_b16 a[238:239], v110 offset:50176
    v_mfma_f32_32x32x16_bf16 v[224:239], a[252:255], v[164:167], v[224:239]
    ds_read_b64_tr_b16 a[240:241], v111 offset:49152
    ds_read_b64_tr_b16 a[242:243], v111 offset:50176
    buffer_load_dwordx4 v97, s[36:39], s53 offen offset:1024 lds
    s_waitcnt lgkmcnt(4)
    v_mfma_f32_32x32x16_bf16 v[176:191], v[240:243], v[152:155], v[176:191]
    ds_read_b128 v[156:159], v105 offset:32768
    ds_read_b64_tr_b16 v[244:245], v108 offset:53248
    ds_read_b64_tr_b16 v[246:247], v108 offset:54272
    buffer_load_dwordx4 v98, s[36:39], s53 offen offset:2048 lds
    v_mfma_f32_32x32x16_bf16 v[192:207], a[232:235], v[152:155], v[192:207]
    ds_read_b64_tr_b16 a[244:245], v109 offset:53248
    ds_read_b64_tr_b16 a[246:247], v109 offset:54272
    buffer_load_dwordx4 v99, s[36:39], s53 offen offset:3072 lds
    s_waitcnt lgkmcnt(5)
    v_mfma_f32_32x32x16_bf16 v[208:223], a[236:239], v[152:155], v[208:223]
    ds_read_b64_tr_b16 a[248:249], v110 offset:53248
    ds_read_b64_tr_b16 a[250:251], v110 offset:54272
    s_add_u32 m0, s55, 81920
    s_add_u32 s54, s54, s52
    v_mfma_f32_32x32x16_bf16 v[224:239], a[240:243], v[152:155], v[224:239]
    ds_read_b64_tr_b16 a[252:253], v111 offset:53248
    ds_read_b64_tr_b16 a[254:255], v111 offset:54272
    buffer_load_dwordx4 v100, s[32:35], s54 offen offset:0 lds
    s_waitcnt lgkmcnt(4)
    v_mfma_f32_32x32x16_bf16 v[176:191], v[244:247], v[156:159], v[176:191]
    ds_read_b128 v[160:163], v106 offset:32768
    ds_read_b64_tr_b16 v[248:249], v108 offset:57344
    ds_read_b64_tr_b16 v[250:251], v108 offset:58368
    buffer_load_dwordx4 v101, s[32:35], s54 offen offset:1024 lds
    v_mfma_f32_32x32x16_bf16 v[192:207], a[244:247], v[156:159], v[192:207]
    ds_read_b64_tr_b16 a[232:233], v109 offset:57344
    ds_read_b64_tr_b16 a[234:235], v109 offset:58368
    s_waitcnt lgkmcnt(5)
    v_mfma_f32_32x32x16_bf16 v[208:223], a[248:251], v[156:159], v[208:223]
    ds_read_b64_tr_b16 a[236:237], v110 offset:57344
    ds_read_b64_tr_b16 a[238:239], v110 offset:58368
    buffer_load_dwordx4 v102, s[32:35], s54 offen offset:2048 lds
    v_mfma_f32_32x32x16_bf16 v[224:239], a[252:255], v[156:159], v[224:239]
    ds_read_b64_tr_b16 a[240:241], v111 offset:57344
    ds_read_b64_tr_b16 a[242:243], v111 offset:58368
    buffer_load_dwordx4 v103, s[32:35], s54 offen offset:3072 lds
    s_waitcnt lgkmcnt(4)
    v_mfma_f32_32x32x16_bf16 v[176:191], v[248:251], v[160:163], v[176:191]
    ds_read_b128 v[164:167], v107 offset:32768
    ds_read_b64_tr_b16 v[252:253], v108 offset:61440
    ds_read_b64_tr_b16 v[254:255], v108 offset:62464
    s_add_u32 s50, s50, 1
    s_cmp_eq_u32 s50, 9
    s_cselect_b32 s50, 0, s50
    v_mfma_f32_32x32x16_bf16 v[192:207], a[232:235], v[160:163], v[192:207]
    ds_read_b64_tr_b16 a[244:245], v109 offset:61440
    ds_read_b64_tr_b16 a[246:247], v109 offset:62464
    s_waitcnt lgkmcnt(5)
    v_mfma_f32_32x32x16_bf16 v[208:223], a[236:239], v[160:163], v[208:223]
    ds_read_b64_tr_b16 a[248:249], v110 offset:61440
    ds_read_b64_tr_b16 a[250:251], v110 offset:62464
    v_mfma_f32_32x32x16_bf16 v[224:239], a[240:243], v[160:163], v[224:239]
    ds_read_b64_tr_b16 a[252:253], v111 offset:61440
    ds_read_b64_tr_b16 a[254:255], v111 offset:62464
    s_waitcnt lgkmcnt(0)
    v_dot2c_f32_bf16 v112, s47, v152
    v_dot2c_f32_bf16 v113, v152, v152
    v_dot2c_f32_bf16 v114, s47, v240
    v_dot2c_f32_bf16 v112, s47, v153
    v_dot2c_f32_bf16 v113, v153, v153
    v_dot2c_f32_bf16 v114, s47, v241
    v_dot2c_f32_bf16 v112, s47, v154
    v_dot2c_f32_bf16 v113, v154, v154
    v_dot2c_f32_bf16 v114, s47, v242
    v_dot2c_f32_bf16 v112, s47, v155
    v_dot2c_f32_bf16 v113, v155, v155
    v_dot2c_f32_bf16 v114, s47, v243
    v_dot2c_f32_bf16 v112, s47, v156
    v_dot2c_f32_bf16 v113, v156, v156
    v_dot2c_f32_bf16 v114, s47, v244
    v_dot2c_f32_bf16 v112, s47, v157
    v_dot2c_f32_bf16 v113, v157, v157
    v_dot2c_f32_bf16 v114, s47, v245
    v_dot2c_f32_bf16 v112, s47, v158
    v_dot2c_f32_bf16 v113, v158, v158
    v_dot2c_f32_bf16 v114, s47, v246
    v_dot2c_f32_bf16 v112, s47, v159
    v_dot2c_f32_bf16 v113, v159, v159
    v_dot2c_f32_bf16 v114, s47, v247
    v_dot2c_f32_bf16 v112, s47, v160
    v_dot2c_f32_bf16 v113, v160, v160
    v_dot2c_f32_bf16 v114, s47, v248
    v_dot2c_f32_bf16 v112, s47, v161
    v_dot2c_f32_bf16 v113, v161, v161
    v_dot2c_f32_bf16 v114, s47, v249
    v_dot2c_f32_bf16 v112, s47, v162
    v_dot2c_f32_bf16 v113, v162, v162
    v_dot2c_f32_bf16 v114, s47, v250
    v_dot2c_f32_bf16 v112, s47, v163
    v_dot2c_f32_bf16 v113, v163, v163
    v_dot2c_f32_bf16 v114, s47, v251
    v_dot2c_f32_bf16 v112, s47, v164
    v_dot2c_f32_bf16 v113, v164, v164
    v_dot2c_f32_bf16 v114, s47, v252
    v_dot2c_f32_bf16 v112, s47, v165
    v_dot2c_f32_bf16 v113, v165, v165
    v_dot2c_f32_bf16 v114, s47, v253
    v_dot2c_f32_bf16 v112, s47, v166
    v_dot2c_f32_bf16 v113, v166, v166
    v_dot2c_f32_bf16 v114, s47, v254
    v_dot2c_f32_bf16 v112, s47, v167
    v_dot2c_f32_bf16 v113, v167, v167
    v_dot2c_f32_bf16 v114, s47, v255
    v_mfma_f32_32x32x16_bf16 v[176:191], v[252:255], v[164:167], v[176:191]
    s_waitcnt vmcnt(24)
    s_barrier
    v_add_u32 v104, 0x10000, v104
    v_add_u32 v105, 0x10000, v105
    v_add_u32 v106, 0x10000, v106
    v_add_u32 v107, 0x10000, v107
    v_add_u32 v108, 0x10000, v108
    v_add_u32 v109, 0x10000, v109
    v_add_u32 v110, 0x10000, v110
    v_add_u32 v111, 0x10000, v111
    ds_read_b128 v[152:155], v104 offset:0
    ds_read_b64_tr_b16 v[240:241], v108 offset:16384
    ds_read_b64_tr_b16 v[242:243], v108 offset:17408
    s_lshl_b32 s53, s50, 7
    s_add_u32 s53, s53, s51
    s_add_u32 m0, s55, 98304
    s_mul_i32 s54, s50, 221184
    v_mfma_f32_32x32x16_bf16 v[192:207], a[244:247], v[164:167], v[192:207]
    ds_read_b64_tr_b16 a[232:233], v109 offset:16384
    ds_read_b64_tr_b16 a[234:235], v109 offset:17408
    buffer_load_dwordx4 v96, s[36:39], s53 offen offset:0 lds
    v_mfma_f32_32x32x16_bf16 v[208:223], a[248:251], v[164:167], v[208:223]
    ds_read_b64_tr_b16 a[236:237], v110 offset:16384
    ds_read_b64_tr_b16 a[238:239], v110 offset:17408
    v_mfma_f32_32x32x16_bf16 v[224:239], a[252:255], v[164:167], v[224:239]
    ds_read_b64_tr_b16 a[240:241], v111 offset:16384
    ds_read_b64_tr_b16 a[242:243], v111 offset:17408
    buffer_load_dwordx4 v97, s[36:39], s53 offen offset:1024 lds
    s_waitcnt lgkmcnt(4)
    v_mfma_f32_32x32x16_bf16 v[176:191], v[240:243], v[152:155], v[176:191]
    ds_read_b128 v[156:159], v105 offset:0
    ds_read_b64_tr_b16 v[244:245], v108 offset:20480
    ds_read_b64_tr_b16 v[246:247], v108 offset:21504
    buffer_load_dwordx4 v98, s[36:39], s53 offen offset:2048 lds
    v_mfma_f32_32x32x16_bf16 v[192:207], a[232:235], v[152:155], v[192:207]
    ds_read_b64_tr_b16 a[244:245], v109 offset:20480
    ds_read_b64_tr_b16 a[246:247], v109 offset:21504
    buffer_load_dwordx4 v99, s[36:39], s53 offen offset:3072 lds
    s_waitcnt lgkmcnt(5)
    v_mfma_f32_32x32x16_bf16 v[208:223], a[236:239], v[152:155], v[208:223]
    ds_read_b64_tr_b16 a[248:249], v110 offset:20480
    ds_read_b64_tr_b16 a[250:251], v110 offset:21504
    s_add_u32 m0, s55, 114688
    s_add_u32 s54, s54, s52
    v_mfma_f32_32x32x16_bf16 v[224:239], a[240:243], v[152:155], v[224:239]
    ds_read_b64_tr_b16 a[252:253], v111 offset:20480
    ds_read_b64_tr_b16 a[254:255], v111 offset:21504
    buffer_load_dwordx4 v100, s[32:35], s54 offen offset:0 lds
    s_waitcnt lgkmcnt(4)
    v_mfma_f32_32x32x16_bf16 v[176:191], v[244:247], v[156:159], v[176:191]
    ds_read_b128 v[160:163], v106 offset:0
    ds_read_b64_tr_b16 v[248:249], v108 offset:24576
    ds_read_b64_tr_b16 v[250:251], v108 offset:25600
    buffer_load_dwordx4 v101, s[32:35], s54 offen offset:1024 lds
    v_mfma_f32_32x32x16_bf16 v[192:207], a[244:247], v[156:159], v[192:207]
    ds_read_b64_tr_b16 a[232:233], v109 offset:24576
    ds_read_b64_tr_b16 a[234:235], v109 offset:25600
    s_waitcnt lgkmcnt(5)
    v_mfma_f32_32x32x16_bf16 v[208:223], a[248:251], v[156:159], v[208:223]
    ds_read_b64_tr_b16 a[236:237], v110 offset:24576
    ds_read_b64_tr_b16 a[238:239], v110 offset:25600
    buffer_load_dwordx4 v102, s[32:35], s54 offen offset:2048 lds
    v_mfma_f32_32x32x16_bf16 v[224:239], a[252:255], v[156:159], v[224:239]
    ds_read_b64_tr_b16 a[240:241], v111 offset:24576
    ds_read_b64_tr_b16 a[242:243], v111 offset:25600
    buffer_load_dwordx4 v103, s[32:35], s54 offen offset:3072 lds
    s_waitcnt lgkmcnt(4)
    v_mfma_f32_32x32x16_bf16 v[176:191], v[248:251], v[160:163], v[176:191]
    ds_read_b128 v[164:167], v107 offset:0
    ds_read_b64_tr_b16 v[252:253], v108 offset:28672
    ds_read_b64_tr_b16 v[254:255], v108 offset:29696
    s_add_u32 s50, s50, 1
    s_cmp_eq_u32 s50, 9
    s_cselect_b32 s50, 0, s50
    v_mfma_f32_32x32x16_bf16 v[192:207], a[232:235], v[160:163], v[192:207]
    ds_read_b64_tr_b16 a[244:245], v109 offset:28672
    ds_read_b64_tr_b16 a[246:247], v109 offset:29696
    s_waitcnt lgkmcnt(5)
    v_mfma_f32_32x32x16_bf16 v[208:223], a[236:239], v[160:163], v[208:223]
    ds_read_b64_tr_b16 a[248:249], v110 offset:28672
    ds_read_b64_tr_b16 a[250:251], v110 offset:29696
    v_mfma_f32_32x32x16_bf16 v[224:239], a[240:243], v[160:163], v[224:239]
    ds_read_b64_tr_b16 a[252:253], v111 offset:28672
    ds_read_b64_tr_b16 a[254:255], v111 offset:29696
    s_waitcnt lgkmcnt(0)
    v_dot2c_f32_bf16 v112, s47, v152
    v_dot2c_f32_bf16 v113, v152, v152
    v_dot2c_f32_bf16 v114, s47, v240
    v_dot2c_f32_bf16 v112, s47, v153
    v_dot2c_f32_bf16 v113, v153, v153
    v_dot2c_f32_bf16 v114, s47, v241
    v_dot2c_f32_bf16 v112, s47, v154
    v_dot2c_f32_bf16 v113, v154, v154
    v_dot2c_f32_bf16 v114, s47, v242
    v_dot2c_f32_bf16 v112, s47, v155
    v_dot2c_f32_bf16 v113, v155, v155
    v_dot2c_f32_bf16 v114, s47, v243
    v_dot2c_f32_bf16 v112, s47, v156
    v_dot2c_f32_bf16 v113, v156, v156
    v_dot2c_f32_bf16 v114, s47, v244
    v_dot2c_f32_bf16 v112, s47, v157
    v_dot2c_f32_bf16 v113, v157, v157
    v_dot2c_f32_bf16 v114, s47, v245
    v_dot2c_f32_bf16 v112, s47, v158
    v_dot2c_f32_bf16 v113, v158, v158
    v_dot2c_f32_bf16 v114, s47, v246
    v_dot2c_f32_bf16 v112, s47, v159
    v_dot2c_f32_bf16 v113, v159, v159
    v_dot2c_f32_bf16 v114, s47, v247
    v_dot2c_f32_bf16 v112, s47, v160
    v_dot2c_f32_bf16 v113, v160, v160
    v_dot2c_f32_bf16 v114, s47, v248
    v_dot2c_f32_bf16 v112, s47, v161
    v_dot2c_f32_bf16 v113, v161, v161
    v_dot2c_f32_bf16 v114, s47, v249
    v_dot2c_f32_bf16 v112, s47, v162
    v_dot2c_f32_bf16 v113, v162, v162
    v_dot2c_f32_bf16 v114, s47, v250
    v_dot2c_f32_bf16 v112, s47, v163
    v_dot2c_f32_bf16 v113, v163, v163
    v_dot2c_f32_bf16 v114, s47, v251
    v_dot2c_f32_bf16 v112, s47, v164
    v_dot2c_f32_bf16 v113, v164, v164
    v_dot2c_f32_bf16 v114, s47, v252
    v_dot2c_f32_bf16 v112, s47, v165
    v_dot2c_f32_bf16 v113, v165, v165
    v_dot2c_f32_bf16 v114, s47, v253
    v_dot2c_f32_bf16 v112, s47, v166
    v_dot2c_f32_bf16 v113, v166, v166
    v_dot2c_f32_bf16 v114, s47, v254
    v_dot2c_f32_bf16 v112, s47, v167
    v_dot2c_f32_bf16 v113, v167, v167
    v_dot2c_f32_bf16 v114, s47, v255
    v_mfma_f32_32x32x16_bf16 v[176:191], v[252:255], v[164:167], v[176:191]
    s_waitcnt vmcnt(24)
    s_barrier
    v_add_u32 v104, 0xfffe0000, v104
    v_add_u32 v105, 0xfffe0000, v105
    v_add_u32 v106, 0xfffe0000, v106
    v_add_u32 v107, 0xfffe0000, v107
    v_add_u32 v108, 0xfffe0000, v108
    v_add_u32 v109, 0xfffe0000, v109
    v_add_u32 v110, 0xfffe0000, v110
    v_add_u32 v111, 0xfffe0000, v111
    ds_read_b128 v[152:155], v104 offset:0
    ds_read_b64_tr_b16 v[240:241], v108 offset:16384
    ds_read_b64_tr_b16 v[242:243], v108 offset:17408
    v_mfma_f32_32x32x16_bf16 v[192:207], a[244:247], v[164:167], v[192:207]
    ds_read_b64_tr_b16 a[232:233], v109 offset:16384
    ds_read_b64_tr_b16 a[234:235], v109 offset:17408
    v_mfma_f32_32x32x16_bf16 v[208:223], a[248:251], v[164:167], v[208:223]
    ds_read_b64_tr_b16 a[236:237], v110 offset:16384
    ds_read_b64_tr_b16 a[238:239], v110 offset:17408
    v_mfma_f32_32x32x16_bf16 v[224:239], a[252:255], v[164:167], v[224:239]
    ds_read_b64_tr_b16 a[240:241], v111 offset:16384
    ds_read_b64_tr_b16 a[242:243], v111 offset:17408
    s_waitcnt lgkmcnt(4)
    v_mfma_f32_32x32x16_bf16 v[176:191], v[240:243], v[152:155], v[176:191]
    ds_read_b128 v[156:159], v105 offset:0
    ds_read_b64_tr_b16 v[244:245], v108 offset:20480
    ds_read_b64_tr_b16 v[246:247], v108 offset:21504
    v_mfma_f32_32x32x16_bf16 v[192:207], a[232:235], v[152:155], v[192:207]
    ds_read_b64_tr_b16 a[244:245], v109 offset:20480
    ds_read_b64_tr_b16 a[246:247], v109 offset:21504
    v_mov_b32 v92, -1
    v_mov_b32 v93, -1
    v_mov_b32 v94, -1
    v_mov_b32 v95, -1
    s_waitcnt lgkmcnt(5)
    v_mfma_f32_32x32x16_bf16 v[208:223], a[236:239], v[152:155], v[208:223]
    ds_read_b64_tr_b16 a[248:249], v110 offset:20480
    ds_read_b64_tr_b16 a[250:251], v110 offset:21504
    v_mfma_f32_32x32x16_bf16 v[224:239], a[240:243], v[152:155], v[224:239]
    ds_read_b64_tr_b16 a[252:253], v111 offset:20480
    ds_read_b64_tr_b16 a[254:255], v111 offset:21504
    s_mul_i32 s0, s57, 72
    s_add_u32 s0, s0, s59
    s_lshl_b32 s0, s0, 10
    s_add_u32 s0, s0, 0x900000
    s_waitcnt lgkmcnt(4)
    v_mfma_f32_32x32x16_bf16 v[176:191], v[244:247], v[156:159], v[176:191]
    ds_read_b128 v[160:163], v106 offset:0
    ds_read_b64_tr_b16 v[248:249], v108 offset:24576
    ds_read_b64_tr_b16 v[250:251], v108 offset:25600
    v_mfma_f32_32x32x16_bf16 v[192:207], a[244:247], v[156:159], v[192:207]
    ds_read_b64_tr_b16 a[232:233], v109 offset:24576
    ds_read_b64_tr_b16 a[234:235], v109 offset:25600
    buffer_store_dwordx4 v[92:95], v2, s[28:31], s0 offen sc1
    s_waitcnt lgkmcnt(5)
    v_mfma_f32_32x32x16_bf16 v[208:223], a[248:251], v[156:159], v[208:223]
    ds_read_b64_tr_b16 a[236:237], v110 offset:24576
    ds_read_b64_tr_b16 a[238:239], v110 offset:25600
    v_mfma_f32_32x32x16_bf16 v[224:239], a[252:255], v[156:159], v[224:239]
    ds_read_b64_tr_b16 a[240:241], v111 offset:24576
    ds_read_b64_tr_b16 a[242:243], v111 offset:25600
    s_add_u32 s0, s0, 36864
    buffer_store_dwordx4 v[92:95], v2, s[28:31], s0 offen sc1
    s_waitcnt lgkmcnt(4)
    v_mfma_f32_32x32x16_bf16 v[176:191], v[248:251], v[160:163], v[176:191]
    ds_read_b128 v[164:167], v107 offset:0
    ds_read_b64_tr_b16 v[252:253], v108 offset:28672
    ds_read_b64_tr_b16 v[254:255], v108 offset:29696
    v_mfma_f32_32x32x16_bf16 v[192:207], a[232:235], v[160:163], v[192:207]
    ds_read_b64_tr_b16 a[244:245], v109 offset:28672
    ds_read_b64_tr_b16 a[246:247], v109 offset:29696
    s_waitcnt lgkmcnt(5)
    v_mfma_f32_32x32x16_bf16 v[208:223], a[236:239], v[160:163], v[208:223]
    ds_read_b64_tr_b16 a[248:249], v110 offset:28672
    ds_read_b64_tr_b16 a[250:251], v110 offset:29696
    s_mul_i32 s1, s65, 36
    s_mul_i32 s0, s66, 9
    s_add_u32 s1, s1, s0
    s_lshl_b32 s1, s1, 10
    s_lshl_b32 s0, s46, 11
    s_add_u32 s0, s0, s1
    s_add_u32 s0, s0, 0xc00000
    v_mfma_f32_32x32x16_bf16 v[224:239], a[240:243], v[160:163], v[224:239]
    ds_read_b64_tr_b16 a[252:253], v111 offset:28672
    ds_read_b64_tr_b16 a[254:255], v111 offset:29696
    s_waitcnt lgkmcnt(0)
    v_dot2c_f32_bf16 v112, s47, v152
    v_dot2c_f32_bf16 v113, v152, v152
    v_dot2c_f32_bf16 v114, s47, v240
    v_dot2c_f32_bf16 v112, s47, v153
    v_dot2c_f32_bf16 v113, v153, v153
    v_dot2c_f32_bf16 v114, s47, v241
    v_dot2c_f32_bf16 v112, s47, v154
    v_dot2c_f32_bf16 v113, v154, v154
    v_dot2c_f32_bf16 v114, s47, v242
    v_dot2c_f32_bf16 v112, s47, v155
    v_dot2c_f32_bf16 v113, v155, v155
    v_dot2c_f32_bf16 v114, s47, v243
    v_dot2c_f32_bf16 v112, s47, v156
    v_dot2c_f32_bf16 v113, v156, v156
    v_dot2c_f32_bf16 v114, s47, v244
    v_dot2c_f32_bf16 v112, s47, v157
    v_dot2c_f32_bf16 v113, v157, v157
    v_dot2c_f32_bf16 v114, s47, v245
    v_dot2c_f32_bf16 v112, s47, v158
    v_dot2c_f32_bf16 v113, v158, v158
    v_dot2c_f32_bf16 v114, s47, v246
    v_dot2c_f32_bf16 v112, s47, v159
    v_dot2c_f32_bf16 v113, v159, v159
    v_dot2c_f32_bf16 v114, s47, v247
    v_dot2c_f32_bf16 v112, s47, v160
    v_dot2c_f32_bf16 v113, v160, v160
    v_dot2c_f32_bf16 v114, s47, v248
    v_dot2c_f32_bf16 v112, s47, v161
    v_dot2c_f32_bf16 v113, v161, v161
    v_dot2c_f32_bf16 v114, s47, v249
    v_dot2c_f32_bf16 v112, s47, v162
    v_dot2c_f32_bf16 v113, v162, v162
    v_dot2c_f32_bf16 v114, s47, v250
    v_dot2c_f32_bf16 v112, s47, v163
    v_dot2c_f32_bf16 v113, v163, v163
    v_dot2c_f32_bf16 v114, s47, v251
    v_dot2c_f32_bf16 v112, s47, v164
    v_dot2c_f32_bf16 v113, v164, v164
    v_dot2c_f32_bf16 v114, s47, v252
    v_dot2c_f32_bf16 v112, s47, v165
    v_dot2c_f32_bf16 v113, v165, v165
    v_dot2c_f32_bf16 v114, s47, v253
    v_dot2c_f32_bf16 v112, s47, v166
    v_dot2c_f32_bf16 v113, v166, v166
    v_dot2c_f32_bf16 v114, s47, v254
    v_dot2c_f32_bf16 v112, s47, v167
    v_dot2c_f32_bf16 v113, v167, v167
    v_dot2c_f32_bf16 v114, s47, v255
    v_mfma_f32_32x32x16_bf16 v[176:191], v[252:255], v[164:167], v[176:191]
    s_waitcnt vmcnt(18)
    s_barrier
    ds_read_b128 v[152:155], v104 offset:32768
    ds_read_b64_tr_b16 v[240:241], v108 offset:49152
    ds_read_b64_tr_b16 v[242:243], v108 offset:50176
    v_mfma_f32_32x32x16_bf16 v[192:207], a[244:247], v[164:167], v[192:207]
    ds_read_b64_tr_b16 a[232:233], v109 offset:49152
    ds_read_b64_tr_b16 a[234:235], v109 offset:50176
    buffer_store_dwordx4 v[92:95], v2, s[28:31], s0 offen sc1
    v_mfma_f32_32x32x16_bf16 v[208:223], a[248:251], v[164:167], v[208:223]
    ds_read_b64_tr_b16 a[236:237], v110 offset:49152
    ds_read_b64_tr_b16 a[238:239], v110 offset:50176
    v_mfma_f32_32x32x16_bf16 v[224:239], a[252:255], v[164:167], v[224:239]
    ds_read_b64_tr_b16 a[240:241], v111 offset:49152
    ds_read_b64_tr_b16 a[242:243], v111 offset:50176
    buffer_store_dwordx4 v[92:95], v2, s[28:31], s0 offen offset:1024 sc1
    s_add_u32 s0, s0, 0x300000
    s_waitcnt lgkmcnt(4)
    v_mfma_f32_32x32x16_bf16 v[176:191], v[240:243], v[152:155], v[176:191]
    ds_read_b128 v[156:159], v105 offset:32768
    ds_read_b64_tr_b16 v[244:245], v108 offset:53248
    ds_read_b64_tr_b16 v[246:247], v108 offset:54272
    v_mfma_f32_32x32x16_bf16 v[192:207], a[232:235], v[152:155], v[192:207]
    ds_read_b64_tr_b16 a[244:245], v109 offset:53248
    ds_read_b64_tr_b16 a[246:247], v109 offset:54272
    buffer_store_dwordx4 v[92:95], v2, s[28:31], s0 offen sc1
    s_waitcnt lgkmcnt(5)
    v_mfma_f32_32x32x16_bf16 v[208:223], a[236:239], v[152:155], v[208:223]
    ds_read_b64_tr_b16 a[248:249], v110 offset:53248
    ds_read_b64_tr_b16 a[250:251], v110 offset:54272
    v_mfma_f32_32x32x16_bf16 v[224:239], a[240:243], v[152:155], v[224:239]
    ds_read_b64_tr_b16 a[252:253], v111 offset:53248
    ds_read_b64_tr_b16 a[254:255], v111 offset:54272
    s_waitcnt lgkmcnt(4)
    v_mfma_f32_32x32x16_bf16 v[176:191], v[244:247], v[156:159], v[176:191]
    ds_read_b128 v[160:163], v106 offset:32768
    ds_read_b64_tr_b16 v[248:249], v108 offset:57344
    ds_read_b64_tr_b16 v[250:251], v108 offset:58368
    buffer_store_dwordx4 v[92:95], v2, s[28:31], s0 offen offset:1024 sc1
    s_add_u32 s0, s0, 0x300000
    v_mfma_f32_32x32x16_bf16 v[192:207], a[244:247], v[156:159], v[192:207]
    ds_read_b64_tr_b16 a[232:233], v109 offset:57344
    ds_read_b64_tr_b16 a[234:235], v109 offset:58368
    s_waitcnt lgkmcnt(5)
    v_mfma_f32_32x32x16_bf16 v[208:223], a[248:251], v[156:159], v[208:223]
    ds_read_b64_tr_b16 a[236:237], v110 offset:57344
    ds_read_b64_tr_b16 a[238:239], v110 offset:58368
    buffer_store_dwordx4 v[92:95], v2, s[28:31], s0 offen sc1
    v_mfma_f32_32x32x16_bf16 v[224:239], a[252:255], v[156:159], v[224:239]
    ds_read_b64_tr_b16 a[240:241], v111 offset:57344
    ds_read_b64_tr_b16 a[242:243], v111 offset:58368
    s_waitcnt lgkmcnt(4)
    v_mfma_f32_32x32x16_bf16 v[176:191], v[248:251], v[160:163], v[176:191]
    ds_read_b128 v[164:167], v107 offset:32768
    ds_read_b64_tr_b16 v[252:253], v108 offset:61440
    ds_read_b64_tr_b16 v[254:255], v108 offset:62464
    buffer_store_dwordx4 v[92:95], v2, s[28:31], s0 offen offset:1024 sc1
    v_mfma_f32_32x32x16_bf16 v[192:207], a[232:235], v[160:163], v[192:207]
    ds_read_b64_tr_b16 a[244:245], v109 offset:61440
    ds_read_b64_tr_b16 a[246:247], v109 offset:62464
    s_waitcnt lgkmcnt(5)
    v_mfma_f32_32x32x16_bf16 v[208:223], a[236:239], v[160:163], v[208:223]
    ds_read_b64_tr_b16 a[248:249], v110 offset:61440
    ds_read_b64_tr_b16 a[250:251], v110 offset:62464
    v_mfma_f32_32x32x16_bf16 v[224:239], a[240:243], v[160:163], v[224:239]
    ds_read_b64_tr_b16 a[252:253], v111 offset:61440
    ds_read_b64_tr_b16 a[254:255], v111 offset:62464
    s_mul_i32 s0, s46, 0x300000
    s_add_u32 s0, s0, s1
    s_add_u32 s0, s0, 0xc02000
    s_lshl_b32 s1, s65, 2
    s_add_u32 s1, s1, s66
    s_lshl_b32 s1, s1, 10
    s_add_u32 s1, s1, 0x1500000
    s_cmp_eq_u32 s46, 3
    s_cselect_b32 s0, s1, s0
    s_waitcnt lgkmcnt(0)
    v_dot2c_f32_bf16 v112, s47, v152
    v_dot2c_f32_bf16 v113, v152, v152
    v_dot2c_f32_bf16 v114, s47, v240
    v_dot2c_f32_bf16 v112, s47, v153
    v_dot2c_f32_bf16 v113, v153, v153
    v_dot2c_f32_bf16 v114, s47, v241
    v_dot2c_f32_bf16 v112, s47, v154
    v_dot2c_f32_bf16 v113, v154, v154
    v_dot2c_f32_bf16 v114, s47, v242
    v_dot2c_f32_bf16 v112, s47, v155
    v_dot2c_f32_bf16 v113, v155, v155
    v_dot2c_f32_bf16 v114, s47, v243
    v_dot2c_f32_bf16 v112, s47, v156
    v_dot2c_f32_bf16 v113, v156, v156
    v_dot2c_f32_bf16 v114, s47, v244
    v_dot2c_f32_bf16 v112, s47, v157
    v_dot2c_f32_bf16 v113, v157, v157
    v_dot2c_f32_bf16 v114, s47, v245
    v_dot2c_f32_bf16 v112, s47, v158
    v_dot2c_f32_bf16 v113, v158, v158
    v_dot2c_f32_bf16 v114, s47, v246
    v_dot2c_f32_bf16 v112, s47, v159
    v_dot2c_f32_bf16 v113, v159, v159
    v_dot2c_f32_bf16 v114, s47, v247
    v_dot2c_f32_bf16 v112, s47, v160
    v_dot2c_f32_bf16 v113, v160, v160
    v_dot2c_f32_bf16 v114, s47, v248
    v_dot2c_f32_bf16 v112, s47, v161
    v_dot2c_f32_bf16 v113, v161, v161
    v_dot2c_f32_bf16 v114, s47, v249
    v_dot2c_f32_bf16 v112, s47, v162
    v_dot2c_f32_bf16 v113, v162, v162
    v_dot2c_f32_bf16 v114, s47, v250
    v_dot2c_f32_bf16 v112, s47, v163
    v_dot2c_f32_bf16 v113, v163, v163
    v_dot2c_f32_bf16 v114, s47, v251
    v_dot2c_f32_bf16 v112, s47, v164
    v_dot2c_f32_bf16 v113, v164, v164
    v_dot2c_f32_bf16 v114, s47, v252
    v_dot2c_f32_bf16 v112, s47, v165
    v_dot2c_f32_bf16 v113, v165, v165
    v_dot2c_f32_bf16 v114, s47, v253
    v_dot2c_f32_bf16 v112, s47, v166
    v_dot2c_f32_bf16 v113, v166, v166
    v_dot2c_f32_bf16 v114, s47, v254
    v_dot2c_f32_bf16 v112, s47, v167
    v_dot2c_f32_bf16 v113, v167, v167
    v_dot2c_f32_bf16 v114, s47, v255
    v_mfma_f32_32x32x16_bf16 v[176:191], v[252:255], v[164:167], v[176:191]
    s_waitcnt vmcnt(16)
    s_barrier
    v_add_u32 v104, 0x10000, v104
    v_add_u32 v105, 0x10000, v105
    v_add_u32 v106, 0x10000, v106
    v_add_u32 v107, 0x10000, v107
    v_add_u32 v108, 0x10000, v108
    v_add_u32 v109, 0x10000, v109
    v_add_u32 v110, 0x10000, v110
    v_add_u32 v111, 0x10000, v111
    ds_read_b128 v[152:155], v104 offset:0
    ds_read_b64_tr_b16 v[240:241], v108 offset:16384
    ds_read_b64_tr_b16 v[242:243], v108 offset:17408
    v_mfma_f32_32x32x16_bf16 v[192:207], a[244:247], v[164:167], v[192:207]
    ds_read_b64_tr_b16 a[232:233], v109 offset:16384
    ds_read_b64_tr_b16 a[234:235], v109 offset:17408
    v_mfma_f32_32x32x16_bf16 v[208:223], a[248:251], v[164:167], v[208:223]
    ds_read_b64_tr_b16 a[236:237], v110 offset:16384
    ds_read_b64_tr_b16 a[238:239], v110 offset:17408
    v_mfma_f32_32x32x16_bf16 v[224:239], a[252:255], v[164:167], v[224:239]
    ds_read_b64_tr_b16 a[240:241], v111 offset:16384
    ds_read_b64_tr_b16 a[242:243], v111 offset:17408
    buffer_store_dwordx4 v[92:95], v2, s[28:31], s0 offen sc1
    s_waitcnt lgkmcnt(4)
    v_mfma_f32_32x32x16_bf16 v[176:191], v[240:243], v[152:155], v[176:191]
    ds_read_b128 v[156:159], v105 offset:0
    ds_read_b64_tr_b16 v[244:245], v108 offset:20480
    ds_read_b64_tr_b16 v[246:247], v108 offset:21504
    v_mfma_f32_32x32x16_bf16 v[192:207], a[232:235], v[152:155], v[192:207]
    ds_read_b64_tr_b16 a[244:245], v109 offset:20480
    ds_read_b64_tr_b16 a[246:247], v109 offset:21504
    s_waitcnt lgkmcnt(5)
    v_mfma_f32_32x32x16_bf16 v[208:223], a[236:239], v[152:155], v[208:223]
    ds_read_b64_tr_b16 a[248:249], v110 offset:20480
    ds_read_b64_tr_b16 a[250:251], v110 offset:21504
    v_mfma_f32_32x32x16_bf16 v[224:239], a[240:243], v[152:155], v[224:239]
    ds_read_b64_tr_b16 a[252:253], v111 offset:20480
    ds_read_b64_tr_b16 a[254:255], v111 offset:21504
    s_lshl_b32 s0, s46, 9
    s_add_u32 s1, s1, s0
    s_add_u32 s1, s1, 0x7fc00
    s_lshl_b32 s0, s57, 1
    s_add_u32 s0, s0, s46
    s_mul_i32 s0, s0, 72
    s_add_u32 s0, s0, s58
    s_lshl_b32 s0, s0, 9
    s_add_u32 s0, s0, 0x908000
    s_cmp_ge_u32 s46, 2
    s_cselect_b32 s0, s1, s0
    s_waitcnt lgkmcnt(4)
    v_mfma_f32_32x32x16_bf16 v[176:191], v[244:247], v[156:159], v[176:191]
    ds_read_b128 v[160:163], v106 offset:0
    ds_read_b64_tr_b16 v[248:249], v108 offset:24576
    ds_read_b64_tr_b16 v[250:251], v108 offset:25600
    v_mfma_f32_32x32x16_bf16 v[192:207], a[244:247], v[156:159], v[192:207]
    ds_read_b64_tr_b16 a[232:233], v109 offset:24576
    ds_read_b64_tr_b16 a[234:235], v109 offset:25600
    s_waitcnt lgkmcnt(5)
    v_mfma_f32_32x32x16_bf16 v[208:223], a[248:251], v[156:159], v[208:223]
    ds_read_b64_tr_b16 a[236:237], v110 offset:24576
    ds_read_b64_tr_b16 a[238:239], v110 offset:25600
    v_mfma_f32_32x32x16_bf16 v[224:239], a[252:255], v[156:159], v[224:239]
    ds_read_b64_tr_b16 a[240:241], v111 offset:24576
    ds_read_b64_tr_b16 a[242:243], v111 offset:25600
    s_mov_b32 exec_hi, 0
    buffer_store_dwordx4 v[92:95], v2, s[28:31], s0 offen sc1
    s_mov_b64 exec, -1
    s_waitcnt lgkmcnt(4)
    v_mfma_f32_32x32x16_bf16 v[176:191], v[248:251], v[160:163], v[176:191]
    ds_read_b128 v[164:167], v107 offset:0
    ds_read_b64_tr_b16 v[252:253], v108 offset:28672
    ds_read_b64_tr_b16 v[254:255], v108 offset:29696
    v_mfma_f32_32x32x16_bf16 v[192:207], a[232:235], v[160:163], v[192:207]
    ds_read_b64_tr_b16 a[244:245], v109 offset:28672
    ds_read_b64_tr_b16 a[246:247], v109 offset:29696
    s_waitcnt lgkmcnt(5)
    v_mfma_f32_32x32x16_bf16 v[208:223], a[236:239], v[160:163], v[208:223]
    ds_read_b64_tr_b16 a[248:249], v110 offset:28672
    ds_read_b64_tr_b16 a[250:251], v110 offset:29696
    v_mfma_f32_32x32x16_bf16 v[224:239], a[240:243], v[160:163], v[224:239]
    ds_read_b64_tr_b16 a[252:253], v111 offset:28672
    ds_read_b64_tr_b16 a[254:255], v111 offset:29696
    s_waitcnt lgkmcnt(0)
    v_dot2c_f32_bf16 v112, s47, v152
    v_dot2c_f32_bf16 v113, v152, v152
    v_dot2c_f32_bf16 v114, s47, v240
    v_dot2c_f32_bf16 v112, s47, v153
    v_dot2c_f32_bf16 v113, v153, v153
    v_dot2c_f32_bf16 v114, s47, v241
    v_dot2c_f32_bf16 v112, s47, v154
    v_dot2c_f32_bf16 v113, v154, v154
    v_dot2c_f32_bf16 v114, s47, v242
    v_dot2c_f32_bf16 v112, s47, v155
    v_dot2c_f32_bf16 v113, v155, v155
    v_dot2c_f32_bf16 v114, s47, v243
    v_dot2c_f32_bf16 v112, s47, v156
    v_dot2c_f32_bf16 v113, v156, v156
    v_dot2c_f32_bf16 v114, s47, v244
    v_dot2c_f32_bf16 v112, s47, v157
    v_dot2c_f32_bf16 v113, v157, v157
    v_dot2c_f32_bf16 v114, s47, v245
    v_dot2c_f32_bf16 v112, s47, v158
    v_dot2c_f32_bf16 v113, v158, v158
    v_dot2c_f32_bf16 v114, s47, v246
    v_dot2c_f32_bf16 v112, s47, v159
    v_dot2c_f32_bf16 v113, v159, v159
    v_dot2c_f32_bf16 v114, s47, v247
    v_dot2c_f32_bf16 v112, s47, v160
    v_dot2c_f32_bf16 v113, v160, v160
    v_dot2c_f32_bf16 v114, s47, v248
    v_dot2c_f32_bf16 v112, s47, v161
    v_dot2c_f32_bf16 v113, v161, v161
    v_dot2c_f32_bf16 v114, s47, v249
    v_dot2c_f32_bf16 v112, s47, v162
    v_dot2c_f32_bf16 v113, v162, v162
    v_dot2c_f32_bf16 v114, s47, v250
    v_dot2c_f32_bf16 v112, s47, v163
    v_dot2c_f32_bf16 v113, v163, v163
    v_dot2c_f32_bf16 v114, s47, v251
    v_dot2c_f32_bf16 v112, s47, v164
    v_dot2c_f32_bf16 v113, v164, v164
    v_dot2c_f32_bf16 v114, s47, v252
    v_dot2c_f32_bf16 v112, s47, v165
    v_dot2c_f32_bf16 v113, v165, v165
    v_dot2c_f32_bf16 v114, s47, v253
    v_dot2c_f32_bf16 v112, s47, v166
    v_dot2c_f32_bf16 v113, v166, v166
    v_dot2c_f32_bf16 v114, s47, v254
    v_dot2c_f32_bf16 v112, s47, v167
    v_dot2c_f32_bf16 v113, v167, v167
    v_dot2c_f32_bf16 v114, s47, v255
    v_mfma_f32_32x32x16_bf16 v[176:191], v[252:255], v[164:167], v[176:191]
    s_waitcnt vmcnt(10)
    s_barrier
    ds_read_b128 v[152:155], v104 offset:32768
    ds_read_b64_tr_b16 v[240:241], v108 offset:49152
    ds_read_b64_tr_b16 v[242:243], v108 offset:50176
    v_mfma_f32_32x32x16_bf16 v[192:207], a[244:247], v[164:167], v[192:207]
    ds_read_b128 v[156:159], v105 offset:32768
    ds_read_b64_tr_b16 v[244:245], v108 offset:53248
    ds_read_b64_tr_b16 v[246:247], v108 offset:54272
    v_lshlrev_b32 v126, 2, v1
    s_cmp_eq_u32 s46, 0
    s_cselect_b32 s69, 0, 0x8000000
    s_mov_b32 exec_hi, 0
    buffer_load_dword v127, v126, s[40:43], s69 offen sc1
    s_mov_b64 exec, -1
    v_mfma_f32_32x32x16_bf16 v[208:223], a[248:251], v[164:167], v[208:223]
    ds_read_b128 v[160:163], v106 offset:32768
    ds_read_b64_tr_b16 v[248:249], v108 offset:57344
    ds_read_b64_tr_b16 v[250:251], v108 offset:58368
    ds_read_b64_tr_b16 v[252:253], v108 offset:61440
    ds_read_b64_tr_b16 v[254:255], v108 offset:62464
    v_mfma_f32_32x32x16_bf16 v[224:239], a[252:255], v[164:167], v[224:239]
    ds_read_b128 v[164:167], v107 offset:32768
    s_waitcnt lgkmcnt(0)
    ds_read_b64_tr_b16 a[184:185], v109 offset:49152
    ds_read_b64_tr_b16 a[186:187], v109 offset:50176
    ds_read_b64_tr_b16 a[188:189], v109 offset:53248
    ds_read_b64_tr_b16 a[190:191], v109 offset:54272
    ds_read_b64_tr_b16 a[192:193], v109 offset:57344
    ds_read_b64_tr_b16 a[194:195], v109 offset:58368
    ds_read_b64_tr_b16 a[196:197], v109 offset:61440
    ds_read_b64_tr_b16 a[198:199], v109 offset:62464
    ds_read_b64_tr_b16 a[200:201], v110 offset:49152
    ds_read_b64_tr_b16 a[202:203], v110 offset:50176
    ds_read_b64_tr_b16 a[204:205], v110 offset:53248
    ds_read_b64_tr_b16 a[206:207], v110 offset:54272
    v_dot2c_f32_bf16 v112, s47, v152
    v_dot2c_f32_bf16 v113, v152, v152
    v_dot2c_f32_bf16 v114, s47, v240
    v_dot2c_f32_bf16 v112, s47, v153
    v_dot2c_f32_bf16 v113, v153, v153
    v_dot2c_f32_bf16 v114, s47, v241
    v_dot2c_f32_bf16 v112, s47, v154
    v_dot2c_f32_bf16 v113, v154, v154
    v_dot2c_f32_bf16 v114, s47, v242
    v_dot2c_f32_bf16 v112, s47, v155
    v_dot2c_f32_bf16 v113, v155, v155
    v_dot2c_f32_bf16 v114, s47, v243
    v_dot2c_f32_bf16 v112, s47, v156
    v_dot2c_f32_bf16 v113, v156, v156
    v_dot2c_f32_bf16 v114, s47, v244
    v_dot2c_f32_bf16 v112, s47, v157
    v_dot2c_f32_bf16 v113, v157, v157
    v_dot2c_f32_bf16 v114, s47, v245
    v_dot2c_f32_bf16 v112, s47, v158
    v_dot2c_f32_bf16 v113, v158, v158
    v_dot2c_f32_bf16 v114, s47, v246
    v_dot2c_f32_bf16 v112, s47, v159
    v_dot2c_f32_bf16 v113, v159, v159
    v_dot2c_f32_bf16 v114, s47, v247
    v_dot2c_f32_bf16 v112, s47, v160
    v_dot2c_f32_bf16 v113, v160, v160
    v_dot2c_f32_bf16 v114, s47, v248
    v_dot2c_f32_bf16 v112, s47, v161
    v_dot2c_f32_bf16 v113, v161, v161
    v_dot2c_f32_bf16 v114, s47, v249
    v_dot2c_f32_bf16 v112, s47, v162
    v_dot2c_f32_bf16 v113, v162, v162
    v_dot2c_f32_bf16 v114, s47, v250
    v_dot2c_f32_bf16 v112, s47, v163
    v_dot2c_f32_bf16 v113, v163, v163
    v_dot2c_f32_bf16 v114, s47, v251
    v_dot2c_f32_bf16 v112, s47, v164
    v_dot2c_f32_bf16 v113, v164, v164
    v_dot2c_f32_bf16 v114, s47, v252
    v_dot2c_f32_bf16 v112, s47, v165
    v_dot2c_f32_bf16 v113, v165, v165
    v_dot2c_f32_bf16 v114, s47, v253
    v_dot2c_f32_bf16 v112, s47, v166
    v_dot2c_f32_bf16 v113, v166, v166
    v_dot2c_f32_bf16 v114, s47, v254
    v_dot2c_f32_bf16 v112, s47, v167
    v_dot2c_f32_bf16 v113, v167, v167
    v_dot2c_f32_bf16 v114, s47, v255
    ds_read_b64_tr_b16 a[208:209], v110 offset:57344
    ds_read_b64_tr_b16 a[210:211], v110 offset:58368
    ds_read_b64_tr_b16 a[212:213], v110 offset:61440
    ds_read_b64_tr_b16 a[214:215], v110 offset:62464
    ds_read_b64_tr_b16 a[216:217], v111 offset:49152
    ds_read_b64_tr_b16 a[218:219], v111 offset:50176
    ds_read_b64_tr_b16 a[220:221], v111 offset:53248
    ds_read_b64_tr_b16 a[222:223], v111 offset:54272
    ds_read_b64_tr_b16 a[224:225], v111 offset:57344
    ds_read_b64_tr_b16 a[226:227], v111 offset:58368
    ds_read_b64_tr_b16 a[228:229], v111 offset:61440
    ds_read_b64_tr_b16 a[230:231], v111 offset:62464
    v_mfma_f32_32x32x16_bf16 v[176:191], v[240:243], v[152:155], v[176:191]
    v_mov_b32 v115, v114
    v_and_b32 v116, 31, v1
    v_lshlrev_b32 v116, 2, v116
    v_permlane32_swap_b32 v114, v115
    s_lshl_b32 s53, s46, 7
    s_add_u32 s53, s53, 131072
    v_mfma_f32_32x32x16_bf16 v[176:191], v[244:247], v[156:159], v[176:191]
    v_add_f32 v114, v114, v115
    v_add_u32 v117, s53, v116
    ds_write_b32 v117, v114
    v_mov_b32 v115, v112
    v_mov_b32 v118, v113
    v_mfma_f32_32x32x16_bf16 v[176:191], v[248:251], v[160:163], v[176:191]
    v_cmp_gt_u32 vcc, 32, v1
    v_permlane32_swap_b32 v112, v115
    v_permlane32_swap_b32 v113, v118
    v_add_f32 v112, v112, v115
    v_add_f32 v113, v113, v118
    v_mfma_f32_32x32x16_bf16 v[176:191], v[252:255], v[164:167], v[176:191]
    s_waitcnt lgkmcnt(0)
    s_barrier
    v_mfma_f32_32x32x16_bf16 v[192:207], a[184:187], v[152:155], v[192:207]
    s_add_u32 s53, s46, 0
    s_and_b32 s53, s53, 3
    s_lshl_b32 s53, s53, 7
    s_add_u32 s53, s53, 131072
    v_add_u32 v117, s53, v116
    ds_read_b32 v122, v117
    s_add_u32 s53, s46, 1
    s_and_b32 s53, s53, 3
    s_lshl_b32 s53, s53, 7
    s_add_u32 s53, s53, 131072
    v_add_u32 v117, s53, v116
    ds_read_b32 v123, v117
    v_mfma_f32_32x32x16_bf16 v[192:207], a[188:191], v[156:159], v[192:207]
    s_add_u32 s53, s46, 2
    s_and_b32 s53, s53, 3
    s_lshl_b32 s53, s53, 7
    s_add_u32 s53, s53, 131072
    v_add_u32 v117, s53, v116
    ds_read_b32 v124, v117
    s_add_u32 s53, s46, 3
    s_and_b32 s53, s53, 3
    s_lshl_b32 s53, s53, 7
    s_add_u32 s53, s53, 131072
    v_add_u32 v117, s53, v116
    ds_read_b32 v125, v117
    v_mul_f32 v112, 0xbae38e39, v112
    v_mul_f32 v113, 0x3ae38e39, v113
    v_fma_f32 v113, -v112, v112, v113
    v_max_f32 v113, 0, v113
    v_add_f32 v113, 0x3727c5ac, v113
    v_rsq_f32 v113, v113
    v_mfma_f32_32x32x16_bf16 v[192:207], a[192:195], v[160:163], v[192:207]
    v_cndmask_b32 v112, 0, v112, vcc
    v_cvt_pk_bf16_f32 v80, v112, v112
    v_mov_b32 v82, 0
    v_mov_b32 v83, 0
    v_and_b32 v118, 0xffff0000, v80
    v_sub_f32 v118, v112, v118
    v_cvt_pk_bf16_f32 v81, v118, 0
    s_waitcnt lgkmcnt(3)
    v_cvt_pk_bf16_f32 v129, v122, 0
    v_mov_b32 v130, 0
    v_lshlrev_b32 v118, 16, v129
    v_sub_f32 v118, v122, v118
    v_mov_b32 v131, 0
    v_cvt_pk_bf16_f32 v128, v122, v118
    s_waitcnt lgkmcnt(2)
    v_cvt_pk_bf16_f32 v133, v123, 0
    v_mov_b32 v134, 0
    v_mfma_f32_32x32x16_bf16 v[192:207], a[196:199], v[164:167], v[192:207]
    v_lshlrev_b32 v118, 16, v133
    v_sub_f32 v118, v123, v118
    v_mov_b32 v135, 0
    v_cvt_pk_bf16_f32 v132, v123, v118
    s_waitcnt lgkmcnt(1)
    v_cvt_pk_bf16_f32 v137, v124, 0
    v_mov_b32 v138, 0
    v_lshlrev_b32 v118, 16, v137
    v_sub_f32 v118, v124, v118
    v_mov_b32 v139, 0
    v_cvt_pk_bf16_f32 v136, v124, v118
    s_waitcnt lgkmcnt(0)
    v_cvt_pk_bf16_f32 v141, v125, 0
    v_mov_b32 v142, 0
    v_lshlrev_b32 v118, 16, v141
    v_sub_f32 v118, v125, v118
    v_mov_b32 v143, 0
    v_cvt_pk_bf16_f32 v140, v125, v118
    v_mfma_f32_32x32x16_bf16 v[176:191], v[128:131], v[80:83], v[176:191]
    v_mfma_f32_32x32x16_bf16 v[192:207], v[132:135], v[80:83], v[192:207]
    v_mfma_f32_32x32x16_bf16 v[208:223], a[200:203], v[152:155], v[208:223]
    v_mfma_f32_32x32x16_bf16 v[208:223], a[204:207], v[156:159], v[208:223]
    v_lshlrev_b32 v116, 4, v1
    s_lshl_b32 s51, s48, 2
    s_add_u32 s51, s51, s46
    s_mul_i32 s51, s51, 73728
    s_add_u32 s51, s51, 0x100000
    s_add_u32 s53, s46, 0
    s_and_b32 s53, s53, 3
    s_lshl_b32 s54, s49, 2
    s_add_u32 s53, s53, s54
    s_cmp_lt_u32 s53, 18
    s_cselect_b32 s54, 0x3eae1a93, 1.0
    v_mul_f32 v118, s54, v113
    v_mfma_f32_32x32x16_bf16 v[208:223], a[208:211], v[160:163], v[208:223]
    s_lshl_b32 s54, s53, 11
    s_add_u32 s54, s54, s51
    v_mul_f32 v176, v176, v118
    v_mul_f32 v177, v177, v118
    v_mul_f32 v178, v178, v118
    v_mul_f32 v179, v179, v118
    v_mul_f32 v180, v180, v118
    v_mul_f32 v181, v181, v118
    v_mul_f32 v182, v182, v118
    v_mul_f32 v183, v183, v118
    v_cvt_pk_bf16_f32 v176, v176, v177
    v_mfma_f32_32x32x16_bf16 v[208:223], a[212:215], v[164:167], v[208:223]
    v_cvt_pk_bf16_f32 v177, v178, v179
    v_cvt_pk_bf16_f32 v178, v180, v181
    v_cvt_pk_bf16_f32 v179, v182, v183
    buffer_store_dwordx4 v[176:179], v116, s[28:31], s54 offen offset:0 sc1
    v_mul_f32 v184, v184, v118
    v_mul_f32 v185, v185, v118
    v_mul_f32 v186, v186, v118
    v_mul_f32 v187, v187, v118
    v_mul_f32 v188, v188, v118
    v_mfma_f32_32x32x16_bf16 v[208:223], v[136:139], v[80:83], v[208:223]
    v_mul_f32 v189, v189, v118
    v_mul_f32 v190, v190, v118
    v_mul_f32 v191, v191, v118
    v_cvt_pk_bf16_f32 v180, v184, v185
    v_cvt_pk_bf16_f32 v181, v186, v187
    v_cvt_pk_bf16_f32 v182, v188, v189
    v_cvt_pk_bf16_f32 v183, v190, v191
    buffer_store_dwordx4 v[180:183], v116, s[28:31], s54 offen offset:1024 sc1
    v_mfma_f32_32x32x16_bf16 v[224:239], a[216:219], v[152:155], v[224:239]
    s_add_u32 s53, s46, 1
    s_and_b32 s53, s53, 3
    s_lshl_b32 s54, s49, 2
    s_add_u32 s53, s53, s54
    s_cmp_lt_u32 s53, 18
    s_cselect_b32 s54, 0x3eae1a93, 1.0
    v_mul_f32 v118, s54, v113
    s_lshl_b32 s54, s53, 11
    s_add_u32 s54, s54, s51
    v_mfma_f32_32x32x16_bf16 v[224:239], a[220:223], v[156:159], v[224:239]
    v_mul_f32 v192, v192, v118
    v_mul_f32 v193, v193, v118
    v_mul_f32 v194, v194, v118
    v_mul_f32 v195, v195, v118
    v_mul_f32 v196, v196, v118
    v_mul_f32 v197, v197, v118
    v_mul_f32 v198, v198, v118
    v_mfma_f32_32x32x16_bf16 v[224:239], a[224:227], v[160:163], v[224:239]
    v_mul_f32 v199, v199, v118
    v_cvt_pk_bf16_f32 v192, v192, v193
    v_cvt_pk_bf16_f32 v193, v194, v195
    v_cvt_pk_bf16_f32 v194, v196, v197
    v_cvt_pk_bf16_f32 v195, v198, v199
    buffer_store_dwordx4 v[192:195], v116, s[28:31], s54 offen offset:0 sc1
    v_mfma_f32_32x32x16_bf16 v[224:239], a[228:231], v[164:167], v[224:239]
    v_mul_f32 v200, v200, v118
    v_mul_f32 v201, v201, v118
    v_mul_f32 v202, v202, v118
    v_mul_f32 v203, v203, v118
    v_mul_f32 v204, v204, v118
    v_mul_f32 v205, v205, v118
    v_mul_f32 v206, v206, v118
    v_mul_f32 v207, v207, v118
    v_mfma_f32_32x32x16_bf16 v[224:239], v[140:143], v[80:83], v[224:239]
    v_cvt_pk_bf16_f32 v196, v200, v201
    v_cvt_pk_bf16_f32 v197, v202, v203
    v_cvt_pk_bf16_f32 v198, v204, v205
    v_cvt_pk_bf16_f32 v199, v206, v207
    buffer_store_dwordx4 v[196:199], v116, s[28:31], s54 offen offset:1024 sc1
    s_add_u32 s53, s46, 2
    s_and_b32 s53, s53, 3
    s_lshl_b32 s54, s49, 2
    s_add_u32 s53, s53, s54
    s_cmp_lt_u32 s53, 18
    s_cselect_b32 s54, 0x3eae1a93, 1.0
    v_mul_f32 v118, s54, v113
    s_lshl_b32 s54, s53, 11
    s_add_u32 s54, s54, s51
    v_pk_mul_f32 v[208:209], v[208:209], v[118:119] op_sel_hi:[1,0]
    v_pk_mul_f32 v[210:211], v[210:211], v[118:119] op_sel_hi:[1,0]
    v_pk_mul_f32 v[212:213], v[212:213], v[118:119] op_sel_hi:[1,0]
    v_pk_mul_f32 v[214:215], v[214:215], v[118:119] op_sel_hi:[1,0]
    v_cvt_pk_bf16_f32 v208, v208, v209
    v_cvt_pk_bf16_f32 v209, v210, v211
    v_cvt_pk_bf16_f32 v210, v212, v213
    v_cvt_pk_bf16_f32 v211, v214, v215
    buffer_store_dwordx4 v[208:211], v116, s[28:31], s54 offen offset:0 sc1
    v_pk_mul_f32 v[216:217], v[216:217], v[118:119] op_sel_hi:[1,0]
    v_pk_mul_f32 v[218:219], v[218:219], v[118:119] op_sel_hi:[1,0]
    v_pk_mul_f32 v[220:221], v[220:221], v[118:119] op_sel_hi:[1,0]
    v_pk_mul_f32 v[222:223], v[222:223], v[118:119] op_sel_hi:[1,0]
    v_cvt_pk_bf16_f32 v212, v216, v217
    v_cvt_pk_bf16_f32 v213, v218, v219
    v_cvt_pk_bf16_f32 v214, v220, v221
    v_cvt_pk_bf16_f32 v215, v222, v223
    buffer_store_dwordx4 v[212:215], v116, s[28:31], s54 offen offset:1024 sc1
    s_add_u32 s53, s46, 3
    s_and_b32 s53, s53, 3
    s_lshl_b32 s54, s49, 2
    s_add_u32 s53, s53, s54
    s_cmp_lt_u32 s53, 18
    s_cselect_b32 s54, 0x3eae1a93, 1.0
    v_mul_f32 v118, s54, v113
    s_lshl_b32 s54, s53, 11
    s_add_u32 s54, s54, s51
    v_pk_mul_f32 v[224:225], v[224:225], v[118:119] op_sel_hi:[1,0]
    v_pk_mul_f32 v[226:227], v[226:227], v[118:119] op_sel_hi:[1,0]
    v_pk_mul_f32 v[228:229], v[228:229], v[118:119] op_sel_hi:[1,0]
    v_pk_mul_f32 v[230:231], v[230:231], v[118:119] op_sel_hi:[1,0]
    v_cvt_pk_bf16_f32 v224, v224, v225
    v_cvt_pk_bf16_f32 v225, v226, v227
    v_cvt_pk_bf16_f32 v226, v228, v229
    v_cvt_pk_bf16_f32 v227, v230, v231
    buffer_store_dwordx4 v[224:227], v116, s[28:31], s54 offen offset:0 sc1
    v_pk_mul_f32 v[232:233], v[232:233], v[118:119] op_sel_hi:[1,0]
    v_pk_mul_f32 v[234:235], v[234:235], v[118:119] op_sel_hi:[1,0]
    v_pk_mul_f32 v[236:237], v[236:237], v[118:119] op_sel_hi:[1,0]
    v_pk_mul_f32 v[238:239], v[238:239], v[118:119] op_sel_hi:[1,0]
    v_cvt_pk_bf16_f32 v228, v232, v233
    v_cvt_pk_bf16_f32 v229, v234, v235
    v_cvt_pk_bf16_f32 v230, v236, v237
    v_cvt_pk_bf16_f32 v231, v238, v239
    buffer_store_dwordx4 v[228:231], v116, s[28:31], s54 offen offset:1024 sc1
    s_branch L_p1done
L_p1v:
    v_and_b32 v115, 31, v1
    v_lshlrev_b32 v115, 7, v115
    v_add_u32 v115, s55, v115
    v_bfe_u32 v116, v1, 1, 3
    v_lshrrev_b32 v117, 5, v1
    v_xor_b32 v116, v116, v117
    v_xor_b32 v118, 0, v116
    v_lshl_add_u32 v104, v118, 4, v115
    v_xor_b32 v118, 2, v116
    v_lshl_add_u32 v105, v118, 4, v115
    v_xor_b32 v118, 4, v116
    v_lshl_add_u32 v106, v118, 4, v115
    v_xor_b32 v118, 6, v116
    v_lshl_add_u32 v107, v118, 4, v115
    v_bfe_u32 v115, v1, 2, 2
    v_lshl_add_u32 v116, v117, 3, v115
    v_lshlrev_b32 v116, 8, v116
    v_bfe_u32 v118, v1, 4, 1
    v_lshl_add_u32 v116, v118, 5, v116
    v_and_b32 v118, 3, v1
    v_lshl_add_u32 v116, v118, 3, v116
    s_add_u32 s53, s46, 0
    s_and_b32 s53, s53, 3
    v_xor_b32 v118, s53, v115
    v_lshl_add_u32 v108, v118, 6, v116
    s_add_u32 s53, s46, 1
    s_and_b32 s53, s53, 3
    v_xor_b32 v118, s53, v115
    v_lshl_add_u32 v109, v118, 6, v116
    s_add_u32 s53, s46, 2
    s_and_b32 s53, s53, 3
    v_xor_b32 v118, s53, v115
    v_lshl_add_u32 v110, v118, 6, v116
    s_add_u32 s53, s46, 3
    s_and_b32 s53, s53, 3
    v_xor_b32 v118, s53, v115
    v_lshl_add_u32 v111, v118, 6, v116
    v_mov_b32 v112, 0
    v_mov_b32 v113, 0
    v_mov_b32 v114, 0
    s_waitcnt vmcnt(8)
    s_barrier
    ds_read_b128 v[152:155], v104 offset:0
    ds_read_b64_tr_b16 v[240:241], v108 offset:16384
    ds_read_b64_tr_b16 v[242:243], v108 offset:17408
    ds_read_b64_tr_b16 a[232:233], v109 offset:16384
    ds_read_b64_tr_b16 a[234:235], v109 offset:17408
    ds_read_b64_tr_b16 a[236:237], v110 offset:16384
    ds_read_b64_tr_b16 a[238:239], v110 offset:17408
    ds_read_b64_tr_b16 a[240:241], v111 offset:16384
    ds_read_b64_tr_b16 a[242:243], v111 offset:17408
    s_waitcnt lgkmcnt(4)
    v_mfma_f32_32x32x16_bf16 v[176:191], v[152:155], v[240:243], 0
    ds_read_b128 v[156:159], v105 offset:0
    ds_read_b64_tr_b16 v[244:245], v108 offset:20480
    ds_read_b64_tr_b16 v[246:247], v108 offset:21504
    s_lshl_b32 s53, s50, 7
    s_add_u32 s53, s53, s51
    s_add_u32 m0, s55, 65536
    s_mul_i32 s54, s50, 221184
    buffer_load_dwordx4 v96, s[36:39], s53 offen offset:0 lds
    buffer_load_dwordx4 v97, s[36:39], s53 offen offset:1024 lds
    v_mfma_f32_32x32x16_bf16 v[192:207], v[152:155], a[232:235], 0
    ds_read_b64_tr_b16 a[244:245], v109 offset:20480
    ds_read_b64_tr_b16 a[246:247], v109 offset:21504
    buffer_load_dwordx4 v98, s[36:39], s53 offen offset:2048 lds
    buffer_load_dwordx4 v99, s[36:39], s53 offen offset:3072 lds
    s_add_u32 m0, s55, 81920
    s_waitcnt lgkmcnt(5)
    v_mfma_f32_32x32x16_bf16 v[208:223], v[152:155], a[236:239], 0
    ds_read_b64_tr_b16 a[248:249], v110 offset:20480
    ds_read_b64_tr_b16 a[250:251], v110 offset:21504
    s_add_u32 s54, s54, s52
    buffer_load_dwordx4 v100, s[32:35], s54 offen offset:0 lds
    buffer_load_dwordx4 v101, s[32:35], s54 offen offset:1024 lds
    v_mfma_f32_32x32x16_bf16 v[224:239], v[152:155], a[240:243], 0
    ds_read_b64_tr_b16 a[252:253], v111 offset:20480
    ds_read_b64_tr_b16 a[254:255], v111 offset:21504
    buffer_load_dwordx4 v102, s[32:35], s54 offen offset:2048 lds
    buffer_load_dwordx4 v103, s[32:35], s54 offen offset:3072 lds
    s_add_u32 s50, s50, 1
    s_cmp_eq_u32 s50, 9
    s_cselect_b32 s50, 0, s50
    s_waitcnt lgkmcnt(4)
    v_mfma_f32_32x32x16_bf16 v[176:191], v[156:159], v[244:247], v[176:191]
    ds_read_b128 v[160:163], v106 offset:0
    ds_read_b64_tr_b16 v[248:249], v108 offset:24576
    ds_read_b64_tr_b16 v[250:251], v108 offset:25600
    s_lshl_b32 s53, s50, 7
    s_add_u32 s53, s53, s51
    s_add_u32 m0, s55, 98304
    s_mul_i32 s54, s50, 221184
    buffer_load_dwordx4 v96, s[36:39], s53 offen offset:0 lds
    buffer_load_dwordx4 v97, s[36:39], s53 offen offset:1024 lds
    v_mfma_f32_32x32x16_bf16 v[192:207], v[156:159], a[244:247], v[192:207]
    ds_read_b64_tr_b16 a[232:233], v109 offset:24576
    ds_read_b64_tr_b16 a[234:235], v109 offset:25600
    buffer_load_dwordx4 v98, s[36:39], s53 offen offset:2048 lds
    buffer_load_dwordx4 v99, s[36:39], s53 offen offset:3072 lds
    s_add_u32 m0, s55, 114688
    s_waitcnt lgkmcnt(5)
    v_mfma_f32_32x32x16_bf16 v[208:223], v[156:159], a[248:251], v[208:223]
    ds_read_b64_tr_b16 a[236:237], v110 offset:24576
    ds_read_b64_tr_b16 a[238:239], v110 offset:25600
    s_add_u32 s54, s54, s52
    buffer_load_dwordx4 v100, s[32:35], s54 offen offset:0 lds
    buffer_load_dwordx4 v101, s[32:35], s54 offen offset:1024 lds
    v_mfma_f32_32x32x16_bf16 v[224:239], v[156:159], a[252:255], v[224:239]
    ds_read_b64_tr_b16 a[240:241], v111 offset:24576
    ds_read_b64_tr_b16 a[242:243], v111 offset:25600
    buffer_load_dwordx4 v102, s[32:35], s54 offen offset:2048 lds
    buffer_load_dwordx4 v103, s[32:35], s54 offen offset:3072 lds
    s_add_u32 s50, s50, 1
    s_cmp_eq_u32 s50, 9
    s_cselect_b32 s50, 0, s50
    s_waitcnt lgkmcnt(4)
    v_mfma_f32_32x32x16_bf16 v[176:191], v[160:163], v[248:251], v[176:191]
    ds_read_b128 v[164:167], v107 offset:0
    ds_read_b64_tr_b16 v[252:253], v108 offset:28672
    ds_read_b64_tr_b16 v[254:255], v108 offset:29696
    s_lshl_b32 s53, s50, 7
    s_add_u32 s53, s53, s51
    s_add_u32 m0, s55, 131072
    s_mul_i32 s54, s50, 221184
    buffer_load_dwordx4 v96, s[36:39], s53 offen offset:0 lds
    buffer_load_dwordx4 v97, s[36:39], s53 offen offset:1024 lds
    v_mfma_f32_32x32x16_bf16 v[192:207], v[160:163], a[232:235], v[192:207]
    ds_read_b64_tr_b16 a[244:245], v109 offset:28672
    ds_read_b64_tr_b16 a[246:247], v109 offset:29696
    buffer_load_dwordx4 v98, s[36:39], s53 offen offset:2048 lds
    buffer_load_dwordx4 v99, s[36:39], s53 offen offset:3072 lds
    s_add_u32 m0, s55, 147456
    s_waitcnt lgkmcnt(5)
    v_mfma_f32_32x32x16_bf16 v[208:223], v[160:163], a[236:239], v[208:223]
    ds_read_b64_tr_b16 a[248:249], v110 offset:28672
    ds_read_b64_tr_b16 a[250:251], v110 offset:29696
    s_add_u32 s54, s54, s52
    buffer_load_dwordx4 v100, s[32:35], s54 offen offset:0 lds
    buffer_load_dwordx4 v101, s[32:35], s54 offen offset:1024 lds
    v_mfma_f32_32x32x16_bf16 v[224:239], v[160:163], a[240:243], v[224:239]
    ds_read_b64_tr_b16 a[252:253], v111 offset:28672
    ds_read_b64_tr_b16 a[254:255], v111 offset:29696
    buffer_load_dwordx4 v102, s[32:35], s54 offen offset:2048 lds
    buffer_load_dwordx4 v103, s[32:35], s54 offen offset:3072 lds
    s_add_u32 s50, s50, 1
    s_cmp_eq_u32 s50, 9
    s_cselect_b32 s50, 0, s50
    s_waitcnt lgkmcnt(0)
    v_dot2c_f32_bf16 v112, s47, v152
    v_dot2c_f32_bf16 v113, v152, v152
    v_dot2c_f32_bf16 v114, s47, v240
    v_dot2c_f32_bf16 v112, s47, v153
    v_dot2c_f32_bf16 v113, v153, v153
    v_dot2c_f32_bf16 v114, s47, v241
    v_dot2c_f32_bf16 v112, s47, v154
    v_dot2c_f32_bf16 v113, v154, v154
    v_dot2c_f32_bf16 v114, s47, v242
    v_dot2c_f32_bf16 v112, s47, v155
    v_dot2c_f32_bf16 v113, v155, v155
    v_dot2c_f32_bf16 v114, s47, v243
    v_dot2c_f32_bf16 v112, s47, v156
    v_dot2c_f32_bf16 v113, v156, v156
    v_dot2c_f32_bf16 v114, s47, v244
    v_dot2c_f32_bf16 v112, s47, v157
    v_dot2c_f32_bf16 v113, v157, v157
    v_dot2c_f32_bf16 v114, s47, v245
    v_dot2c_f32_bf16 v112, s47, v158
    v_dot2c_f32_bf16 v113, v158, v158
    v_dot2c_f32_bf16 v114, s47, v246
    v_dot2c_f32_bf16 v112, s47, v159
    v_dot2c_f32_bf16 v113, v159, v159
    v_dot2c_f32_bf16 v114, s47, v247
    v_dot2c_f32_bf16 v112, s47, v160
    v_dot2c_f32_bf16 v113, v160, v160
    v_dot2c_f32_bf16 v114, s47, v248
    v_dot2c_f32_bf16 v112, s47, v161
    v_dot2c_f32_bf16 v113, v161, v161
    v_dot2c_f32_bf16 v114, s47, v249
    v_dot2c_f32_bf16 v112, s47, v162
    v_dot2c_f32_bf16 v113, v162, v162
    v_dot2c_f32_bf16 v114, s47, v250
    v_dot2c_f32_bf16 v112, s47, v163
    v_dot2c_f32_bf16 v113, v163, v163
    v_dot2c_f32_bf16 v114, s47, v251
    v_dot2c_f32_bf16 v112, s47, v164
    v_dot2c_f32_bf16 v113, v164, v164
    v_dot2c_f32_bf16 v114, s47, v252
    v_dot2c_f32_bf16 v112, s47, v165
    v_dot2c_f32_bf16 v113, v165, v165
    v_dot2c_f32_bf16 v114, s47, v253
    v_dot2c_f32_bf16 v112, s47, v166
    v_dot2c_f32_bf16 v113, v166, v166
    v_dot2c_f32_bf16 v114, s47, v254
    v_dot2c_f32_bf16 v112, s47, v167
    v_dot2c_f32_bf16 v113, v167, v167
    v_dot2c_f32_bf16 v114, s47, v255
    v_mfma_f32_32x32x16_bf16 v[176:191], v[164:167], v[252:255], v[176:191]
    s_waitcnt vmcnt(24)
    s_barrier
    ds_read_b128 v[152:155], v104 offset:32768
    ds_read_b64_tr_b16 v[240:241], v108 offset:49152
    ds_read_b64_tr_b16 v[242:243], v108 offset:50176
    s_lshl_b32 s53, s50, 7
    s_add_u32 s53, s53, s51
    s_add_u32 m0, s55, 0
    s_mul_i32 s54, s50, 221184
    v_mfma_f32_32x32x16_bf16 v[192:207], v[164:167], a[244:247], v[192:207]
    ds_read_b64_tr_b16 a[232:233], v109 offset:49152
    ds_read_b64_tr_b16 a[234:235], v109 offset:50176
    buffer_load_dwordx4 v96, s[36:39], s53 offen offset:0 lds
    v_mfma_f32_32x32x16_bf16 v[208:223], v[164:167], a[248:251], v[208:223]
    ds_read_b64_tr_b16 a[236:237], v110 offset:49152
    ds_read_b64_tr_b16 a[238:239], v110 offset:50176
    v_mfma_f32_32x32x16_bf16 v[224:239], v[164:167], a[252:255], v[224:239]
    ds_read_b64_tr_b16 a[240:241], v111 offset:49152
    ds_read_b64_tr_b16 a[242:243], v111 offset:50176
    buffer_load_dwordx4 v97, s[36:39], s53 offen offset:1024 lds
    s_waitcnt lgkmcnt(4)
    v_mfma_f32_32x32x16_bf16 v[176:191], v[152:155], v[240:243], v[176:191]
    ds_read_b128 v[156:159], v105 offset:32768
    ds_read_b64_tr_b16 v[244:245], v108 offset:53248
    ds_read_b64_tr_b16 v[246:247], v108 offset:54272
    buffer_load_dwordx4 v98, s[36:39], s53 offen offset:2048 lds
    v_mfma_f32_32x32x16_bf16 v[192:207], v[152:155], a[232:235], v[192:207]
    ds_read_b64_tr_b16 a[244:245], v109 offset:53248
    ds_read_b64_tr_b16 a[246:247], v109 offset:54272
    buffer_load_dwordx4 v99, s[36:39], s53 offen offset:3072 lds
    s_waitcnt lgkmcnt(5)
    v_mfma_f32_32x32x16_bf16 v[208:223], v[152:155], a[236:239], v[208:223]
    ds_read_b64_tr_b16 a[248:249], v110 offset:53248
    ds_read_b64_tr_b16 a[250:251], v110 offset:54272
    s_add_u32 m0, s55, 16384
    s_add_u32 s54, s54, s52
    v_mfma_f32_32x32x16_bf16 v[224:239], v[152:155], a[240:243], v[224:239]
    ds_read_b64_tr_b16 a[252:253], v111 offset:53248
    ds_read_b64_tr_b16 a[254:255], v111 offset:54272
    buffer_load_dwordx4 v100, s[32:35], s54 offen offset:0 lds
    s_waitcnt lgkmcnt(4)
    v_mfma_f32_32x32x16_bf16 v[176:191], v[156:159], v[244:247], v[176:191]
    ds_read_b128 v[160:163], v106 offset:32768
    ds_read_b64_tr_b16 v[248:249], v108 offset:57344
    ds_read_b64_tr_b16 v[250:251], v108 offset:58368
    buffer_load_dwordx4 v101, s[32:35], s54 offen offset:1024 lds
    v_mfma_f32_32x32x16_bf16 v[192:207], v[156:159], a[244:247], v[192:207]
    ds_read_b64_tr_b16 a[232:233], v109 offset:57344
    ds_read_b64_tr_b16 a[234:235], v109 offset:58368
    s_waitcnt lgkmcnt(5)
    v_mfma_f32_32x32x16_bf16 v[208:223], v[156:159], a[248:251], v[208:223]
    ds_read_b64_tr_b16 a[236:237], v110 offset:57344
    ds_read_b64_tr_b16 a[238:239], v110 offset:58368
    buffer_load_dwordx4 v102, s[32:35], s54 offen offset:2048 lds
    v_mfma_f32_32x32x16_bf16 v[224:239], v[156:159], a[252:255], v[224:239]
    ds_read_b64_tr_b16 a[240:241], v111 offset:57344
    ds_read_b64_tr_b16 a[242:243], v111 offset:58368
    buffer_load_dwordx4 v103, s[32:35], s54 offen offset:3072 lds
    s_waitcnt lgkmcnt(4)
    v_mfma_f32_32x32x16_bf16 v[176:191], v[160:163], v[248:251], v[176:191]
    ds_read_b128 v[164:167], v107 offset:32768
    ds_read_b64_tr_b16 v[252:253], v108 offset:61440
    ds_read_b64_tr_b16 v[254:255], v108 offset:62464
    s_add_u32 s50, s50, 1
    s_cmp_eq_u32 s50, 9
    s_cselect_b32 s50, 0, s50
    v_mfma_f32_32x32x16_bf16 v[192:207], v[160:163], a[232:235], v[192:207]
    ds_read_b64_tr_b16 a[244:245], v109 offset:61440
    ds_read_b64_tr_b16 a[246:247], v109 offset:62464
    s_waitcnt lgkmcnt(5)
    v_mfma_f32_32x32x16_bf16 v[208:223], v[160:163], a[236:239], v[208:223]
    ds_read_b64_tr_b16 a[248:249], v110 offset:61440
    ds_read_b64_tr_b16 a[250:251], v110 offset:62464
    v_mfma_f32_32x32x16_bf16 v[224:239], v[160:163], a[240:243], v[224:239]
    ds_read_b64_tr_b16 a[252:253], v111 offset:61440
    ds_read_b64_tr_b16 a[254:255], v111 offset:62464
    s_waitcnt lgkmcnt(0)
    v_dot2c_f32_bf16 v112, s47, v152
    v_dot2c_f32_bf16 v113, v152, v152
    v_dot2c_f32_bf16 v114, s47, v240
    v_dot2c_f32_bf16 v112, s47, v153
    v_dot2c_f32_bf16 v113, v153, v153
    v_dot2c_f32_bf16 v114, s47, v241
    v_dot2c_f32_bf16 v112, s47, v154
    v_dot2c_f32_bf16 v113, v154, v154
    v_dot2c_f32_bf16 v114, s47, v242
    v_dot2c_f32_bf16 v112, s47, v155
    v_dot2c_f32_bf16 v113, v155, v155
    v_dot2c_f32_bf16 v114, s47, v243
    v_dot2c_f32_bf16 v112, s47, v156
    v_dot2c_f32_bf16 v113, v156, v156
    v_dot2c_f32_bf16 v114, s47, v244
    v_dot2c_f32_bf16 v112, s47, v157
    v_dot2c_f32_bf16 v113, v157, v157
    v_dot2c_f32_bf16 v114, s47, v245
    v_dot2c_f32_bf16 v112, s47, v158
    v_dot2c_f32_bf16 v113, v158, v158
    v_dot2c_f32_bf16 v114, s47, v246
    v_dot2c_f32_bf16 v112, s47, v159
    v_dot2c_f32_bf16 v113, v159, v159
    v_dot2c_f32_bf16 v114, s47, v247
    v_dot2c_f32_bf16 v112, s47, v160
    v_dot2c_f32_bf16 v113, v160, v160
    v_dot2c_f32_bf16 v114, s47, v248
    v_dot2c_f32_bf16 v112, s47, v161
    v_dot2c_f32_bf16 v113, v161, v161
    v_dot2c_f32_bf16 v114, s47, v249
    v_dot2c_f32_bf16 v112, s47, v162
    v_dot2c_f32_bf16 v113, v162, v162
    v_dot2c_f32_bf16 v114, s47, v250
    v_dot2c_f32_bf16 v112, s47, v163
    v_dot2c_f32_bf16 v113, v163, v163
    v_dot2c_f32_bf16 v114, s47, v251
    v_dot2c_f32_bf16 v112, s47, v164
    v_dot2c_f32_bf16 v113, v164, v164
    v_dot2c_f32_bf16 v114, s47, v252
    v_dot2c_f32_bf16 v112, s47, v165
    v_dot2c_f32_bf16 v113, v165, v165
    v_dot2c_f32_bf16 v114, s47, v253
    v_dot2c_f32_bf16 v112, s47, v166
    v_dot2c_f32_bf16 v113, v166, v166
    v_dot2c_f32_bf16 v114, s47, v254
    v_dot2c_f32_bf16 v112, s47, v167
    v_dot2c_f32_bf16 v113, v167, v167
    v_dot2c_f32_bf16 v114, s47, v255
    v_mfma_f32_32x32x16_bf16 v[176:191], v[164:167], v[252:255], v[176:191]
    s_waitcnt vmcnt(24)
    s_barrier
    v_add_u32 v104, 0x10000, v104
    v_add_u32 v105, 0x10000, v105
    v_add_u32 v106, 0x10000, v106
    v_add_u32 v107, 0x10000, v107
    v_add_u32 v108, 0x10000, v108
    v_add_u32 v109, 0x10000, v109
    v_add_u32 v110, 0x10000, v110
    v_add_u32 v111, 0x10000, v111
    ds_read_b128 v[152:155], v104 offset:0
    ds_read_b64_tr_b16 v[240:241], v108 offset:16384
    ds_read_b64_tr_b16 v[242:243], v108 offset:17408
    s_lshl_b32 s53, s50, 7
    s_add_u32 s53, s53, s51
    s_add_u32 m0, s55, 32768
    s_mul_i32 s54, s50, 221184
    v_mfma_f32_32x32x16_bf16 v[192:207], v[164:167], a[244:247], v[192:207]
    ds_read_b64_tr_b16 a[232:233], v109 offset:16384
    ds_read_b64_tr_b16 a[234:235], v109 offset:17408
    buffer_load_dwordx4 v96, s[36:39], s53 offen offset:0 lds
    v_mfma_f32_32x32x16_bf16 v[208:223], v[164:167], a[248:251], v[208:223]
    ds_read_b64_tr_b16 a[236:237], v110 offset:16384
    ds_read_b64_tr_b16 a[238:239], v110 offset:17408
    v_mfma_f32_32x32x16_bf16 v[224:239], v[164:167], a[252:255], v[224:239]
    ds_read_b64_tr_b16 a[240:241], v111 offset:16384
    ds_read_b64_tr_b16 a[242:243], v111 offset:17408
    buffer_load_dwordx4 v97, s[36:39], s53 offen offset:1024 lds
    s_waitcnt lgkmcnt(4)
    v_mfma_f32_32x32x16_bf16 v[176:191], v[152:155], v[240:243], v[176:191]
    ds_read_b128 v[156:159], v105 offset:0
    ds_read_b64_tr_b16 v[244:245], v108 offset:20480
    ds_read_b64_tr_b16 v[246:247], v108 offset:21504
    buffer_load_dwordx4 v98, s[36:39], s53 offen offset:2048 lds
    v_mfma_f32_32x32x16_bf16 v[192:207], v[152:155], a[232:235], v[192:207]
    ds_read_b64_tr_b16 a[244:245], v109 offset:20480
    ds_read_b64_tr_b16 a[246:247], v109 offset:21504
    buffer_load_dwordx4 v99, s[36:39], s53 offen offset:3072 lds
    s_waitcnt lgkmcnt(5)
    v_mfma_f32_32x32x16_bf16 v[208:223], v[152:155], a[236:239], v[208:223]
    ds_read_b64_tr_b16 a[248:249], v110 offset:20480
    ds_read_b64_tr_b16 a[250:251], v110 offset:21504
    s_add_u32 m0, s55, 49152
    s_add_u32 s54, s54, s52
    v_mfma_f32_32x32x16_bf16 v[224:239], v[152:155], a[240:243], v[224:239]
    ds_read_b64_tr_b16 a[252:253], v111 offset:20480
    ds_read_b64_tr_b16 a[254:255], v111 offset:21504
    buffer_load_dwordx4 v100, s[32:35], s54 offen offset:0 lds
    s_waitcnt lgkmcnt(4)
    v_mfma_f32_32x32x16_bf16 v[176:191], v[156:159], v[244:247], v[176:191]
    ds_read_b128 v[160:163], v106 offset:0
    ds_read_b64_tr_b16 v[248:249], v108 offset:24576
    ds_read_b64_tr_b16 v[250:251], v108 offset:25600
    buffer_load_dwordx4 v101, s[32:35], s54 offen offset:1024 lds
    v_mfma_f32_32x32x16_bf16 v[192:207], v[156:159], a[244:247], v[192:207]
    ds_read_b64_tr_b16 a[232:233], v109 offset:24576
    ds_read_b64_tr_b16 a[234:235], v109 offset:25600
    s_waitcnt lgkmcnt(5)
    v_mfma_f32_32x32x16_bf16 v[208:223], v[156:159], a[248:251], v[208:223]
    ds_read_b64_tr_b16 a[236:237], v110 offset:24576
    ds_read_b64_tr_b16 a[238:239], v110 offset:25600
    buffer_load_dwordx4 v102, s[32:35], s54 offen offset:2048 lds
    v_mfma_f32_32x32x16_bf16 v[224:239], v[156:159], a[252:255], v[224:239]
    ds_read_b64_tr_b16 a[240:241], v111 offset:24576
    ds_read_b64_tr_b16 a[242:243], v111 offset:25600
    buffer_load_dwordx4 v103, s[32:35], s54 offen offset:3072 lds
    s_waitcnt lgkmcnt(4)
    v_mfma_f32_32x32x16_bf16 v[176:191], v[160:163], v[248:251], v[176:191]
    ds_read_b128 v[164:167], v107 offset:0
    ds_read_b64_tr_b16 v[252:253], v108 offset:28672
    ds_read_b64_tr_b16 v[254:255], v108 offset:29696
    s_add_u32 s50, s50, 1
    s_cmp_eq_u32 s50, 9
    s_cselect_b32 s50, 0, s50
    v_mfma_f32_32x32x16_bf16 v[192:207], v[160:163], a[232:235], v[192:207]
    ds_read_b64_tr_b16 a[244:245], v109 offset:28672
    ds_read_b64_tr_b16 a[246:247], v109 offset:29696
    s_waitcnt lgkmcnt(5)
    v_mfma_f32_32x32x16_bf16 v[208:223], v[160:163], a[236:239], v[208:223]
    ds_read_b64_tr_b16 a[248:249], v110 offset:28672
    ds_read_b64_tr_b16 a[250:251], v110 offset:29696
    v_mfma_f32_32x32x16_bf16 v[224:239], v[160:163], a[240:243], v[224:239]
    ds_read_b64_tr_b16 a[252:253], v111 offset:28672
    ds_read_b64_tr_b16 a[254:255], v111 offset:29696
    s_waitcnt lgkmcnt(0)
    v_dot2c_f32_bf16 v112, s47, v152
    v_dot2c_f32_bf16 v113, v152, v152
    v_dot2c_f32_bf16 v114, s47, v240
    v_dot2c_f32_bf16 v112, s47, v153
    v_dot2c_f32_bf16 v113, v153, v153
    v_dot2c_f32_bf16 v114, s47, v241
    v_dot2c_f32_bf16 v112, s47, v154
    v_dot2c_f32_bf16 v113, v154, v154
    v_dot2c_f32_bf16 v114, s47, v242
    v_dot2c_f32_bf16 v112, s47, v155
    v_dot2c_f32_bf16 v113, v155, v155
    v_dot2c_f32_bf16 v114, s47, v243
    v_dot2c_f32_bf16 v112, s47, v156
    v_dot2c_f32_bf16 v113, v156, v156
    v_dot2c_f32_bf16 v114, s47, v244
    v_dot2c_f32_bf16 v112, s47, v157
    v_dot2c_f32_bf16 v113, v157, v157
    v_dot2c_f32_bf16 v114, s47, v245
    v_dot2c_f32_bf16 v112, s47, v158
    v_dot2c_f32_bf16 v113, v158, v158
    v_dot2c_f32_bf16 v114, s47, v246
    v_dot2c_f32_bf16 v112, s47, v159
    v_dot2c_f32_bf16 v113, v159, v159
    v_dot2c_f32_bf16 v114, s47, v247
    v_dot2c_f32_bf16 v112, s47, v160
    v_dot2c_f32_bf16 v113, v160, v160
    v_dot2c_f32_bf16 v114, s47, v248
    v_dot2c_f32_bf16 v112, s47, v161
    v_dot2c_f32_bf16 v113, v161, v161
    v_dot2c_f32_bf16 v114, s47, v249
    v_dot2c_f32_bf16 v112, s47, v162
    v_dot2c_f32_bf16 v113, v162, v162
    v_dot2c_f32_bf16 v114, s47, v250
    v_dot2c_f32_bf16 v112, s47, v163
    v_dot2c_f32_bf16 v113, v163, v163
    v_dot2c_f32_bf16 v114, s47, v251
    v_dot2c_f32_bf16 v112, s47, v164
    v_dot2c_f32_bf16 v113, v164, v164
    v_dot2c_f32_bf16 v114, s47, v252
    v_dot2c_f32_bf16 v112, s47, v165
    v_dot2c_f32_bf16 v113, v165, v165
    v_dot2c_f32_bf16 v114, s47, v253
    v_dot2c_f32_bf16 v112, s47, v166
    v_dot2c_f32_bf16 v113, v166, v166
    v_dot2c_f32_bf16 v114, s47, v254
    v_dot2c_f32_bf16 v112, s47, v167
    v_dot2c_f32_bf16 v113, v167, v167
    v_dot2c_f32_bf16 v114, s47, v255
    v_mfma_f32_32x32x16_bf16 v[176:191], v[164:167], v[252:255], v[176:191]
    s_waitcnt vmcnt(24)
    s_barrier
    ds_read_b128 v[152:155], v104 offset:32768
    ds_read_b64_tr_b16 v[240:241], v108 offset:49152
    ds_read_b64_tr_b16 v[242:243], v108 offset:50176
    s_lshl_b32 s53, s50, 7
    s_add_u32 s53, s53, s51
    s_add_u32 m0, s55, 65536
    s_mul_i32 s54, s50, 221184
    v_mfma_f32_32x32x16_bf16 v[192:207], v[164:167], a[244:247], v[192:207]
    ds_read_b64_tr_b16 a[232:233], v109 offset:49152
    ds_read_b64_tr_b16 a[234:235], v109 offset:50176
    buffer_load_dwordx4 v96, s[36:39], s53 offen offset:0 lds
    v_mfma_f32_32x32x16_bf16 v[208:223], v[164:167], a[248:251], v[208:223]
    ds_read_b64_tr_b16 a[236:237], v110 offset:49152
    ds_read_b64_tr_b16 a[238:239], v110 offset:50176
    v_mfma_f32_32x32x16_bf16 v[224:239], v[164:167], a[252:255], v[224:239]
    ds_read_b64_tr_b16 a[240:241], v111 offset:49152
    ds_read_b64_tr_b16 a[242:243], v111 offset:50176
    buffer_load_dwordx4 v97, s[36:39], s53 offen offset:1024 lds
    s_waitcnt lgkmcnt(4)
    v_mfma_f32_32x32x16_bf16 v[176:191], v[152:155], v[240:243], v[176:191]
    ds_read_b128 v[156:159], v105 offset:32768
    ds_read_b64_tr_b16 v[244:245], v108 offset:53248
    ds_read_b64_tr_b16 v[246:247], v108 offset:54272
    buffer_load_dwordx4 v98, s[36:39], s53 offen offset:2048 lds
    v_mfma_f32_32x32x16_bf16 v[192:207], v[152:155], a[232:235], v[192:207]
    ds_read_b64_tr_b16 a[244:245], v109 offset:53248
    ds_read_b64_tr_b16 a[246:247], v109 offset:54272
    buffer_load_dwordx4 v99, s[36:39], s53 offen offset:3072 lds
    s_waitcnt lgkmcnt(5)
    v_mfma_f32_32x32x16_bf16 v[208:223], v[152:155], a[236:239], v[208:223]
    ds_read_b64_tr_b16 a[248:249], v110 offset:53248
    ds_read_b64_tr_b16 a[250:251], v110 offset:54272
    s_add_u32 m0, s55, 81920
    s_add_u32 s54, s54, s52
    v_mfma_f32_32x32x16_bf16 v[224:239], v[152:155], a[240:243], v[224:239]
    ds_read_b64_tr_b16 a[252:253], v111 offset:53248
    ds_read_b64_tr_b16 a[254:255], v111 offset:54272
    buffer_load_dwordx4 v100, s[32:35], s54 offen offset:0 lds
    s_waitcnt lgkmcnt(4)
    v_mfma_f32_32x32x16_bf16 v[176:191], v[156:159], v[244:247], v[176:191]
    ds_read_b128 v[160:163], v106 offset:32768
    ds_read_b64_tr_b16 v[248:249], v108 offset:57344
    ds_read_b64_tr_b16 v[250:251], v108 offset:58368
    buffer_load_dwordx4 v101, s[32:35], s54 offen offset:1024 lds
    v_mfma_f32_32x32x16_bf16 v[192:207], v[156:159], a[244:247], v[192:207]
    ds_read_b64_tr_b16 a[232:233], v109 offset:57344
    ds_read_b64_tr_b16 a[234:235], v109 offset:58368
    s_waitcnt lgkmcnt(5)
    v_mfma_f32_32x32x16_bf16 v[208:223], v[156:159], a[248:251], v[208:223]
    ds_read_b64_tr_b16 a[236:237], v110 offset:57344
    ds_read_b64_tr_b16 a[238:239], v110 offset:58368
    buffer_load_dwordx4 v102, s[32:35], s54 offen offset:2048 lds
    v_mfma_f32_32x32x16_bf16 v[224:239], v[156:159], a[252:255], v[224:239]
    ds_read_b64_tr_b16 a[240:241], v111 offset:57344
    ds_read_b64_tr_b16 a[242:243], v111 offset:58368
    buffer_load_dwordx4 v103, s[32:35], s54 offen offset:3072 lds
    s_waitcnt lgkmcnt(4)
    v_mfma_f32_32x32x16_bf16 v[176:191], v[160:163], v[248:251], v[176:191]
    ds_read_b128 v[164:167], v107 offset:32768
    ds_read_b64_tr_b16 v[252:253], v108 offset:61440
    ds_read_b64_tr_b16 v[254:255], v108 offset:62464
    s_add_u32 s50, s50, 1
    s_cmp_eq_u32 s50, 9
    s_cselect_b32 s50, 0, s50
    v_mfma_f32_32x32x16_bf16 v[192:207], v[160:163], a[232:235], v[192:207]
    ds_read_b64_tr_b16 a[244:245], v109 offset:61440
    ds_read_b64_tr_b16 a[246:247], v109 offset:62464
    s_waitcnt lgkmcnt(5)
    v_mfma_f32_32x32x16_bf16 v[208:223], v[160:163], a[236:239], v[208:223]
    ds_read_b64_tr_b16 a[248:249], v110 offset:61440
    ds_read_b64_tr_b16 a[250:251], v110 offset:62464
    v_mfma_f32_32x32x16_bf16 v[224:239], v[160:163], a[240:243], v[224:239]
    ds_read_b64_tr_b16 a[252:253], v111 offset:61440
    ds_read_b64_tr_b16 a[254:255], v111 offset:62464
    s_waitcnt lgkmcnt(0)
    v_dot2c_f32_bf16 v112, s47, v152
    v_dot2c_f32_bf16 v113, v152, v152
    v_dot2c_f32_bf16 v114, s47, v240
    v_dot2c_f32_bf16 v112, s47, v153
    v_dot2c_f32_bf16 v113, v153, v153
    v_dot2c_f32_bf16 v114, s47, v241
    v_dot2c_f32_bf16 v112, s47, v154
    v_dot2c_f32_bf16 v113, v154, v154
    v_dot2c_f32_bf16 v114, s47, v242
    v_dot2c_f32_bf16 v112, s47, v155
    v_dot2c_f32_bf16 v113, v155, v155
    v_dot2c_f32_bf16 v114, s47, v243
    v_dot2c_f32_bf16 v112, s47, v156
    v_dot2c_f32_bf16 v113, v156, v156
    v_dot2c_f32_bf16 v114, s47, v244
    v_dot2c_f32_bf16 v112, s47, v157
    v_dot2c_f32_bf16 v113, v157, v157
    v_dot2c_f32_bf16 v114, s47, v245
    v_dot2c_f32_bf16 v112, s47, v158
    v_dot2c_f32_bf16 v113, v158, v158
    v_dot2c_f32_bf16 v114, s47, v246
    v_dot2c_f32_bf16 v112, s47, v159
    v_dot2c_f32_bf16 v113, v159, v159
    v_dot2c_f32_bf16 v114, s47, v247
    v_dot2c_f32_bf16 v112, s47, v160
    v_dot2c_f32_bf16 v113, v160, v160
    v_dot2c_f32_bf16 v114, s47, v248
    v_dot2c_f32_bf16 v112, s47, v161
    v_dot2c_f32_bf16 v113, v161, v161
    v_dot2c_f32_bf16 v114, s47, v249
    v_dot2c_f32_bf16 v112, s47, v162
    v_dot2c_f32_bf16 v113, v162, v162
    v_dot2c_f32_bf16 v114, s47, v250
    v_dot2c_f32_bf16 v112, s47, v163
    v_dot2c_f32_bf16 v113, v163, v163
    v_dot2c_f32_bf16 v114, s47, v251
    v_dot2c_f32_bf16 v112, s47, v164
    v_dot2c_f32_bf16 v113, v164, v164
    v_dot2c_f32_bf16 v114, s47, v252
    v_dot2c_f32_bf16 v112, s47, v165
    v_dot2c_f32_bf16 v113, v165, v165
    v_dot2c_f32_bf16 v114, s47, v253
    v_dot2c_f32_bf16 v112, s47, v166
    v_dot2c_f32_bf16 v113, v166, v166
    v_dot2c_f32_bf16 v114, s47, v254
    v_dot2c_f32_bf16 v112, s47, v167
    v_dot2c_f32_bf16 v113, v167, v167
    v_dot2c_f32_bf16 v114, s47, v255
    v_mfma_f32_32x32x16_bf16 v[176:191], v[164:167], v[252:255], v[176:191]
    s_waitcnt vmcnt(24)
    s_barrier
    v_add_u32 v104, 0x10000, v104
    v_add_u32 v105, 0x10000, v105
    v_add_u32 v106, 0x10000, v106
    v_add_u32 v107, 0x10000, v107
    v_add_u32 v108, 0x10000, v108
    v_add_u32 v109, 0x10000, v109
    v_add_u32 v110, 0x10000, v110
    v_add_u32 v111, 0x10000, v111
    ds_read_b128 v[152:155], v104 offset:0
    ds_read_b64_tr_b16 v[240:241], v108 offset:16384
    ds_read_b64_tr_b16 v[242:243], v108 offset:17408
    s_lshl_b32 s53, s50, 7
    s_add_u32 s53, s53, s51
    s_add_u32 m0, s55, 98304
    s_mul_i32 s54, s50, 221184
    v_mfma_f32_32x32x16_bf16 v[192:207], v[164:167], a[244:247], v[192:207]
    ds_read_b64_tr_b16 a[232:233], v109 offset:16384
    ds_read_b64_tr_b16 a[234:235], v109 offset:17408
    buffer_load_dwordx4 v96, s[36:39], s53 offen offset:0 lds
    v_mfma_f32_32x32x16_bf16 v[208:223], v[164:167], a[248:251], v[208:223]
    ds_read_b64_tr_b16 a[236:237], v110 offset:16384
    ds_read_b64_tr_b16 a[238:239], v110 offset:17408
    v_mfma_f32_32x32x16_bf16 v[224:239], v[164:167], a[252:255], v[224:239]
    ds_read_b64_tr_b16 a[240:241], v111 offset:16384
    ds_read_b64_tr_b16 a[242:243], v111 offset:17408
    buffer_load_dwordx4 v97, s[36:39], s53 offen offset:1024 lds
    s_waitcnt lgkmcnt(4)
    v_mfma_f32_32x32x16_bf16 v[176:191], v[152:155], v[240:243], v[176:191]
    ds_read_b128 v[156:159], v105 offset:0
    ds_read_b64_tr_b16 v[244:245], v108 offset:20480
    ds_read_b64_tr_b16 v[246:247], v108 offset:21504
    buffer_load_dwordx4 v98, s[36:39], s53 offen offset:2048 lds
    v_mfma_f32_32x32x16_bf16 v[192:207], v[152:155], a[232:235], v[192:207]
    ds_read_b64_tr_b16 a[244:245], v109 offset:20480
    ds_read_b64_tr_b16 a[246:247], v109 offset:21504
    buffer_load_dwordx4 v99, s[36:39], s53 offen offset:3072 lds
    s_waitcnt lgkmcnt(5)
    v_mfma_f32_32x32x16_bf16 v[208:223], v[152:155], a[236:239], v[208:223]
    ds_read_b64_tr_b16 a[248:249], v110 offset:20480
    ds_read_b64_tr_b16 a[250:251], v110 offset:21504
    s_add_u32 m0, s55, 114688
    s_add_u32 s54, s54, s52
    v_mfma_f32_32x32x16_bf16 v[224:239], v[152:155], a[240:243], v[224:239]
    ds_read_b64_tr_b16 a[252:253], v111 offset:20480
    ds_read_b64_tr_b16 a[254:255], v111 offset:21504
    buffer_load_dwordx4 v100, s[32:35], s54 offen offset:0 lds
    s_waitcnt lgkmcnt(4)
    v_mfma_f32_32x32x16_bf16 v[176:191], v[156:159], v[244:247], v[176:191]
    ds_read_b128 v[160:163], v106 offset:0
    ds_read_b64_tr_b16 v[248:249], v108 offset:24576
    ds_read_b64_tr_b16 v[250:251], v108 offset:25600
    buffer_load_dwordx4 v101, s[32:35], s54 offen offset:1024 lds
    v_mfma_f32_32x32x16_bf16 v[192:207], v[156:159], a[244:247], v[192:207]
    ds_read_b64_tr_b16 a[232:233], v109 offset:24576
    ds_read_b64_tr_b16 a[234:235], v109 offset:25600
    s_waitcnt lgkmcnt(5)
    v_mfma_f32_32x32x16_bf16 v[208:223], v[156:159], a[248:251], v[208:223]
    ds_read_b64_tr_b16 a[236:237], v110 offset:24576
    ds_read_b64_tr_b16 a[238:239], v110 offset:25600
    buffer_load_dwordx4 v102, s[32:35], s54 offen offset:2048 lds
    v_mfma_f32_32x32x16_bf16 v[224:239], v[156:159], a[252:255], v[224:239]
    ds_read_b64_tr_b16 a[240:241], v111 offset:24576
    ds_read_b64_tr_b16 a[242:243], v111 offset:25600
    buffer_load_dwordx4 v103, s[32:35], s54 offen offset:3072 lds
    s_waitcnt lgkmcnt(4)
    v_mfma_f32_32x32x16_bf16 v[176:191], v[160:163], v[248:251], v[176:191]
    ds_read_b128 v[164:167], v107 offset:0
    ds_read_b64_tr_b16 v[252:253], v108 offset:28672
    ds_read_b64_tr_b16 v[254:255], v108 offset:29696
    s_add_u32 s50, s50, 1
    s_cmp_eq_u32 s50, 9
    s_cselect_b32 s50, 0, s50
    v_mfma_f32_32x32x16_bf16 v[192:207], v[160:163], a[232:235], v[192:207]
    ds_read_b64_tr_b16 a[244:245], v109 offset:28672
    ds_read_b64_tr_b16 a[246:247], v109 offset:29696
    s_waitcnt lgkmcnt(5)
    v_mfma_f32_32x32x16_bf16 v[208:223], v[160:163], a[236:239], v[208:223]
    ds_read_b64_tr_b16 a[248:249], v110 offset:28672
    ds_read_b64_tr_b16 a[250:251], v110 offset:29696
    v_mfma_f32_32x32x16_bf16 v[224:239], v[160:163], a[240:243], v[224:239]
    ds_read_b64_tr_b16 a[252:253], v111 offset:28672
    ds_read_b64_tr_b16 a[254:255], v111 offset:29696
    s_waitcnt lgkmcnt(0)
    v_dot2c_f32_bf16 v112, s47, v152
    v_dot2c_f32_bf16 v113, v152, v152
    v_dot2c_f32_bf16 v114, s47, v240
    v_dot2c_f32_bf16 v112, s47, v153
    v_dot2c_f32_bf16 v113, v153, v153
    v_dot2c_f32_bf16 v114, s47, v241
    v_dot2c_f32_bf16 v112, s47, v154
    v_dot2c_f32_bf16 v113, v154, v154
    v_dot2c_f32_bf16 v114, s47, v242
    v_dot2c_f32_bf16 v112, s47, v155
    v_dot2c_f32_bf16 v113, v155, v155
    v_dot2c_f32_bf16 v114, s47, v243
    v_dot2c_f32_bf16 v112, s47, v156
    v_dot2c_f32_bf16 v113, v156, v156
    v_dot2c_f32_bf16 v114, s47, v244
    v_dot2c_f32_bf16 v112, s47, v157
    v_dot2c_f32_bf16 v113, v157, v157
    v_dot2c_f32_bf16 v114, s47, v245
    v_dot2c_f32_bf16 v112, s47, v158
    v_dot2c_f32_bf16 v113, v158, v158
    v_dot2c_f32_bf16 v114, s47, v246
    v_dot2c_f32_bf16 v112, s47, v159
    v_dot2c_f32_bf16 v113, v159, v159
    v_dot2c_f32_bf16 v114, s47, v247
    v_dot2c_f32_bf16 v112, s47, v160
    v_dot2c_f32_bf16 v113, v160, v160
    v_dot2c_f32_bf16 v114, s47, v248
    v_dot2c_f32_bf16 v112, s47, v161
    v_dot2c_f32_bf16 v113, v161, v161
    v_dot2c_f32_bf16 v114, s47, v249
    v_dot2c_f32_bf16 v112, s47, v162
    v_dot2c_f32_bf16 v113, v162, v162
    v_dot2c_f32_bf16 v114, s47, v250
    v_dot2c_f32_bf16 v112, s47, v163
    v_dot2c_f32_bf16 v113, v163, v163
    v_dot2c_f32_bf16 v114, s47, v251
    v_dot2c_f32_bf16 v112, s47, v164
    v_dot2c_f32_bf16 v113, v164, v164
    v_dot2c_f32_bf16 v114, s47, v252
    v_dot2c_f32_bf16 v112, s47, v165
    v_dot2c_f32_bf16 v113, v165, v165
    v_dot2c_f32_bf16 v114, s47, v253
    v_dot2c_f32_bf16 v112, s47, v166
    v_dot2c_f32_bf16 v113, v166, v166
    v_dot2c_f32_bf16 v114, s47, v254
    v_dot2c_f32_bf16 v112, s47, v167
    v_dot2c_f32_bf16 v113, v167, v167
    v_dot2c_f32_bf16 v114, s47, v255
    v_mfma_f32_32x32x16_bf16 v[176:191], v[164:167], v[252:255], v[176:191]
    s_waitcnt vmcnt(24)
    s_barrier
    v_add_u32 v104, 0xfffe0000, v104
    v_add_u32 v105, 0xfffe0000, v105
    v_add_u32 v106, 0xfffe0000, v106
    v_add_u32 v107, 0xfffe0000, v107
    v_add_u32 v108, 0xfffe0000, v108
    v_add_u32 v109, 0xfffe0000, v109
    v_add_u32 v110, 0xfffe0000, v110
    v_add_u32 v111, 0xfffe0000, v111
    ds_read_b128 v[152:155], v104 offset:0
    ds_read_b64_tr_b16 v[240:241], v108 offset:16384
    ds_read_b64_tr_b16 v[242:243], v108 offset:17408
    v_mfma_f32_32x32x16_bf16 v[192:207], v[164:167], a[244:247], v[192:207]
    ds_read_b64_tr_b16 a[232:233], v109 offset:16384
    ds_read_b64_tr_b16 a[234:235], v109 offset:17408
    v_mfma_f32_32x32x16_bf16 v[208:223], v[164:167], a[248:251], v[208:223]
    ds_read_b64_tr_b16 a[236:237], v110 offset:16384
    ds_read_b64_tr_b16 a[238:239], v110 offset:17408
    v_mfma_f32_32x32x16_bf16 v[224:239], v[164:167], a[252:255], v[224:239]
    ds_read_b64_tr_b16 a[240:241], v111 offset:16384
    ds_read_b64_tr_b16 a[242:243], v111 offset:17408
    s_waitcnt lgkmcnt(4)
    v_mfma_f32_32x32x16_bf16 v[176:191], v[152:155], v[240:243], v[176:191]
    ds_read_b128 v[156:159], v105 offset:0
    ds_read_b64_tr_b16 v[244:245], v108 offset:20480
    ds_read_b64_tr_b16 v[246:247], v108 offset:21504
    v_mfma_f32_32x32x16_bf16 v[192:207], v[152:155], a[232:235], v[192:207]
    ds_read_b64_tr_b16 a[244:245], v109 offset:20480
    ds_read_b64_tr_b16 a[246:247], v109 offset:21504
    v_mov_b32 v92, -1
    v_mov_b32 v93, -1
    v_mov_b32 v94, -1
    v_mov_b32 v95, -1
    s_waitcnt lgkmcnt(5)
    v_mfma_f32_32x32x16_bf16 v[208:223], v[152:155], a[236:239], v[208:223]
    ds_read_b64_tr_b16 a[248:249], v110 offset:20480
    ds_read_b64_tr_b16 a[250:251], v110 offset:21504
    v_mfma_f32_32x32x16_bf16 v[224:239], v[152:155], a[240:243], v[224:239]
    ds_read_b64_tr_b16 a[252:253], v111 offset:20480
    ds_read_b64_tr_b16 a[254:255], v111 offset:21504
    s_mul_i32 s0, s57, 72
    s_add_u32 s0, s0, s59
    s_lshl_b32 s0, s0, 10
    s_add_u32 s0, s0, 0x900000
    s_waitcnt lgkmcnt(4)
    v_mfma_f32_32x32x16_bf16 v[176:191], v[156:159], v[244:247], v[176:191]
    ds_read_b128 v[160:163], v106 offset:0
    ds_read_b64_tr_b16 v[248:249], v108 offset:24576
    ds_read_b64_tr_b16 v[250:251], v108 offset:25600
    v_mfma_f32_32x32x16_bf16 v[192:207], v[156:159], a[244:247], v[192:207]
    ds_read_b64_tr_b16 a[232:233], v109 offset:24576
    ds_read_b64_tr_b16 a[234:235], v109 offset:25600
    buffer_store_dwordx4 v[92:95], v2, s[28:31], s0 offen sc1
    s_waitcnt lgkmcnt(5)
    v_mfma_f32_32x32x16_bf16 v[208:223], v[156:159], a[248:251], v[208:223]
    ds_read_b64_tr_b16 a[236:237], v110 offset:24576
    ds_read_b64_tr_b16 a[238:239], v110 offset:25600
    v_mfma_f32_32x32x16_bf16 v[224:239], v[156:159], a[252:255], v[224:239]
    ds_read_b64_tr_b16 a[240:241], v111 offset:24576
    ds_read_b64_tr_b16 a[242:243], v111 offset:25600
    s_add_u32 s0, s0, 36864
    buffer_store_dwordx4 v[92:95], v2, s[28:31], s0 offen sc1
    s_waitcnt lgkmcnt(4)
    v_mfma_f32_32x32x16_bf16 v[176:191], v[160:163], v[248:251], v[176:191]
    ds_read_b128 v[164:167], v107 offset:0
    ds_read_b64_tr_b16 v[252:253], v108 offset:28672
    ds_read_b64_tr_b16 v[254:255], v108 offset:29696
    v_mfma_f32_32x32x16_bf16 v[192:207], v[160:163], a[232:235], v[192:207]
    ds_read_b64_tr_b16 a[244:245], v109 offset:28672
    ds_read_b64_tr_b16 a[246:247], v109 offset:29696
    s_waitcnt lgkmcnt(5)
    v_mfma_f32_32x32x16_bf16 v[208:223], v[160:163], a[236:239], v[208:223]
    ds_read_b64_tr_b16 a[248:249], v110 offset:28672
    ds_read_b64_tr_b16 a[250:251], v110 offset:29696
    s_mul_i32 s1, s65, 36
    s_mul_i32 s0, s66, 9
    s_add_u32 s1, s1, s0
    s_lshl_b32 s1, s1, 10
    s_lshl_b32 s0, s46, 11
    s_add_u32 s0, s0, s1
    s_add_u32 s0, s0, 0xc00000
    v_mfma_f32_32x32x16_bf16 v[224:239], v[160:163], a[240:243], v[224:239]
    ds_read_b64_tr_b16 a[252:253], v111 offset:28672
    ds_read_b64_tr_b16 a[254:255], v111 offset:29696
    s_waitcnt lgkmcnt(0)
    v_dot2c_f32_bf16 v112, s47, v152
    v_dot2c_f32_bf16 v113, v152, v152
    v_dot2c_f32_bf16 v114, s47, v240
    v_dot2c_f32_bf16 v112, s47, v153
    v_dot2c_f32_bf16 v113, v153, v153
    v_dot2c_f32_bf16 v114, s47, v241
    v_dot2c_f32_bf16 v112, s47, v154
    v_dot2c_f32_bf16 v113, v154, v154
    v_dot2c_f32_bf16 v114, s47, v242
    v_dot2c_f32_bf16 v112, s47, v155
    v_dot2c_f32_bf16 v113, v155, v155
    v_dot2c_f32_bf16 v114, s47, v243
    v_dot2c_f32_bf16 v112, s47, v156
    v_dot2c_f32_bf16 v113, v156, v156
    v_dot2c_f32_bf16 v114, s47, v244
    v_dot2c_f32_bf16 v112, s47, v157
    v_dot2c_f32_bf16 v113, v157, v157
    v_dot2c_f32_bf16 v114, s47, v245
    v_dot2c_f32_bf16 v112, s47, v158
    v_dot2c_f32_bf16 v113, v158, v158
    v_dot2c_f32_bf16 v114, s47, v246
    v_dot2c_f32_bf16 v112, s47, v159
    v_dot2c_f32_bf16 v113, v159, v159
    v_dot2c_f32_bf16 v114, s47, v247
    v_dot2c_f32_bf16 v112, s47, v160
    v_dot2c_f32_bf16 v113, v160, v160
    v_dot2c_f32_bf16 v114, s47, v248
    v_dot2c_f32_bf16 v112, s47, v161
    v_dot2c_f32_bf16 v113, v161, v161
    v_dot2c_f32_bf16 v114, s47, v249
    v_dot2c_f32_bf16 v112, s47, v162
    v_dot2c_f32_bf16 v113, v162, v162
    v_dot2c_f32_bf16 v114, s47, v250
    v_dot2c_f32_bf16 v112, s47, v163
    v_dot2c_f32_bf16 v113, v163, v163
    v_dot2c_f32_bf16 v114, s47, v251
    v_dot2c_f32_bf16 v112, s47, v164
    v_dot2c_f32_bf16 v113, v164, v164
    v_dot2c_f32_bf16 v114, s47, v252
    v_dot2c_f32_bf16 v112, s47, v165
    v_dot2c_f32_bf16 v113, v165, v165
    v_dot2c_f32_bf16 v114, s47, v253
    v_dot2c_f32_bf16 v112, s47, v166
    v_dot2c_f32_bf16 v113, v166, v166
    v_dot2c_f32_bf16 v114, s47, v254
    v_dot2c_f32_bf16 v112, s47, v167
    v_dot2c_f32_bf16 v113, v167, v167
    v_dot2c_f32_bf16 v114, s47, v255
    v_mfma_f32_32x32x16_bf16 v[176:191], v[164:167], v[252:255], v[176:191]
    s_waitcnt vmcnt(18)
    s_barrier
    ds_read_b128 v[152:155], v104 offset:32768
    ds_read_b64_tr_b16 v[240:241], v108 offset:49152
    ds_read_b64_tr_b16 v[242:243], v108 offset:50176
    v_mfma_f32_32x32x16_bf16 v[192:207], v[164:167], a[244:247], v[192:207]
    ds_read_b64_tr_b16 a[232:233], v109 offset:49152
    ds_read_b64_tr_b16 a[234:235], v109 offset:50176
    buffer_store_dwordx4 v[92:95], v2, s[28:31], s0 offen sc1
    v_mfma_f32_32x32x16_bf16 v[208:223], v[164:167], a[248:251], v[208:223]
    ds_read_b64_tr_b16 a[236:237], v110 offset:49152
    ds_read_b64_tr_b16 a[238:239], v110 offset:50176
    v_mfma_f32_32x32x16_bf16 v[224:239], v[164:167], a[252:255], v[224:239]
    ds_read_b64_tr_b16 a[240:241], v111 offset:49152
    ds_read_b64_tr_b16 a[242:243], v111 offset:50176
    buffer_store_dwordx4 v[92:95], v2, s[28:31], s0 offen offset:1024 sc1
    s_add_u32 s0, s0, 0x300000
    s_waitcnt lgkmcnt(4)
    v_mfma_f32_32x32x16_bf16 v[176:191], v[152:155], v[240:243], v[176:191]
    ds_read_b128 v[156:159], v105 offset:32768
    ds_read_b64_tr_b16 v[244:245], v108 offset:53248
    ds_read_b64_tr_b16 v[246:247], v108 offset:54272
    v_mfma_f32_32x32x16_bf16 v[192:207], v[152:155], a[232:235], v[192:207]
    ds_read_b64_tr_b16 a[244:245], v109 offset:53248
    ds_read_b64_tr_b16 a[246:247], v109 offset:54272
    buffer_store_dwordx4 v[92:95], v2, s[28:31], s0 offen sc1
    s_waitcnt lgkmcnt(5)
    v_mfma_f32_32x32x16_bf16 v[208:223], v[152:155], a[236:239], v[208:223]
    ds_read_b64_tr_b16 a[248:249], v110 offset:53248
    ds_read_b64_tr_b16 a[250:251], v110 offset:54272
    v_mfma_f32_32x32x16_bf16 v[224:239], v[152:155], a[240:243], v[224:239]
    ds_read_b64_tr_b16 a[252:253], v111 offset:53248
    ds_read_b64_tr_b16 a[254:255], v111 offset:54272
    s_waitcnt lgkmcnt(4)
    v_mfma_f32_32x32x16_bf16 v[176:191], v[156:159], v[244:247], v[176:191]
    ds_read_b128 v[160:163], v106 offset:32768
    ds_read_b64_tr_b16 v[248:249], v108 offset:57344
    ds_read_b64_tr_b16 v[250:251], v108 offset:58368
    buffer_store_dwordx4 v[92:95], v2, s[28:31], s0 offen offset:1024 sc1
    s_add_u32 s0, s0, 0x300000
    v_mfma_f32_32x32x16_bf16 v[192:207], v[156:159], a[244:247], v[192:207]
    ds_read_b64_tr_b16 a[232:233], v109 offset:57344
    ds_read_b64_tr_b16 a[234:235], v109 offset:58368
    s_waitcnt lgkmcnt(5)
    v_mfma_f32_32x32x16_bf16 v[208:223], v[156:159], a[248:251], v[208:223]
    ds_read_b64_tr_b16 a[236:237], v110 offset:57344
    ds_read_b64_tr_b16 a[238:239], v110 offset:58368
    buffer_store_dwordx4 v[92:95], v2, s[28:31], s0 offen sc1
    v_mfma_f32_32x32x16_bf16 v[224:239], v[156:159], a[252:255], v[224:239]
    ds_read_b64_tr_b16 a[240:241], v111 offset:57344
    ds_read_b64_tr_b16 a[242:243], v111 offset:58368
    s_waitcnt lgkmcnt(4)
    v_mfma_f32_32x32x16_bf16 v[176:191], v[160:163], v[248:251], v[176:191]
    ds_read_b128 v[164:167], v107 offset:32768
    ds_read_b64_tr_b16 v[252:253], v108 offset:61440
    ds_read_b64_tr_b16 v[254:255], v108 offset:62464
    buffer_store_dwordx4 v[92:95], v2, s[28:31], s0 offen offset:1024 sc1
    v_mfma_f32_32x32x16_bf16 v[192:207], v[160:163], a[232:235], v[192:207]
    ds_read_b64_tr_b16 a[244:245], v109 offset:61440
    ds_read_b64_tr_b16 a[246:247], v109 offset:62464
    s_waitcnt lgkmcnt(5)
    v_mfma_f32_32x32x16_bf16 v[208:223], v[160:163], a[236:239], v[208:223]
    ds_read_b64_tr_b16 a[248:249], v110 offset:61440
    ds_read_b64_tr_b16 a[250:251], v110 offset:62464
    v_mfma_f32_32x32x16_bf16 v[224:239], v[160:163], a[240:243], v[224:239]
    ds_read_b64_tr_b16 a[252:253], v111 offset:61440
    ds_read_b64_tr_b16 a[254:255], v111 offset:62464
    s_mul_i32 s0, s46, 0x300000
    s_add_u32 s0, s0, s1
    s_add_u32 s0, s0, 0xc02000
    s_lshl_b32 s1, s65, 2
    s_add_u32 s1, s1, s66
    s_lshl_b32 s1, s1, 10
    s_add_u32 s1, s1, 0x1500000
    s_cmp_eq_u32 s46, 3
    s_cselect_b32 s0, s1, s0
    s_waitcnt lgkmcnt(0)
    v_dot2c_f32_bf16 v112, s47, v152
    v_dot2c_f32_bf16 v113, v152, v152
    v_dot2c_f32_bf16 v114, s47, v240
    v_dot2c_f32_bf16 v112, s47, v153
    v_dot2c_f32_bf16 v113, v153, v153
    v_dot2c_f32_bf16 v114, s47, v241
    v_dot2c_f32_bf16 v112, s47, v154
    v_dot2c_f32_bf16 v113, v154, v154
    v_dot2c_f32_bf16 v114, s47, v242
    v_dot2c_f32_bf16 v112, s47, v155
    v_dot2c_f32_bf16 v113, v155, v155
    v_dot2c_f32_bf16 v114, s47, v243
    v_dot2c_f32_bf16 v112, s47, v156
    v_dot2c_f32_bf16 v113, v156, v156
    v_dot2c_f32_bf16 v114, s47, v244
    v_dot2c_f32_bf16 v112, s47, v157
    v_dot2c_f32_bf16 v113, v157, v157
    v_dot2c_f32_bf16 v114, s47, v245
    v_dot2c_f32_bf16 v112, s47, v158
    v_dot2c_f32_bf16 v113, v158, v158
    v_dot2c_f32_bf16 v114, s47, v246
    v_dot2c_f32_bf16 v112, s47, v159
    v_dot2c_f32_bf16 v113, v159, v159
    v_dot2c_f32_bf16 v114, s47, v247
    v_dot2c_f32_bf16 v112, s47, v160
    v_dot2c_f32_bf16 v113, v160, v160
    v_dot2c_f32_bf16 v114, s47, v248
    v_dot2c_f32_bf16 v112, s47, v161
    v_dot2c_f32_bf16 v113, v161, v161
    v_dot2c_f32_bf16 v114, s47, v249
    v_dot2c_f32_bf16 v112, s47, v162
    v_dot2c_f32_bf16 v113, v162, v162
    v_dot2c_f32_bf16 v114, s47, v250
    v_dot2c_f32_bf16 v112, s47, v163
    v_dot2c_f32_bf16 v113, v163, v163
    v_dot2c_f32_bf16 v114, s47, v251
    v_dot2c_f32_bf16 v112, s47, v164
    v_dot2c_f32_bf16 v113, v164, v164
    v_dot2c_f32_bf16 v114, s47, v252
    v_dot2c_f32_bf16 v112, s47, v165
    v_dot2c_f32_bf16 v113, v165, v165
    v_dot2c_f32_bf16 v114, s47, v253
    v_dot2c_f32_bf16 v112, s47, v166
    v_dot2c_f32_bf16 v113, v166, v166
    v_dot2c_f32_bf16 v114, s47, v254
    v_dot2c_f32_bf16 v112, s47, v167
    v_dot2c_f32_bf16 v113, v167, v167
    v_dot2c_f32_bf16 v114, s47, v255
    v_mfma_f32_32x32x16_bf16 v[176:191], v[164:167], v[252:255], v[176:191]
    s_waitcnt vmcnt(16)
    s_barrier
    v_add_u32 v104, 0x10000, v104
    v_add_u32 v105, 0x10000, v105
    v_add_u32 v106, 0x10000, v106
    v_add_u32 v107, 0x10000, v107
    v_add_u32 v108, 0x10000, v108
    v_add_u32 v109, 0x10000, v109
    v_add_u32 v110, 0x10000, v110
    v_add_u32 v111, 0x10000, v111
    ds_read_b128 v[152:155], v104 offset:0
    ds_read_b64_tr_b16 v[240:241], v108 offset:16384
    ds_read_b64_tr_b16 v[242:243], v108 offset:17408
    v_mfma_f32_32x32x16_bf16 v[192:207], v[164:167], a[244:247], v[192:207]
    ds_read_b64_tr_b16 a[232:233], v109 offset:16384
    ds_read_b64_tr_b16 a[234:235], v109 offset:17408
    v_mfma_f32_32x32x16_bf16 v[208:223], v[164:167], a[248:251], v[208:223]
    ds_read_b64_tr_b16 a[236:237], v110 offset:16384
    ds_read_b64_tr_b16 a[238:239], v110 offset:17408
    v_mfma_f32_32x32x16_bf16 v[224:239], v[164:167], a[252:255], v[224:239]
    ds_read_b64_tr_b16 a[240:241], v111 offset:16384
    ds_read_b64_tr_b16 a[242:243], v111 offset:17408
    buffer_store_dwordx4 v[92:95], v2, s[28:31], s0 offen sc1
    s_waitcnt lgkmcnt(4)
    v_mfma_f32_32x32x16_bf16 v[176:191], v[152:155], v[240:243], v[176:191]
    ds_read_b128 v[156:159], v105 offset:0
    ds_read_b64_tr_b16 v[244:245], v108 offset:20480
    ds_read_b64_tr_b16 v[246:247], v108 offset:21504
    v_mfma_f32_32x32x16_bf16 v[192:207], v[152:155], a[232:235], v[192:207]
    ds_read_b64_tr_b16 a[244:245], v109 offset:20480
    ds_read_b64_tr_b16 a[246:247], v109 offset:21504
    s_waitcnt lgkmcnt(5)
    v_mfma_f32_32x32x16_bf16 v[208:223], v[152:155], a[236:239], v[208:223]
    ds_read_b64_tr_b16 a[248:249], v110 offset:20480
    ds_read_b64_tr_b16 a[250:251], v110 offset:21504
    v_mfma_f32_32x32x16_bf16 v[224:239], v[152:155], a[240:243], v[224:239]
    ds_read_b64_tr_b16 a[252:253], v111 offset:20480
    ds_read_b64_tr_b16 a[254:255], v111 offset:21504
    s_lshl_b32 s0, s46, 9
    s_add_u32 s1, s1, s0
    s_add_u32 s1, s1, 0x7fc00
    s_lshl_b32 s0, s57, 1
    s_add_u32 s0, s0, s46
    s_mul_i32 s0, s0, 72
    s_add_u32 s0, s0, s58
    s_lshl_b32 s0, s0, 9
    s_add_u32 s0, s0, 0x908000
    s_cmp_ge_u32 s46, 2
    s_cselect_b32 s0, s1, s0
    s_waitcnt lgkmcnt(4)
    v_mfma_f32_32x32x16_bf16 v[176:191], v[156:159], v[244:247], v[176:191]
    ds_read_b128 v[160:163], v106 offset:0
    ds_read_b64_tr_b16 v[248:249], v108 offset:24576
    ds_read_b64_tr_b16 v[250:251], v108 offset:25600
    v_mfma_f32_32x32x16_bf16 v[192:207], v[156:159], a[244:247], v[192:207]
    ds_read_b64_tr_b16 a[232:233], v109 offset:24576
    ds_read_b64_tr_b16 a[234:235], v109 offset:25600
    s_waitcnt lgkmcnt(5)
    v_mfma_f32_32x32x16_bf16 v[208:223], v[156:159], a[248:251], v[208:223]
    ds_read_b64_tr_b16 a[236:237], v110 offset:24576
    ds_read_b64_tr_b16 a[238:239], v110 offset:25600
    v_mfma_f32_32x32x16_bf16 v[224:239], v[156:159], a[252:255], v[224:239]
    ds_read_b64_tr_b16 a[240:241], v111 offset:24576
    ds_read_b64_tr_b16 a[242:243], v111 offset:25600
    s_mov_b32 exec_hi, 0
    buffer_store_dwordx4 v[92:95], v2, s[28:31], s0 offen sc1
    s_mov_b64 exec, -1
    s_waitcnt lgkmcnt(4)
    v_mfma_f32_32x32x16_bf16 v[176:191], v[160:163], v[248:251], v[176:191]
    ds_read_b128 v[164:167], v107 offset:0
    ds_read_b64_tr_b16 v[252:253], v108 offset:28672
    ds_read_b64_tr_b16 v[254:255], v108 offset:29696
    v_mfma_f32_32x32x16_bf16 v[192:207], v[160:163], a[232:235], v[192:207]
    ds_read_b64_tr_b16 a[244:245], v109 offset:28672
    ds_read_b64_tr_b16 a[246:247], v109 offset:29696
    s_waitcnt lgkmcnt(5)
    v_mfma_f32_32x32x16_bf16 v[208:223], v[160:163], a[236:239], v[208:223]
    ds_read_b64_tr_b16 a[248:249], v110 offset:28672
    ds_read_b64_tr_b16 a[250:251], v110 offset:29696
    v_mfma_f32_32x32x16_bf16 v[224:239], v[160:163], a[240:243], v[224:239]
    ds_read_b64_tr_b16 a[252:253], v111 offset:28672
    ds_read_b64_tr_b16 a[254:255], v111 offset:29696
    s_waitcnt lgkmcnt(0)
    v_dot2c_f32_bf16 v112, s47, v152
    v_dot2c_f32_bf16 v113, v152, v152
    v_dot2c_f32_bf16 v114, s47, v240
    v_dot2c_f32_bf16 v112, s47, v153
    v_dot2c_f32_bf16 v113, v153, v153
    v_dot2c_f32_bf16 v114, s47, v241
    v_dot2c_f32_bf16 v112, s47, v154
    v_dot2c_f32_bf16 v113, v154, v154
    v_dot2c_f32_bf16 v114, s47, v242
    v_dot2c_f32_bf16 v112, s47, v155
    v_dot2c_f32_bf16 v113, v155, v155
    v_dot2c_f32_bf16 v114, s47, v243
    v_dot2c_f32_bf16 v112, s47, v156
    v_dot2c_f32_bf16 v113, v156, v156
    v_dot2c_f32_bf16 v114, s47, v244
    v_dot2c_f32_bf16 v112, s47, v157
    v_dot2c_f32_bf16 v113, v157, v157
    v_dot2c_f32_bf16 v114, s47, v245
    v_dot2c_f32_bf16 v112, s47, v158
    v_dot2c_f32_bf16 v113, v158, v158
    v_dot2c_f32_bf16 v114, s47, v246
    v_dot2c_f32_bf16 v112, s47, v159
    v_dot2c_f32_bf16 v113, v159, v159
    v_dot2c_f32_bf16 v114, s47, v247
    v_dot2c_f32_bf16 v112, s47, v160
    v_dot2c_f32_bf16 v113, v160, v160
    v_dot2c_f32_bf16 v114, s47, v248
    v_dot2c_f32_bf16 v112, s47, v161
    v_dot2c_f32_bf16 v113, v161, v161
    v_dot2c_f32_bf16 v114, s47, v249
    v_dot2c_f32_bf16 v112, s47, v162
    v_dot2c_f32_bf16 v113, v162, v162
    v_dot2c_f32_bf16 v114, s47, v250
    v_dot2c_f32_bf16 v112, s47, v163
    v_dot2c_f32_bf16 v113, v163, v163
    v_dot2c_f32_bf16 v114, s47, v251
    v_dot2c_f32_bf16 v112, s47, v164
    v_dot2c_f32_bf16 v113, v164, v164
    v_dot2c_f32_bf16 v114, s47, v252
    v_dot2c_f32_bf16 v112, s47, v165
    v_dot2c_f32_bf16 v113, v165, v165
    v_dot2c_f32_bf16 v114, s47, v253
    v_dot2c_f32_bf16 v112, s47, v166
    v_dot2c_f32_bf16 v113, v166, v166
    v_dot2c_f32_bf16 v114, s47, v254
    v_dot2c_f32_bf16 v112, s47, v167
    v_dot2c_f32_bf16 v113, v167, v167
    v_dot2c_f32_bf16 v114, s47, v255
    v_mfma_f32_32x32x16_bf16 v[176:191], v[164:167], v[252:255], v[176:191]
    s_waitcnt vmcnt(10)
    s_barrier
    ds_read_b128 v[152:155], v104 offset:32768
    ds_read_b64_tr_b16 v[240:241], v108 offset:49152
    ds_read_b64_tr_b16 v[242:243], v108 offset:50176
    v_mfma_f32_32x32x16_bf16 v[192:207], v[164:167], a[244:247], v[192:207]
    ds_read_b128 v[156:159], v105 offset:32768
    ds_read_b64_tr_b16 v[244:245], v108 offset:53248
    ds_read_b64_tr_b16 v[246:247], v108 offset:54272
    v_lshlrev_b32 v126, 2, v1
    s_cmp_eq_u32 s46, 0
    s_cselect_b32 s69, 0, 0x8000000
    s_mov_b32 exec_hi, 0
    buffer_load_dword v127, v126, s[40:43], s69 offen sc1
    s_mov_b64 exec, -1
    v_mfma_f32_32x32x16_bf16 v[208:223], v[164:167], a[248:251], v[208:223]
    ds_read_b128 v[160:163], v106 offset:32768
    ds_read_b64_tr_b16 v[248:249], v108 offset:57344
    ds_read_b64_tr_b16 v[250:251], v108 offset:58368
    ds_read_b64_tr_b16 v[252:253], v108 offset:61440
    ds_read_b64_tr_b16 v[254:255], v108 offset:62464
    v_mfma_f32_32x32x16_bf16 v[224:239], v[164:167], a[252:255], v[224:239]
    ds_read_b128 v[164:167], v107 offset:32768
    s_waitcnt lgkmcnt(0)
    ds_read_b64_tr_b16 a[184:185], v109 offset:49152
    ds_read_b64_tr_b16 a[186:187], v109 offset:50176
    ds_read_b64_tr_b16 a[188:189], v109 offset:53248
    ds_read_b64_tr_b16 a[190:191], v109 offset:54272
    ds_read_b64_tr_b16 a[192:193], v109 offset:57344
    ds_read_b64_tr_b16 a[194:195], v109 offset:58368
    ds_read_b64_tr_b16 a[196:197], v109 offset:61440
    ds_read_b64_tr_b16 a[198:199], v109 offset:62464
    ds_read_b64_tr_b16 a[200:201], v110 offset:49152
    ds_read_b64_tr_b16 a[202:203], v110 offset:50176
    ds_read_b64_tr_b16 a[204:205], v110 offset:53248
    ds_read_b64_tr_b16 a[206:207], v110 offset:54272
    v_dot2c_f32_bf16 v112, s47, v152
    v_dot2c_f32_bf16 v113, v152, v152
    v_dot2c_f32_bf16 v114, s47, v240
    v_dot2c_f32_bf16 v112, s47, v153
    v_dot2c_f32_bf16 v113, v153, v153
    v_dot2c_f32_bf16 v114, s47, v241
    v_dot2c_f32_bf16 v112, s47, v154
    v_dot2c_f32_bf16 v113, v154, v154
    v_dot2c_f32_bf16 v114, s47, v242
    v_dot2c_f32_bf16 v112, s47, v155
    v_dot2c_f32_bf16 v113, v155, v155
    v_dot2c_f32_bf16 v114, s47, v243
    v_dot2c_f32_bf16 v112, s47, v156
    v_dot2c_f32_bf16 v113, v156, v156
    v_dot2c_f32_bf16 v114, s47, v244
    v_dot2c_f32_bf16 v112, s47, v157
    v_dot2c_f32_bf16 v113, v157, v157
    v_dot2c_f32_bf16 v114, s47, v245
    v_dot2c_f32_bf16 v112, s47, v158
    v_dot2c_f32_bf16 v113, v158, v158
    v_dot2c_f32_bf16 v114, s47, v246
    v_dot2c_f32_bf16 v112, s47, v159
    v_dot2c_f32_bf16 v113, v159, v159
    v_dot2c_f32_bf16 v114, s47, v247
    v_dot2c_f32_bf16 v112, s47, v160
    v_dot2c_f32_bf16 v113, v160, v160
    v_dot2c_f32_bf16 v114, s47, v248
    v_dot2c_f32_bf16 v112, s47, v161
    v_dot2c_f32_bf16 v113, v161, v161
    v_dot2c_f32_bf16 v114, s47, v249
    v_dot2c_f32_bf16 v112, s47, v162
    v_dot2c_f32_bf16 v113, v162, v162
    v_dot2c_f32_bf16 v114, s47, v250
    v_dot2c_f32_bf16 v112, s47, v163
    v_dot2c_f32_bf16 v113, v163, v163
    v_dot2c_f32_bf16 v114, s47, v251
    v_dot2c_f32_bf16 v112, s47, v164
    v_dot2c_f32_bf16 v113, v164, v164
    v_dot2c_f32_bf16 v114, s47, v252
    v_dot2c_f32_bf16 v112, s47, v165
    v_dot2c_f32_bf16 v113, v165, v165
    v_dot2c_f32_bf16 v114, s47, v253
    v_dot2c_f32_bf16 v112, s47, v166
    v_dot2c_f32_bf16 v113, v166, v166
    v_dot2c_f32_bf16 v114, s47, v254
    v_dot2c_f32_bf16 v112, s47, v167
    v_dot2c_f32_bf16 v113, v167, v167
    v_dot2c_f32_bf16 v114, s47, v255
    ds_read_b64_tr_b16 a[208:209], v110 offset:57344
    ds_read_b64_tr_b16 a[210:211], v110 offset:58368
    ds_read_b64_tr_b16 a[212:213], v110 offset:61440
    ds_read_b64_tr_b16 a[214:215], v110 offset:62464
    ds_read_b64_tr_b16 a[216:217], v111 offset:49152
    ds_read_b64_tr_b16 a[218:219], v111 offset:50176
    ds_read_b64_tr_b16 a[220:221], v111 offset:53248
    ds_read_b64_tr_b16 a[222:223], v111 offset:54272
    ds_read_b64_tr_b16 a[224:225], v111 offset:57344
    ds_read_b64_tr_b16 a[226:227], v111 offset:58368
    ds_read_b64_tr_b16 a[228:229], v111 offset:61440
    ds_read_b64_tr_b16 a[230:231], v111 offset:62464
    v_mfma_f32_32x32x16_bf16 v[176:191], v[152:155], v[240:243], v[176:191]
    v_mov_b32 v115, v114
    v_and_b32 v116, 31, v1
    v_lshlrev_b32 v116, 2, v116
    v_permlane32_swap_b32 v114, v115
    s_lshl_b32 s53, s46, 7
    s_add_u32 s53, s53, 131072
    v_mfma_f32_32x32x16_bf16 v[176:191], v[156:159], v[244:247], v[176:191]
    v_add_f32 v114, v114, v115
    v_add_u32 v117, s53, v116
    ds_write_b32 v117, v114
    v_mov_b32 v115, v112
    v_mov_b32 v118, v113
    v_mfma_f32_32x32x16_bf16 v[176:191], v[160:163], v[248:251], v[176:191]
    v_cmp_gt_u32 vcc, 32, v1
    v_permlane32_swap_b32 v112, v115
    v_permlane32_swap_b32 v113, v118
    v_add_f32 v112, v112, v115
    v_add_f32 v113, v113, v118
    v_mfma_f32_32x32x16_bf16 v[176:191], v[164:167], v[252:255], v[176:191]
    s_waitcnt lgkmcnt(0)
    s_barrier
    v_mfma_f32_32x32x16_bf16 v[192:207], v[152:155], a[184:187], v[192:207]
    s_add_u32 s53, s46, 0
    s_and_b32 s53, s53, 3
    s_lshl_b32 s53, s53, 7
    s_add_u32 s53, s53, 131072
    v_add_u32 v117, s53, v116
    ds_read_b32 v122, v117
    s_add_u32 s53, s46, 1
    s_and_b32 s53, s53, 3
    s_lshl_b32 s53, s53, 7
    s_add_u32 s53, s53, 131072
    v_add_u32 v117, s53, v116
    ds_read_b32 v123, v117
    s_add_u32 s53, s46, 2
    s_and_b32 s53, s53, 3
    s_lshl_b32 s53, s53, 7
    s_add_u32 s53, s53, 131072
    v_add_u32 v117, s53, v116
    ds_read_b32 v124, v117
    v_mfma_f32_32x32x16_bf16 v[192:207], v[156:159], a[188:191], v[192:207]
    s_add_u32 s53, s46, 3
    s_and_b32 s53, s53, 3
    s_lshl_b32 s53, s53, 7
    s_add_u32 s53, s53, 131072
    v_add_u32 v117, s53, v116
    ds_read_b32 v125, v117
    v_mul_f32 v112, 0xbae38e39, v112
    v_mul_f32 v113, 0x3ae38e39, v113
    v_fma_f32 v113, -v112, v112, v113
    v_max_f32 v113, 0, v113
    v_add_f32 v113, 0x3727c5ac, v113
    v_rsq_f32 v113, v113
    v_cndmask_b32 v112, 0, v112, vcc
    v_cvt_pk_bf16_f32 v80, v112, v112
    v_mov_b32 v82, 0
    v_mov_b32 v83, 0
    v_and_b32 v118, 0xffff0000, v80
    v_sub_f32 v118, v112, v118
    v_mfma_f32_32x32x16_bf16 v[192:207], v[160:163], a[192:195], v[192:207]
    v_cvt_pk_bf16_f32 v81, v118, 0
    s_waitcnt lgkmcnt(3)
    v_cvt_pk_bf16_f32 v129, v122, 0
    v_mov_b32 v130, 0
    v_lshlrev_b32 v118, 16, v129
    v_sub_f32 v118, v122, v118
    v_mov_b32 v131, 0
    v_cvt_pk_bf16_f32 v128, v122, v118
    s_waitcnt lgkmcnt(2)
    v_cvt_pk_bf16_f32 v133, v123, 0
    v_mov_b32 v134, 0
    v_lshlrev_b32 v118, 16, v133
    v_sub_f32 v118, v123, v118
    v_mov_b32 v135, 0
    v_cvt_pk_bf16_f32 v132, v123, v118
    s_waitcnt lgkmcnt(1)
    v_cvt_pk_bf16_f32 v137, v124, 0
    v_mov_b32 v138, 0
    v_lshlrev_b32 v118, 16, v137
    v_sub_f32 v118, v124, v118
    v_mov_b32 v139, 0
    v_cvt_pk_bf16_f32 v136, v124, v118
    s_waitcnt lgkmcnt(0)
    v_cvt_pk_bf16_f32 v141, v125, 0
    v_mfma_f32_32x32x16_bf16 v[192:207], v[164:167], a[196:199], v[192:207]
    v_mov_b32 v142, 0
    v_lshlrev_b32 v118, 16, v141
    v_sub_f32 v118, v125, v118
    v_mov_b32 v143, 0
    v_cvt_pk_bf16_f32 v140, v125, v118
    v_cndmask_b32 v118, 0, v113, vcc
    v_cvt_pk_bf16_f32 v119, v118, 0
    v_lshlrev_b32 v119, 16, v119
    v_sub_f32 v119, v118, v119
    v_cvt_pk_bf16_f32 v84, v118, v119
    v_and_b32 v120, 0xffff0000, v84
    v_sub_f32 v120, v119, v120
    v_cvt_pk_bf16_f32 v85, v120, 0
    v_mov_b32 v86, 0
    v_mov_b32 v87, 0
    v_mov_b32 v88, s47
    v_mov_b32 v89, s47
    v_mov_b32 v90, s47
    v_mov_b32 v91, s47
    v_mfma_f32_32x32x16_bf16 v[176:191], v[80:83], v[128:131], v[176:191]
    v_mfma_f32_32x32x16_bf16 v[192:207], v[80:83], v[132:135], v[192:207]
    v_mfma_f32_32x32x16_bf16 v[64:79], v[84:87], v[88:91], 0
    v_mfma_f32_32x32x16_bf16 v[208:223], v[152:155], a[200:203], v[208:223]
    v_and_b32 v116, 31, v1
    v_lshlrev_b32 v116, 5, v116
    v_lshrrev_b32 v117, 5, v1
    v_lshl_add_u32 v116, v117, 4, v116
    v_add_u32 v117, 18432, v116
    s_lshl_b32 s51, s48, 2
    s_add_u32 s51, s51, s46
    s_mul_i32 s51, s51, 36864
    s_add_u32 s51, s51, 0x5f7000
    s_add_u32 s53, s46, 0
    s_and_b32 s53, s53, 3
    s_lshl_b32 s54, s49, 2
    s_add_u32 s53, s53, s54
    v_mfma_f32_32x32x16_bf16 v[208:223], v[156:159], a[204:207], v[208:223]
    s_lshl_b32 s54, s53, 10
    s_add_u32 s54, s54, s51
    s_cmp_lt_u32 s53, 54
    s_cselect_b32 s54, s54, 0x8000000
    v_mul_f32 v176, v176, v64
    v_mul_f32 v177, v177, v65
    v_mul_f32 v178, v178, v66
    v_mul_f32 v179, v179, v67
    v_mul_f32 v180, v180, v68
    v_mul_f32 v181, v181, v69
    v_mul_f32 v182, v182, v70
    v_mul_f32 v183, v183, v71
    v_mfma_f32_32x32x16_bf16 v[208:223], v[160:163], a[208:211], v[208:223]
    v_cvt_pk_bf16_f32 v176, v176, v177
    v_cvt_pk_bf16_f32 v177, v178, v179
    v_cvt_pk_bf16_f32 v178, v180, v181
    v_cvt_pk_bf16_f32 v179, v182, v183
    buffer_store_dwordx4 v[176:179], v116, s[28:31], s54 offen sc1
    v_mul_f32 v184, v184, v72
    v_mul_f32 v185, v185, v73
    v_mul_f32 v186, v186, v74
    v_mul_f32 v187, v187, v75
    v_mfma_f32_32x32x16_bf16 v[208:223], v[164:167], a[212:215], v[208:223]
    v_mul_f32 v188, v188, v76
    v_mul_f32 v189, v189, v77
    v_mul_f32 v190, v190, v78
    v_mul_f32 v191, v191, v79
    v_cvt_pk_bf16_f32 v180, v184, v185
    v_cvt_pk_bf16_f32 v181, v186, v187
    v_cvt_pk_bf16_f32 v182, v188, v189
    v_cvt_pk_bf16_f32 v183, v190, v191
    buffer_store_dwordx4 v[180:183], v117, s[28:31], s54 offen sc1
    v_mfma_f32_32x32x16_bf16 v[208:223], v[80:83], v[136:139], v[208:223]
    s_add_u32 s53, s46, 1
    s_and_b32 s53, s53, 3
    s_lshl_b32 s54, s49, 2
    s_add_u32 s53, s53, s54
    s_lshl_b32 s54, s53, 10
    s_add_u32 s54, s54, s51
    s_cmp_lt_u32 s53, 54
    s_cselect_b32 s54, s54, 0x8000000
    v_mfma_f32_32x32x16_bf16 v[224:239], v[152:155], a[216:219], v[224:239]
    v_mul_f32 v192, v192, v64
    v_mul_f32 v193, v193, v65
    v_mul_f32 v194, v194, v66
    v_mul_f32 v195, v195, v67
    v_mul_f32 v196, v196, v68
    v_mul_f32 v197, v197, v69
    v_mul_f32 v198, v198, v70
    v_mul_f32 v199, v199, v71
    v_mfma_f32_32x32x16_bf16 v[224:239], v[156:159], a[220:223], v[224:239]
    v_cvt_pk_bf16_f32 v192, v192, v193
    v_cvt_pk_bf16_f32 v193, v194, v195
    v_cvt_pk_bf16_f32 v194, v196, v197
    v_cvt_pk_bf16_f32 v195, v198, v199
    buffer_store_dwordx4 v[192:195], v116, s[28:31], s54 offen sc1
    v_mfma_f32_32x32x16_bf16 v[224:239], v[160:163], a[224:227], v[224:239]
    v_mul_f32 v200, v200, v72
    v_mul_f32 v201, v201, v73
    v_mul_f32 v202, v202, v74
    v_mul_f32 v203, v203, v75
    v_mul_f32 v204, v204, v76
    v_mul_f32 v205, v205, v77
    v_mul_f32 v206, v206, v78
    v_mul_f32 v207, v207, v79
    v_mfma_f32_32x32x16_bf16 v[224:239], v[164:167], a[228:231], v[224:239]
    v_cvt_pk_bf16_f32 v196, v200, v201
    v_cvt_pk_bf16_f32 v197, v202, v203
    v_cvt_pk_bf16_f32 v198, v204, v205
    v_cvt_pk_bf16_f32 v199, v206, v207
    buffer_store_dwordx4 v[196:199], v117, s[28:31], s54 offen sc1
    v_mfma_f32_32x32x16_bf16 v[224:239], v[80:83], v[140:143], v[224:239]
    s_add_u32 s53, s46, 2
    s_and_b32 s53, s53, 3
    s_lshl_b32 s54, s49, 2
    s_add_u32 s53, s53, s54
    s_lshl_b32 s54, s53, 10
    s_add_u32 s54, s54, s51
    s_cmp_lt_u32 s53, 54
    s_cselect_b32 s54, s54, 0x8000000
    v_pk_mul_f32 v[208:209], v[208:209], v[64:65]
    v_pk_mul_f32 v[210:211], v[210:211], v[66:67]
    v_pk_mul_f32 v[212:213], v[212:213], v[68:69]
    v_pk_mul_f32 v[214:215], v[214:215], v[70:71]
    v_cvt_pk_bf16_f32 v208, v208, v209
    v_cvt_pk_bf16_f32 v209, v210, v211
    v_cvt_pk_bf16_f32 v210, v212, v213
    v_cvt_pk_bf16_f32 v211, v214, v215
    buffer_store_dwordx4 v[208:211], v116, s[28:31], s54 offen sc1
    v_pk_mul_f32 v[216:217], v[216:217], v[72:73]
    v_pk_mul_f32 v[218:219], v[218:219], v[74:75]
    v_pk_mul_f32 v[220:221], v[220:221], v[76:77]
    v_pk_mul_f32 v[222:223], v[222:223], v[78:79]
    v_cvt_pk_bf16_f32 v212, v216, v217
    v_cvt_pk_bf16_f32 v213, v218, v219
    v_cvt_pk_bf16_f32 v214, v220, v221
    v_cvt_pk_bf16_f32 v215, v222, v223
    buffer_store_dwordx4 v[212:215], v117, s[28:31], s54 offen sc1
    s_add_u32 s53, s46, 3
    s_and_b32 s53, s53, 3
    s_lshl_b32 s54, s49, 2
    s_add_u32 s53, s53, s54
    s_lshl_b32 s54, s53, 10
    s_add_u32 s54, s54, s51
    s_cmp_lt_u32 s53, 54
    s_cselect_b32 s54, s54, 0x8000000
    v_pk_mul_f32 v[224:225], v[224:225], v[64:65]
    v_pk_mul_f32 v[226:227], v[226:227], v[66:67]
    v_pk_mul_f32 v[228:229], v[228:229], v[68:69]
    v_pk_mul_f32 v[230:231], v[230:231], v[70:71]
    v_cvt_pk_bf16_f32 v224, v224, v225
    v_cvt_pk_bf16_f32 v225, v226, v227
    v_cvt_pk_bf16_f32 v226, v228, v229
    v_cvt_pk_bf16_f32 v227, v230, v231
    buffer_store_dwordx4 v[224:227], v116, s[28:31], s54 offen sc1
    v_pk_mul_f32 v[232:233], v[232:233], v[72:73]
    v_pk_mul_f32 v[234:235], v[234:235], v[74:75]
    v_pk_mul_f32 v[236:237], v[236:237], v[76:77]
    v_pk_mul_f32 v[238:239], v[238:239], v[78:79]
    v_cvt_pk_bf16_f32 v228, v232, v233
    v_cvt_pk_bf16_f32 v229, v234, v235
    v_cvt_pk_bf16_f32 v230, v236, v237
    v_cvt_pk_bf16_f32 v231, v238, v239
    buffer_store_dwordx4 v[228:231], v117, s[28:31], s54 offen sc1
L_p1done:
    v_and_b32 v6, 0x13, v1
    v_bfe_u32 v7, v1, 2, 1
    v_lshl_add_u32 v6, v7, 3, v6
    v_bfe_u32 v7, v1, 3, 1
    v_lshl_add_u32 v6, v7, 2, v6
    v_lshrrev_b32 v7, 5, v1
    v_lshlrev_b32 v8, 4, v7
    v_lshl_add_u32 v3, v6, 5, v8
    v_add_u32 v4, 18432, v3
    v_and_b32 v6, 31, v1
    v_lshlrev_b32 v7, 2, v7
    v_sub_u32 v6, v6, v7
    v_mov_b32 v8, 0xff800000
    v_mov_b32 v9, 0
    v_cmp_le_i32 vcc, 0, v6
    s_nop 1
    v_cndmask_b32 v32, v8, v9, vcc
    v_cndmask_b32 v48, v9, v8, vcc
    v_cmp_le_i32 vcc, 1, v6
    s_nop 1
    v_cndmask_b32 v33, v8, v9, vcc
    v_cndmask_b32 v49, v9, v8, vcc
    v_cmp_le_i32 vcc, 2, v6
    s_nop 1
    v_cndmask_b32 v34, v8, v9, vcc
    v_cndmask_b32 v50, v9, v8, vcc
    v_cmp_le_i32 vcc, 3, v6
    s_nop 1
    v_cndmask_b32 v35, v8, v9, vcc
    v_cndmask_b32 v51, v9, v8, vcc
    v_cmp_le_i32 vcc, 8, v6
    s_nop 1
    v_cndmask_b32 v36, v8, v9, vcc
    v_cndmask_b32 v52, v9, v8, vcc
    v_cmp_le_i32 vcc, 9, v6
    s_nop 1
    v_cndmask_b32 v37, v8, v9, vcc
    v_cndmask_b32 v53, v9, v8, vcc
    v_cmp_le_i32 vcc, 10, v6
    s_nop 1
    v_cndmask_b32 v38, v8, v9, vcc
    v_cndmask_b32 v54, v9, v8, vcc
    v_cmp_le_i32 vcc, 11, v6
    s_nop 1
    v_cndmask_b32 v39, v8, v9, vcc
    v_cndmask_b32 v55, v9, v8, vcc
    v_cmp_le_i32 vcc, 16, v6
    s_nop 1
    v_cndmask_b32 v40, v8, v9, vcc
    v_cndmask_b32 v56, v9, v8, vcc
    v_cmp_le_i32 vcc, 17, v6
    s_nop 1
    v_cndmask_b32 v41, v8, v9, vcc
    v_cndmask_b32 v57, v9, v8, vcc
    v_cmp_le_i32 vcc, 18, v6
    s_nop 1
    v_cndmask_b32 v42, v8, v9, vcc
    v_cndmask_b32 v58, v9, v8, vcc
    v_cmp_le_i32 vcc, 19, v6
    s_nop 1
    v_cndmask_b32 v43, v8, v9, vcc
    v_cndmask_b32 v59, v9, v8, vcc
    v_cmp_le_i32 vcc, 24, v6
    s_nop 1
    v_cndmask_b32 v44, v8, v9, vcc
    v_cndmask_b32 v60, v9, v8, vcc
    v_cmp_le_i32 vcc, 25, v6
    s_nop 1
    v_cndmask_b32 v45, v8, v9, vcc
    v_cndmask_b32 v61, v9, v8, vcc
    v_cmp_le_i32 vcc, 26, v6
    s_nop 1
    v_cndmask_b32 v46, v8, v9, vcc
    v_cndmask_b32 v62, v9, v8, vcc
    v_cmp_le_i32 vcc, 27, v6
    s_nop 1
    v_cndmask_b32 v47, v8, v9, vcc
    v_cndmask_b32 v63, v9, v8, vcc
    v_and_b32 v6, 27, v1
    v_cmp_eq_u32 vcc, 18, v6
    v_mov_b32 v7, s47
    s_nop 0
    v_cndmask_b32 v6, 0, v7, vcc
    s_mov_b32 exec_lo, 0xfffc0000
    s_mov_b32 exec_hi, 0xfffc0000
    v_accvgpr_write_b32 a80, v6
    v_accvgpr_write_b32 a81, v6
    v_accvgpr_write_b32 a82, v6
    v_accvgpr_write_b32 a83, v6
    v_accvgpr_write_b32 a84, v6
    v_accvgpr_write_b32 a85, v6
    v_accvgpr_write_b32 a86, v6
    v_accvgpr_write_b32 a87, v6
    v_accvgpr_write_b32 a88, v6
    v_accvgpr_write_b32 a89, v6
    v_accvgpr_write_b32 a90, v6
    v_accvgpr_write_b32 a91, v6
    v_accvgpr_write_b32 a92, v6
    v_accvgpr_write_b32 a93, v6
    v_accvgpr_write_b32 a94, v6
    v_accvgpr_write_b32 a95, v6
    v_accvgpr_write_b32 a96, v6
    v_accvgpr_write_b32 a97, v6
    v_accvgpr_write_b32 a98, v6
    v_accvgpr_write_b32 a99, v6
    v_accvgpr_write_b32 a100, v6
    v_accvgpr_write_b32 a101, v6
    v_accvgpr_write_b32 a102, v6
    v_accvgpr_write_b32 a103, v6
    v_accvgpr_write_b32 a104, v6
    v_accvgpr_write_b32 a105, v6
    v_accvgpr_write_b32 a106, v6
    v_accvgpr_write_b32 a107, v6
    v_accvgpr_write_b32 a108, v6
    v_accvgpr_write_b32 a109, v6
    v_accvgpr_write_b32 a110, v6
    v_accvgpr_write_b32 a111, v6
    v_accvgpr_write_b32 a112, v6
    v_accvgpr_write_b32 a113, v6
    v_accvgpr_write_b32 a114, v6
    v_accvgpr_write_b32 a115, v6
    v_accvgpr_write_b32 a116, v6
    v_accvgpr_write_b32 a117, v6
    v_accvgpr_write_b32 a118, v6
    v_accvgpr_write_b32 a119, v6
    v_accvgpr_write_b32 a120, v6
    v_accvgpr_write_b32 a121, v6
    v_accvgpr_write_b32 a122, v6
    v_accvgpr_write_b32 a123, v6
    v_accvgpr_write_b32 a124, v6
    v_accvgpr_write_b32 a125, v6
    v_accvgpr_write_b32 a126, v6
    v_accvgpr_write_b32 a127, v6
    v_accvgpr_write_b32 a128, v6
    v_accvgpr_write_b32 a129, v6
    v_accvgpr_write_b32 a130, v6
    v_accvgpr_write_b32 a131, v6
    v_accvgpr_write_b32 a132, v6
    v_accvgpr_write_b32 a133, v6
    v_accvgpr_write_b32 a134, v6
    v_accvgpr_write_b32 a135, v6
    v_accvgpr_write_b32 a136, v6
    v_accvgpr_write_b32 a137, v6
    v_accvgpr_write_b32 a138, v6
    v_accvgpr_write_b32 a139, v6
    v_accvgpr_write_b32 a140, v6
    v_accvgpr_write_b32 a141, v6
    v_accvgpr_write_b32 a142, v6
    v_accvgpr_write_b32 a143, v6
    v_accvgpr_write_b32 a144, v6
    v_accvgpr_write_b32 a145, v6
    v_accvgpr_write_b32 a146, v6
    v_accvgpr_write_b32 a147, v6
    v_accvgpr_write_b32 a148, v6
    v_accvgpr_write_b32 a149, v6
    v_accvgpr_write_b32 a150, v6
    v_accvgpr_write_b32 a151, v6
    v_accvgpr_write_b32 a152, v6
    v_accvgpr_write_b32 a153, v6
    v_accvgpr_write_b32 a154, v6
    v_accvgpr_write_b32 a155, v6
    v_accvgpr_write_b32 a156, v6
    v_accvgpr_write_b32 a157, v6
    v_accvgpr_write_b32 a158, v6
    v_accvgpr_write_b32 a159, v6
    s_mov_b64 exec, -1
    s_mov_b32 exec_lo, 0
    s_lshl_b32 s53, s57, 1
    s_cmp_ge_u32 s53, 8
    s_cselect_b32 s54, 0x3f800000, 0x3f80ff80
    v_accvgpr_write_b32 a4, s54
    v_accvgpr_write_b32 a5, s47
    v_accvgpr_write_b32 a6, 0
    v_accvgpr_write_b32 a7, 0
    s_cmp_ge_u32 s53, 7
    s_cselect_b32 s54, 0x3f800000, 0x3f80ff80
    v_accvgpr_write_b32 a12, s54
    v_accvgpr_write_b32 a13, s47
    v_accvgpr_write_b32 a14, 0
    v_accvgpr_write_b32 a15, 0
    s_cmp_ge_u32 s53, 6
    s_cselect_b32 s54, 0x3f800000, 0x3f80ff80
    v_accvgpr_write_b32 a20, s54
    v_accvgpr_write_b32 a21, s47
    v_accvgpr_write_b32 a22, 0
    v_accvgpr_write_b32 a23, 0
    s_cmp_ge_u32 s53, 5
    s_cselect_b32 s54, 0x3f800000, 0x3f80ff80
    v_accvgpr_write_b32 a28, s54
    v_accvgpr_write_b32 a29, s47
    v_accvgpr_write_b32 a30, 0
    v_accvgpr_write_b32 a31, 0
    s_cmp_ge_u32 s53, 4
    s_cselect_b32 s54, 0x3f800000, 0x3f80ff80
    v_accvgpr_write_b32 a36, s54
    v_accvgpr_write_b32 a37, s47
    v_accvgpr_write_b32 a38, 0
    v_accvgpr_write_b32 a39, 0
    s_cmp_ge_u32 s53, 3
    s_cselect_b32 s54, 0x3f800000, 0x3f80ff80
    v_accvgpr_write_b32 a44, s54
    v_accvgpr_write_b32 a45, s47
    v_accvgpr_write_b32 a46, 0
    v_accvgpr_write_b32 a47, 0
    s_cmp_ge_u32 s53, 2
    s_cselect_b32 s54, 0x3f800000, 0x3f80ff80
    v_accvgpr_write_b32 a52, s54
    v_accvgpr_write_b32 a53, s47
    v_accvgpr_write_b32 a54, 0
    v_accvgpr_write_b32 a55, 0
    s_cmp_ge_u32 s53, 1
    s_cselect_b32 s54, 0x3f800000, 0x3f80ff80
    v_accvgpr_write_b32 a60, s54
    v_accvgpr_write_b32 a61, s47
    v_accvgpr_write_b32 a62, 0
    v_accvgpr_write_b32 a63, 0
    s_cmp_ge_u32 s53, 0
    s_cselect_b32 s54, 0x3f800000, 0x3f80ff80
    v_accvgpr_write_b32 a68, s54
    v_accvgpr_write_b32 a69, s47
    v_accvgpr_write_b32 a70, 0
    v_accvgpr_write_b32 a71, 0
    s_cmp_ge_u32 s53, 0
    s_cselect_b32 s54, 0x3f800000, 0x3f80ff80
    v_accvgpr_write_b32 a76, s54
    v_accvgpr_write_b32 a77, s47
    v_accvgpr_write_b32 a78, 0
    v_accvgpr_write_b32 a79, 0
    v_mov_b32 v20, 0x3f80
    v_mov_b32 v21, 0
    v_mov_b32 v22, 0
    v_mov_b32 v23, 0
    v_mov_b32 v28, 0x3f80
    v_mov_b32 v29, 0
    v_mov_b32 v30, 0
    v_mov_b32 v31, 0
    s_mov_b64 exec, -1
    v_mul_u32_u24 v6, 43, v1
    v_lshrrev_b32 v6, 8, v6
    v_mul_u32_u24 v7, 6, v6
    v_sub_u32 v7, v1, v7
    s_lshr_b32 s53, s57, 1
    v_sub_u32 v6, s53, v6
    v_max_i32 v6, 0, v6
    v_lshrrev_b32 v8, 1, v7
    v_mul_u32_u24 v8, 576, v8
    v_and_b32 v7, 1, v7
    v_mul_u32_u24 v7, 71, v7
    s_mul_i32 s53, s58, 72
    v_add3_u32 v7, v7, v8, s53
    v_lshrrev_b32 v7, 7, v7
    v_lshlrev_b32 v7, 3, v7
    v_mul_u32_u24 v6, 1152, v6
    s_mov_b32 s53, 0x1a00000
    v_add3_u32 v5, v6, v7, s53
    s_waitcnt vmcnt(0)
    s_barrier
    s_cmp_lg_u32 s46, 0
    s_cbranch_scc1 L_p2
    v_cmp_gt_u32 vcc, 1, v127
    s_nop 1
    s_cmp_eq_u32 vcc_lo, 0
    s_cbranch_scc1 L_clr_3
    s_mov_b32 exec_lo, 0xffffffff
    s_mov_b32 exec_hi, 0
    s_mov_b32 s69, 0
L_poll_4:
    buffer_load_dword v127, v126, s[40:43], 0 offen sc1
    s_add_u32 s69, s69, 1
    s_cmp_gt_u32 s69, 400000
    s_waitcnt vmcnt(0)
    s_cbranch_scc1 L_pollout_5
    v_cmp_gt_u32 vcc, 1, v127
    s_nop 1
    s_cbranch_vccnz L_poll_4
L_pollout_5:
    s_mov_b64 exec, -1
L_clr_3:
    s_mul_i32 s53, s48, 1152
    s_lshl_b32 s54, s49, 3
    s_add_u32 s53, s53, s54
    s_add_u32 s53, s53, 0x1a00000
    v_mov_b32 v126, 0
    v_mov_b32 v127, 1
    s_mov_b64 exec, 1
    buffer_store_dword v127, v126, s[28:31], s53 offen sc1
    s_mov_b64 exec, -1
    s_branch L_p2
L_idle2:
    s_lshl_b32 s54, s48, 12
    s_add_u32 s54, s54, 0x1c00000
    v_lshlrev_b32 v96, 4, v0
    v_mov_b32 v100, 0
    v_mov_b32 v101, 0
    v_mov_b32 v102, 0
    v_mov_b32 v103, 0
    buffer_store_dwordx4 v[100:103], v96, s[28:31], s54 offen sc1
    v_lshrrev_b32 v97, 5, v0
    v_mul_u32_u24 v97, 1152, v97
    v_and_b32 v98, 31, v0
    v_lshl_add_u32 v97, v98, 2, v97
    s_mul_i32 s54, s48, 9216
    s_add_u32 s54, s54, 0x1a00000
    buffer_store_dword v100, v97, s[28:31], s54 offen sc1
    v_mov_b32 v104, -1
    v_mov_b32 v105, -1
    v_mov_b32 v106, -1
    v_mov_b32 v107, -1
    s_mul_i32 s0, s57, 72
    s_add_u32 s0, s0, s59
    s_lshl_b32 s0, s0, 10
    s_add_u32 s0, s0, 0x900000
    buffer_store_dwordx4 v[104:107], v2, s[28:31], s0 offen sc1
    s_add_u32 s0, s0, 36864
    buffer_store_dwordx4 v[104:107], v2, s[28:31], s0 offen sc1
    s_mul_i32 s1, s65, 36
    s_mul_i32 s0, s66, 9
    s_add_u32 s1, s1, s0
    s_lshl_b32 s1, s1, 10
    s_lshl_b32 s0, s46, 11
    s_add_u32 s0, s0, s1
    s_add_u32 s0, s0, 0xc00000
    buffer_store_dwordx4 v[104:107], v2, s[28:31], s0 offen sc1
    buffer_store_dwordx4 v[104:107], v2, s[28:31], s0 offen offset:1024 sc1
    s_add_u32 s0, s0, 0x300000
    buffer_store_dwordx4 v[104:107], v2, s[28:31], s0 offen sc1
    buffer_store_dwordx4 v[104:107], v2, s[28:31], s0 offen offset:1024 sc1
    s_add_u32 s0, s0, 0x300000
    buffer_store_dwordx4 v[104:107], v2, s[28:31], s0 offen sc1
    buffer_store_dwordx4 v[104:107], v2, s[28:31], s0 offen offset:1024 sc1
    s_mul_i32 s0, s46, 0x300000
    s_add_u32 s0, s0, s1
    s_add_u32 s0, s0, 0xc02000
    s_lshl_b32 s1, s65, 2
    s_add_u32 s1, s1, s66
    s_lshl_b32 s1, s1, 10
    s_add_u32 s1, s1, 0x1500000
    s_cmp_eq_u32 s46, 3
    s_cselect_b32 s0, s1, s0
    buffer_store_dwordx4 v[104:107], v2, s[28:31], s0 offen sc1
    s_lshl_b32 s0, s46, 9
    s_add_u32 s1, s1, s0
    s_add_u32 s1, s1, 0x7fc00
    s_lshl_b32 s0, s57, 1
    s_add_u32 s0, s0, s46
    s_mul_i32 s0, s0, 72
    s_add_u32 s0, s0, s58
    s_lshl_b32 s0, s0, 9
    s_add_u32 s0, s0, 0x908000
    s_cmp_ge_u32 s46, 2
    s_cselect_b32 s0, s1, s0
    s_mov_b32 exec_hi, 0
    buffer_store_dwordx4 v[104:107], v2, s[28:31], s0 offen sc1
    s_mov_b64 exec, -1
    s_waitcnt vmcnt(0)
    s_barrier
    s_lshl_b32 s53, s48, 2
    v_mov_b32 v96, 0
    v_mov_b32 v97, 1
    s_cmp_eq_u32 s46, 0
    s_cselect_b32 s53, s53, 0x8000000
    s_mov_b64 exec, 1
    buffer_store_dword v97, v96, s[40:43], s53 offen offset:0 sc1
    s_mov_b64 exec, -1
    s_cmp_ge_u32 s48, 27
    s_cbranch_scc1 L_noprep
    v_lshrrev_b32 v232, 5, v1
    v_bfe_u32 v234, v1, 2, 2
    v_lshl_add_u32 v232, v232, 3, v234
    v_mul_u32_u24 v232, 1152, v232
    v_and_b32 v234, 1, v1
    v_lshl_add_u32 v232, v234, 4, v232
    v_bfe_u32 v234, v1, 1, 1
    v_lshl_add_u32 v232, v234, 3, v232
    s_mul_i32 s53, s46, 288
    v_add_u32 v233, s53, v232
    v_bfe_u32 v234, v1, 4, 1
    v_lshl_add_u32 v232, v234, 5, v233
    ds_read_b64_tr_b16 v[152:153], v232 offset:0
    ds_read_b64_tr_b16 v[154:155], v232 offset:4608
    ds_read_b64_tr_b16 v[156:157], v232 offset:64
    ds_read_b64_tr_b16 v[158:159], v232 offset:4672
    ds_read_b64_tr_b16 v[160:161], v232 offset:128
    ds_read_b64_tr_b16 v[162:163], v232 offset:4736
    ds_read_b64_tr_b16 v[164:165], v232 offset:192
    ds_read_b64_tr_b16 v[166:167], v232 offset:4800
    ds_read_b64_tr_b16 v[168:169], v233 offset:256
    ds_read_b64_tr_b16 v[170:171], v233 offset:4864
    ds_read_b64_tr_b16 v[172:173], v232 offset:18432
    ds_read_b64_tr_b16 v[174:175], v232 offset:23040
    ds_read_b64_tr_b16 v[176:177], v232 offset:18496
    ds_read_b64_tr_b16 v[178:179], v232 offset:23104
    ds_read_b64_tr_b16 v[180:181], v232 offset:18560
    ds_read_b64_tr_b16 v[182:183], v232 offset:23168
    ds_read_b64_tr_b16 v[184:185], v232 offset:18624
    ds_read_b64_tr_b16 v[186:187], v232 offset:23232
    ds_read_b64_tr_b16 v[188:189], v233 offset:18688
    ds_read_b64_tr_b16 v[190:191], v233 offset:23296
    ds_read_b64_tr_b16 v[192:193], v232 offset:36864
    ds_read_b64_tr_b16 v[194:195], v232 offset:41472
    ds_read_b64_tr_b16 v[196:197], v232 offset:36928
    ds_read_b64_tr_b16 v[198:199], v232 offset:41536
    ds_read_b64_tr_b16 v[200:201], v232 offset:36992
    ds_read_b64_tr_b16 v[202:203], v232 offset:41600
    ds_read_b64_tr_b16 v[204:205], v232 offset:37056
    ds_read_b64_tr_b16 v[206:207], v232 offset:41664
    ds_read_b64_tr_b16 v[208:209], v233 offset:37120
    ds_read_b64_tr_b16 v[210:211], v233 offset:41728
    ds_read_b64_tr_b16 v[212:213], v232 offset:55296
    ds_read_b64_tr_b16 v[214:215], v232 offset:59904
    ds_read_b64_tr_b16 v[216:217], v232 offset:55360
    ds_read_b64_tr_b16 v[218:219], v232 offset:59968
    ds_read_b64_tr_b16 v[220:221], v232 offset:55424
    ds_read_b64_tr_b16 v[222:223], v232 offset:60032
    ds_read_b64_tr_b16 v[224:225], v232 offset:55488
    ds_read_b64_tr_b16 v[226:227], v232 offset:60096
    ds_read_b64_tr_b16 v[228:229], v233 offset:55552
    ds_read_b64_tr_b16 v[230:231], v233 offset:60160
    s_lshl_b32 s52, s49, 2
    s_add_u32 s52, s52, s46
    s_mul_i32 s52, s52, 184320
    s_add_u32 s52, s52, 0x1700000
    s_cmp_eq_u32 s49, 2
    s_cbranch_scc1 L_w2
    s_lshl_b32 s55, s51, 12
    s_add_u32 s55, s55, s52
    s_add_u32 s55, s55, 9216
    s_waitcnt lgkmcnt(15)
    buffer_store_dwordx4 v[152:155], v2, s[28:31], s55 offen offset:0 sc1
    buffer_store_dwordx4 v[172:175], v2, s[28:31], s55 offen offset:1024 sc1
    buffer_store_dwordx4 v[192:195], v2, s[28:31], s55 offen offset:2048 sc1
    s_waitcnt lgkmcnt(8)
    buffer_store_dwordx4 v[212:215], v2, s[28:31], s55 offen offset:3072 sc1
    s_add_u32 s55, s55, 46080
    buffer_store_dwordx4 v[156:159], v2, s[28:31], s55 offen offset:0 sc1
    buffer_store_dwordx4 v[176:179], v2, s[28:31], s55 offen offset:1024 sc1
    buffer_store_dwordx4 v[196:199], v2, s[28:31], s55 offen offset:2048 sc1
    s_waitcnt lgkmcnt(6)
    buffer_store_dwordx4 v[216:219], v2, s[28:31], s55 offen offset:3072 sc1
    s_add_u32 s55, s55, 46080
    buffer_store_dwordx4 v[160:163], v2, s[28:31], s55 offen offset:0 sc1
    buffer_store_dwordx4 v[180:183], v2, s[28:31], s55 offen offset:1024 sc1
    buffer_store_dwordx4 v[200:203], v2, s[28:31], s55 offen offset:2048 sc1
    s_waitcnt lgkmcnt(4)
    buffer_store_dwordx4 v[220:223], v2, s[28:31], s55 offen offset:3072 sc1
    s_add_u32 s55, s55, 46080
    buffer_store_dwordx4 v[164:167], v2, s[28:31], s55 offen offset:0 sc1
    buffer_store_dwordx4 v[184:187], v2, s[28:31], s55 offen offset:1024 sc1
    buffer_store_dwordx4 v[204:207], v2, s[28:31], s55 offen offset:2048 sc1
    s_waitcnt lgkmcnt(2)
    buffer_store_dwordx4 v[224:227], v2, s[28:31], s55 offen offset:3072 sc1
    s_add_u32 s55, s55, 46080
    s_branch L_half
L_w2:
    v_and_b32 v234, 0x13, v1
    v_bfe_u32 v235, v1, 2, 1
    v_lshl_add_u32 v234, v235, 3, v234
    v_bfe_u32 v235, v1, 3, 1
    v_lshl_add_u32 v234, v235, 2, v234
    v_bfe_u32 v236, v234, 1, 3
    v_lshrrev_b32 v235, 5, v1
    v_add_u32 v236, v236, v235
    v_mul_u32_u24 v237, 1152, v234
    v_lshl_add_u32 v234, v236, 4, v237
    v_add_u32 v235, 64, v236
    v_subrev_u32 v238, 72, v235
    v_min_u32 v235, v235, v238
    v_lshl_add_u32 v124, v235, 4, v237
    v_add_u32 v235, 66, v236
    v_subrev_u32 v238, 72, v235
    v_min_u32 v235, v235, v238
    v_lshl_add_u32 v125, v235, 4, v237
    v_add_u32 v235, 68, v236
    v_subrev_u32 v238, 72, v235
    v_min_u32 v235, v235, v238
    v_lshl_add_u32 v126, v235, 4, v237
    v_add_u32 v235, 70, v236
    v_subrev_u32 v238, 72, v235
    v_min_u32 v235, v235, v238
    v_lshl_add_u32 v127, v235, 4, v237
    v_mov_b32 v144, s47
    v_mov_b32 v145, s47
    v_mov_b32 v146, s47
    v_mov_b32 v147, s47
    ds_read_b128 a[160:163], v234 offset:0
    ds_read_b128 a[164:167], v234 offset:32
    ds_read_b128 a[168:171], v234 offset:64
    ds_read_b128 a[172:175], v234 offset:96
    ds_read_b128 a[176:179], v234 offset:128
    ds_read_b128 a[180:183], v234 offset:160
    ds_read_b128 a[184:187], v234 offset:192
    ds_read_b128 a[188:191], v234 offset:224
    ds_read_b128 a[192:195], v234 offset:256
    ds_read_b128 a[196:199], v234 offset:288
    s_waitcnt lgkmcnt(9)
    v_mfma_f32_32x32x16_bf16 v[64:79], a[160:163], v[144:147], 0
    ds_read_b128 a[200:203], v234 offset:320
    s_waitcnt lgkmcnt(9)
    v_mfma_f32_32x32x16_bf16 v[64:79], a[164:167], v[144:147], v[64:79]
    ds_read_b128 a[204:207], v234 offset:352
    s_lshl_b32 s55, s51, 12
    s_add_u32 s55, s55, s52
    s_add_u32 s55, s55, 9216
    s_waitcnt lgkmcnt(9)
    v_mfma_f32_32x32x16_bf16 v[64:79], a[168:171], v[144:147], v[64:79]
    ds_read_b128 a[160:163], v234 offset:384
    s_waitcnt lgkmcnt(9)
    v_mfma_f32_32x32x16_bf16 v[64:79], a[172:175], v[144:147], v[64:79]
    ds_read_b128 a[164:167], v234 offset:416
    s_waitcnt lgkmcnt(9)
    v_mfma_f32_32x32x16_bf16 v[64:79], a[176:179], v[144:147], v[64:79]
    ds_read_b128 a[168:171], v234 offset:448
    buffer_store_dwordx4 v[152:155], v2, s[28:31], s55 offen offset:0 sc1
    s_waitcnt lgkmcnt(9)
    v_mfma_f32_32x32x16_bf16 v[64:79], a[180:183], v[144:147], v[64:79]
    ds_read_b128 a[172:175], v234 offset:480
    s_waitcnt lgkmcnt(9)
    v_mfma_f32_32x32x16_bf16 v[64:79], a[184:187], v[144:147], v[64:79]
    ds_read_b128 a[176:179], v234 offset:512
    s_waitcnt lgkmcnt(9)
    v_mfma_f32_32x32x16_bf16 v[64:79], a[188:191], v[144:147], v[64:79]
    ds_read_b128 a[180:183], v234 offset:544
    s_waitcnt lgkmcnt(9)
    v_mfma_f32_32x32x16_bf16 v[64:79], a[192:195], v[144:147], v[64:79]
    ds_read_b128 a[184:187], v234 offset:576
    buffer_store_dwordx4 v[172:175], v2, s[28:31], s55 offen offset:1024 sc1
    s_waitcnt lgkmcnt(9)
    v_mfma_f32_32x32x16_bf16 v[64:79], a[196:199], v[144:147], v[64:79]
    ds_read_b128 a[188:191], v234 offset:608
    s_waitcnt lgkmcnt(9)
    v_mfma_f32_32x32x16_bf16 v[64:79], a[200:203], v[144:147], v[64:79]
    ds_read_b128 a[192:195], v234 offset:640
    s_waitcnt lgkmcnt(9)
    v_mfma_f32_32x32x16_bf16 v[64:79], a[204:207], v[144:147], v[64:79]
    ds_read_b128 a[196:199], v234 offset:672
    s_waitcnt lgkmcnt(9)
    v_mfma_f32_32x32x16_bf16 v[64:79], a[160:163], v[144:147], v[64:79]
    ds_read_b128 a[200:203], v234 offset:704
    buffer_store_dwordx4 v[192:195], v2, s[28:31], s55 offen offset:2048 sc1
    s_waitcnt lgkmcnt(9)
    v_mfma_f32_32x32x16_bf16 v[64:79], a[164:167], v[144:147], v[64:79]
    ds_read_b128 a[204:207], v234 offset:736
    s_waitcnt lgkmcnt(9)
    v_mfma_f32_32x32x16_bf16 v[64:79], a[168:171], v[144:147], v[64:79]
    ds_read_b128 a[160:163], v234 offset:768
    s_waitcnt lgkmcnt(9)
    v_mfma_f32_32x32x16_bf16 v[64:79], a[172:175], v[144:147], v[64:79]
    ds_read_b128 a[164:167], v234 offset:800
    s_waitcnt lgkmcnt(9)
    v_mfma_f32_32x32x16_bf16 v[64:79], a[176:179], v[144:147], v[64:79]
    ds_read_b128 a[168:171], v234 offset:832
    buffer_store_dwordx4 v[212:215], v2, s[28:31], s55 offen offset:3072 sc1
    s_waitcnt lgkmcnt(9)
    v_mfma_f32_32x32x16_bf16 v[64:79], a[180:183], v[144:147], v[64:79]
    ds_read_b128 a[172:175], v234 offset:864
    s_waitcnt lgkmcnt(9)
    v_mfma_f32_32x32x16_bf16 v[64:79], a[184:187], v[144:147], v[64:79]
    ds_read_b128 a[176:179], v234 offset:896
    s_waitcnt lgkmcnt(9)
    v_mfma_f32_32x32x16_bf16 v[64:79], a[188:191], v[144:147], v[64:79]
    ds_read_b128 a[180:183], v234 offset:928
    s_add_u32 s55, s55, 46080
    s_waitcnt lgkmcnt(9)
    v_mfma_f32_32x32x16_bf16 v[64:79], a[192:195], v[144:147], v[64:79]
    ds_read_b128 a[184:187], v234 offset:960
    s_waitcnt lgkmcnt(9)
    v_mfma_f32_32x32x16_bf16 v[64:79], a[196:199], v[144:147], v[64:79]
    ds_read_b128 a[188:191], v234 offset:992
    buffer_store_dwordx4 v[156:159], v2, s[28:31], s55 offen offset:0 sc1
    s_waitcnt lgkmcnt(9)
    v_mfma_f32_32x32x16_bf16 v[64:79], a[200:203], v[144:147], v[64:79]
    ds_read_b128 a[192:195], v124 offset:0
    s_waitcnt lgkmcnt(9)
    v_mfma_f32_32x32x16_bf16 v[64:79], a[204:207], v[144:147], v[64:79]
    ds_read_b128 a[196:199], v125 offset:0
    s_waitcnt lgkmcnt(9)
    v_mfma_f32_32x32x16_bf16 v[64:79], a[160:163], v[144:147], v[64:79]
    ds_read_b128 a[200:203], v126 offset:0
    s_waitcnt lgkmcnt(9)
    v_mfma_f32_32x32x16_bf16 v[64:79], a[164:167], v[144:147], v[64:79]
    ds_read_b128 a[204:207], v127 offset:0
    buffer_store_dwordx4 v[176:179], v2, s[28:31], s55 offen offset:1024 sc1
    s_waitcnt lgkmcnt(9)
    v_mfma_f32_32x32x16_bf16 v[64:79], a[168:171], v[144:147], v[64:79]
    ds_read_b128 a[160:163], v234 offset:36864
    s_waitcnt lgkmcnt(9)
    v_mfma_f32_32x32x16_bf16 v[64:79], a[172:175], v[144:147], v[64:79]
    ds_read_b128 a[164:167], v234 offset:36896
    s_waitcnt lgkmcnt(9)
    v_mfma_f32_32x32x16_bf16 v[64:79], a[176:179], v[144:147], v[64:79]
    ds_read_b128 a[168:171], v234 offset:36928
    s_waitcnt lgkmcnt(9)
    v_mfma_f32_32x32x16_bf16 v[64:79], a[180:183], v[144:147], v[64:79]
    ds_read_b128 a[172:175], v234 offset:36960
    buffer_store_dwordx4 v[196:199], v2, s[28:31], s55 offen offset:2048 sc1
    s_waitcnt lgkmcnt(9)
    v_mfma_f32_32x32x16_bf16 v[64:79], a[184:187], v[144:147], v[64:79]
    ds_read_b128 a[176:179], v234 offset:36992
    s_waitcnt lgkmcnt(9)
    v_mfma_f32_32x32x16_bf16 v[64:79], a[188:191], v[144:147], v[64:79]
    ds_read_b128 a[180:183], v234 offset:37024
    s_waitcnt lgkmcnt(9)
    v_mfma_f32_32x32x16_bf16 v[64:79], a[192:195], v[144:147], v[64:79]
    ds_read_b128 a[184:187], v234 offset:37056
    s_waitcnt lgkmcnt(9)
    v_mfma_f32_32x32x16_bf16 v[64:79], a[196:199], v[144:147], v[64:79]
    ds_read_b128 a[188:191], v234 offset:37088
    buffer_store_dwordx4 v[216:219], v2, s[28:31], s55 offen offset:3072 sc1
    s_waitcnt lgkmcnt(9)
    v_mfma_f32_32x32x16_bf16 v[64:79], a[200:203], v[144:147], v[64:79]
    ds_read_b128 a[192:195], v234 offset:37120
    s_waitcnt lgkmcnt(9)
    v_mfma_f32_32x32x16_bf16 v[64:79], a[204:207], v[144:147], v[64:79]
    ds_read_b128 a[196:199], v234 offset:37152
    s_waitcnt lgkmcnt(9)
    v_mfma_f32_32x32x16_bf16 v[80:95], a[160:163], v[144:147], 0
    ds_read_b128 a[200:203], v234 offset:37184
    s_add_u32 s55, s55, 46080
    s_waitcnt lgkmcnt(9)
    v_mfma_f32_32x32x16_bf16 v[80:95], a[164:167], v[144:147], v[80:95]
    ds_read_b128 a[204:207], v234 offset:37216
    s_waitcnt lgkmcnt(9)
    v_mfma_f32_32x32x16_bf16 v[80:95], a[168:171], v[144:147], v[80:95]
    ds_read_b128 a[160:163], v234 offset:37248
    buffer_store_dwordx4 v[160:163], v2, s[28:31], s55 offen offset:0 sc1
    s_waitcnt lgkmcnt(9)
    v_mfma_f32_32x32x16_bf16 v[80:95], a[172:175], v[144:147], v[80:95]
    ds_read_b128 a[164:167], v234 offset:37280
    s_waitcnt lgkmcnt(9)
    v_mfma_f32_32x32x16_bf16 v[80:95], a[176:179], v[144:147], v[80:95]
    ds_read_b128 a[168:171], v234 offset:37312
    s_waitcnt lgkmcnt(9)
    v_mfma_f32_32x32x16_bf16 v[80:95], a[180:183], v[144:147], v[80:95]
    ds_read_b128 a[172:175], v234 offset:37344
    s_waitcnt lgkmcnt(9)
    v_mfma_f32_32x32x16_bf16 v[80:95], a[184:187], v[144:147], v[80:95]
    ds_read_b128 a[176:179], v234 offset:37376
    buffer_store_dwordx4 v[180:183], v2, s[28:31], s55 offen offset:1024 sc1
    s_waitcnt lgkmcnt(9)
    v_mfma_f32_32x32x16_bf16 v[80:95], a[188:191], v[144:147], v[80:95]
    ds_read_b128 a[180:183], v234 offset:37408
    s_waitcnt lgkmcnt(9)
    v_mfma_f32_32x32x16_bf16 v[80:95], a[192:195], v[144:147], v[80:95]
    ds_read_b128 a[184:187], v234 offset:37440
    s_waitcnt lgkmcnt(9)
    v_mfma_f32_32x32x16_bf16 v[80:95], a[196:199], v[144:147], v[80:95]
    ds_read_b128 a[188:191], v234 offset:37472
    s_waitcnt lgkmcnt(9)
    v_mfma_f32_32x32x16_bf16 v[80:95], a[200:203], v[144:147], v[80:95]
    ds_read_b128 a[192:195], v234 offset:37504
    buffer_store_dwordx4 v[200:203], v2, s[28:31], s55 offen offset:2048 sc1
    s_waitcnt lgkmcnt(9)
    v_mfma_f32_32x32x16_bf16 v[80:95], a[204:207], v[144:147], v[80:95]
    ds_read_b128 a[196:199], v234 offset:37536
    s_waitcnt lgkmcnt(9)
    v_mfma_f32_32x32x16_bf16 v[80:95], a[160:163], v[144:147], v[80:95]
    ds_read_b128 a[200:203], v234 offset:37568
    s_waitcnt lgkmcnt(9)
    v_mfma_f32_32x32x16_bf16 v[80:95], a[164:167], v[144:147], v[80:95]
    ds_read_b128 a[204:207], v234 offset:37600
    s_waitcnt lgkmcnt(9)
    v_mfma_f32_32x32x16_bf16 v[80:95], a[168:171], v[144:147], v[80:95]
    ds_read_b128 a[160:163], v234 offset:37632
    buffer_store_dwordx4 v[220:223], v2, s[28:31], s55 offen offset:3072 sc1
    s_waitcnt lgkmcnt(9)
    v_mfma_f32_32x32x16_bf16 v[80:95], a[172:175], v[144:147], v[80:95]
    ds_read_b128 a[164:167], v234 offset:37664
    s_waitcnt lgkmcnt(9)
    v_mfma_f32_32x32x16_bf16 v[80:95], a[176:179], v[144:147], v[80:95]
    ds_read_b128 a[168:171], v234 offset:37696
    s_waitcnt lgkmcnt(9)
    v_mfma_f32_32x32x16_bf16 v[80:95], a[180:183], v[144:147], v[80:95]
    ds_read_b128 a[172:175], v234 offset:37728
    s_add_u32 s55, s55, 46080
    s_waitcnt lgkmcnt(9)
    v_mfma_f32_32x32x16_bf16 v[80:95], a[184:187], v[144:147], v[80:95]
    ds_read_b128 a[176:179], v234 offset:37760
    s_waitcnt lgkmcnt(9)
    v_mfma_f32_32x32x16_bf16 v[80:95], a[188:191], v[144:147], v[80:95]
    ds_read_b128 a[180:183], v234 offset:37792
    buffer_store_dwordx4 v[164:167], v2, s[28:31], s55 offen offset:0 sc1
    s_waitcnt lgkmcnt(9)
    v_mfma_f32_32x32x16_bf16 v[80:95], a[192:195], v[144:147], v[80:95]
    ds_read_b128 a[184:187], v234 offset:37824
    s_waitcnt lgkmcnt(9)
    v_mfma_f32_32x32x16_bf16 v[80:95], a[196:199], v[144:147], v[80:95]
    ds_read_b128 a[188:191], v234 offset:37856
    s_waitcnt lgkmcnt(9)
    v_mfma_f32_32x32x16_bf16 v[80:95], a[200:203], v[144:147], v[80:95]
    ds_read_b128 a[192:195], v124 offset:36864
    s_waitcnt lgkmcnt(9)
    v_mfma_f32_32x32x16_bf16 v[80:95], a[204:207], v[144:147], v[80:95]
    ds_read_b128 a[196:199], v125 offset:36864
    buffer_store_dwordx4 v[184:187], v2, s[28:31], s55 offen offset:1024 sc1
    s_waitcnt lgkmcnt(9)
    v_mfma_f32_32x32x16_bf16 v[80:95], a[160:163], v[144:147], v[80:95]
    ds_read_b128 a[200:203], v126 offset:36864
    s_waitcnt lgkmcnt(9)
    v_mfma_f32_32x32x16_bf16 v[80:95], a[164:167], v[144:147], v[80:95]
    ds_read_b128 a[204:207], v127 offset:36864
    s_waitcnt lgkmcnt(9)
    v_mfma_f32_32x32x16_bf16 v[80:95], a[168:171], v[144:147], v[80:95]
    s_waitcnt lgkmcnt(8)
    v_mfma_f32_32x32x16_bf16 v[80:95], a[172:175], v[144:147], v[80:95]
    buffer_store_dwordx4 v[204:207], v2, s[28:31], s55 offen offset:2048 sc1
    s_waitcnt lgkmcnt(7)
    v_mfma_f32_32x32x16_bf16 v[80:95], a[176:179], v[144:147], v[80:95]
    s_waitcnt lgkmcnt(6)
    v_mfma_f32_32x32x16_bf16 v[80:95], a[180:183], v[144:147], v[80:95]
    s_waitcnt lgkmcnt(5)
    v_mfma_f32_32x32x16_bf16 v[80:95], a[184:187], v[144:147], v[80:95]
    s_waitcnt lgkmcnt(4)
    v_mfma_f32_32x32x16_bf16 v[80:95], a[188:191], v[144:147], v[80:95]
    buffer_store_dwordx4 v[224:227], v2, s[28:31], s55 offen offset:3072 sc1
    s_waitcnt lgkmcnt(3)
    v_mfma_f32_32x32x16_bf16 v[80:95], a[192:195], v[144:147], v[80:95]
    s_waitcnt lgkmcnt(2)
    v_mfma_f32_32x32x16_bf16 v[80:95], a[196:199], v[144:147], v[80:95]
    s_waitcnt lgkmcnt(1)
    v_mfma_f32_32x32x16_bf16 v[80:95], a[200:203], v[144:147], v[80:95]
    s_add_u32 s55, s55, 46080
    s_waitcnt lgkmcnt(0)
    v_mfma_f32_32x32x16_bf16 v[80:95], a[204:207], v[144:147], v[80:95]
    v_mul_f32 v64, 0x3ae38e39, v64
    v_mul_f32 v65, 0x3ae38e39, v65
    v_mul_f32 v66, 0x3ae38e39, v66
    v_mul_f32 v67, 0x3ae38e39, v67
    v_mul_f32 v68, 0x3ae38e39, v68
    v_mul_f32 v69, 0x3ae38e39, v69
    v_mul_f32 v70, 0x3ae38e39, v70
    v_mul_f32 v71, 0x3ae38e39, v71
    v_mul_f32 v72, 0x3ae38e39, v72
    v_mul_f32 v73, 0x3ae38e39, v73
    v_mul_f32 v74, 0x3ae38e39, v74
    v_mul_f32 v75, 0x3ae38e39, v75
    v_mul_f32 v76, 0x3ae38e39, v76
    v_mul_f32 v77, 0x3ae38e39, v77
    v_mul_f32 v78, 0x3ae38e39, v78
    v_mul_f32 v79, 0x3ae38e39, v79
    v_mul_f32 v80, 0x3ae38e39, v80
    v_mul_f32 v81, 0x3ae38e39, v81
    v_mul_f32 v82, 0x3ae38e39, v82
    v_mul_f32 v83, 0x3ae38e39, v83
    v_mul_f32 v84, 0x3ae38e39, v84
    v_mul_f32 v85, 0x3ae38e39, v85
    v_mul_f32 v86, 0x3ae38e39, v86
    v_mul_f32 v87, 0x3ae38e39, v87
    v_mul_f32 v88, 0x3ae38e39, v88
    v_mul_f32 v89, 0x3ae38e39, v89
    v_mul_f32 v90, 0x3ae38e39, v90
    v_mul_f32 v91, 0x3ae38e39, v91
    v_mul_f32 v92, 0x3ae38e39, v92
    v_mul_f32 v93, 0x3ae38e39, v93
    v_mul_f32 v94, 0x3ae38e39, v94
    v_mul_f32 v95, 0x3ae38e39, v95
    v_cvt_pk_bf16_f32 v108, v64, v65
    v_lshlrev_b32 v235, 16, v108
    v_sub_f32 v64, v64, v235
    v_and_b32 v235, 0xffff0000, v108
    v_sub_f32 v65, v65, v235
    v_cvt_pk_bf16_f32 v128, v64, v65
    v_cvt_pk_bf16_f32 v109, v66, v67
    v_lshlrev_b32 v235, 16, v109
    v_sub_f32 v66, v66, v235
    v_and_b32 v235, 0xffff0000, v109
    v_sub_f32 v67, v67, v235
    v_cvt_pk_bf16_f32 v129, v66, v67
    v_cvt_pk_bf16_f32 v110, v68, v69
    v_lshlrev_b32 v235, 16, v110
    v_sub_f32 v68, v68, v235
    v_and_b32 v235, 0xffff0000, v110
    v_sub_f32 v69, v69, v235
    v_cvt_pk_bf16_f32 v130, v68, v69
    v_cvt_pk_bf16_f32 v111, v70, v71
    v_lshlrev_b32 v235, 16, v111
    v_sub_f32 v70, v70, v235
    v_and_b32 v235, 0xffff0000, v111
    v_sub_f32 v71, v71, v235
    v_cvt_pk_bf16_f32 v131, v70, v71
    v_cvt_pk_bf16_f32 v112, v72, v73
    v_lshlrev_b32 v235, 16, v112
    v_sub_f32 v72, v72, v235
    v_and_b32 v235, 0xffff0000, v112
    v_sub_f32 v73, v73, v235
    v_cvt_pk_bf16_f32 v132, v72, v73
    v_cvt_pk_bf16_f32 v113, v74, v75
    v_lshlrev_b32 v235, 16, v113
    v_sub_f32 v74, v74, v235
    v_and_b32 v235, 0xffff0000, v113
    v_sub_f32 v75, v75, v235
    v_cvt_pk_bf16_f32 v133, v74, v75
    v_cvt_pk_bf16_f32 v114, v76, v77
    v_lshlrev_b32 v235, 16, v114
    v_sub_f32 v76, v76, v235
    v_and_b32 v235, 0xffff0000, v114
    v_sub_f32 v77, v77, v235
    v_cvt_pk_bf16_f32 v134, v76, v77
    v_cvt_pk_bf16_f32 v115, v78, v79
    v_lshlrev_b32 v235, 16, v115
    v_sub_f32 v78, v78, v235
    v_and_b32 v235, 0xffff0000, v115
    v_sub_f32 v79, v79, v235
    v_cvt_pk_bf16_f32 v135, v78, v79
    v_cvt_pk_bf16_f32 v116, v80, v81
    v_lshlrev_b32 v235, 16, v116
    v_sub_f32 v80, v80, v235
    v_and_b32 v235, 0xffff0000, v116
    v_sub_f32 v81, v81, v235
    v_cvt_pk_bf16_f32 v136, v80, v81
    v_cvt_pk_bf16_f32 v117, v82, v83
    v_lshlrev_b32 v235, 16, v117
    v_sub_f32 v82, v82, v235
    v_and_b32 v235, 0xffff0000, v117
    v_sub_f32 v83, v83, v235
    v_cvt_pk_bf16_f32 v137, v82, v83
    v_cvt_pk_bf16_f32 v118, v84, v85
    v_lshlrev_b32 v235, 16, v118
    v_sub_f32 v84, v84, v235
    v_and_b32 v235, 0xffff0000, v118
    v_sub_f32 v85, v85, v235
    v_cvt_pk_bf16_f32 v138, v84, v85
    v_cvt_pk_bf16_f32 v119, v86, v87
    v_lshlrev_b32 v235, 16, v119
    v_sub_f32 v86, v86, v235
    v_and_b32 v235, 0xffff0000, v119
    v_sub_f32 v87, v87, v235
    v_cvt_pk_bf16_f32 v139, v86, v87
    v_cvt_pk_bf16_f32 v120, v88, v89
    v_lshlrev_b32 v235, 16, v120
    v_sub_f32 v88, v88, v235
    v_and_b32 v235, 0xffff0000, v120
    v_sub_f32 v89, v89, v235
    v_cvt_pk_bf16_f32 v140, v88, v89
    v_cvt_pk_bf16_f32 v121, v90, v91
    v_lshlrev_b32 v235, 16, v121
    v_sub_f32 v90, v90, v235
    v_and_b32 v235, 0xffff0000, v121
    v_sub_f32 v91, v91, v235
    v_cvt_pk_bf16_f32 v141, v90, v91
    v_cvt_pk_bf16_f32 v122, v92, v93
    v_lshlrev_b32 v235, 16, v122
    v_sub_f32 v92, v92, v235
    v_and_b32 v235, 0xffff0000, v122
    v_sub_f32 v93, v93, v235
    v_cvt_pk_bf16_f32 v142, v92, v93
    v_cvt_pk_bf16_f32 v123, v94, v95
    v_lshlrev_b32 v235, 16, v123
    v_sub_f32 v94, v94, v235
    v_and_b32 v235, 0xffff0000, v123
    v_sub_f32 v95, v95, v235
    v_cvt_pk_bf16_f32 v143, v94, v95
    s_mov_b32 exec_lo, 0x110000
    s_mov_b32 exec_hi, 0x110000
    v_mov_b32 v168, v108
    v_mov_b32 v169, v109
    v_mov_b32 v170, v110
    v_mov_b32 v171, v111
    v_mov_b32 v188, v112
    v_mov_b32 v189, v113
    v_mov_b32 v190, v114
    v_mov_b32 v191, v115
    v_mov_b32 v208, v116
    v_mov_b32 v209, v117
    v_mov_b32 v210, v118
    v_mov_b32 v211, v119
    v_mov_b32 v228, v120
    v_mov_b32 v229, v121
    v_mov_b32 v230, v122
    v_mov_b32 v231, v123
    s_mov_b32 exec_lo, 0x220000
    s_mov_b32 exec_hi, 0x220000
    v_mov_b32 v168, v128
    v_mov_b32 v169, v129
    v_mov_b32 v170, v130
    v_mov_b32 v171, v131
    v_mov_b32 v188, v132
    v_mov_b32 v189, v133
    v_mov_b32 v190, v134
    v_mov_b32 v191, v135
    v_mov_b32 v208, v136
    v_mov_b32 v209, v137
    v_mov_b32 v210, v138
    v_mov_b32 v211, v139
    v_mov_b32 v228, v140
    v_mov_b32 v229, v141
    v_mov_b32 v230, v142
    v_mov_b32 v231, v143
    s_mov_b64 exec, -1
L_half:
    s_waitcnt lgkmcnt(0)
    s_mov_b32 exec_lo, 0x33ffff
    s_mov_b32 exec_hi, 0x33ffff
    s_lshl_b32 s53, s51, 2
    s_add_u32 s53, s53, 0
    s_mul_i32 s54, s53, 57
    s_lshr_b32 s54, s54, 9
    s_mul_i32 s54, s54, 36
    s_add_u32 s53, s53, s54
    s_lshl_b32 s53, s53, 10
    s_add_u32 s53, s53, s52
    buffer_store_dwordx4 v[168:171], v2, s[28:31], s53 offen sc1
    s_lshl_b32 s53, s51, 2
    s_add_u32 s53, s53, 1
    s_mul_i32 s54, s53, 57
    s_lshr_b32 s54, s54, 9
    s_mul_i32 s54, s54, 36
    s_add_u32 s53, s53, s54
    s_lshl_b32 s53, s53, 10
    s_add_u32 s53, s53, s52
    buffer_store_dwordx4 v[188:191], v2, s[28:31], s53 offen sc1
    s_lshl_b32 s53, s51, 2
    s_add_u32 s53, s53, 2
    s_mul_i32 s54, s53, 57
    s_lshr_b32 s54, s54, 9
    s_mul_i32 s54, s54, 36
    s_add_u32 s53, s53, s54
    s_lshl_b32 s53, s53, 10
    s_add_u32 s53, s53, s52
    buffer_store_dwordx4 v[208:211], v2, s[28:31], s53 offen sc1
    s_lshl_b32 s53, s51, 2
    s_add_u32 s53, s53, 3
    s_mul_i32 s54, s53, 57
    s_lshr_b32 s54, s54, 9
    s_mul_i32 s54, s54, 36
    s_add_u32 s53, s53, s54
    s_lshl_b32 s53, s53, 10
    s_add_u32 s53, s53, s52
    buffer_store_dwordx4 v[228:231], v2, s[28:31], s53 offen sc1
    s_mov_b64 exec, -1
    s_branch L_packed
L_noprep:
    s_mov_b32 s32, s12
    s_mov_b32 s33, s13
    s_mov_b32 s34, 0xa2000
    s_mov_b32 s35, 0x20000
    v_lshrrev_b32 v240, 4, v0
    v_mul_u32_u24 v240, 1152, v240
    v_and_b32 v241, 15, v0
    v_lshl_add_u32 v240, v241, 4, v240
    s_sub_u32 s51, s48, 27
    s_lshl_b32 s52, s51, 8
    buffer_load_dwordx4 v[96:99], v240, s[32:35], s52 offen
    s_add_u32 s52, s52, 18432
    buffer_load_dwordx4 v[100:103], v240, s[32:35], s52 offen
    s_add_u32 s52, s52, 18432
    buffer_load_dwordx4 v[104:107], v240, s[32:35], s52 offen
    s_add_u32 s52, s52, 18432
    buffer_load_dwordx4 v[108:111], v240, s[32:35], s52 offen
    s_add_u32 s52, s52, 18432
    buffer_load_dwordx4 v[112:115], v240, s[32:35], s52 offen
    s_add_u32 s52, s52, 18432
    buffer_load_dwordx4 v[116:119], v240, s[32:35], s52 offen
    s_add_u32 s52, s52, 18432
    buffer_load_dwordx4 v[120:123], v240, s[32:35], s52 offen
    s_add_u32 s52, s52, 18432
    buffer_load_dwordx4 v[124:127], v240, s[32:35], s52 offen
    s_add_u32 s52, s52, 18432
    buffer_load_dwordx4 v[128:131], v240, s[32:35], s52 offen
    s_add_u32 s52, s52, 18432
    buffer_load_dwordx4 v[132:135], v240, s[32:35], s52 offen
    s_add_u32 s52, s52, 18432
    buffer_load_dwordx4 v[136:139], v240, s[32:35], s52 offen
    s_add_u32 s52, s52, 18432
    buffer_load_dwordx4 v[140:143], v240, s[32:35], s52 offen
    s_add_u32 s52, s52, 18432
    buffer_load_dwordx4 v[144:147], v240, s[32:35], s52 offen
    s_add_u32 s52, s52, 18432
    buffer_load_dwordx4 v[148:151], v240, s[32:35], s52 offen
    s_add_u32 s52, s52, 18432
    buffer_load_dwordx4 v[152:155], v240, s[32:35], s52 offen
    s_add_u32 s52, s52, 18432
    buffer_load_dwordx4 v[156:159], v240, s[32:35], s52 offen
    s_add_u32 s52, s52, 18432
    buffer_load_dwordx4 v[160:163], v240, s[32:35], s52 offen
    s_add_u32 s52, s52, 18432
    buffer_load_dwordx4 v[164:167], v240, s[32:35], s52 offen
    s_add_u32 s52, s52, 18432
    buffer_load_dwordx4 v[168:171], v240, s[32:35], s52 offen
    s_add_u32 s52, s52, 18432
    buffer_load_dwordx4 v[172:175], v240, s[32:35], s52 offen
    s_add_u32 s52, s52, 18432
    buffer_load_dwordx4 v[176:179], v240, s[32:35], s52 offen
    s_add_u32 s52, s52, 18432
    buffer_load_dwordx4 v[180:183], v240, s[32:35], s52 offen
    s_add_u32 s52, s52, 18432
    buffer_load_dwordx4 v[184:187], v240, s[32:35], s52 offen
    s_add_u32 s52, s52, 18432
    buffer_load_dwordx4 v[188:191], v240, s[32:35], s52 offen
    s_add_u32 s52, s52, 18432
    buffer_load_dwordx4 v[192:195], v240, s[32:35], s52 offen
    s_add_u32 s52, s52, 18432
    buffer_load_dwordx4 v[196:199], v240, s[32:35], s52 offen
    s_add_u32 s52, s52, 18432
    buffer_load_dwordx4 v[200:203], v240, s[32:35], s52 offen
    s_add_u32 s52, s52, 18432
    buffer_load_dwordx4 v[204:207], v240, s[32:35], s52 offen
    s_add_u32 s52, s52, 18432
    buffer_load_dwordx4 v[208:211], v240, s[32:35], s52 offen
    s_add_u32 s52, s52, 18432
    buffer_load_dwordx4 v[212:215], v240, s[32:35], s52 offen
    s_add_u32 s52, s52, 18432
    buffer_load_dwordx4 v[216:219], v240, s[32:35], s52 offen
    s_add_u32 s52, s52, 18432
    buffer_load_dwordx4 v[220:223], v240, s[32:35], s52 offen
    s_add_u32 s52, s52, 18432
    buffer_load_dwordx4 v[224:227], v240, s[32:35], s52 offen
    s_add_u32 s52, s52, 18432
    buffer_load_dwordx4 v[228:231], v240, s[32:35], s52 offen
    s_add_u32 s52, s52, 18432
    buffer_load_dwordx4 v[232:235], v240, s[32:35], s52 offen
    s_add_u32 s52, s52, 18432
    buffer_load_dwordx4 v[236:239], v240, s[32:35], s52 offen
    s_add_u32 s52, s52, 18432
    s_mov_b32 s53, 0x3f80
    s_mov_b32 s54, 0x3f800000
    v_mov_b32 v240, 0
    v_mov_b32 v241, 0
    v_mov_b32 v242, 0
    v_mov_b32 v243, 0
    v_mov_b32 v244, 0
    v_mov_b32 v245, 0
    v_mov_b32 v246, 0
    v_mov_b32 v247, 0
    s_waitcnt vmcnt(35)
    v_dot2c_f32_bf16 v240, s53, v96
    v_dot2c_f32_bf16 v241, s54, v96
    v_dot2c_f32_bf16 v242, s53, v97
    v_dot2c_f32_bf16 v243, s54, v97
    v_dot2c_f32_bf16 v244, s53, v98
    v_dot2c_f32_bf16 v245, s54, v98
    v_dot2c_f32_bf16 v246, s53, v99
    v_dot2c_f32_bf16 v247, s54, v99
    s_waitcnt vmcnt(34)
    v_dot2c_f32_bf16 v240, s53, v100
    v_dot2c_f32_bf16 v241, s54, v100
    v_dot2c_f32_bf16 v242, s53, v101
    v_dot2c_f32_bf16 v243, s54, v101
    v_dot2c_f32_bf16 v244, s53, v102
    v_dot2c_f32_bf16 v245, s54, v102
    v_dot2c_f32_bf16 v246, s53, v103
    v_dot2c_f32_bf16 v247, s54, v103
    s_waitcnt vmcnt(33)
    v_dot2c_f32_bf16 v240, s53, v104
    v_dot2c_f32_bf16 v241, s54, v104
    v_dot2c_f32_bf16 v242, s53, v105
    v_dot2c_f32_bf16 v243, s54, v105
    v_dot2c_f32_bf16 v244, s53, v106
    v_dot2c_f32_bf16 v245, s54, v106
    v_dot2c_f32_bf16 v246, s53, v107
    v_dot2c_f32_bf16 v247, s54, v107
    s_waitcnt vmcnt(32)
    v_dot2c_f32_bf16 v240, s53, v108
    v_dot2c_f32_bf16 v241, s54, v108
    v_dot2c_f32_bf16 v242, s53, v109
    v_dot2c_f32_bf16 v243, s54, v109
    v_dot2c_f32_bf16 v244, s53, v110
    v_dot2c_f32_bf16 v245, s54, v110
    v_dot2c_f32_bf16 v246, s53, v111
    v_dot2c_f32_bf16 v247, s54, v111
    s_waitcnt vmcnt(31)
    v_dot2c_f32_bf16 v240, s53, v112
    v_dot2c_f32_bf16 v241, s54, v112
    v_dot2c_f32_bf16 v242, s53, v113
    v_dot2c_f32_bf16 v243, s54, v113
    v_dot2c_f32_bf16 v244, s53, v114
    v_dot2c_f32_bf16 v245, s54, v114
    v_dot2c_f32_bf16 v246, s53, v115
    v_dot2c_f32_bf16 v247, s54, v115
    s_waitcnt vmcnt(30)
    v_dot2c_f32_bf16 v240, s53, v116
    v_dot2c_f32_bf16 v241, s54, v116
    v_dot2c_f32_bf16 v242, s53, v117
    v_dot2c_f32_bf16 v243, s54, v117
    v_dot2c_f32_bf16 v244, s53, v118
    v_dot2c_f32_bf16 v245, s54, v118
    v_dot2c_f32_bf16 v246, s53, v119
    v_dot2c_f32_bf16 v247, s54, v119
    s_waitcnt vmcnt(29)
    v_dot2c_f32_bf16 v240, s53, v120
    v_dot2c_f32_bf16 v241, s54, v120
    v_dot2c_f32_bf16 v242, s53, v121
    v_dot2c_f32_bf16 v243, s54, v121
    v_dot2c_f32_bf16 v244, s53, v122
    v_dot2c_f32_bf16 v245, s54, v122
    v_dot2c_f32_bf16 v246, s53, v123
    v_dot2c_f32_bf16 v247, s54, v123
    s_waitcnt vmcnt(28)
    v_dot2c_f32_bf16 v240, s53, v124
    v_dot2c_f32_bf16 v241, s54, v124
    v_dot2c_f32_bf16 v242, s53, v125
    v_dot2c_f32_bf16 v243, s54, v125
    v_dot2c_f32_bf16 v244, s53, v126
    v_dot2c_f32_bf16 v245, s54, v126
    v_dot2c_f32_bf16 v246, s53, v127
    v_dot2c_f32_bf16 v247, s54, v127
    s_waitcnt vmcnt(27)
    v_dot2c_f32_bf16 v240, s53, v128
    v_dot2c_f32_bf16 v241, s54, v128
    v_dot2c_f32_bf16 v242, s53, v129
    v_dot2c_f32_bf16 v243, s54, v129
    v_dot2c_f32_bf16 v244, s53, v130
    v_dot2c_f32_bf16 v245, s54, v130
    v_dot2c_f32_bf16 v246, s53, v131
    v_dot2c_f32_bf16 v247, s54, v131
    s_waitcnt vmcnt(26)
    v_dot2c_f32_bf16 v240, s53, v132
    v_dot2c_f32_bf16 v241, s54, v132
    v_dot2c_f32_bf16 v242, s53, v133
    v_dot2c_f32_bf16 v243, s54, v133
    v_dot2c_f32_bf16 v244, s53, v134
    v_dot2c_f32_bf16 v245, s54, v134
    v_dot2c_f32_bf16 v246, s53, v135
    v_dot2c_f32_bf16 v247, s54, v135
    s_waitcnt vmcnt(25)
    v_dot2c_f32_bf16 v240, s53, v136
    v_dot2c_f32_bf16 v241, s54, v136
    v_dot2c_f32_bf16 v242, s53, v137
    v_dot2c_f32_bf16 v243, s54, v137
    v_dot2c_f32_bf16 v244, s53, v138
    v_dot2c_f32_bf16 v245, s54, v138
    v_dot2c_f32_bf16 v246, s53, v139
    v_dot2c_f32_bf16 v247, s54, v139
    s_waitcnt vmcnt(24)
    v_dot2c_f32_bf16 v240, s53, v140
    v_dot2c_f32_bf16 v241, s54, v140
    v_dot2c_f32_bf16 v242, s53, v141
    v_dot2c_f32_bf16 v243, s54, v141
    v_dot2c_f32_bf16 v244, s53, v142
    v_dot2c_f32_bf16 v245, s54, v142
    v_dot2c_f32_bf16 v246, s53, v143
    v_dot2c_f32_bf16 v247, s54, v143
    s_waitcnt vmcnt(23)
    v_dot2c_f32_bf16 v240, s53, v144
    v_dot2c_f32_bf16 v241, s54, v144
    v_dot2c_f32_bf16 v242, s53, v145
    v_dot2c_f32_bf16 v243, s54, v145
    v_dot2c_f32_bf16 v244, s53, v146
    v_dot2c_f32_bf16 v245, s54, v146
    v_dot2c_f32_bf16 v246, s53, v147
    v_dot2c_f32_bf16 v247, s54, v147
    s_waitcnt vmcnt(22)
    v_dot2c_f32_bf16 v240, s53, v148
    v_dot2c_f32_bf16 v241, s54, v148
    v_dot2c_f32_bf16 v242, s53, v149
    v_dot2c_f32_bf16 v243, s54, v149
    v_dot2c_f32_bf16 v244, s53, v150
    v_dot2c_f32_bf16 v245, s54, v150
    v_dot2c_f32_bf16 v246, s53, v151
    v_dot2c_f32_bf16 v247, s54, v151
    s_waitcnt vmcnt(21)
    v_dot2c_f32_bf16 v240, s53, v152
    v_dot2c_f32_bf16 v241, s54, v152
    v_dot2c_f32_bf16 v242, s53, v153
    v_dot2c_f32_bf16 v243, s54, v153
    v_dot2c_f32_bf16 v244, s53, v154
    v_dot2c_f32_bf16 v245, s54, v154
    v_dot2c_f32_bf16 v246, s53, v155
    v_dot2c_f32_bf16 v247, s54, v155
    s_waitcnt vmcnt(20)
    v_dot2c_f32_bf16 v240, s53, v156
    v_dot2c_f32_bf16 v241, s54, v156
    v_dot2c_f32_bf16 v242, s53, v157
    v_dot2c_f32_bf16 v243, s54, v157
    v_dot2c_f32_bf16 v244, s53, v158
    v_dot2c_f32_bf16 v245, s54, v158
    v_dot2c_f32_bf16 v246, s53, v159
    v_dot2c_f32_bf16 v247, s54, v159
    s_waitcnt vmcnt(19)
    v_dot2c_f32_bf16 v240, s53, v160
    v_dot2c_f32_bf16 v241, s54, v160
    v_dot2c_f32_bf16 v242, s53, v161
    v_dot2c_f32_bf16 v243, s54, v161
    v_dot2c_f32_bf16 v244, s53, v162
    v_dot2c_f32_bf16 v245, s54, v162
    v_dot2c_f32_bf16 v246, s53, v163
    v_dot2c_f32_bf16 v247, s54, v163
    s_waitcnt vmcnt(18)
    v_dot2c_f32_bf16 v240, s53, v164
    v_dot2c_f32_bf16 v241, s54, v164
    v_dot2c_f32_bf16 v242, s53, v165
    v_dot2c_f32_bf16 v243, s54, v165
    v_dot2c_f32_bf16 v244, s53, v166
    v_dot2c_f32_bf16 v245, s54, v166
    v_dot2c_f32_bf16 v246, s53, v167
    v_dot2c_f32_bf16 v247, s54, v167
    s_waitcnt vmcnt(17)
    v_dot2c_f32_bf16 v240, s53, v168
    v_dot2c_f32_bf16 v241, s54, v168
    v_dot2c_f32_bf16 v242, s53, v169
    v_dot2c_f32_bf16 v243, s54, v169
    v_dot2c_f32_bf16 v244, s53, v170
    v_dot2c_f32_bf16 v245, s54, v170
    v_dot2c_f32_bf16 v246, s53, v171
    v_dot2c_f32_bf16 v247, s54, v171
    s_waitcnt vmcnt(16)
    v_dot2c_f32_bf16 v240, s53, v172
    v_dot2c_f32_bf16 v241, s54, v172
    v_dot2c_f32_bf16 v242, s53, v173
    v_dot2c_f32_bf16 v243, s54, v173
    v_dot2c_f32_bf16 v244, s53, v174
    v_dot2c_f32_bf16 v245, s54, v174
    v_dot2c_f32_bf16 v246, s53, v175
    v_dot2c_f32_bf16 v247, s54, v175
    s_waitcnt vmcnt(15)
    v_dot2c_f32_bf16 v240, s53, v176
    v_dot2c_f32_bf16 v241, s54, v176
    v_dot2c_f32_bf16 v242, s53, v177
    v_dot2c_f32_bf16 v243, s54, v177
    v_dot2c_f32_bf16 v244, s53, v178
    v_dot2c_f32_bf16 v245, s54, v178
    v_dot2c_f32_bf16 v246, s53, v179
    v_dot2c_f32_bf16 v247, s54, v179
    s_waitcnt vmcnt(14)
    v_dot2c_f32_bf16 v240, s53, v180
    v_dot2c_f32_bf16 v241, s54, v180
    v_dot2c_f32_bf16 v242, s53, v181
    v_dot2c_f32_bf16 v243, s54, v181
    v_dot2c_f32_bf16 v244, s53, v182
    v_dot2c_f32_bf16 v245, s54, v182
    v_dot2c_f32_bf16 v246, s53, v183
    v_dot2c_f32_bf16 v247, s54, v183
    s_waitcnt vmcnt(13)
    v_dot2c_f32_bf16 v240, s53, v184
    v_dot2c_f32_bf16 v241, s54, v184
    v_dot2c_f32_bf16 v242, s53, v185
    v_dot2c_f32_bf16 v243, s54, v185
    v_dot2c_f32_bf16 v244, s53, v186
    v_dot2c_f32_bf16 v245, s54, v186
    v_dot2c_f32_bf16 v246, s53, v187
    v_dot2c_f32_bf16 v247, s54, v187
    s_waitcnt vmcnt(12)
    v_dot2c_f32_bf16 v240, s53, v188
    v_dot2c_f32_bf16 v241, s54, v188
    v_dot2c_f32_bf16 v242, s53, v189
    v_dot2c_f32_bf16 v243, s54, v189
    v_dot2c_f32_bf16 v244, s53, v190
    v_dot2c_f32_bf16 v245, s54, v190
    v_dot2c_f32_bf16 v246, s53, v191
    v_dot2c_f32_bf16 v247, s54, v191
    s_waitcnt vmcnt(11)
    v_dot2c_f32_bf16 v240, s53, v192
    v_dot2c_f32_bf16 v241, s54, v192
    v_dot2c_f32_bf16 v242, s53, v193
    v_dot2c_f32_bf16 v243, s54, v193
    v_dot2c_f32_bf16 v244, s53, v194
    v_dot2c_f32_bf16 v245, s54, v194
    v_dot2c_f32_bf16 v246, s53, v195
    v_dot2c_f32_bf16 v247, s54, v195
    s_waitcnt vmcnt(10)
    v_dot2c_f32_bf16 v240, s53, v196
    v_dot2c_f32_bf16 v241, s54, v196
    v_dot2c_f32_bf16 v242, s53, v197
    v_dot2c_f32_bf16 v243, s54, v197
    v_dot2c_f32_bf16 v244, s53, v198
    v_dot2c_f32_bf16 v245, s54, v198
    v_dot2c_f32_bf16 v246, s53, v199
    v_dot2c_f32_bf16 v247, s54, v199
    s_waitcnt vmcnt(9)
    v_dot2c_f32_bf16 v240, s53, v200
    v_dot2c_f32_bf16 v241, s54, v200
    v_dot2c_f32_bf16 v242, s53, v201
    v_dot2c_f32_bf16 v243, s54, v201
    v_dot2c_f32_bf16 v244, s53, v202
    v_dot2c_f32_bf16 v245, s54, v202
    v_dot2c_f32_bf16 v246, s53, v203
    v_dot2c_f32_bf16 v247, s54, v203
    s_waitcnt vmcnt(8)
    v_dot2c_f32_bf16 v240, s53, v204
    v_dot2c_f32_bf16 v241, s54, v204
    v_dot2c_f32_bf16 v242, s53, v205
    v_dot2c_f32_bf16 v243, s54, v205
    v_dot2c_f32_bf16 v244, s53, v206
    v_dot2c_f32_bf16 v245, s54, v206
    v_dot2c_f32_bf16 v246, s53, v207
    v_dot2c_f32_bf16 v247, s54, v207
    s_waitcnt vmcnt(7)
    v_dot2c_f32_bf16 v240, s53, v208
    v_dot2c_f32_bf16 v241, s54, v208
    v_dot2c_f32_bf16 v242, s53, v209
    v_dot2c_f32_bf16 v243, s54, v209
    v_dot2c_f32_bf16 v244, s53, v210
    v_dot2c_f32_bf16 v245, s54, v210
    v_dot2c_f32_bf16 v246, s53, v211
    v_dot2c_f32_bf16 v247, s54, v211
    s_waitcnt vmcnt(6)
    v_dot2c_f32_bf16 v240, s53, v212
    v_dot2c_f32_bf16 v241, s54, v212
    v_dot2c_f32_bf16 v242, s53, v213
    v_dot2c_f32_bf16 v243, s54, v213
    v_dot2c_f32_bf16 v244, s53, v214
    v_dot2c_f32_bf16 v245, s54, v214
    v_dot2c_f32_bf16 v246, s53, v215
    v_dot2c_f32_bf16 v247, s54, v215
    s_waitcnt vmcnt(5)
    v_dot2c_f32_bf16 v240, s53, v216
    v_dot2c_f32_bf16 v241, s54, v216
    v_dot2c_f32_bf16 v242, s53, v217
    v_dot2c_f32_bf16 v243, s54, v217
    v_dot2c_f32_bf16 v244, s53, v218
    v_dot2c_f32_bf16 v245, s54, v218
    v_dot2c_f32_bf16 v246, s53, v219
    v_dot2c_f32_bf16 v247, s54, v219
    s_waitcnt vmcnt(4)
    v_dot2c_f32_bf16 v240, s53, v220
    v_dot2c_f32_bf16 v241, s54, v220
    v_dot2c_f32_bf16 v242, s53, v221
    v_dot2c_f32_bf16 v243, s54, v221
    v_dot2c_f32_bf16 v244, s53, v222
    v_dot2c_f32_bf16 v245, s54, v222
    v_dot2c_f32_bf16 v246, s53, v223
    v_dot2c_f32_bf16 v247, s54, v223
    s_waitcnt vmcnt(3)
    v_dot2c_f32_bf16 v240, s53, v224
    v_dot2c_f32_bf16 v241, s54, v224
    v_dot2c_f32_bf16 v242, s53, v225
    v_dot2c_f32_bf16 v243, s54, v225
    v_dot2c_f32_bf16 v244, s53, v226
    v_dot2c_f32_bf16 v245, s54, v226
    v_dot2c_f32_bf16 v246, s53, v227
    v_dot2c_f32_bf16 v247, s54, v227
    s_waitcnt vmcnt(2)
    v_dot2c_f32_bf16 v240, s53, v228
    v_dot2c_f32_bf16 v241, s54, v228
    v_dot2c_f32_bf16 v242, s53, v229
    v_dot2c_f32_bf16 v243, s54, v229
    v_dot2c_f32_bf16 v244, s53, v230
    v_dot2c_f32_bf16 v245, s54, v230
    v_dot2c_f32_bf16 v246, s53, v231
    v_dot2c_f32_bf16 v247, s54, v231
    s_waitcnt vmcnt(1)
    v_dot2c_f32_bf16 v240, s53, v232
    v_dot2c_f32_bf16 v241, s54, v232
    v_dot2c_f32_bf16 v242, s53, v233
    v_dot2c_f32_bf16 v243, s54, v233
    v_dot2c_f32_bf16 v244, s53, v234
    v_dot2c_f32_bf16 v245, s54, v234
    v_dot2c_f32_bf16 v246, s53, v235
    v_dot2c_f32_bf16 v247, s54, v235
    s_waitcnt vmcnt(0)
    v_dot2c_f32_bf16 v240, s53, v236
    v_dot2c_f32_bf16 v241, s54, v236
    v_dot2c_f32_bf16 v242, s53, v237
    v_dot2c_f32_bf16 v243, s54, v237
    v_dot2c_f32_bf16 v244, s53, v238
    v_dot2c_f32_bf16 v245, s54, v238
    v_dot2c_f32_bf16 v246, s53, v239
    v_dot2c_f32_bf16 v247, s54, v239
    v_mov_b32 v96, v240
    v_mov_b32 v97, v241
    v_mov_b32 v98, v242
    v_mov_b32 v99, v243
    v_mov_b32 v100, v244
    v_mov_b32 v101, v245
    v_mov_b32 v102, v246
    v_mov_b32 v103, v247
    v_permlane16_swap_b32 v240, v96
    v_permlane16_swap_b32 v241, v97
    v_permlane16_swap_b32 v242, v98
    v_permlane16_swap_b32 v243, v99
    v_permlane16_swap_b32 v244, v100
    v_permlane16_swap_b32 v245, v101
    v_permlane16_swap_b32 v246, v102
    v_permlane16_swap_b32 v247, v103
    v_add_f32 v240, v240, v96
    v_add_f32 v241, v241, v97
    v_add_f32 v242, v242, v98
    v_add_f32 v243, v243, v99
    v_add_f32 v244, v244, v100
    v_add_f32 v245, v245, v101
    v_add_f32 v246, v246, v102
    v_add_f32 v247, v247, v103
    v_mov_b32 v96, v240
    v_mov_b32 v97, v241
    v_mov_b32 v98, v242
    v_mov_b32 v99, v243
    v_mov_b32 v100, v244
    v_mov_b32 v101, v245
    v_mov_b32 v102, v246
    v_mov_b32 v103, v247
    v_permlane32_swap_b32 v240, v96
    v_permlane32_swap_b32 v241, v97
    v_permlane32_swap_b32 v242, v98
    v_permlane32_swap_b32 v243, v99
    v_permlane32_swap_b32 v244, v100
    v_permlane32_swap_b32 v245, v101
    v_permlane32_swap_b32 v246, v102
    v_permlane32_swap_b32 v247, v103
    v_add_f32 v240, v240, v96
    v_add_f32 v241, v241, v97
    v_add_f32 v242, v242, v98
    v_add_f32 v243, v243, v99
    v_add_f32 v244, v244, v100
    v_add_f32 v245, v245, v101
    v_add_f32 v246, v246, v102
    v_add_f32 v247, v247, v103
    v_and_b32 v96, 15, v1
    v_lshlrev_b32 v96, 5, v96
    s_lshl_b32 s53, s46, 9
    v_add_u32 v96, s53, v96
    ds_write_b128 v96, v[240:243]
    ds_write_b128 v96, v[244:247] offset:16
    s_waitcnt lgkmcnt(0)
    s_barrier
    v_and_b32 v96, 31, v1
    v_lshlrev_b32 v96, 4, v96
    ds_read_b128 v[100:103], v96 offset:0
    ds_read_b128 v[104:107], v96 offset:512
    ds_read_b128 v[108:111], v96 offset:1024
    ds_read_b128 v[112:115], v96 offset:1536
    s_waitcnt lgkmcnt(2)
    v_add_f32 v100, v100, v104
    v_add_f32 v101, v101, v105
    v_add_f32 v102, v102, v106
    v_add_f32 v103, v103, v107
    s_waitcnt lgkmcnt(1)
    v_add_f32 v100, v100, v108
    v_add_f32 v101, v101, v109
    v_add_f32 v102, v102, v110
    v_add_f32 v103, v103, v111
    s_waitcnt lgkmcnt(0)
    v_add_f32 v100, v100, v112
    v_add_f32 v101, v101, v113
    v_add_f32 v102, v102, v114
    v_add_f32 v103, v103, v115
    s_lshl_b32 s53, s51, 9
    s_add_u32 s53, s53, 0x1980000
    s_cmp_eq_u32 s46, 0
    s_cselect_b32 s53, s53, 0x8000000
    s_mov_b32 exec_hi, 0
    buffer_store_dwordx4 v[100:103], v96, s[28:31], s53 offen sc1
    s_mov_b64 exec, -1
L_packed:
    s_waitcnt vmcnt(0)
    s_barrier
    s_lshl_b32 s53, s48, 2
    v_mov_b32 v96, 0
    v_mov_b32 v97, 1
    s_cmp_eq_u32 s46, 0
    s_cselect_b32 s53, s53, 0x8000000
    s_mov_b64 exec, 1
    buffer_store_dword v97, v96, s[40:43], s53 offen offset:128 sc1
    s_mov_b64 exec, -1
    v_lshlrev_b32 v126, 2, v1
    s_cmp_eq_u32 s46, 0
    s_cselect_b32 s69, 0, 0x8000000
    s_mov_b32 exec_hi, 0
    buffer_load_dword v127, v126, s[40:43], s69 offen sc1
    s_mov_b64 exec, -1
    s_waitcnt vmcnt(0)
    s_cmp_lg_u32 s46, 0
    s_cbranch_scc1 L_p2
    v_cmp_gt_u32 vcc, 1, v127
    s_nop 1
    s_cmp_eq_u32 vcc_lo, 0
    s_cbranch_scc1 L_clr_6
    s_mov_b32 exec_lo, 0xffffffff
    s_mov_b32 exec_hi, 0
    s_mov_b32 s69, 0
L_poll_7:
    buffer_load_dword v127, v126, s[40:43], 0 offen sc1
    s_add_u32 s69, s69, 1
    s_cmp_gt_u32 s69, 400000
    s_waitcnt vmcnt(0)
    s_cbranch_scc1 L_pollout_8
    v_cmp_gt_u32 vcc, 1, v127
    s_nop 1
    s_cbranch_vccnz L_poll_7
L_pollout_8:
    s_mov_b64 exec, -1
L_clr_6:
L_p2:
    s_mul_i32 s48, s57, 288
    s_add_u32 s48, s48, s60
    s_lshl_b32 s48, s48, 9
    s_add_u32 s48, s48, 0x100000
    s_add_u32 s49, s48, 73728
    s_add_u32 s55, s48, 0xfff79000
    s_mul_i32 s56, s57, 73728
    s_mul_i32 s62, s59, 576
    s_add_u32 s56, s56, s62
    s_add_u32 s56, s56, 0x5b8000
    s_lshl_b32 s63, s57, 1
    s_cmp_lg_u32 s46, 0
    s_cbranch_scc1 L_p2go_9
    s_mov_b32 exec_lo, 0x3ffff
    s_mov_b32 exec_hi, 0
    s_mov_b32 s69, 0
L_poll_10:
    buffer_load_dword v6, v5, s[28:31], 0 offen sc1
    s_add_u32 s69, s69, 1
    s_cmp_gt_u32 s69, 400000
    s_waitcnt vmcnt(0)
    s_cbranch_scc1 L_pollout_11
    v_cmp_gt_u32 vcc, 1, v6
    s_nop 1
    s_cbranch_vccnz L_poll_10
L_pollout_11:
    s_mov_b64 exec, -1
L_p2go_9:
    s_barrier
    buffer_load_dwordx4 v[16:19], v2, s[28:31], s48 offen sc1
    s_mov_b32 exec_hi, 0
    buffer_load_dwordx4 v[20:23], v2, s[28:31], s48 offen offset:1024 sc1
    s_mov_b64 exec, -1
    s_add_u32 s62, s55, 0
    s_cmp_ge_u32 s63, 8
    s_cselect_b32 s62, s62, 0x8000000
    buffer_load_dwordx4 a[0:3], v2, s[28:31], s62 offen sc1
    s_mov_b32 exec_hi, 0
    buffer_load_dwordx4 a[4:7], v2, s[28:31], s62 offen offset:1024 sc1
    s_mov_b64 exec, -1
    s_add_u32 s62, s55, 73728
    s_cmp_ge_u32 s63, 7
    s_cselect_b32 s62, s62, 0x8000000
    buffer_load_dwordx4 a[8:11], v2, s[28:31], s62 offen sc1
    s_mov_b32 exec_hi, 0
    buffer_load_dwordx4 a[12:15], v2, s[28:31], s62 offen offset:1024 sc1
    s_mov_b64 exec, -1
    s_add_u32 s62, s55, 147456
    s_cmp_ge_u32 s63, 6
    s_cselect_b32 s62, s62, 0x8000000
    buffer_load_dwordx4 a[16:19], v2, s[28:31], s62 offen sc1
    s_mov_b32 exec_hi, 0
    buffer_load_dwordx4 a[20:23], v2, s[28:31], s62 offen offset:1024 sc1
    s_mov_b64 exec, -1
    s_add_u32 s62, s55, 221184
    s_cmp_ge_u32 s63, 5
    s_cselect_b32 s62, s62, 0x8000000
    buffer_load_dwordx4 a[24:27], v2, s[28:31], s62 offen sc1
    s_mov_b32 exec_hi, 0
    buffer_load_dwordx4 a[28:31], v2, s[28:31], s62 offen offset:1024 sc1
    s_mov_b64 exec, -1
    s_add_u32 s62, s55, 294912
    s_cmp_ge_u32 s63, 4
    s_cselect_b32 s62, s62, 0x8000000
    buffer_load_dwordx4 a[32:35], v2, s[28:31], s62 offen sc1
    s_mov_b32 exec_hi, 0
    buffer_load_dwordx4 a[36:39], v2, s[28:31], s62 offen offset:1024 sc1
    s_mov_b64 exec, -1
    s_add_u32 s62, s55, 368640
    s_cmp_ge_u32 s63, 3
    s_cselect_b32 s62, s62, 0x8000000
    buffer_load_dwordx4 a[40:43], v2, s[28:31], s62 offen sc1
    s_mov_b32 exec_hi, 0
    buffer_load_dwordx4 a[44:47], v2, s[28:31], s62 offen offset:1024 sc1
    s_mov_b64 exec, -1
    s_add_u32 s62, s55, 442368
    s_cmp_ge_u32 s63, 2
    s_cselect_b32 s62, s62, 0x8000000
    buffer_load_dwordx4 a[48:51], v2, s[28:31], s62 offen sc1
    s_mov_b32 exec_hi, 0
    buffer_load_dwordx4 a[52:55], v2, s[28:31], s62 offen offset:1024 sc1
    s_mov_b64 exec, -1
    s_add_u32 s62, s55, 516096
    s_cmp_ge_u32 s63, 1
    s_cselect_b32 s62, s62, 0x8000000
    buffer_load_dwordx4 a[56:59], v2, s[28:31], s62 offen sc1
    s_mov_b32 exec_hi, 0
    buffer_load_dwordx4 a[60:63], v2, s[28:31], s62 offen offset:1024 sc1
    s_mov_b64 exec, -1
    s_add_u32 s62, s55, 589824
    buffer_load_dwordx4 a[64:67], v2, s[28:31], s62 offen sc1
    s_mov_b32 exec_hi, 0
    buffer_load_dwordx4 a[68:71], v2, s[28:31], s62 offen offset:1024 sc1
    s_mov_b64 exec, -1
    buffer_load_dwordx4 v[24:27], v2, s[28:31], s49 offen sc1
    s_mov_b32 exec_hi, 0
    buffer_load_dwordx4 v[28:31], v2, s[28:31], s49 offen offset:1024 sc1
    s_mov_b64 exec, -1
    s_add_u32 s62, s55, 663552
    buffer_load_dwordx4 a[72:75], v2, s[28:31], s62 offen sc1
    s_mov_b32 exec_hi, 0
    buffer_load_dwordx4 a[76:79], v2, s[28:31], s62 offen offset:1024 sc1
    s_mov_b64 exec, -1
    v_and_b32 v7, 31, v1
    v_lshlrev_b32 v7, 2, v7
    v_add_u32 v7, 128, v7
    buffer_load_dword v15, v7, s[40:43], 0 offen sc1
    s_mov_b32 exec_hi, 0
    s_cmp_gt_u32 s61, 0
    s_cselect_b32 s53, 0, -1
    s_waitcnt vmcnt(24)
    v_and_b32 v16, s53, v16
    s_cmp_gt_u32 s61, 1
    s_cselect_b32 s53, 0, -1
    v_and_b32 v17, s53, v17
    s_cmp_gt_u32 s61, 2
    s_cselect_b32 s53, 0, -1
    v_and_b32 v18, s53, v18
    s_cmp_ge_u32 s61, 1
    s_cselect_b32 s53, -1, 0
    s_waitcnt vmcnt(23)
    v_and_b32 v21, s53, v21
    s_cmp_ge_u32 s61, 2
    s_cselect_b32 s53, -1, 0
    v_and_b32 v22, s53, v22
    s_cmp_ge_u32 s61, 3
    s_cselect_b32 s53, -1, 0
    v_and_b32 v23, s53, v23
    s_mov_b64 exec, -1
    s_waitcnt vmcnt(22)
    v_mfma_f32_32x32x16_bf16 v[64:79], a[0:3], v[16:19], v[48:63]
    s_waitcnt vmcnt(21)
    v_mfma_f32_32x32x16_bf16 v[64:79], a[4:7], v[20:23], v[64:79]
    s_waitcnt vmcnt(20)
    v_mfma_f32_32x32x16_bf16 v[80:95], a[8:11], v[16:19], 0
    s_waitcnt vmcnt(19)
    v_mfma_f32_32x32x16_bf16 v[80:95], a[12:15], v[20:23], v[80:95]
    s_add_u32 s62, s56, 0
    s_cmp_ge_u32 s63, 8
    s_cselect_b32 s62, s62, 0x8000000
    s_mov_b32 exec_lo, 0x3ffff
    s_mov_b32 exec_hi, 0x3ffff
    buffer_load_dwordx4 a[80:83], v3, s[28:31], s62 offen sc1
    buffer_load_dwordx4 a[84:87], v4, s[28:31], s62 offen sc1
    s_mov_b64 exec, -1
    v_max_f32 v10, v64, v65
    v_max_f32 v11, v66, v67
    v_max3_f32 v10, v68, v69, v10
    v_max3_f32 v11, v70, v71, v11
    v_max3_f32 v10, v72, v73, v10
    v_max3_f32 v11, v74, v75, v11
    v_max3_f32 v10, v76, v77, v10
    v_max3_f32 v11, v78, v79, v11
    s_waitcnt vmcnt(20)
    v_mfma_f32_32x32x16_bf16 v[64:79], a[16:19], v[16:19], 0
    s_waitcnt vmcnt(19)
    v_mfma_f32_32x32x16_bf16 v[64:79], a[20:23], v[20:23], v[64:79]
    s_add_u32 s62, s56, 36864
    s_cmp_ge_u32 s63, 7
    s_cselect_b32 s62, s62, 0x8000000
    s_mov_b32 exec_lo, 0x3ffff
    s_mov_b32 exec_hi, 0x3ffff
    buffer_load_dwordx4 a[88:91], v3, s[28:31], s62 offen sc1
    buffer_load_dwordx4 a[92:95], v4, s[28:31], s62 offen sc1
    s_mov_b64 exec, -1
    v_max3_f32 v10, v80, v81, v10
    v_max3_f32 v11, v82, v83, v11
    v_max3_f32 v10, v84, v85, v10
    v_max3_f32 v11, v86, v87, v11
    v_max3_f32 v10, v88, v89, v10
    v_max3_f32 v11, v90, v91, v11
    v_max3_f32 v10, v92, v93, v10
    v_max3_f32 v11, v94, v95, v11
    s_waitcnt vmcnt(20)
    v_mfma_f32_32x32x16_bf16 v[80:95], a[24:27], v[16:19], 0
    s_waitcnt vmcnt(19)
    v_mfma_f32_32x32x16_bf16 v[80:95], a[28:31], v[20:23], v[80:95]
    s_add_u32 s62, s56, 73728
    s_cmp_ge_u32 s63, 6
    s_cselect_b32 s62, s62, 0x8000000
    s_mov_b32 exec_lo, 0x3ffff
    s_mov_b32 exec_hi, 0x3ffff
    buffer_load_dwordx4 a[96:99], v3, s[28:31], s62 offen sc1
    buffer_load_dwordx4 a[100:103], v4, s[28:31], s62 offen sc1
    s_mov_b64 exec, -1
    v_max3_f32 v10, v64, v65, v10
    v_max3_f32 v11, v66, v67, v11
    v_max3_f32 v10, v68, v69, v10
    v_max3_f32 v11, v70, v71, v11
    v_max3_f32 v10, v72, v73, v10
    v_max3_f32 v11, v74, v75, v11
    v_max3_f32 v10, v76, v77, v10
    v_max3_f32 v11, v78, v79, v11
    s_waitcnt vmcnt(20)
    v_mfma_f32_32x32x16_bf16 v[64:79], a[32:35], v[16:19], 0
    s_waitcnt vmcnt(19)
    v_mfma_f32_32x32x16_bf16 v[64:79], a[36:39], v[20:23], v[64:79]
    s_add_u32 s62, s56, 110592
    s_cmp_ge_u32 s63, 5
    s_cselect_b32 s62, s62, 0x8000000
    s_mov_b32 exec_lo, 0x3ffff
    s_mov_b32 exec_hi, 0x3ffff
    buffer_load_dwordx4 a[104:107], v3, s[28:31], s62 offen sc1
    buffer_load_dwordx4 a[108:111], v4, s[28:31], s62 offen sc1
    s_mov_b64 exec, -1
    v_max3_f32 v10, v80, v81, v10
    v_max3_f32 v11, v82, v83, v11
    v_max3_f32 v10, v84, v85, v10
    v_max3_f32 v11, v86, v87, v11
    v_max3_f32 v10, v88, v89, v10
    v_max3_f32 v11, v90, v91, v11
    v_max3_f32 v10, v92, v93, v10
    v_max3_f32 v11, v94, v95, v11
    s_waitcnt vmcnt(20)
    v_mfma_f32_32x32x16_bf16 v[80:95], a[40:43], v[16:19], 0
    s_waitcnt vmcnt(19)
    v_mfma_f32_32x32x16_bf16 v[80:95], a[44:47], v[20:23], v[80:95]
    s_add_u32 s62, s56, 147456
    s_cmp_ge_u32 s63, 4
    s_cselect_b32 s62, s62, 0x8000000
    s_mov_b32 exec_lo, 0x3ffff
    s_mov_b32 exec_hi, 0x3ffff
    buffer_load_dwordx4 a[112:115], v3, s[28:31], s62 offen sc1
    buffer_load_dwordx4 a[116:119], v4, s[28:31], s62 offen sc1
    s_mov_b64 exec, -1
    v_max3_f32 v10, v64, v65, v10
    v_max3_f32 v11, v66, v67, v11
    v_max3_f32 v10, v68, v69, v10
    v_max3_f32 v11, v70, v71, v11
    v_max3_f32 v10, v72, v73, v10
    v_max3_f32 v11, v74, v75, v11
    v_max3_f32 v10, v76, v77, v10
    v_max3_f32 v11, v78, v79, v11
    s_waitcnt vmcnt(20)
    v_mfma_f32_32x32x16_bf16 v[64:79], a[48:51], v[16:19], 0
    s_waitcnt vmcnt(19)
    v_mfma_f32_32x32x16_bf16 v[64:79], a[52:55], v[20:23], v[64:79]
    s_add_u32 s62, s56, 184320
    s_cmp_ge_u32 s63, 3
    s_cselect_b32 s62, s62, 0x8000000
    s_mov_b32 exec_lo, 0x3ffff
    s_mov_b32 exec_hi, 0x3ffff
    buffer_load_dwordx4 a[120:123], v3, s[28:31], s62 offen sc1
    buffer_load_dwordx4 a[124:127], v4, s[28:31], s62 offen sc1
    s_mov_b64 exec, -1
    v_max3_f32 v10, v80, v81, v10
    v_max3_f32 v11, v82, v83, v11
    v_max3_f32 v10, v84, v85, v10
    v_max3_f32 v11, v86, v87, v11
    v_max3_f32 v10, v88, v89, v10
    v_max3_f32 v11, v90, v91, v11
    v_max3_f32 v10, v92, v93, v10
    v_max3_f32 v11, v94, v95, v11
    s_waitcnt vmcnt(20)
    v_mfma_f32_32x32x16_bf16 v[80:95], a[56:59], v[16:19], 0
    s_waitcnt vmcnt(19)
    v_mfma_f32_32x32x16_bf16 v[80:95], a[60:63], v[20:23], v[80:95]
    s_add_u32 s62, s56, 221184
    s_cmp_ge_u32 s63, 2
    s_cselect_b32 s62, s62, 0x8000000
    s_mov_b32 exec_lo, 0x3ffff
    s_mov_b32 exec_hi, 0x3ffff
    buffer_load_dwordx4 a[128:131], v3, s[28:31], s62 offen sc1
    buffer_load_dwordx4 a[132:135], v4, s[28:31], s62 offen sc1
    s_mov_b64 exec, -1
    v_max3_f32 v10, v64, v65, v10
    v_max3_f32 v11, v66, v67, v11
    v_max3_f32 v10, v68, v69, v10
    v_max3_f32 v11, v70, v71, v11
    v_max3_f32 v10, v72, v73, v10
    v_max3_f32 v11, v74, v75, v11
    v_max3_f32 v10, v76, v77, v10
    v_max3_f32 v11, v78, v79, v11
    s_waitcnt vmcnt(20)
    v_mfma_f32_32x32x16_bf16 v[64:79], a[64:67], v[16:19], v[32:47]
    s_waitcnt vmcnt(19)
    v_mfma_f32_32x32x16_bf16 v[64:79], a[68:71], v[20:23], v[64:79]
    s_add_u32 s62, s56, 258048
    s_cmp_ge_u32 s63, 1
    s_cselect_b32 s62, s62, 0x8000000
    s_mov_b32 exec_lo, 0x3ffff
    s_mov_b32 exec_hi, 0x3ffff
    buffer_load_dwordx4 a[136:139], v3, s[28:31], s62 offen sc1
    buffer_load_dwordx4 a[140:143], v4, s[28:31], s62 offen sc1
    s_mov_b64 exec, -1
    v_max3_f32 v10, v80, v81, v10
    v_max3_f32 v11, v82, v83, v11
    v_max3_f32 v10, v84, v85, v10
    v_max3_f32 v11, v86, v87, v11
    v_max3_f32 v10, v88, v89, v10
    v_max3_f32 v11, v90, v91, v11
    v_max3_f32 v10, v92, v93, v10
    v_max3_f32 v11, v94, v95, v11
    s_add_u32 s62, s56, 294912
    s_mov_b32 exec_lo, 0x3ffff
    s_mov_b32 exec_hi, 0x3ffff
    buffer_load_dwordx4 a[144:147], v3, s[28:31], s62 offen sc1
    buffer_load_dwordx4 a[148:151], v4, s[28:31], s62 offen sc1
    s_mov_b64 exec, -1
    v_max3_f32 v10, v64, v65, v10
    v_max3_f32 v11, v66, v67, v11
    v_max3_f32 v10, v68, v69, v10
    v_max3_f32 v11, v70, v71, v11
    v_max3_f32 v10, v72, v73, v10
    v_max3_f32 v11, v74, v75, v11
    v_max3_f32 v10, v76, v77, v10
    v_max3_f32 v11, v78, v79, v11
    v_max_f32 v10, v10, v11
    v_mov_b32 v11, v10
    s_nop 1
    v_permlane32_swap_b32 v10, v11
    v_max_f32 v10, v10, v11
    v_sub_f32 v10, 0, v10
    v_cvt_pk_bf16_f32 v12, v10, v10
    v_and_b32 v12, 0xffff0000, v12
    v_sub_f32 v13, v10, v12
    v_cvt_pk_bf16_f32 v14, v13, v13
    v_and_b32 v14, 0xffff0000, v14
    v_sub_f32 v14, v13, v14
    s_mov_b64 exec, -1
    s_mov_b32 exec_lo, 0
    v_or_b32 v20, 0x3f80, v12
    v_cvt_pk_bf16_f32 v21, v13, v14
    s_mov_b64 exec, -1
    s_mov_b32 exec_hi, 0
    s_cmp_gt_u32 s61, 0
    s_cselect_b32 s53, 0, -1
    s_waitcnt vmcnt(22)
    v_and_b32 v24, s53, v24
    s_cmp_gt_u32 s61, 1
    s_cselect_b32 s53, 0, -1
    v_and_b32 v25, s53, v25
    s_cmp_gt_u32 s61, 2
    s_cselect_b32 s53, 0, -1
    v_and_b32 v26, s53, v26
    s_cmp_ge_u32 s61, 1
    s_cselect_b32 s53, -1, 0
    s_waitcnt vmcnt(21)
    v_and_b32 v29, s53, v29
    s_cmp_ge_u32 s61, 2
    s_cselect_b32 s53, -1, 0
    v_and_b32 v30, s53, v30
    s_cmp_ge_u32 s61, 3
    s_cselect_b32 s53, -1, 0
    v_and_b32 v31, s53, v31
    s_mov_b64 exec, -1
    s_add_u32 s62, s56, 331776
    s_mov_b32 exec_lo, 0x3ffff
    s_mov_b32 exec_hi, 0x3ffff
    buffer_load_dwordx4 a[152:155], v3, s[28:31], s62 offen sc1
    buffer_load_dwordx4 a[156:159], v4, s[28:31], s62 offen sc1
    s_mov_b64 exec, -1
    v_lshrrev_b32 v6, 4, v1
    v_lshl_add_u32 v6, s46, 2, v6
    v_mul_u32_u24 v6, 1152, v6
    v_and_b32 v8, 15, v1
    v_min_u32 v8, 13, v8
    v_lshl_add_u32 v6, v8, 3, v6
    v_add_u32 v8, 0x1a00000, v6
    buffer_load_dword v9, v8, s[28:31], 0 offen sc1
    s_waitcnt vmcnt(21)
    v_cmp_gt_u32 vcc, 1, v15
    s_nop 1
    s_cmp_eq_u32 vcc_lo, 0
    s_cbranch_scc1 L_packed_12
    s_mov_b32 exec_lo, 0xffffffff
    s_mov_b32 exec_hi, 0
    s_mov_b32 s69, 0
L_poll_13:
    buffer_load_dword v15, v7, s[40:43], 0 offen sc1
    s_add_u32 s69, s69, 1
    s_cmp_gt_u32 s69, 400000
    s_waitcnt vmcnt(0)
    s_cbranch_scc1 L_pollout_14
    v_cmp_gt_u32 vcc, 1, v15
    s_nop 1
    s_cbranch_vccnz L_poll_13
L_pollout_14:
    s_mov_b64 exec, -1
L_packed_12:
    v_mfma_f32_32x32x16_bf16 v[64:79], a[0:3], v[16:19], v[48:63]
    v_mfma_f32_32x32x16_bf16 v[64:79], a[4:7], v[20:23], v[64:79]
    v_mfma_f32_32x32x16_bf16 v[80:95], a[8:11], v[16:19], 0
    s_add_u32 s68, s67, 0
    s_mov_b32 exec_lo, 0xffff
    s_mov_b32 exec_hi, 0xffff
    buffer_load_dwordx4 a[180:183], v2, s[28:31], s68 offen offset:0 sc1
    s_mov_b64 exec, -1
    s_nop 5
    v_exp_f32 v64, v64
    v_exp_f32 v65, v65
    v_exp_f32 v66, v66
    v_exp_f32 v67, v67
    v_mfma_f32_32x32x16_bf16 v[80:95], a[12:15], v[20:23], v[80:95]
    v_mfma_f32_32x32x16_bf16 v[128:143], a[8:11], v[24:27], v[48:63]
    s_mov_b32 exec_lo, 0xffff
    s_mov_b32 exec_hi, 0xffff
    buffer_load_dwordx4 a[184:187], v2, s[28:31], s68 offen offset:1024 sc1
    s_mov_b64 exec, -1
    v_cvt_pk_bf16_f32 v96, v64, v65
    v_exp_f32 v68, v68
    v_exp_f32 v69, v69
    v_exp_f32 v70, v70
    v_exp_f32 v71, v71
    v_exp_f32 v72, v72
    v_mfma_f32_32x32x16_bf16 v[128:143], a[12:15], v[28:31], v[128:143]
    s_mov_b32 exec_lo, 0xffff
    s_mov_b32 exec_hi, 0xffff
    buffer_load_dwordx4 a[188:191], v2, s[28:31], s68 offen offset:2048 sc1
    s_mov_b64 exec, -1
    v_cvt_pk_bf16_f32 v97, v66, v67
    v_cvt_pk_bf16_f32 v98, v68, v69
    v_cvt_pk_bf16_f32 v99, v70, v71
    v_exp_f32 v73, v73
    v_exp_f32 v74, v74
    v_exp_f32 v75, v75
    v_exp_f32 v76, v76
    v_exp_f32 v77, v77
    v_exp_f32 v78, v78
    v_exp_f32 v79, v79
    v_cvt_pk_bf16_f32 v100, v72, v73
    v_cvt_pk_bf16_f32 v101, v74, v75
    v_cvt_pk_bf16_f32 v102, v76, v77
    v_cvt_pk_bf16_f32 v103, v78, v79
    v_mfma_f32_32x32x16_bf16 v[64:79], a[16:19], v[16:19], 0
    v_max_f32 v10, v128, v129
    v_max_f32 v11, v130, v131
    v_max3_f32 v10, v132, v133, v10
    v_max3_f32 v11, v134, v135, v11
    v_max3_f32 v10, v136, v137, v10
    v_max3_f32 v11, v138, v139, v11
    v_max3_f32 v10, v140, v141, v10
    v_max3_f32 v11, v142, v143, v11
    s_mov_b32 exec_lo, 0xffff
    s_mov_b32 exec_hi, 0xffff
    buffer_load_dwordx4 a[192:195], v2, s[28:31], s68 offen offset:3072 sc1
    s_mov_b64 exec, -1
    v_exp_f32 v80, v80
    v_exp_f32 v81, v81
    v_exp_f32 v82, v82
    v_exp_f32 v83, v83
    v_mfma_f32_32x32x16_bf16 v[64:79], a[20:23], v[20:23], v[64:79]
    v_mfma_f32_32x32x16_bf16 v[128:143], a[16:19], v[24:27], 0
    s_add_u32 s68, s67, 4096
    s_mov_b32 exec_lo, 0xffff
    s_mov_b32 exec_hi, 0xffff
    buffer_load_dwordx4 a[196:199], v2, s[28:31], s68 offen offset:0 sc1
    s_mov_b64 exec, -1
    v_cvt_pk_bf16_f32 v104, v80, v81
    v_exp_f32 v84, v84
    v_exp_f32 v85, v85
    v_exp_f32 v86, v86
    v_exp_f32 v87, v87
    v_exp_f32 v88, v88
    s_waitcnt vmcnt(25)
    v_mfma_f32_32x32x16_bf16 v[112:127], a[80:83], v[96:99], 0
    v_mfma_f32_32x32x16_bf16 v[128:143], a[20:23], v[28:31], v[128:143]
    s_mov_b32 exec_lo, 0xffff
    s_mov_b32 exec_hi, 0xffff
    buffer_load_dwordx4 a[200:203], v2, s[28:31], s68 offen offset:1024 sc1
    s_mov_b64 exec, -1
    v_cvt_pk_bf16_f32 v105, v82, v83
    v_cvt_pk_bf16_f32 v106, v84, v85
    v_cvt_pk_bf16_f32 v107, v86, v87
    v_exp_f32 v89, v89
    v_exp_f32 v90, v90
    v_exp_f32 v91, v91
    v_exp_f32 v92, v92
    s_waitcnt vmcnt(25)
    v_mfma_f32_32x32x16_bf16 v[112:127], a[84:87], v[100:103], v[112:127]
    v_exp_f32 v93, v93
    v_exp_f32 v94, v94
    v_exp_f32 v95, v95
    v_cvt_pk_bf16_f32 v108, v88, v89
    v_cvt_pk_bf16_f32 v109, v90, v91
    v_cvt_pk_bf16_f32 v110, v92, v93
    v_cvt_pk_bf16_f32 v111, v94, v95
    v_mfma_f32_32x32x16_bf16 v[80:95], a[24:27], v[16:19], 0
    v_max3_f32 v10, v128, v129, v10
    v_max3_f32 v11, v130, v131, v11
    v_max3_f32 v10, v132, v133, v10
    v_max3_f32 v11, v134, v135, v11
    v_max3_f32 v10, v136, v137, v10
    v_max3_f32 v11, v138, v139, v11
    v_max3_f32 v10, v140, v141, v10
    v_max3_f32 v11, v142, v143, v11
    s_mov_b32 exec_lo, 0xffff
    s_mov_b32 exec_hi, 0xffff
    buffer_load_dwordx4 a[204:207], v2, s[28:31], s68 offen offset:2048 sc1
    s_mov_b64 exec, -1
    v_exp_f32 v64, v64
    v_exp_f32 v65, v65
    v_exp_f32 v66, v66
    v_exp_f32 v67, v67
    v_mfma_f32_32x32x16_bf16 v[80:95], a[28:31], v[20:23], v[80:95]
    v_mfma_f32_32x32x16_bf16 v[128:143], a[24:27], v[24:27], 0
    s_mov_b32 exec_lo, 0xffff
    s_mov_b32 exec_hi, 0xffff
    buffer_load_dwordx4 a[208:211], v2, s[28:31], s68 offen offset:3072 sc1
    s_mov_b64 exec, -1
    v_cvt_pk_bf16_f32 v96, v64, v65
    v_exp_f32 v68, v68
    v_exp_f32 v69, v69
    v_exp_f32 v70, v70
    v_exp_f32 v71, v71
    v_exp_f32 v72, v72
    s_waitcnt vmcnt(26)
    v_mfma_f32_32x32x16_bf16 v[112:127], a[88:91], v[104:107], v[112:127]
    v_mfma_f32_32x32x16_bf16 v[128:143], a[28:31], v[28:31], v[128:143]
    s_add_u32 s68, s67, 8192
    s_mov_b32 exec_lo, 0xffff
    s_mov_b32 exec_hi, 0xffff
    buffer_load_dwordx4 a[212:215], v2, s[28:31], s68 offen offset:0 sc1
    s_mov_b64 exec, -1
    v_cvt_pk_bf16_f32 v97, v66, v67
    v_cvt_pk_bf16_f32 v98, v68, v69
    v_cvt_pk_bf16_f32 v99, v70, v71
    v_exp_f32 v73, v73
    v_exp_f32 v74, v74
    v_exp_f32 v75, v75
    v_exp_f32 v76, v76
    s_waitcnt vmcnt(26)
    v_mfma_f32_32x32x16_bf16 v[112:127], a[92:95], v[108:111], v[112:127]
    v_exp_f32 v77, v77
    v_exp_f32 v78, v78
    v_exp_f32 v79, v79
    v_cvt_pk_bf16_f32 v100, v72, v73
    v_cvt_pk_bf16_f32 v101, v74, v75
    v_cvt_pk_bf16_f32 v102, v76, v77
    v_cvt_pk_bf16_f32 v103, v78, v79
    v_mfma_f32_32x32x16_bf16 v[64:79], a[32:35], v[16:19], 0
    v_max3_f32 v10, v128, v129, v10
    v_max3_f32 v11, v130, v131, v11
    v_max3_f32 v10, v132, v133, v10
    v_max3_f32 v11, v134, v135, v11
    v_max3_f32 v10, v136, v137, v10
    v_max3_f32 v11, v138, v139, v11
    v_max3_f32 v10, v140, v141, v10
    v_max3_f32 v11, v142, v143, v11
    buffer_load_dwordx4 a[216:219], v2, s[28:31], s68 offen offset:1024 sc1
    v_exp_f32 v80, v80
    v_exp_f32 v81, v81
    v_exp_f32 v82, v82
    v_exp_f32 v83, v83
    v_mfma_f32_32x32x16_bf16 v[64:79], a[36:39], v[20:23], v[64:79]
    v_mfma_f32_32x32x16_bf16 v[128:143], a[32:35], v[24:27], 0
    buffer_load_dwordx4 a[220:223], v2, s[28:31], s68 offen offset:2048 sc1
    v_cvt_pk_bf16_f32 v104, v80, v81
    v_exp_f32 v84, v84
    v_exp_f32 v85, v85
    v_exp_f32 v86, v86
    v_exp_f32 v87, v87
    v_exp_f32 v88, v88
    s_waitcnt vmcnt(27)
    v_mfma_f32_32x32x16_bf16 v[112:127], a[96:99], v[96:99], v[112:127]
    v_mfma_f32_32x32x16_bf16 v[128:143], a[36:39], v[28:31], v[128:143]
    buffer_load_dwordx4 a[224:227], v2, s[28:31], s68 offen offset:3072 sc1
    v_cvt_pk_bf16_f32 v105, v82, v83
    v_cvt_pk_bf16_f32 v106, v84, v85
    v_cvt_pk_bf16_f32 v107, v86, v87
    v_exp_f32 v89, v89
    v_exp_f32 v90, v90
    v_exp_f32 v91, v91
    v_exp_f32 v92, v92
    s_waitcnt vmcnt(27)
    v_mfma_f32_32x32x16_bf16 v[112:127], a[100:103], v[100:103], v[112:127]
    v_exp_f32 v93, v93
    v_exp_f32 v94, v94
    v_exp_f32 v95, v95
    v_cvt_pk_bf16_f32 v108, v88, v89
    v_cvt_pk_bf16_f32 v109, v90, v91
    v_cvt_pk_bf16_f32 v110, v92, v93
    v_cvt_pk_bf16_f32 v111, v94, v95
    v_mfma_f32_32x32x16_bf16 v[80:95], a[40:43], v[16:19], 0
    v_max3_f32 v10, v128, v129, v10
    v_max3_f32 v11, v130, v131, v11
    v_max3_f32 v10, v132, v133, v10
    v_max3_f32 v11, v134, v135, v11
    v_max3_f32 v10, v136, v137, v10
    v_max3_f32 v11, v138, v139, v11
    v_max3_f32 v10, v140, v141, v10
    v_max3_f32 v11, v142, v143, v11
    s_add_u32 s68, s67, 12288
    buffer_load_dwordx4 a[228:231], v2, s[28:31], s68 offen offset:0 sc1
    v_exp_f32 v64, v64
    v_exp_f32 v65, v65
    v_exp_f32 v66, v66
    v_exp_f32 v67, v67
    v_mfma_f32_32x32x16_bf16 v[80:95], a[44:47], v[20:23], v[80:95]
    v_mfma_f32_32x32x16_bf16 v[128:143], a[40:43], v[24:27], 0
    buffer_load_dwordx4 a[232:235], v2, s[28:31], s68 offen offset:1024 sc1
    v_cvt_pk_bf16_f32 v96, v64, v65
    v_exp_f32 v68, v68
    v_exp_f32 v69, v69
    v_exp_f32 v70, v70
    v_exp_f32 v71, v71
    v_exp_f32 v72, v72
    s_waitcnt vmcnt(28)
    v_mfma_f32_32x32x16_bf16 v[112:127], a[104:107], v[104:107], v[112:127]
    v_mfma_f32_32x32x16_bf16 v[128:143], a[44:47], v[28:31], v[128:143]
    buffer_load_dwordx4 a[236:239], v2, s[28:31], s68 offen offset:2048 sc1
    v_cvt_pk_bf16_f32 v97, v66, v67
    v_cvt_pk_bf16_f32 v98, v68, v69
    v_cvt_pk_bf16_f32 v99, v70, v71
    v_exp_f32 v73, v73
    v_exp_f32 v74, v74
    v_exp_f32 v75, v75
    v_exp_f32 v76, v76
    s_waitcnt vmcnt(28)
    v_mfma_f32_32x32x16_bf16 v[112:127], a[108:111], v[108:111], v[112:127]
    v_exp_f32 v77, v77
    v_exp_f32 v78, v78
    v_exp_f32 v79, v79
    v_cvt_pk_bf16_f32 v100, v72, v73
    v_cvt_pk_bf16_f32 v101, v74, v75
    v_cvt_pk_bf16_f32 v102, v76, v77
    v_cvt_pk_bf16_f32 v103, v78, v79
    v_mfma_f32_32x32x16_bf16 v[64:79], a[48:51], v[16:19], 0
    v_max3_f32 v10, v128, v129, v10
    v_max3_f32 v11, v130, v131, v11
    v_max3_f32 v10, v132, v133, v10
    v_max3_f32 v11, v134, v135, v11
    v_max3_f32 v10, v136, v137, v10
    v_max3_f32 v11, v138, v139, v11
    v_max3_f32 v10, v140, v141, v10
    v_max3_f32 v11, v142, v143, v11
    buffer_load_dwordx4 a[240:243], v2, s[28:31], s68 offen offset:3072 sc1
    v_exp_f32 v80, v80
    v_exp_f32 v81, v81
    v_exp_f32 v82, v82
    v_exp_f32 v83, v83
    v_mfma_f32_32x32x16_bf16 v[64:79], a[52:55], v[20:23], v[64:79]
    v_mfma_f32_32x32x16_bf16 v[128:143], a[48:51], v[24:27], 0
    s_add_u32 s68, s67, 16384
    buffer_load_dwordx4 a[244:247], v2, s[28:31], s68 offen offset:0 sc1
    v_cvt_pk_bf16_f32 v104, v80, v81
    v_exp_f32 v84, v84
    v_exp_f32 v85, v85
    v_exp_f32 v86, v86
    v_exp_f32 v87, v87
    v_exp_f32 v88, v88
    s_waitcnt vmcnt(29)
    v_mfma_f32_32x32x16_bf16 v[112:127], a[112:115], v[96:99], v[112:127]
    v_mfma_f32_32x32x16_bf16 v[128:143], a[52:55], v[28:31], v[128:143]
    buffer_load_dwordx4 a[248:251], v2, s[28:31], s68 offen offset:1024 sc1
    v_cvt_pk_bf16_f32 v105, v82, v83
    v_cvt_pk_bf16_f32 v106, v84, v85
    v_cvt_pk_bf16_f32 v107, v86, v87
    v_exp_f32 v89, v89
    v_exp_f32 v90, v90
    v_exp_f32 v91, v91
    v_exp_f32 v92, v92
    s_waitcnt vmcnt(29)
    v_mfma_f32_32x32x16_bf16 v[112:127], a[116:119], v[100:103], v[112:127]
    v_exp_f32 v93, v93
    v_exp_f32 v94, v94
    v_exp_f32 v95, v95
    v_cvt_pk_bf16_f32 v108, v88, v89
    v_cvt_pk_bf16_f32 v109, v90, v91
    v_cvt_pk_bf16_f32 v110, v92, v93
    v_cvt_pk_bf16_f32 v111, v94, v95
    v_mfma_f32_32x32x16_bf16 v[80:95], a[56:59], v[16:19], 0
    v_max3_f32 v10, v128, v129, v10
    v_max3_f32 v11, v130, v131, v11
    v_max3_f32 v10, v132, v133, v10
    v_max3_f32 v11, v134, v135, v11
    v_max3_f32 v10, v136, v137, v10
    v_max3_f32 v11, v138, v139, v11
    v_max3_f32 v10, v140, v141, v10
    v_max3_f32 v11, v142, v143, v11
    buffer_load_dwordx4 a[252:255], v2, s[28:31], s68 offen offset:2048 sc1
    v_exp_f32 v64, v64
    v_exp_f32 v65, v65
    v_exp_f32 v66, v66
    v_exp_f32 v67, v67
    v_mfma_f32_32x32x16_bf16 v[80:95], a[60:63], v[20:23], v[80:95]
    v_mfma_f32_32x32x16_bf16 v[128:143], a[56:59], v[24:27], 0
    buffer_load_dwordx4 v[152:155], v2, s[28:31], s68 offen offset:3072 sc1
    v_cvt_pk_bf16_f32 v96, v64, v65
    v_exp_f32 v68, v68
    v_exp_f32 v69, v69
    v_exp_f32 v70, v70
    v_exp_f32 v71, v71
    v_exp_f32 v72, v72
    s_waitcnt vmcnt(30)
    v_mfma_f32_32x32x16_bf16 v[112:127], a[120:123], v[104:107], v[112:127]
    v_mfma_f32_32x32x16_bf16 v[128:143], a[60:63], v[28:31], v[128:143]
    s_add_u32 s68, s67, 20480
    buffer_load_dwordx4 v[156:159], v2, s[28:31], s68 offen offset:0 sc1
    v_cvt_pk_bf16_f32 v97, v66, v67
    v_cvt_pk_bf16_f32 v98, v68, v69
    v_cvt_pk_bf16_f32 v99, v70, v71
    v_exp_f32 v73, v73
    v_exp_f32 v74, v74
    v_exp_f32 v75, v75
    v_exp_f32 v76, v76
    s_waitcnt vmcnt(30)
    v_mfma_f32_32x32x16_bf16 v[112:127], a[124:127], v[108:111], v[112:127]
    v_exp_f32 v77, v77
    v_exp_f32 v78, v78
    v_exp_f32 v79, v79
    v_cvt_pk_bf16_f32 v100, v72, v73
    v_cvt_pk_bf16_f32 v101, v74, v75
    v_cvt_pk_bf16_f32 v102, v76, v77
    v_cvt_pk_bf16_f32 v103, v78, v79
    v_mfma_f32_32x32x16_bf16 v[64:79], a[64:67], v[16:19], v[32:47]
    v_max3_f32 v10, v128, v129, v10
    v_max3_f32 v11, v130, v131, v11
    v_max3_f32 v10, v132, v133, v10
    v_max3_f32 v11, v134, v135, v11
    v_max3_f32 v10, v136, v137, v10
    v_max3_f32 v11, v138, v139, v11
    v_max3_f32 v10, v140, v141, v10
    v_max3_f32 v11, v142, v143, v11
    buffer_load_dwordx4 v[160:163], v2, s[28:31], s68 offen offset:1024 sc1
    v_exp_f32 v80, v80
    v_exp_f32 v81, v81
    v_exp_f32 v82, v82
    v_exp_f32 v83, v83
    v_mfma_f32_32x32x16_bf16 v[64:79], a[68:71], v[20:23], v[64:79]
    v_mfma_f32_32x32x16_bf16 v[128:143], a[64:67], v[24:27], 0
    buffer_load_dwordx4 v[164:167], v2, s[28:31], s68 offen offset:2048 sc1
    v_cvt_pk_bf16_f32 v104, v80, v81
    v_exp_f32 v84, v84
    v_exp_f32 v85, v85
    v_exp_f32 v86, v86
    v_exp_f32 v87, v87
    v_exp_f32 v88, v88
    s_waitcnt vmcnt(31)
    v_mfma_f32_32x32x16_bf16 v[112:127], a[128:131], v[96:99], v[112:127]
    v_mfma_f32_32x32x16_bf16 v[128:143], a[68:71], v[28:31], v[128:143]
    buffer_load_dwordx4 v[168:171], v2, s[28:31], s68 offen offset:3072 sc1
    v_cvt_pk_bf16_f32 v105, v82, v83
    v_cvt_pk_bf16_f32 v106, v84, v85
    v_cvt_pk_bf16_f32 v107, v86, v87
    v_exp_f32 v89, v89
    v_exp_f32 v90, v90
    v_exp_f32 v91, v91
    v_exp_f32 v92, v92
    s_waitcnt vmcnt(31)
    v_mfma_f32_32x32x16_bf16 v[112:127], a[132:135], v[100:103], v[112:127]
    v_exp_f32 v93, v93
    v_exp_f32 v94, v94
    v_exp_f32 v95, v95
    v_cvt_pk_bf16_f32 v108, v88, v89
    v_cvt_pk_bf16_f32 v109, v90, v91
    v_cvt_pk_bf16_f32 v110, v92, v93
    v_cvt_pk_bf16_f32 v111, v94, v95
    v_max3_f32 v10, v128, v129, v10
    v_max3_f32 v11, v130, v131, v11
    v_max3_f32 v10, v132, v133, v10
    v_max3_f32 v11, v134, v135, v11
    v_max3_f32 v10, v136, v137, v10
    v_max3_f32 v11, v138, v139, v11
    v_max3_f32 v10, v140, v141, v10
    v_max3_f32 v11, v142, v143, v11
    s_add_u32 s68, s67, 24576
    buffer_load_dwordx4 v[172:175], v2, s[28:31], s68 offen offset:0 sc1
    v_exp_f32 v64, v64
    v_exp_f32 v65, v65
    v_exp_f32 v66, v66
    v_exp_f32 v67, v67
    v_mfma_f32_32x32x16_bf16 v[128:143], a[72:75], v[24:27], v[32:47]
    buffer_load_dwordx4 v[176:179], v2, s[28:31], s68 offen offset:1024 sc1
    v_cvt_pk_bf16_f32 v96, v64, v65
    v_exp_f32 v68, v68
    v_exp_f32 v69, v69
    v_exp_f32 v70, v70
    v_exp_f32 v71, v71
    v_exp_f32 v72, v72
    s_waitcnt vmcnt(32)
    v_mfma_f32_32x32x16_bf16 v[112:127], a[136:139], v[104:107], v[112:127]
    v_mfma_f32_32x32x16_bf16 v[128:143], a[76:79], v[28:31], v[128:143]
    buffer_load_dwordx4 v[180:183], v2, s[28:31], s68 offen offset:2048 sc1
    v_cvt_pk_bf16_f32 v97, v66, v67
    v_cvt_pk_bf16_f32 v98, v68, v69
    v_cvt_pk_bf16_f32 v99, v70, v71
    v_exp_f32 v73, v73
    v_exp_f32 v74, v74
    v_exp_f32 v75, v75
    v_exp_f32 v76, v76
    s_waitcnt vmcnt(32)
    v_mfma_f32_32x32x16_bf16 v[112:127], a[140:143], v[108:111], v[112:127]
    v_exp_f32 v77, v77
    v_exp_f32 v78, v78
    v_exp_f32 v79, v79
    v_cvt_pk_bf16_f32 v100, v72, v73
    v_cvt_pk_bf16_f32 v101, v74, v75
    v_cvt_pk_bf16_f32 v102, v76, v77
    v_cvt_pk_bf16_f32 v103, v78, v79
    s_waitcnt vmcnt(31)
    v_mfma_f32_32x32x16_bf16 v[112:127], a[144:147], v[96:99], v[112:127]
    s_waitcnt vmcnt(30)
    v_mfma_f32_32x32x16_bf16 v[112:127], a[148:151], v[100:103], v[112:127]
    v_max3_f32 v10, v128, v129, v10
    v_max3_f32 v11, v130, v131, v11
    v_max3_f32 v10, v132, v133, v10
    v_max3_f32 v11, v134, v135, v11
    v_max3_f32 v10, v136, v137, v10
    v_max3_f32 v11, v138, v139, v11
    v_max3_f32 v10, v140, v141, v10
    v_max3_f32 v11, v142, v143, v11
    v_max_f32 v10, v10, v11
    v_mov_b32 v11, v10
    s_nop 1
    v_permlane32_swap_b32 v10, v11
    v_max_f32 v10, v10, v11
    v_sub_f32 v10, 0, v10
    v_cvt_pk_bf16_f32 v12, v10, v10
    v_and_b32 v12, 0xffff0000, v12
    v_sub_f32 v13, v10, v12
    v_cvt_pk_bf16_f32 v14, v13, v13
    v_and_b32 v14, 0xffff0000, v14
    v_sub_f32 v14, v13, v14
    s_mov_b64 exec, -1
    s_mov_b32 exec_lo, 0
    v_or_b32 v28, 0x3f80, v12
    v_cvt_pk_bf16_f32 v29, v13, v14
    s_mov_b64 exec, -1
    v_rcp_f32 v12, v122
    s_lshl_b32 s53, s57, 1
    s_add_u32 s53, s53, 0
    s_mul_i32 s53, s53, 36
    s_add_u32 s54, s53, s59
    s_lshl_b32 s54, s54, 10
    s_add_u32 s54, s54, 0x900000
    v_mul_f32 v112, v112, v12
    v_mul_f32 v113, v113, v12
    v_mul_f32 v114, v114, v12
    v_mul_f32 v115, v115, v12
    v_mul_f32 v116, v116, v12
    v_mul_f32 v117, v117, v12
    v_mul_f32 v118, v118, v12
    v_mul_f32 v119, v119, v12
    v_mul_f32 v120, v120, v12
    v_mul_f32 v121, v121, v12
    v_cvt_pk_bf16_f32 v112, v112, v113
    v_cvt_pk_bf16_f32 v113, v114, v115
    v_cvt_pk_bf16_f32 v114, v116, v117
    v_cvt_pk_bf16_f32 v115, v118, v119
    v_cvt_pk_bf16_f32 v116, v120, v121
    v_min_u32 v112, 0xfffffffe, v112
    v_min_u32 v113, 0xfffffffe, v113
    v_min_u32 v114, 0xfffffffe, v114
    v_min_u32 v115, 0xfffffffe, v115
    v_min_u32 v116, 0xfffffffe, v116
    buffer_store_dwordx4 v[112:115], v2, s[28:31], s54 offen sc1
    s_add_u32 s53, s53, 32
    s_lshl_b32 s53, s53, 10
    s_lshr_b32 s54, s59, 2
    s_lshl_b32 s54, s54, 9
    s_add_u32 s53, s53, s54
    s_lshl_b32 s54, s61, 2
    s_add_u32 s53, s53, s54
    s_add_u32 s53, s53, 0x900000
    s_mov_b32 exec_hi, 0
    buffer_store_dword v116, v2, s[28:31], s53 offen sc1
    s_mov_b64 exec, -1
    v_mfma_f32_32x32x16_bf16 v[64:79], a[8:11], v[24:27], v[48:63]
    v_mfma_f32_32x32x16_bf16 v[64:79], a[12:15], v[28:31], v[64:79]
    v_mfma_f32_32x32x16_bf16 v[80:95], a[16:19], v[24:27], 0
    buffer_load_dwordx4 v[184:187], v2, s[28:31], s68 offen offset:3072 sc1
    s_nop 9
    v_exp_f32 v64, v64
    v_exp_f32 v65, v65
    v_exp_f32 v66, v66
    v_exp_f32 v67, v67
    v_mfma_f32_32x32x16_bf16 v[80:95], a[20:23], v[28:31], v[80:95]
    s_add_u32 s68, s67, 28672
    buffer_load_dwordx4 v[188:191], v2, s[28:31], s68 offen offset:0 sc1
    v_cvt_pk_bf16_f32 v96, v64, v65
    v_exp_f32 v68, v68
    v_exp_f32 v69, v69
    v_exp_f32 v70, v70
    v_exp_f32 v71, v71
    v_exp_f32 v72, v72
    buffer_load_dwordx4 v[192:195], v2, s[28:31], s68 offen offset:1024 sc1
    v_cvt_pk_bf16_f32 v97, v66, v67
    v_cvt_pk_bf16_f32 v98, v68, v69
    v_cvt_pk_bf16_f32 v99, v70, v71
    v_exp_f32 v73, v73
    v_exp_f32 v74, v74
    v_exp_f32 v75, v75
    v_exp_f32 v76, v76
    v_exp_f32 v77, v77
    v_exp_f32 v78, v78
    v_exp_f32 v79, v79
    v_cvt_pk_bf16_f32 v100, v72, v73
    v_cvt_pk_bf16_f32 v101, v74, v75
    v_cvt_pk_bf16_f32 v102, v76, v77
    v_cvt_pk_bf16_f32 v103, v78, v79
    v_mfma_f32_32x32x16_bf16 v[64:79], a[24:27], v[24:27], 0
    buffer_load_dwordx4 v[196:199], v2, s[28:31], s68 offen offset:2048 sc1
    v_exp_f32 v80, v80
    v_exp_f32 v81, v81
    v_exp_f32 v82, v82
    v_exp_f32 v83, v83
    v_mfma_f32_32x32x16_bf16 v[64:79], a[28:31], v[28:31], v[64:79]
    buffer_load_dwordx4 v[200:203], v2, s[28:31], s68 offen offset:3072 sc1
    v_cvt_pk_bf16_f32 v104, v80, v81
    v_exp_f32 v84, v84
    v_exp_f32 v85, v85
    v_exp_f32 v86, v86
    v_exp_f32 v87, v87
    v_exp_f32 v88, v88
    v_mfma_f32_32x32x16_bf16 v[128:143], a[88:91], v[96:99], 0
    s_add_u32 s68, s67, 32768
    buffer_load_dwordx4 v[204:207], v2, s[28:31], s68 offen offset:0 sc1
    v_cvt_pk_bf16_f32 v105, v82, v83
    v_cvt_pk_bf16_f32 v106, v84, v85
    v_cvt_pk_bf16_f32 v107, v86, v87
    v_exp_f32 v89, v89
    v_exp_f32 v90, v90
    v_exp_f32 v91, v91
    v_exp_f32 v92, v92
    v_mfma_f32_32x32x16_bf16 v[128:143], a[92:95], v[100:103], v[128:143]
    v_exp_f32 v93, v93
    v_exp_f32 v94, v94
    v_exp_f32 v95, v95
    v_cvt_pk_bf16_f32 v108, v88, v89
    v_cvt_pk_bf16_f32 v109, v90, v91
    v_cvt_pk_bf16_f32 v110, v92, v93
    v_cvt_pk_bf16_f32 v111, v94, v95
    v_mfma_f32_32x32x16_bf16 v[80:95], a[32:35], v[24:27], 0
    buffer_load_dwordx4 v[208:211], v2, s[28:31], s68 offen offset:1024 sc1
    v_exp_f32 v64, v64
    v_exp_f32 v65, v65
    v_exp_f32 v66, v66
    v_exp_f32 v67, v67
    v_mfma_f32_32x32x16_bf16 v[80:95], a[36:39], v[28:31], v[80:95]
    buffer_load_dwordx4 v[212:215], v2, s[28:31], s68 offen offset:2048 sc1
    v_cvt_pk_bf16_f32 v96, v64, v65
    v_exp_f32 v68, v68
    v_exp_f32 v69, v69
    v_exp_f32 v70, v70
    v_exp_f32 v71, v71
    v_exp_f32 v72, v72
    v_mfma_f32_32x32x16_bf16 v[128:143], a[96:99], v[104:107], v[128:143]
    buffer_load_dwordx4 v[216:219], v2, s[28:31], s68 offen offset:3072 sc1
    v_cvt_pk_bf16_f32 v97, v66, v67
    v_cvt_pk_bf16_f32 v98, v68, v69
    v_cvt_pk_bf16_f32 v99, v70, v71
    v_exp_f32 v73, v73
    v_exp_f32 v74, v74
    v_exp_f32 v75, v75
    v_exp_f32 v76, v76
    v_mfma_f32_32x32x16_bf16 v[128:143], a[100:103], v[108:111], v[128:143]
    v_exp_f32 v77, v77
    v_exp_f32 v78, v78
    v_exp_f32 v79, v79
    v_cvt_pk_bf16_f32 v100, v72, v73
    v_cvt_pk_bf16_f32 v101, v74, v75
    v_cvt_pk_bf16_f32 v102, v76, v77
    v_cvt_pk_bf16_f32 v103, v78, v79
    v_mfma_f32_32x32x16_bf16 v[64:79], a[40:43], v[24:27], 0
    s_add_u32 s68, s67, 36864
    buffer_load_dwordx4 v[220:223], v2, s[28:31], s68 offen offset:0 sc1
    v_exp_f32 v80, v80
    v_exp_f32 v81, v81
    v_exp_f32 v82, v82
    v_exp_f32 v83, v83
    v_mfma_f32_32x32x16_bf16 v[64:79], a[44:47], v[28:31], v[64:79]
    buffer_load_dwordx4 v[224:227], v2, s[28:31], s68 offen offset:1024 sc1
    v_cvt_pk_bf16_f32 v104, v80, v81
    v_exp_f32 v84, v84
    v_exp_f32 v85, v85
    v_exp_f32 v86, v86
    v_exp_f32 v87, v87
    v_exp_f32 v88, v88
    v_mfma_f32_32x32x16_bf16 v[128:143], a[104:107], v[96:99], v[128:143]
    buffer_load_dwordx4 v[228:231], v2, s[28:31], s68 offen offset:2048 sc1
    v_cvt_pk_bf16_f32 v105, v82, v83
    v_cvt_pk_bf16_f32 v106, v84, v85
    v_cvt_pk_bf16_f32 v107, v86, v87
    v_exp_f32 v89, v89
    v_exp_f32 v90, v90
    v_exp_f32 v91, v91
    v_exp_f32 v92, v92
    v_mfma_f32_32x32x16_bf16 v[128:143], a[108:111], v[100:103], v[128:143]
    v_exp_f32 v93, v93
    v_exp_f32 v94, v94
    v_exp_f32 v95, v95
    v_cvt_pk_bf16_f32 v108, v88, v89
    v_cvt_pk_bf16_f32 v109, v90, v91
    v_cvt_pk_bf16_f32 v110, v92, v93
    v_cvt_pk_bf16_f32 v111, v94, v95
    v_mfma_f32_32x32x16_bf16 v[80:95], a[48:51], v[24:27], 0
    buffer_load_dwordx4 v[232:235], v2, s[28:31], s68 offen offset:3072 sc1
    v_exp_f32 v64, v64
    v_exp_f32 v65, v65
    v_exp_f32 v66, v66
    v_exp_f32 v67, v67
    v_mfma_f32_32x32x16_bf16 v[80:95], a[52:55], v[28:31], v[80:95]
    v_cvt_pk_bf16_f32 v96, v64, v65
    v_exp_f32 v68, v68
    v_exp_f32 v69, v69
    v_exp_f32 v70, v70
    v_exp_f32 v71, v71
    v_exp_f32 v72, v72
    v_mfma_f32_32x32x16_bf16 v[128:143], a[112:115], v[104:107], v[128:143]
    v_cvt_pk_bf16_f32 v97, v66, v67
    v_cvt_pk_bf16_f32 v98, v68, v69
    v_cvt_pk_bf16_f32 v99, v70, v71
    v_exp_f32 v73, v73
    v_exp_f32 v74, v74
    v_exp_f32 v75, v75
    v_exp_f32 v76, v76
    v_mfma_f32_32x32x16_bf16 v[128:143], a[116:119], v[108:111], v[128:143]
    v_exp_f32 v77, v77
    v_exp_f32 v78, v78
    v_exp_f32 v79, v79
    v_cvt_pk_bf16_f32 v100, v72, v73
    v_cvt_pk_bf16_f32 v101, v74, v75
    v_cvt_pk_bf16_f32 v102, v76, v77
    v_cvt_pk_bf16_f32 v103, v78, v79
    v_mfma_f32_32x32x16_bf16 v[64:79], a[56:59], v[24:27], 0
    v_exp_f32 v80, v80
    v_exp_f32 v81, v81
    v_exp_f32 v82, v82
    v_exp_f32 v83, v83
    v_mfma_f32_32x32x16_bf16 v[64:79], a[60:63], v[28:31], v[64:79]
    v_cvt_pk_bf16_f32 v104, v80, v81
    v_exp_f32 v84, v84
    v_exp_f32 v85, v85
    v_exp_f32 v86, v86
    v_exp_f32 v87, v87
    v_exp_f32 v88, v88
    v_mfma_f32_32x32x16_bf16 v[128:143], a[120:123], v[96:99], v[128:143]
    v_cvt_pk_bf16_f32 v105, v82, v83
    v_cvt_pk_bf16_f32 v106, v84, v85
    v_cvt_pk_bf16_f32 v107, v86, v87
    v_exp_f32 v89, v89
    v_exp_f32 v90, v90
    v_exp_f32 v91, v91
    v_exp_f32 v92, v92
    v_mfma_f32_32x32x16_bf16 v[128:143], a[124:127], v[100:103], v[128:143]
    v_exp_f32 v93, v93
    v_exp_f32 v94, v94
    v_exp_f32 v95, v95
    v_cvt_pk_bf16_f32 v108, v88, v89
    v_cvt_pk_bf16_f32 v109, v90, v91
    v_cvt_pk_bf16_f32 v110, v92, v93
    v_cvt_pk_bf16_f32 v111, v94, v95
    v_mfma_f32_32x32x16_bf16 v[80:95], a[64:67], v[24:27], 0
    v_exp_f32 v64, v64
    v_exp_f32 v65, v65
    v_exp_f32 v66, v66
    v_exp_f32 v67, v67
    v_mfma_f32_32x32x16_bf16 v[80:95], a[68:71], v[28:31], v[80:95]
    v_cvt_pk_bf16_f32 v96, v64, v65
    v_exp_f32 v68, v68
    v_exp_f32 v69, v69
    v_exp_f32 v70, v70
    v_exp_f32 v71, v71
    v_exp_f32 v72, v72
    v_mfma_f32_32x32x16_bf16 v[128:143], a[128:131], v[104:107], v[128:143]
    v_cvt_pk_bf16_f32 v97, v66, v67
    v_cvt_pk_bf16_f32 v98, v68, v69
    v_cvt_pk_bf16_f32 v99, v70, v71
    v_exp_f32 v73, v73
    v_exp_f32 v74, v74
    v_exp_f32 v75, v75
    v_exp_f32 v76, v76
    v_mfma_f32_32x32x16_bf16 v[128:143], a[132:135], v[108:111], v[128:143]
    v_exp_f32 v77, v77
    v_exp_f32 v78, v78
    v_exp_f32 v79, v79
    v_cvt_pk_bf16_f32 v100, v72, v73
    v_cvt_pk_bf16_f32 v101, v74, v75
    v_cvt_pk_bf16_f32 v102, v76, v77
    v_cvt_pk_bf16_f32 v103, v78, v79
    v_mfma_f32_32x32x16_bf16 v[64:79], a[72:75], v[24:27], v[32:47]
    v_exp_f32 v80, v80
    v_exp_f32 v81, v81
    v_exp_f32 v82, v82
    v_exp_f32 v83, v83
    v_mfma_f32_32x32x16_bf16 v[64:79], a[76:79], v[28:31], v[64:79]
    v_cvt_pk_bf16_f32 v104, v80, v81
    v_exp_f32 v84, v84
    v_exp_f32 v85, v85
    v_exp_f32 v86, v86
    v_exp_f32 v87, v87
    v_exp_f32 v88, v88
    v_mfma_f32_32x32x16_bf16 v[128:143], a[136:139], v[96:99], v[128:143]
    v_cvt_pk_bf16_f32 v105, v82, v83
    v_cvt_pk_bf16_f32 v106, v84, v85
    v_cvt_pk_bf16_f32 v107, v86, v87
    v_exp_f32 v89, v89
    v_exp_f32 v90, v90
    v_exp_f32 v91, v91
    v_exp_f32 v92, v92
    v_mfma_f32_32x32x16_bf16 v[128:143], a[140:143], v[100:103], v[128:143]
    v_exp_f32 v93, v93
    v_exp_f32 v94, v94
    v_exp_f32 v95, v95
    v_cvt_pk_bf16_f32 v108, v88, v89
    v_cvt_pk_bf16_f32 v109, v90, v91
    v_cvt_pk_bf16_f32 v110, v92, v93
    v_cvt_pk_bf16_f32 v111, v94, v95
    v_exp_f32 v64, v64
    v_exp_f32 v65, v65
    v_exp_f32 v66, v66
    v_exp_f32 v67, v67
    v_cvt_pk_bf16_f32 v96, v64, v65
    v_exp_f32 v68, v68
    v_exp_f32 v69, v69
    v_exp_f32 v70, v70
    v_exp_f32 v71, v71
    v_exp_f32 v72, v72
    v_mfma_f32_32x32x16_bf16 v[128:143], a[144:147], v[104:107], v[128:143]
    v_cvt_pk_bf16_f32 v97, v66, v67
    v_cvt_pk_bf16_f32 v98, v68, v69
    v_cvt_pk_bf16_f32 v99, v70, v71
    v_exp_f32 v73, v73
    v_exp_f32 v74, v74
    v_exp_f32 v75, v75
    v_exp_f32 v76, v76
    v_mfma_f32_32x32x16_bf16 v[128:143], a[148:151], v[108:111], v[128:143]
    v_exp_f32 v77, v77
    v_exp_f32 v78, v78
    v_exp_f32 v79, v79
    v_cvt_pk_bf16_f32 v100, v72, v73
    v_cvt_pk_bf16_f32 v101, v74, v75
    v_cvt_pk_bf16_f32 v102, v76, v77
    v_cvt_pk_bf16_f32 v103, v78, v79
    s_waitcnt vmcnt(44)
    v_mfma_f32_32x32x16_bf16 v[128:143], a[152:155], v[96:99], v[128:143]
    s_waitcnt vmcnt(43)
    v_mfma_f32_32x32x16_bf16 v[128:143], a[156:159], v[100:103], v[128:143]
    s_nop 11
    v_rcp_f32 v12, v138
    s_lshl_b32 s53, s57, 1
    s_add_u32 s53, s53, 1
    s_mul_i32 s53, s53, 36
    s_add_u32 s54, s53, s59
    s_lshl_b32 s54, s54, 10
    s_add_u32 s54, s54, 0x900000
    v_mul_f32 v128, v128, v12
    v_mul_f32 v129, v129, v12
    v_mul_f32 v130, v130, v12
    v_mul_f32 v131, v131, v12
    v_mul_f32 v132, v132, v12
    v_mul_f32 v133, v133, v12
    v_mul_f32 v134, v134, v12
    v_mul_f32 v135, v135, v12
    v_mul_f32 v136, v136, v12
    v_mul_f32 v137, v137, v12
    v_cvt_pk_bf16_f32 v128, v128, v129
    v_cvt_pk_bf16_f32 v129, v130, v131
    v_cvt_pk_bf16_f32 v130, v132, v133
    v_cvt_pk_bf16_f32 v131, v134, v135
    v_cvt_pk_bf16_f32 v132, v136, v137
    v_min_u32 v128, 0xfffffffe, v128
    v_min_u32 v129, 0xfffffffe, v129
    v_min_u32 v130, 0xfffffffe, v130
    v_min_u32 v131, 0xfffffffe, v131
    v_min_u32 v132, 0xfffffffe, v132
    buffer_store_dwordx4 v[128:131], v2, s[28:31], s54 offen sc1
    s_add_u32 s53, s53, 32
    s_lshl_b32 s53, s53, 10
    s_lshr_b32 s54, s59, 2
    s_lshl_b32 s54, s54, 9
    s_add_u32 s53, s53, s54
    s_lshl_b32 s54, s61, 2
    s_add_u32 s53, s53, s54
    s_add_u32 s53, s53, 0x900000
    s_mov_b32 exec_hi, 0
    buffer_store_dword v132, v2, s[28:31], s53 offen sc1
    s_mov_b64 exec, -1
    s_waitcnt vmcnt(44)
    v_cmp_gt_u32 vcc, 1, v9
    s_nop 1
    s_cbranch_vccz L_allf1_15
    s_mov_b32 exec_hi, 0xffffffff
    s_mov_b32 s69, 0
L_poll_16:
    buffer_load_dword v9, v8, s[28:31], 0 offen sc1
    s_add_u32 s69, s69, 1
    s_cmp_gt_u32 s69, 400000
    s_waitcnt vmcnt(0)
    s_cbranch_scc1 L_pollout_17
    v_cmp_gt_u32 vcc, 1, v9
    s_nop 1
    s_cbranch_vccnz L_poll_16
L_pollout_17:
    s_mov_b64 exec, -1
L_allf1_15:
    s_barrier
    s_add_u32 s68, s67, 40960
    buffer_load_dwordx4 v[236:239], v2, s[28:31], s68 offen offset:0 sc1
    buffer_load_dwordx4 v[240:243], v2, s[28:31], s68 offen offset:1024 sc1
    buffer_load_dwordx4 v[244:247], v2, s[28:31], s68 offen offset:2048 sc1
    buffer_load_dwordx4 v[248:251], v2, s[28:31], s68 offen offset:3072 sc1
    s_add_u32 s68, s67, 45056
    buffer_load_dwordx4 v[252:255], v2, s[28:31], s68 offen offset:0 sc1
    s_mov_b32 s36, s4
    s_mov_b32 s37, s5
    s_mov_b32 s38, 0x240000
    s_mov_b32 s39, 0x20000
    v_and_b32 v8, 31, v1
    v_mul_u32_u24 v8, 1152, v8
    v_lshrrev_b32 v9, 5, v1
    v_lshl_add_u32 v8, v9, 4, v8
    s_mul_i32 s53, s65, 36864
    s_mul_i32 s54, s66, 288
    s_add_u32 s53, s53, s54
    s_lshl_b32 s54, s46, 6
    s_add_u32 s54, s54, s53
    buffer_load_dwordx4 v[120:123], v8, s[36:39], s54 offen
    buffer_load_dwordx4 v[124:127], v8, s[36:39], s54 offen offset:32
    s_lshl_b32 s54, s46, 2
    s_add_u32 s54, s54, s53
    buffer_load_dword v128, v8, s[36:39], s54 offen offset:256
    s_mul_i32 s53, s46, 9216
    s_add_u32 s53, s53, 110592
    v_add_u32 v3, s53, v2
    v_add_u32 v6, 110592, v2
    s_mul_i32 s53, s46, 9
    v_add_u32 v8, s53, v1
    v_lshlrev_b32 v8, 10, v8
    v_subrev_u32 v9, 16, v1
    v_lshrrev_b32 v4, 2, v9
    v_lshlrev_b32 v4, 9, v4
    v_and_b32 v9, 3, v9
    v_lshl_add_u32 v4, v9, 2, v4
    v_add_u32 v4, 32768, v4
    v_cmp_gt_u32 vcc, 16, v1
    s_mul_i32 s53, s65, 36864
    s_nop 0
    v_cndmask_b32 v4, v4, v8, vcc
    s_add_u32 s53, s53, 0x900000
    v_add_u32 v4, s53, v4
    s_mul_i32 s52, s65, 36864
    s_mul_i32 s53, s46, 9216
    s_add_u32 s52, s52, s53
    s_add_u32 s52, s52, 0x900000
    v_mov_b32 v5, v2
    s_mov_b32 s64, 0
    s_mul_i32 s53, s46, 9216
    s_add_u32 m0, s53, 110592
    s_add_u32 s54, s52, 0
    buffer_load_dwordx4 v5, s[28:31], s54 offen offset:0 sc1 lds
    buffer_load_dwordx4 v5, s[28:31], s54 offen offset:1024 sc1 lds
    buffer_load_dwordx4 v5, s[28:31], s54 offen offset:2048 sc1 lds
    buffer_load_dwordx4 v5, s[28:31], s54 offen offset:3072 sc1 lds
    s_add_u32 m0, s53, 114688
    s_add_u32 s54, s52, 4096
    buffer_load_dwordx4 v5, s[28:31], s54 offen offset:0 sc1 lds
    buffer_load_dwordx4 v5, s[28:31], s54 offen offset:1024 sc1 lds
    buffer_load_dwordx4 v5, s[28:31], s54 offen offset:2048 sc1 lds
    buffer_load_dwordx4 v5, s[28:31], s54 offen offset:3072 sc1 lds
    s_add_u32 m0, s53, 118784
    s_add_u32 s54, s52, 8192
    buffer_load_dwordx4 v5, s[28:31], s54 offen offset:0 sc1 lds
    s_add_u32 s68, s67, 737280
    s_mov_b32 exec_lo, 0xffff
    s_mov_b32 exec_hi, 0xffff
    buffer_load_dwordx4 a[0:3], v2, s[28:31], s68 offen offset:0 sc1
    s_mov_b64 exec, -1
    s_mov_b32 exec_lo, 0xffff
    s_mov_b32 exec_hi, 0xffff
    buffer_load_dwordx4 a[4:7], v2, s[28:31], s68 offen offset:1024 sc1
    s_mov_b64 exec, -1
    s_mov_b32 exec_lo, 0xffff
    s_mov_b32 exec_hi, 0xffff
    buffer_load_dwordx4 a[8:11], v2, s[28:31], s68 offen offset:2048 sc1
    s_mov_b64 exec, -1
    s_mov_b32 exec_lo, 0xffff
    s_mov_b32 exec_hi, 0xffff
    buffer_load_dwordx4 a[12:15], v2, s[28:31], s68 offen offset:3072 sc1
    s_mov_b64 exec, -1
    s_add_u32 s68, s67, 741376
    s_mov_b32 exec_lo, 0xffff
    s_mov_b32 exec_hi, 0xffff
    buffer_load_dwordx4 a[16:19], v2, s[28:31], s68 offen offset:0 sc1
    s_mov_b64 exec, -1
    s_mov_b32 exec_lo, 0xffff
    s_mov_b32 exec_hi, 0xffff
    buffer_load_dwordx4 a[20:23], v2, s[28:31], s68 offen offset:1024 sc1
    s_mov_b64 exec, -1
    s_mov_b32 exec_lo, 0xffff
    s_mov_b32 exec_hi, 0xffff
    buffer_load_dwordx4 a[24:27], v2, s[28:31], s68 offen offset:2048 sc1
    s_mov_b64 exec, -1
    s_mov_b32 exec_lo, 0xffff
    s_mov_b32 exec_hi, 0xffff
    buffer_load_dwordx4 a[28:31], v2, s[28:31], s68 offen offset:3072 sc1
    s_mov_b64 exec, -1
    s_add_u32 s68, s67, 745472
    s_mov_b32 exec_lo, 0xffff
    s_mov_b32 exec_hi, 0xffff
    buffer_load_dwordx4 a[32:35], v2, s[28:31], s68 offen offset:0 sc1
    s_mov_b64 exec, -1
    buffer_load_dwordx4 a[36:39], v2, s[28:31], s68 offen offset:1024 sc1
    buffer_load_dwordx4 a[40:43], v2, s[28:31], s68 offen offset:2048 sc1
    buffer_load_dwordx4 a[44:47], v2, s[28:31], s68 offen offset:3072 sc1
    s_add_u32 s68, s67, 749568
    buffer_load_dwordx4 a[48:51], v2, s[28:31], s68 offen offset:0 sc1
    buffer_load_dwordx4 a[52:55], v2, s[28:31], s68 offen offset:1024 sc1
    s_branch L_go_19
L_again_18:
    s_cmp_eq_u32 s46, 3
    s_cselect_b32 exec_hi, 0xffff, 0
    s_cselect_b32 s53, 0xffff0000, 0
    s_or_b32 exec_lo, s53, 0x1ff
    s_mov_b32 s69, 0
L_pd_20:
    buffer_load_dword v8, v4, s[28:31], 0 offen sc1
    s_add_u32 s69, s69, 1
    s_cmp_gt_u32 s69, 400000
    s_waitcnt vmcnt(0)
    s_cbranch_scc1 L_pdout_21
    v_cmp_eq_u32 vcc, -1, v8
    s_nop 1
    s_cbranch_vccnz L_pd_20
L_pdout_21:
    s_mov_b64 exec, -1
    s_mul_i32 s53, s46, 9216
    s_add_u32 m0, s53, 110592
    s_add_u32 s54, s52, 0
    buffer_load_dwordx4 v5, s[28:31], s54 offen offset:0 sc1 lds
    buffer_load_dwordx4 v5, s[28:31], s54 offen offset:1024 sc1 lds
    buffer_load_dwordx4 v5, s[28:31], s54 offen offset:2048 sc1 lds
    buffer_load_dwordx4 v5, s[28:31], s54 offen offset:3072 sc1 lds
    s_add_u32 m0, s53, 114688
    s_add_u32 s54, s52, 4096
    buffer_load_dwordx4 v5, s[28:31], s54 offen offset:0 sc1 lds
    buffer_load_dwordx4 v5, s[28:31], s54 offen offset:1024 sc1 lds
    buffer_load_dwordx4 v5, s[28:31], s54 offen offset:2048 sc1 lds
    buffer_load_dwordx4 v5, s[28:31], s54 offen offset:3072 sc1 lds
    s_add_u32 m0, s53, 118784
    s_add_u32 s54, s52, 8192
    buffer_load_dwordx4 v5, s[28:31], s54 offen offset:0 sc1 lds
    s_waitcnt vmcnt(0)
L_go_19:
    s_waitcnt vmcnt(14)
    ds_read_b128 v[96:99], v3 offset:0
    ds_read_b128 v[100:103], v3 offset:1024
    ds_read_b128 v[104:107], v3 offset:2048
    ds_read_b128 v[108:111], v3 offset:3072
    ds_read_b128 v[112:115], v3 offset:4096
    v_mov_b32 v7, 0
    s_waitcnt lgkmcnt(3)
    v_mfma_f32_32x32x16_bf16 v[48:63], a[180:183], v[96:99], 0
    v_max_u32 v7, v96, v7
    ds_read_b128 v[116:119], v3 offset:5120
    v_lshlrev_b32 v64, 16, v120
    v_mfma_f32_32x32x16_bf16 v[48:63], a[184:187], v[100:103], v[48:63]
    v_max_u32 v7, v100, v7
    ds_read_b128 v[96:99], v3 offset:6144
    s_waitcnt lgkmcnt(3)
    v_mfma_f32_32x32x16_bf16 v[48:63], a[188:191], v[104:107], v[48:63]
    v_max_u32 v7, v104, v7
    ds_read_b128 v[100:103], v3 offset:7168
    v_and_b32 v65, 0xffff0000, v120
    v_mfma_f32_32x32x16_bf16 v[48:63], a[192:195], v[108:111], v[48:63]
    v_max_u32 v7, v108, v7
    ds_read_b128 v[104:107], v3 offset:8192
    v_lshlrev_b32 v66, 16, v121
    s_waitcnt lgkmcnt(3)
    v_mfma_f32_32x32x16_bf16 v[48:63], a[196:199], v[112:115], v[48:63]
    v_max_u32 v7, v112, v7
    v_and_b32 v67, 0xffff0000, v121
    v_mfma_f32_32x32x16_bf16 v[48:63], a[200:203], v[116:119], v[48:63]
    v_max3_u32 v7, v116, v117, v7
    v_max3_u32 v7, v118, v119, v7
    s_waitcnt lgkmcnt(2)
    v_max3_u32 v7, v96, v97, v7
    v_max3_u32 v7, v98, v99, v7
    s_waitcnt lgkmcnt(1)
    v_max3_u32 v7, v100, v101, v7
    v_max3_u32 v7, v102, v103, v7
    s_waitcnt lgkmcnt(0)
    v_max3_u32 v7, v104, v105, v7
    v_max3_u32 v7, v106, v107, v7
    v_cmp_eq_u32 vcc, -1, v7
    s_nop 1
    s_cbranch_vccz L_good_22
    s_add_u32 s64, s64, 1
    s_cmp_gt_u32 s64, 400000
    s_cbranch_scc1 L_good_22
    s_waitcnt vmcnt(0) lgkmcnt(0)
    s_nop 15
    s_branch L_again_18
L_good_22:
    s_barrier
    ds_read_b128 v[108:111], v6 offset:0
    ds_read_b128 v[112:115], v6 offset:1024
    v_mfma_f32_32x32x16_bf16 v[48:63], a[204:207], v[96:99], v[48:63]
    ds_read_b128 v[116:119], v6 offset:2048
    v_lshlrev_b32 v68, 16, v122
    buffer_load_dwordx4 a[56:59], v2, s[28:31], s68 offen offset:2048 sc1
    v_mfma_f32_32x32x16_bf16 v[48:63], a[208:211], v[100:103], v[48:63]
    ds_read_b128 v[96:99], v6 offset:3072
    v_and_b32 v69, 0xffff0000, v122
    s_waitcnt lgkmcnt(3)
    v_mfma_f32_32x32x16_bf16 v[48:63], a[212:215], v[104:107], v[48:63]
    ds_read_b128 v[100:103], v6 offset:4096
    buffer_load_dwordx4 a[60:63], v2, s[28:31], s68 offen offset:3072 sc1
    v_mfma_f32_32x32x16_bf16 v[32:47], a[216:219], v[108:111], 0
    ds_read_b128 v[104:107], v6 offset:5120
    v_lshlrev_b32 v70, 16, v123
    s_waitcnt lgkmcnt(3)
    v_mfma_f32_32x32x16_bf16 v[32:47], a[220:223], v[112:115], v[32:47]
    ds_read_b128 v[108:111], v6 offset:6144
    v_and_b32 v71, 0xffff0000, v123
    v_mfma_f32_32x32x16_bf16 v[32:47], a[224:227], v[116:119], v[32:47]
    ds_read_b128 v[112:115], v6 offset:7168
    v_lshlrev_b32 v72, 16, v124
    s_add_u32 s68, s67, 753664
    buffer_load_dwordx4 a[64:67], v2, s[28:31], s68 offen offset:0 sc1
    s_waitcnt lgkmcnt(3)
    v_mfma_f32_32x32x16_bf16 v[32:47], a[228:231], v[96:99], v[32:47]
    ds_read_b128 v[116:119], v6 offset:8192
    v_mfma_f32_32x32x16_bf16 v[32:47], a[232:235], v[100:103], v[32:47]
    ds_read_b128 v[96:99], v6 offset:9216
    v_and_b32 v73, 0xffff0000, v124
    buffer_load_dwordx4 a[68:71], v2, s[28:31], s68 offen offset:1024 sc1
    s_waitcnt lgkmcnt(3)
    v_mfma_f32_32x32x16_bf16 v[32:47], a[236:239], v[104:107], v[32:47]
    ds_read_b128 v[100:103], v6 offset:10240
    s_mul_i32 s53, s46, 2560
    s_add_u32 s53, s53, 151552
    v_lshlrev_b32 v8, 3, v1
    v_add_u32 v9, s53, v8
    ds_write_b64 v9, v[48:49] offset:0
    ds_write_b64 v9, v[50:51] offset:512
    ds_write_b64 v9, v[52:53] offset:1024
    ds_write_b64 v9, v[54:55] offset:1536
    v_lshlrev_b32 v74, 16, v125
    v_mfma_f32_32x32x16_bf16 v[32:47], a[240:243], v[108:111], v[32:47]
    ds_read_b128 v[104:107], v6 offset:11264
    v_and_b32 v75, 0xffff0000, v125
    buffer_load_dwordx4 a[72:75], v2, s[28:31], s68 offen offset:2048 sc1
    s_waitcnt lgkmcnt(7)
    v_mfma_f32_32x32x16_bf16 v[32:47], a[244:247], v[112:115], v[32:47]
    ds_read_b128 v[108:111], v6 offset:12288
    v_mfma_f32_32x32x16_bf16 v[32:47], a[248:251], v[116:119], v[32:47]
    ds_read_b128 v[112:115], v6 offset:13312
    v_lshlrev_b32 v76, 16, v126
    buffer_load_dwordx4 a[76:79], v2, s[28:31], s68 offen offset:3072 sc1
    s_waitcnt lgkmcnt(7)
    v_mfma_f32_32x32x16_bf16 v[32:47], a[252:255], v[96:99], v[32:47]
    ds_read_b128 v[116:119], v6 offset:14336
    v_and_b32 v77, 0xffff0000, v126
    v_mfma_f32_32x32x16_bf16 v[32:47], v[152:155], v[100:103], v[32:47]
    ds_read_b128 v[96:99], v6 offset:15360
    s_waitcnt lgkmcnt(5)
    s_barrier
    s_lshl_b32 s53, s46, 9
    s_add_u32 s53, s53, 151552
    v_lshlrev_b32 v8, 3, v1
    v_add_u32 v8, s53, v8
    ds_read_b64 v[144:145], v8 offset:0
    ds_read_b64 v[146:147], v8 offset:2560
    ds_read_b64 v[148:149], v8 offset:5120
    ds_read_b64 v[150:151], v8 offset:7680
    s_add_u32 s68, s67, 757760
    buffer_load_dwordx4 a[80:83], v2, s[28:31], s68 offen offset:0 sc1
    s_waitcnt lgkmcnt(7)
    v_mfma_f32_32x32x16_bf16 v[32:47], v[156:159], v[104:107], v[32:47]
    ds_read_b128 v[100:103], v6 offset:16384
    v_lshlrev_b32 v78, 16, v127
    v_mfma_f32_32x32x16_bf16 v[32:47], v[160:163], v[108:111], v[32:47]
    ds_read_b128 v[104:107], v6 offset:17408
    v_and_b32 v79, 0xffff0000, v127
    buffer_load_dwordx4 a[84:87], v2, s[28:31], s68 offen offset:1024 sc1
    s_waitcnt lgkmcnt(7)
    v_mfma_f32_32x32x16_bf16 v[32:47], v[164:167], v[112:115], v[32:47]
    ds_read_b128 v[108:111], v6 offset:18432
    v_lshlrev_b32 v80, 16, v128
    v_mfma_f32_32x32x16_bf16 v[32:47], v[168:171], v[116:119], v[32:47]
    ds_read_b128 v[112:115], v6 offset:19456
    buffer_load_dwordx4 a[88:91], v2, s[28:31], s68 offen offset:2048 sc1
    s_waitcnt lgkmcnt(3)
    v_mfma_f32_32x32x16_bf16 v[32:47], v[172:175], v[96:99], v[32:47]
    ds_read_b128 v[116:119], v6 offset:20480
    v_add_f32 v144, v144, v146
    v_add_f32 v145, v145, v147
    v_add_f32 v148, v148, v150
    v_add_f32 v149, v149, v151
    v_add_f32 v48, v144, v148
    v_add_f32 v49, v145, v149
    v_and_b32 v81, 0xffff0000, v128
    v_mfma_f32_32x32x16_bf16 v[32:47], v[176:179], v[100:103], v[32:47]
    ds_read_b128 v[96:99], v6 offset:21504
    buffer_load_dwordx4 a[92:95], v2, s[28:31], s68 offen offset:3072 sc1
    s_waitcnt lgkmcnt(3)
    v_mfma_f32_32x32x16_bf16 v[32:47], v[180:183], v[104:107], v[32:47]
    ds_read_b128 v[100:103], v6 offset:22528
    v_mfma_f32_32x32x16_bf16 v[32:47], v[184:187], v[108:111], v[32:47]
    ds_read_b128 v[104:107], v6 offset:23552
    s_waitcnt lgkmcnt(3)
    v_mfma_f32_32x32x16_bf16 v[32:47], v[188:191], v[112:115], v[32:47]
    ds_read_b128 v[108:111], v6 offset:24576
    s_add_u32 s68, s67, 761856
    buffer_load_dwordx4 a[96:99], v2, s[28:31], s68 offen offset:0 sc1
    v_mfma_f32_32x32x16_bf16 v[32:47], v[192:195], v[116:119], v[32:47]
    ds_read_b128 v[112:115], v6 offset:25600
    s_waitcnt lgkmcnt(3)
    v_mfma_f32_32x32x16_bf16 v[32:47], v[196:199], v[96:99], v[32:47]
    ds_read_b128 v[116:119], v6 offset:26624
    buffer_load_dwordx4 a[100:103], v2, s[28:31], s68 offen offset:1024 sc1
    v_mfma_f32_32x32x16_bf16 v[32:47], v[200:203], v[100:103], v[32:47]
    ds_read_b128 v[96:99], v6 offset:27648
    s_waitcnt lgkmcnt(3)
    v_mfma_f32_32x32x16_bf16 v[32:47], v[204:207], v[104:107], v[32:47]
    ds_read_b128 v[100:103], v6 offset:28672
    buffer_load_dwordx4 a[104:107], v2, s[28:31], s68 offen offset:2048 sc1
    v_mfma_f32_32x32x16_bf16 v[32:47], v[208:211], v[108:111], v[32:47]
    ds_read_b128 v[104:107], v6 offset:29696
    s_waitcnt lgkmcnt(3)
    v_mfma_f32_32x32x16_bf16 v[32:47], v[212:215], v[112:115], v[32:47]
    ds_read_b128 v[108:111], v6 offset:30720
    buffer_load_dwordx4 a[108:111], v2, s[28:31], s68 offen offset:3072 sc1
    v_mfma_f32_32x32x16_bf16 v[32:47], v[216:219], v[116:119], v[32:47]
    ds_read_b128 v[112:115], v6 offset:31744
    s_waitcnt lgkmcnt(3)
    v_mfma_f32_32x32x16_bf16 v[32:47], v[220:223], v[96:99], v[32:47]
    ds_read_b128 v[116:119], v6 offset:32768
    s_add_u32 s68, s67, 765952
    buffer_load_dwordx4 a[112:115], v2, s[28:31], s68 offen offset:0 sc1
    v_mfma_f32_32x32x16_bf16 v[32:47], v[224:227], v[100:103], v[32:47]
    ds_read_b128 v[96:99], v6 offset:33792
    s_waitcnt lgkmcnt(3)
    v_mfma_f32_32x32x16_bf16 v[32:47], v[228:231], v[104:107], v[32:47]
    ds_read_b128 v[100:103], v6 offset:34816
    buffer_load_dwordx4 a[116:119], v2, s[28:31], s68 offen offset:1024 sc1
    v_mfma_f32_32x32x16_bf16 v[32:47], v[232:235], v[108:111], v[32:47]
    ds_read_b128 v[104:107], v6 offset:35840
    s_waitcnt lgkmcnt(3)
    v_mfma_f32_32x32x16_bf16 v[32:47], v[236:239], v[112:115], v[32:47]
    buffer_load_dwordx4 a[120:123], v2, s[28:31], s68 offen offset:2048 sc1
    v_mfma_f32_32x32x16_bf16 v[32:47], v[240:243], v[116:119], v[32:47]
    s_waitcnt lgkmcnt(1)
    v_mfma_f32_32x32x16_bf16 v[32:47], v[244:247], v[96:99], v[32:47]
    buffer_load_dwordx4 a[124:127], v2, s[28:31], s68 offen offset:3072 sc1
    v_mfma_f32_32x32x16_bf16 v[32:47], v[248:251], v[100:103], v[32:47]
    s_waitcnt lgkmcnt(0)
    v_mfma_f32_32x32x16_bf16 v[32:47], v[252:255], v[104:107], v[32:47]
    s_barrier
    s_mul_i32 s53, s65, 36
    s_mul_i32 s54, s66, 9
    s_add_u32 s53, s53, s54
    s_lshl_b32 s53, s53, 10
    s_add_u32 s53, s53, 0xc00000
    s_lshl_b32 s54, s46, 11
    s_lshl_b32 s55, s46, 2
    s_add_u32 s54, s54, s53
    s_add_u32 s55, s55, s53
    s_add_u32 s55, s55, 8192
    v_add_f32 v48, v48, v80
    v_add_f32 v49, v49, v81
    v_cvt_pk_bf16_f32 v138, v48, v49
    v_min_u32 v138, 0xfffffffe, v138
    buffer_store_dword v138, v2, s[28:31], s55 offen sc1
    v_add_f32 v32, v32, v64
    v_add_f32 v33, v33, v65
    v_add_f32 v34, v34, v66
    v_add_f32 v35, v35, v67
    v_add_f32 v36, v36, v68
    v_add_f32 v37, v37, v69
    v_add_f32 v38, v38, v70
    v_add_f32 v39, v39, v71
    v_cvt_pk_bf16_f32 v130, v32, v33
    v_cvt_pk_bf16_f32 v131, v34, v35
    v_cvt_pk_bf16_f32 v132, v36, v37
    v_cvt_pk_bf16_f32 v133, v38, v39
    v_min_u32 v130, 0xfffffffe, v130
    buffer_store_dwordx4 v[130:133], v2, s[28:31], s54 offen sc1
    v_add_f32 v40, v40, v72
    v_add_f32 v41, v41, v73
    v_add_f32 v42, v42, v74
    v_add_f32 v43, v43, v75
    v_add_f32 v44, v44, v76
    v_add_f32 v45, v45, v77
    v_add_f32 v46, v46, v78
    v_add_f32 v47, v47, v79
    v_cvt_pk_bf16_f32 v134, v40, v41
    v_cvt_pk_bf16_f32 v135, v42, v43
    v_cvt_pk_bf16_f32 v136, v44, v45
    v_cvt_pk_bf16_f32 v137, v46, v47
    v_min_u32 v134, 0xfffffffe, v134
    buffer_store_dwordx4 v[134:137], v2, s[28:31], s54 offen offset:1024 sc1
    v_mul_f32 v11, v32, v32
    v_mul_f32 v13, v33, v33
    v_add_f32 v10, v32, v33
    v_add_f32 v10, v10, v34
    v_fmac_f32 v11, v34, v34
    v_add_f32 v10, v10, v35
    v_fmac_f32 v13, v35, v35
    v_add_f32 v10, v10, v36
    v_fmac_f32 v11, v36, v36
    v_add_f32 v10, v10, v37
    v_fmac_f32 v13, v37, v37
    v_add_f32 v10, v10, v38
    v_fmac_f32 v11, v38, v38
    v_add_f32 v10, v10, v39
    v_fmac_f32 v13, v39, v39
    v_add_f32 v10, v10, v40
    v_fmac_f32 v11, v40, v40
    v_add_f32 v10, v10, v41
    v_fmac_f32 v13, v41, v41
    v_add_f32 v10, v10, v42
    v_fmac_f32 v11, v42, v42
    v_add_f32 v10, v10, v43
    v_fmac_f32 v13, v43, v43
    v_add_f32 v10, v10, v44
    v_fmac_f32 v11, v44, v44
    v_add_f32 v10, v10, v45
    v_fmac_f32 v13, v45, v45
    v_add_f32 v10, v10, v46
    v_fmac_f32 v11, v46, v46
    v_add_f32 v10, v10, v47
    v_fmac_f32 v13, v47, v47
    v_add_f32 v10, v10, v48
    v_fmac_f32 v11, v48, v48
    v_add_f32 v10, v10, v49
    v_fmac_f32 v13, v49, v49
    v_add_f32 v11, v11, v13
    v_mov_b32 v12, v10
    v_mov_b32 v13, v11
    v_lshlrev_b32 v8, 3, v1
    s_lshl_b32 s53, s65, 4
    v_permlane32_swap_b32 v10, v12
    v_permlane32_swap_b32 v11, v13
    s_lshl_b32 s54, s66, 2
    s_add_u32 s53, s53, s54
    s_add_u32 s53, s53, s46
    s_lshl_b32 s53, s53, 8
    s_add_u32 s53, s53, 0x1500000
    v_add_f32 v10, v10, v12
    v_add_f32 v11, v11, v13
    v_min_u32 v10, 0xfffffffe, v10
    s_mov_b32 exec_hi, 0
    buffer_store_dwordx2 v[10:11], v8, s[28:31], s53 offen sc1
    s_mov_b64 exec, -1
    s_add_u32 s68, s67, 770048
    buffer_load_dwordx4 a[128:131], v2, s[28:31], s68 offen offset:0 sc1
    buffer_load_dwordx4 a[132:135], v2, s[28:31], s68 offen offset:1024 sc1
    buffer_load_dwordx4 a[136:139], v2, s[28:31], s68 offen offset:2048 sc1
    buffer_load_dwordx4 a[140:143], v2, s[28:31], s68 offen offset:3072 sc1
    s_add_u32 s68, s67, 774144
    buffer_load_dwordx4 a[144:147], v2, s[28:31], s68 offen offset:0 sc1
    buffer_load_dwordx4 a[148:151], v2, s[28:31], s68 offen offset:1024 sc1
    buffer_load_dwordx4 a[152:155], v2, s[28:31], s68 offen offset:2048 sc1
    buffer_load_dwordx4 a[156:159], v2, s[28:31], s68 offen offset:3072 sc1
    s_add_u32 s68, s67, 778240
    buffer_load_dwordx4 a[160:163], v2, s[28:31], s68 offen offset:0 sc1
    buffer_load_dwordx4 a[164:167], v2, s[28:31], s68 offen offset:1024 sc1
    buffer_load_dwordx4 a[168:171], v2, s[28:31], s68 offen offset:2048 sc1
    buffer_load_dwordx4 a[172:175], v2, s[28:31], s68 offen offset:3072 sc1
    s_add_u32 s68, s67, 782336
    buffer_load_dwordx4 a[176:179], v2, s[28:31], s68 offen offset:0 sc1
    s_lshl_b32 s53, s65, 2
    s_add_u32 s53, s53, s46
    s_lshl_b32 s53, s53, 10
    s_add_u32 s53, s53, 0x1500000
    v_lshl_add_u32 v4, v1, 8, s53
    s_mul_i32 s52, s65, 36864
    s_mul_i32 s53, s46, 9216
    s_add_u32 s52, s52, s53
    s_add_u32 s52, s52, 0xc00000
    v_mov_b32 v5, v2
    s_mov_b32 s64, 0
    v_lshrrev_b32 v14, 5, v1
    v_lshlrev_b32 v14, 5, v14
    s_mul_i32 s53, s66, 576
    s_add_u32 s53, s53, 0x1980000
    s_lshl_b32 s54, s46, 7
    s_add_u32 s54, s54, s53
    buffer_load_dwordx4 v[64:67], v14, s[28:31], s54 offen offset:0 sc1
    buffer_load_dwordx4 v[68:71], v14, s[28:31], s54 offen offset:16 sc1
    buffer_load_dwordx4 v[72:75], v14, s[28:31], s54 offen offset:64 sc1
    buffer_load_dwordx4 v[76:79], v14, s[28:31], s54 offen offset:80 sc1
    s_lshl_b32 s54, s46, 3
    s_add_u32 s54, s54, s53
    buffer_load_dwordx2 v[142:143], v14, s[28:31], s54 offen offset:512 sc1
    s_mul_i32 s53, s46, 9216
    s_add_u32 m0, s53, 110592
    s_add_u32 s54, s52, 0
    buffer_load_dwordx4 v5, s[28:31], s54 offen offset:0 sc1 lds
    buffer_load_dwordx4 v5, s[28:31], s54 offen offset:1024 sc1 lds
    buffer_load_dwordx4 v5, s[28:31], s54 offen offset:2048 sc1 lds
    buffer_load_dwordx4 v5, s[28:31], s54 offen offset:3072 sc1 lds
    s_add_u32 m0, s53, 114688
    s_add_u32 s54, s52, 4096
    buffer_load_dwordx4 v5, s[28:31], s54 offen offset:0 sc1 lds
    buffer_load_dwordx4 v5, s[28:31], s54 offen offset:1024 sc1 lds
    buffer_load_dwordx4 v5, s[28:31], s54 offen offset:2048 sc1 lds
    buffer_load_dwordx4 v5, s[28:31], s54 offen offset:3072 sc1 lds
    s_add_u32 m0, s53, 118784
    s_add_u32 s54, s52, 8192
    buffer_load_dwordx4 v5, s[28:31], s54 offen offset:0 sc1 lds
    s_lshl_b32 s53, s46, 10
    s_add_u32 m0, s53, 147456
    s_lshl_b32 s54, s65, 12
    s_add_u32 s53, s53, s54
    s_add_u32 s53, s53, 0x1500000
    buffer_load_dwordx4 v2, s[28:31], s53 offen sc1 lds
    s_add_u32 s68, s67, 1474560
    s_mov_b32 exec_lo, 0x33ffff
    s_mov_b32 exec_hi, 0x33ffff
    buffer_load_dwordx4 a[180:183], v2, s[28:31], s68 offen offset:0 sc1
    s_mov_b64 exec, -1
    s_mov_b32 exec_lo, 0x33ffff
    s_mov_b32 exec_hi, 0x33ffff
    buffer_load_dwordx4 a[184:187], v2, s[28:31], s68 offen offset:1024 sc1
    s_mov_b64 exec, -1
    s_mov_b32 exec_lo, 0x33ffff
    s_mov_b32 exec_hi, 0x33ffff
    buffer_load_dwordx4 a[188:191], v2, s[28:31], s68 offen offset:2048 sc1
    s_mov_b64 exec, -1
    s_mov_b32 exec_lo, 0x33ffff
    s_mov_b32 exec_hi, 0x33ffff
    buffer_load_dwordx4 a[192:195], v2, s[28:31], s68 offen offset:3072 sc1
    s_mov_b64 exec, -1
    s_add_u32 s68, s67, 1478656
    s_mov_b32 exec_lo, 0x33ffff
    s_mov_b32 exec_hi, 0x33ffff
    buffer_load_dwordx4 a[196:199], v2, s[28:31], s68 offen offset:0 sc1
    s_mov_b64 exec, -1
    s_mov_b32 exec_lo, 0x33ffff
    s_mov_b32 exec_hi, 0x33ffff
    buffer_load_dwordx4 a[200:203], v2, s[28:31], s68 offen offset:1024 sc1
    s_mov_b64 exec, -1
    s_mov_b32 exec_lo, 0x33ffff
    s_mov_b32 exec_hi, 0x33ffff
    buffer_load_dwordx4 a[204:207], v2, s[28:31], s68 offen offset:2048 sc1
    s_mov_b64 exec, -1
    s_mov_b32 exec_lo, 0x33ffff
    s_mov_b32 exec_hi, 0x33ffff
    buffer_load_dwordx4 a[208:211], v2, s[28:31], s68 offen offset:3072 sc1
    s_mov_b64 exec, -1
    s_add_u32 s68, s67, 1482752
    s_mov_b32 exec_lo, 0x33ffff
    s_mov_b32 exec_hi, 0x33ffff
    buffer_load_dwordx4 a[212:215], v2, s[28:31], s68 offen offset:0 sc1
    s_mov_b64 exec, -1
    buffer_load_dwordx4 a[216:219], v2, s[28:31], s68 offen offset:1024 sc1
    buffer_load_dwordx4 a[220:223], v2, s[28:31], s68 offen offset:2048 sc1
    buffer_load_dwordx4 a[224:227], v2, s[28:31], s68 offen offset:3072 sc1
    s_add_u32 s68, s67, 1486848
    buffer_load_dwordx4 a[228:231], v2, s[28:31], s68 offen offset:0 sc1
    buffer_load_dwordx4 a[232:235], v2, s[28:31], s68 offen offset:1024 sc1
    s_branch L_go_24
L_again_23:
    s_mov_b64 exec, 15
    s_mov_b32 s69, 0
L_pd_25:
    buffer_load_dword v8, v4, s[28:31], 0 offen sc1
    s_add_u32 s69, s69, 1
    s_cmp_gt_u32 s69, 400000
    s_waitcnt vmcnt(0)
    s_cbranch_scc1 L_pdout_26
    v_cmp_eq_u32 vcc, -1, v8
    s_nop 1
    s_cbranch_vccnz L_pd_25
L_pdout_26:
    s_mov_b64 exec, -1
    s_mul_i32 s53, s46, 9216
    s_add_u32 m0, s53, 110592
    s_add_u32 s54, s52, 0
    buffer_load_dwordx4 v5, s[28:31], s54 offen offset:0 sc1 lds
    buffer_load_dwordx4 v5, s[28:31], s54 offen offset:1024 sc1 lds
    buffer_load_dwordx4 v5, s[28:31], s54 offen offset:2048 sc1 lds
    buffer_load_dwordx4 v5, s[28:31], s54 offen offset:3072 sc1 lds
    s_add_u32 m0, s53, 114688
    s_add_u32 s54, s52, 4096
    buffer_load_dwordx4 v5, s[28:31], s54 offen offset:0 sc1 lds
    buffer_load_dwordx4 v5, s[28:31], s54 offen offset:1024 sc1 lds
    buffer_load_dwordx4 v5, s[28:31], s54 offen offset:2048 sc1 lds
    buffer_load_dwordx4 v5, s[28:31], s54 offen offset:3072 sc1 lds
    s_add_u32 m0, s53, 118784
    s_add_u32 s54, s52, 8192
    buffer_load_dwordx4 v5, s[28:31], s54 offen offset:0 sc1 lds
    s_lshl_b32 s53, s46, 10
    s_add_u32 m0, s53, 147456
    s_lshl_b32 s54, s65, 12
    s_add_u32 s53, s53, s54
    s_add_u32 s53, s53, 0x1500000
    buffer_load_dwordx4 v2, s[28:31], s53 offen sc1 lds
    s_waitcnt vmcnt(0)
L_go_24:
    s_waitcnt vmcnt(14)
    ds_read_b128 v[96:99], v3 offset:0
    ds_read_b128 v[100:103], v3 offset:1024
    ds_read_b128 v[104:107], v3 offset:2048
    ds_read_b128 v[108:111], v3 offset:3072
    ds_read_b128 v[112:115], v3 offset:4096
    v_mov_b32 v7, 0
    s_lshl_b32 s53, s46, 10
    s_add_u32 s53, s53, 147456
    v_add_u32 v8, s53, v2
    ds_read_b128 v[144:147], v8
    s_waitcnt lgkmcnt(4)
    v_mfma_f32_32x32x16_bf16 v[48:63], a[0:3], v[96:99], 0
    v_max_u32 v7, v96, v7
    ds_read_b128 v[116:119], v3 offset:5120
    v_mfma_f32_32x32x16_bf16 v[48:63], a[4:7], v[100:103], v[48:63]
    v_max_u32 v7, v100, v7
    ds_read_b128 v[96:99], v3 offset:6144
    s_waitcnt lgkmcnt(4)
    v_mfma_f32_32x32x16_bf16 v[48:63], a[8:11], v[104:107], v[48:63]
    v_max_u32 v7, v104, v7
    ds_read_b128 v[100:103], v3 offset:7168
    v_mfma_f32_32x32x16_bf16 v[48:63], a[12:15], v[108:111], v[48:63]
    v_max_u32 v7, v108, v7
    ds_read_b128 v[104:107], v3 offset:8192
    s_waitcnt lgkmcnt(3)
    v_mfma_f32_32x32x16_bf16 v[48:63], a[16:19], v[112:115], v[48:63]
    v_max_u32 v7, v112, v7
    v_mfma_f32_32x32x16_bf16 v[48:63], a[20:23], v[116:119], v[48:63]
    v_max_u32 v7, v116, v7
    s_waitcnt lgkmcnt(2)
    v_max_u32 v7, v96, v7
    s_waitcnt lgkmcnt(1)
    v_max_u32 v7, v100, v7
    s_waitcnt lgkmcnt(0)
    v_max3_u32 v7, v104, v105, v7
    v_max3_u32 v7, v106, v107, v7
    v_max3_u32 v7, v144, v146, v7
    v_cmp_eq_u32 vcc, -1, v7
    s_nop 1
    s_cbranch_vccz L_good_27
    s_add_u32 s64, s64, 1
    s_cmp_gt_u32 s64, 400000
    s_cbranch_scc1 L_good_27
    s_waitcnt vmcnt(0) lgkmcnt(0)
    s_nop 15
    s_branch L_again_23
L_good_27:
    s_barrier
    ds_read_b128 v[108:111], v6 offset:0
    ds_read_b128 v[112:115], v6 offset:1024
    v_mfma_f32_32x32x16_bf16 v[48:63], a[24:27], v[96:99], v[48:63]
    ds_read_b128 v[116:119], v6 offset:2048
    buffer_load_dwordx4 a[236:239], v2, s[28:31], s68 offen offset:2048 sc1
    v_mfma_f32_32x32x16_bf16 v[48:63], a[28:31], v[100:103], v[48:63]
    ds_read_b128 v[96:99], v6 offset:3072
    s_waitcnt lgkmcnt(3)
    v_mfma_f32_32x32x16_bf16 v[48:63], a[32:35], v[104:107], v[48:63]
    ds_read_b128 v[100:103], v6 offset:4096
    buffer_load_dwordx4 a[240:243], v2, s[28:31], s68 offen offset:3072 sc1
    v_mfma_f32_32x32x16_bf16 v[32:47], a[36:39], v[108:111], 0
    ds_read_b128 v[104:107], v6 offset:5120
    s_waitcnt lgkmcnt(3)
    v_mfma_f32_32x32x16_bf16 v[32:47], a[40:43], v[112:115], v[32:47]
    ds_read_b128 v[108:111], v6 offset:6144
    v_and_b32 v10, 31, v1
    v_lshlrev_b32 v10, 3, v10
    v_lshrrev_b32 v11, 5, v1
    v_mfma_f32_32x32x16_bf16 v[32:47], a[44:47], v[116:119], v[32:47]
    ds_read_b128 v[112:115], v6 offset:7168
    v_lshl_add_u32 v10, v11, 11, v10
    s_add_u32 s68, s67, 1490944
    buffer_load_dwordx4 a[244:247], v2, s[28:31], s68 offen offset:0 sc1
    v_add_u32 v10, 147456, v10
    s_waitcnt lgkmcnt(3)
    v_mfma_f32_32x32x16_bf16 v[32:47], a[48:51], v[96:99], v[32:47]
    ds_read_b128 v[116:119], v6 offset:8192
    ds_read_b64 v[80:81], v10 offset:0
    ds_read_b64 v[82:83], v10 offset:256
    v_mfma_f32_32x32x16_bf16 v[32:47], a[52:55], v[100:103], v[32:47]
    ds_read_b128 v[96:99], v6 offset:9216
    ds_read_b64 v[84:85], v10 offset:512
    buffer_load_dwordx4 a[248:251], v2, s[28:31], s68 offen offset:1024 sc1
    ds_read_b64 v[86:87], v10 offset:768
    s_waitcnt lgkmcnt(7)
    v_mfma_f32_32x32x16_bf16 v[32:47], a[56:59], v[104:107], v[32:47]
    ds_read_b128 v[100:103], v6 offset:10240
    s_mul_i32 s53, s46, 2560
    s_add_u32 s53, s53, 151552
    v_lshlrev_b32 v8, 3, v1
    v_add_u32 v9, s53, v8
    ds_write_b64 v9, v[48:49] offset:0
    ds_write_b64 v9, v[50:51] offset:512
    ds_write_b64 v9, v[52:53] offset:1024
    ds_write_b64 v9, v[54:55] offset:1536
    ds_read_b64 v[88:89], v10 offset:1024
    ds_read_b64 v[90:91], v10 offset:1280
    v_mfma_f32_32x32x16_bf16 v[32:47], a[60:63], v[108:111], v[32:47]
    ds_read_b128 v[104:107], v6 offset:11264
    ds_read_b64 v[92:93], v10 offset:1536
    buffer_load_dwordx4 a[252:255], v2, s[28:31], s68 offen offset:2048 sc1
    ds_read_b64 v[94:95], v10 offset:1792
    s_waitcnt lgkmcnt(15)
    v_mfma_f32_32x32x16_bf16 v[32:47], a[64:67], v[112:115], v[32:47]
    ds_read_b128 v[108:111], v6 offset:12288
    v_mfma_f32_32x32x16_bf16 v[32:47], a[68:71], v[116:119], v[32:47]
    ds_read_b128 v[112:115], v6 offset:13312
    buffer_load_dwordx4 v[152:155], v2, s[28:31], s68 offen offset:3072 sc1
    s_waitcnt lgkmcnt(11)
    v_mfma_f32_32x32x16_bf16 v[32:47], a[72:75], v[96:99], v[32:47]
    ds_read_b128 v[116:119], v6 offset:14336
    v_mfma_f32_32x32x16_bf16 v[32:47], a[76:79], v[100:103], v[32:47]
    ds_read_b128 v[96:99], v6 offset:15360
    s_waitcnt lgkmcnt(9)
    s_barrier
    s_lshl_b32 s53, s46, 9
    s_add_u32 s53, s53, 151552
    v_lshlrev_b32 v8, 3, v1
    v_add_u32 v8, s53, v8
    ds_read_b64 v[144:145], v8 offset:0
    ds_read_b64 v[146:147], v8 offset:2560
    ds_read_b64 v[148:149], v8 offset:5120
    ds_read_b64 v[150:151], v8 offset:7680
    s_add_u32 s68, s67, 1495040
    buffer_load_dwordx4 v[156:159], v2, s[28:31], s68 offen offset:0 sc1
    s_waitcnt lgkmcnt(7)
    v_mfma_f32_32x32x16_bf16 v[32:47], a[80:83], v[104:107], v[32:47]
    ds_read_b128 v[100:103], v6 offset:16384
    v_mfma_f32_32x32x16_bf16 v[32:47], a[84:87], v[108:111], v[32:47]
    ds_read_b128 v[104:107], v6 offset:17408
    buffer_load_dwordx4 v[160:163], v2, s[28:31], s68 offen offset:1024 sc1
    s_waitcnt lgkmcnt(7)
    v_mfma_f32_32x32x16_bf16 v[32:47], a[88:91], v[112:115], v[32:47]
    ds_read_b128 v[108:111], v6 offset:18432
    v_add_f32 v80, v80, v82
    v_add_f32 v81, v81, v83
    v_mfma_f32_32x32x16_bf16 v[32:47], a[92:95], v[116:119], v[32:47]
    ds_read_b128 v[112:115], v6 offset:19456
    buffer_load_dwordx4 v[164:167], v2, s[28:31], s68 offen offset:2048 sc1
    v_add_f32 v84, v84, v86
    s_waitcnt lgkmcnt(3)
    v_mfma_f32_32x32x16_bf16 v[32:47], a[96:99], v[96:99], v[32:47]
    ds_read_b128 v[116:119], v6 offset:20480
    v_add_f32 v144, v144, v146
    v_add_f32 v145, v145, v147
    v_add_f32 v148, v148, v150
    v_add_f32 v149, v149, v151
    v_add_f32 v48, v144, v148
    v_add_f32 v49, v145, v149
    v_add_f32 v85, v85, v87
    v_add_f32 v88, v88, v90
    v_mfma_f32_32x32x16_bf16 v[32:47], a[100:103], v[100:103], v[32:47]
    ds_read_b128 v[96:99], v6 offset:21504
    buffer_load_dwordx4 v[168:171], v2, s[28:31], s68 offen offset:3072 sc1
    v_add_f32 v89, v89, v91
    s_waitcnt lgkmcnt(3)
    v_mfma_f32_32x32x16_bf16 v[32:47], a[104:107], v[104:107], v[32:47]
    ds_read_b128 v[100:103], v6 offset:22528
    v_add_f32 v92, v92, v94
    v_add_f32 v93, v93, v95
    v_mfma_f32_32x32x16_bf16 v[32:47], a[108:111], v[108:111], v[32:47]
    ds_read_b128 v[104:107], v6 offset:23552
    v_add_f32 v80, v80, v84
    s_waitcnt lgkmcnt(3)
    v_mfma_f32_32x32x16_bf16 v[32:47], a[112:115], v[112:115], v[32:47]
    ds_read_b128 v[108:111], v6 offset:24576
    s_add_u32 s68, s67, 1499136
    buffer_load_dwordx4 v[172:175], v2, s[28:31], s68 offen offset:0 sc1
    v_add_f32 v81, v81, v85
    v_add_f32 v88, v88, v92
    v_mfma_f32_32x32x16_bf16 v[32:47], a[116:119], v[116:119], v[32:47]
    ds_read_b128 v[112:115], v6 offset:25600
    v_add_f32 v89, v89, v93
    s_waitcnt lgkmcnt(3)
    v_mfma_f32_32x32x16_bf16 v[32:47], a[120:123], v[96:99], v[32:47]
    ds_read_b128 v[116:119], v6 offset:26624
    buffer_load_dwordx4 v[176:179], v2, s[28:31], s68 offen offset:1024 sc1
    v_add_f32 v12, v80, v88
    v_add_f32 v13, v81, v89
    v_mfma_f32_32x32x16_bf16 v[32:47], a[124:127], v[100:103], v[32:47]
    ds_read_b128 v[96:99], v6 offset:27648
    v_mov_b32 v80, v12
    s_waitcnt lgkmcnt(3)
    v_mfma_f32_32x32x16_bf16 v[32:47], a[128:131], v[104:107], v[32:47]
    ds_read_b128 v[100:103], v6 offset:28672
    buffer_load_dwordx4 v[180:183], v2, s[28:31], s68 offen offset:2048 sc1
    v_mov_b32 v81, v13
    v_permlane32_swap_b32 v12, v80
    v_mfma_f32_32x32x16_bf16 v[32:47], a[132:135], v[108:111], v[32:47]
    ds_read_b128 v[104:107], v6 offset:29696
    v_permlane32_swap_b32 v13, v81
    s_waitcnt lgkmcnt(3)
    v_mfma_f32_32x32x16_bf16 v[32:47], a[136:139], v[112:115], v[32:47]
    ds_read_b128 v[108:111], v6 offset:30720
    buffer_load_dwordx4 v[184:187], v2, s[28:31], s68 offen offset:3072 sc1
    v_add_f32 v12, v12, v80
    v_add_f32 v13, v13, v81
    v_mfma_f32_32x32x16_bf16 v[32:47], a[140:143], v[116:119], v[32:47]
    ds_read_b128 v[112:115], v6 offset:31744
    v_mul_f32 v139, 0xbae38e39, v12
    s_waitcnt lgkmcnt(3)
    v_mfma_f32_32x32x16_bf16 v[32:47], a[144:147], v[96:99], v[32:47]
    ds_read_b128 v[116:119], v6 offset:32768
    s_add_u32 s68, s67, 1503232
    buffer_load_dwordx4 v[188:191], v2, s[28:31], s68 offen offset:0 sc1
    v_mul_f32 v13, 0x3ae38e39, v13
    v_fma_f32 v13, -v139, v139, v13
    v_mfma_f32_32x32x16_bf16 v[32:47], a[148:151], v[100:103], v[32:47]
    ds_read_b128 v[96:99], v6 offset:33792
    v_max_f32 v13, 0, v13
    s_waitcnt lgkmcnt(3)
    v_mfma_f32_32x32x16_bf16 v[32:47], a[152:155], v[104:107], v[32:47]
    ds_read_b128 v[100:103], v6 offset:34816
    buffer_load_dwordx4 v[192:195], v2, s[28:31], s68 offen offset:1024 sc1
    v_add_f32 v11, 0x3727c5ac, v13
    v_mfma_f32_32x32x16_bf16 v[32:47], a[156:159], v[108:111], v[32:47]
    ds_read_b128 v[104:107], v6 offset:35840
    v_rsq_f32 v140, v11
    s_waitcnt lgkmcnt(3)
    v_mfma_f32_32x32x16_bf16 v[32:47], a[160:163], v[112:115], v[32:47]
    buffer_load_dwordx4 v[196:199], v2, s[28:31], s68 offen offset:2048 sc1
    v_mul_f32 v13, v13, v140
    v_mul_f32 v13, v13, v140
    v_mfma_f32_32x32x16_bf16 v[32:47], a[164:167], v[116:119], v[32:47]
    v_add_f32 v13, 0x3727c5ac, v13
    s_waitcnt lgkmcnt(1)
    v_mfma_f32_32x32x16_bf16 v[32:47], a[168:171], v[96:99], v[32:47]
    buffer_load_dwordx4 v[200:203], v2, s[28:31], s68 offen offset:3072 sc1
    v_rsq_f32 v13, v13
    v_mfma_f32_32x32x16_bf16 v[32:47], a[172:175], v[100:103], v[32:47]
    v_mul_f32 v141, v140, v13
    s_waitcnt lgkmcnt(0)
    v_mfma_f32_32x32x16_bf16 v[32:47], a[176:179], v[104:107], v[32:47]
    s_barrier
    s_mul_i32 s53, s65, 36
    s_mul_i32 s54, s66, 9
    s_add_u32 s53, s53, s54
    s_lshl_b32 s53, s53, 10
    s_add_u32 s53, s53, 0xf00000
    s_lshl_b32 s54, s46, 11
    s_lshl_b32 s55, s46, 2
    s_add_u32 s54, s54, s53
    s_add_u32 s55, s55, s53
    s_add_u32 s55, s55, 8192
    v_mov_b32 v8, 0xc0135761
    v_mov_b32 v9, 0xbdd2d3e8
    v_mov_b32 v10, v139
    v_mov_b32 v11, v141
    v_mov_b32 v12, 1.0
    v_pk_fma_f32 v[48:49], v[142:143], v[10:11], v[48:49] op_sel_hi:[1,0,1]
    v_pk_mul_f32 v[48:49], v[48:49], v[10:11] op_sel:[0,1] op_sel_hi:[1,1]
    v_pk_mul_f32 v[112:113], v[48:49], v[48:49]
    v_pk_fma_f32 v[112:113], v[112:113], v[8:9], v[8:9] op_sel:[0,1,0] op_sel_hi:[1,1,0]
    v_pk_mul_f32 v[112:113], v[112:113], v[48:49]
    v_exp_f32 v112, v112
    v_exp_f32 v113, v113
    s_nop 0
    v_pk_add_f32 v[112:113], v[112:113], v[12:13] op_sel_hi:[1,0]
    v_rcp_f32 v112, v112
    v_rcp_f32 v113, v113
    s_nop 0
    v_pk_mul_f32 v[48:49], v[48:49], v[112:113]
    v_cvt_pk_bf16_f32 v128, v48, v49
    v_min_u32 v128, 0xfffffffe, v128
    buffer_store_dword v128, v2, s[28:31], s55 offen sc1
    v_pk_fma_f32 v[32:33], v[64:65], v[10:11], v[32:33] op_sel_hi:[1,0,1]
    v_pk_fma_f32 v[34:35], v[66:67], v[10:11], v[34:35] op_sel_hi:[1,0,1]
    v_pk_mul_f32 v[32:33], v[32:33], v[10:11] op_sel:[0,1] op_sel_hi:[1,1]
    v_pk_mul_f32 v[34:35], v[34:35], v[10:11] op_sel:[0,1] op_sel_hi:[1,1]
    v_pk_mul_f32 v[96:97], v[32:33], v[32:33]
    v_pk_mul_f32 v[98:99], v[34:35], v[34:35]
    v_pk_fma_f32 v[96:97], v[96:97], v[8:9], v[8:9] op_sel:[0,1,0] op_sel_hi:[1,1,0]
    v_pk_fma_f32 v[98:99], v[98:99], v[8:9], v[8:9] op_sel:[0,1,0] op_sel_hi:[1,1,0]
    v_pk_mul_f32 v[96:97], v[96:97], v[32:33]
    v_pk_mul_f32 v[98:99], v[98:99], v[34:35]
    v_exp_f32 v96, v96
    v_exp_f32 v98, v98
    v_exp_f32 v97, v97
    v_exp_f32 v99, v99
    v_pk_add_f32 v[96:97], v[96:97], v[12:13] op_sel_hi:[1,0]
    v_pk_add_f32 v[98:99], v[98:99], v[12:13] op_sel_hi:[1,0]
    v_rcp_f32 v96, v96
    v_rcp_f32 v98, v98
    v_rcp_f32 v97, v97
    v_rcp_f32 v99, v99
    v_pk_mul_f32 v[32:33], v[32:33], v[96:97]
    v_pk_mul_f32 v[34:35], v[34:35], v[98:99]
    v_pk_fma_f32 v[36:37], v[68:69], v[10:11], v[36:37] op_sel_hi:[1,0,1]
    v_pk_fma_f32 v[38:39], v[70:71], v[10:11], v[38:39] op_sel_hi:[1,0,1]
    v_pk_mul_f32 v[36:37], v[36:37], v[10:11] op_sel:[0,1] op_sel_hi:[1,1]
    v_pk_mul_f32 v[38:39], v[38:39], v[10:11] op_sel:[0,1] op_sel_hi:[1,1]
    v_pk_mul_f32 v[100:101], v[36:37], v[36:37]
    v_pk_mul_f32 v[102:103], v[38:39], v[38:39]
    v_pk_fma_f32 v[100:101], v[100:101], v[8:9], v[8:9] op_sel:[0,1,0] op_sel_hi:[1,1,0]
    v_pk_fma_f32 v[102:103], v[102:103], v[8:9], v[8:9] op_sel:[0,1,0] op_sel_hi:[1,1,0]
    v_pk_mul_f32 v[100:101], v[100:101], v[36:37]
    v_pk_mul_f32 v[102:103], v[102:103], v[38:39]
    v_exp_f32 v100, v100
    v_exp_f32 v102, v102
    v_exp_f32 v101, v101
    v_exp_f32 v103, v103
    v_pk_add_f32 v[100:101], v[100:101], v[12:13] op_sel_hi:[1,0]
    v_pk_add_f32 v[102:103], v[102:103], v[12:13] op_sel_hi:[1,0]
    v_rcp_f32 v100, v100
    v_rcp_f32 v102, v102
    v_rcp_f32 v101, v101
    v_rcp_f32 v103, v103
    v_pk_mul_f32 v[36:37], v[36:37], v[100:101]
    v_pk_mul_f32 v[38:39], v[38:39], v[102:103]
    v_cvt_pk_bf16_f32 v120, v32, v33
    v_cvt_pk_bf16_f32 v121, v34, v35
    v_cvt_pk_bf16_f32 v122, v36, v37
    v_cvt_pk_bf16_f32 v123, v38, v39
    v_min_u32 v120, 0xfffffffe, v120
    buffer_store_dwordx4 v[120:123], v2, s[28:31], s54 offen sc1
    v_pk_fma_f32 v[40:41], v[72:73], v[10:11], v[40:41] op_sel_hi:[1,0,1]
    v_pk_fma_f32 v[42:43], v[74:75], v[10:11], v[42:43] op_sel_hi:[1,0,1]
    v_pk_mul_f32 v[40:41], v[40:41], v[10:11] op_sel:[0,1] op_sel_hi:[1,1]
    v_pk_mul_f32 v[42:43], v[42:43], v[10:11] op_sel:[0,1] op_sel_hi:[1,1]
    v_pk_mul_f32 v[104:105], v[40:41], v[40:41]
    v_pk_mul_f32 v[106:107], v[42:43], v[42:43]
    v_pk_fma_f32 v[104:105], v[104:105], v[8:9], v[8:9] op_sel:[0,1,0] op_sel_hi:[1,1,0]
    v_pk_fma_f32 v[106:107], v[106:107], v[8:9], v[8:9] op_sel:[0,1,0] op_sel_hi:[1,1,0]
    v_pk_mul_f32 v[104:105], v[104:105], v[40:41]
    v_pk_mul_f32 v[106:107], v[106:107], v[42:43]
    v_exp_f32 v104, v104
    v_exp_f32 v106, v106
    v_exp_f32 v105, v105
    v_exp_f32 v107, v107
    v_pk_add_f32 v[104:105], v[104:105], v[12:13] op_sel_hi:[1,0]
    v_pk_add_f32 v[106:107], v[106:107], v[12:13] op_sel_hi:[1,0]
    v_rcp_f32 v104, v104
    v_rcp_f32 v106, v106
    v_rcp_f32 v105, v105
    v_rcp_f32 v107, v107
    v_pk_mul_f32 v[40:41], v[40:41], v[104:105]
    v_pk_mul_f32 v[42:43], v[42:43], v[106:107]
    v_pk_fma_f32 v[44:45], v[76:77], v[10:11], v[44:45] op_sel_hi:[1,0,1]
    v_pk_fma_f32 v[46:47], v[78:79], v[10:11], v[46:47] op_sel_hi:[1,0,1]
    v_pk_mul_f32 v[44:45], v[44:45], v[10:11] op_sel:[0,1] op_sel_hi:[1,1]
    v_pk_mul_f32 v[46:47], v[46:47], v[10:11] op_sel:[0,1] op_sel_hi:[1,1]
    v_pk_mul_f32 v[108:109], v[44:45], v[44:45]
    v_pk_mul_f32 v[110:111], v[46:47], v[46:47]
    v_pk_fma_f32 v[108:109], v[108:109], v[8:9], v[8:9] op_sel:[0,1,0] op_sel_hi:[1,1,0]
    v_pk_fma_f32 v[110:111], v[110:111], v[8:9], v[8:9] op_sel:[0,1,0] op_sel_hi:[1,1,0]
    v_pk_mul_f32 v[108:109], v[108:109], v[44:45]
    v_pk_mul_f32 v[110:111], v[110:111], v[46:47]
    v_exp_f32 v108, v108
    v_exp_f32 v110, v110
    v_exp_f32 v109, v109
    v_exp_f32 v111, v111
    v_pk_add_f32 v[108:109], v[108:109], v[12:13] op_sel_hi:[1,0]
    v_pk_add_f32 v[110:111], v[110:111], v[12:13] op_sel_hi:[1,0]
    v_rcp_f32 v108, v108
    v_rcp_f32 v110, v110
    v_rcp_f32 v109, v109
    v_rcp_f32 v111, v111
    v_pk_mul_f32 v[44:45], v[44:45], v[108:109]
    v_pk_mul_f32 v[46:47], v[46:47], v[110:111]
    v_cvt_pk_bf16_f32 v124, v40, v41
    v_cvt_pk_bf16_f32 v125, v42, v43
    v_cvt_pk_bf16_f32 v126, v44, v45
    v_cvt_pk_bf16_f32 v127, v46, v47
    v_min_u32 v124, 0xfffffffe, v124
    buffer_store_dwordx4 v[124:127], v2, s[28:31], s54 offen offset:1024 sc1
    s_add_u32 s68, s67, 1507328
    buffer_load_dwordx4 v[204:207], v2, s[28:31], s68 offen offset:0 sc1
    buffer_load_dwordx4 v[208:211], v2, s[28:31], s68 offen offset:1024 sc1
    buffer_load_dwordx4 v[212:215], v2, s[28:31], s68 offen offset:2048 sc1
    buffer_load_dwordx4 v[216:219], v2, s[28:31], s68 offen offset:3072 sc1
    s_add_u32 s68, s67, 1511424
    buffer_load_dwordx4 v[220:223], v2, s[28:31], s68 offen offset:0 sc1
    buffer_load_dwordx4 v[224:227], v2, s[28:31], s68 offen offset:1024 sc1
    buffer_load_dwordx4 v[228:231], v2, s[28:31], s68 offen offset:2048 sc1
    buffer_load_dwordx4 v[232:235], v2, s[28:31], s68 offen offset:3072 sc1
    s_add_u32 s68, s67, 1515520
    buffer_load_dwordx4 v[236:239], v2, s[28:31], s68 offen offset:0 sc1
    buffer_load_dwordx4 v[240:243], v2, s[28:31], s68 offen offset:1024 sc1
    buffer_load_dwordx4 v[244:247], v2, s[28:31], s68 offen offset:2048 sc1
    buffer_load_dwordx4 v[248:251], v2, s[28:31], s68 offen offset:3072 sc1
    s_add_u32 s68, s67, 1519616
    buffer_load_dwordx4 v[252:255], v2, s[28:31], s68 offen offset:0 sc1
    s_sub_u32 s53, s65, 1
    s_max_i32 s53, s53, 0
    s_add_u32 s54, s65, 1
    s_min_u32 s54, s54, 63
    s_bitcmp1_b32 s46, 0
    s_cselect_b32 s53, s54, s53
    s_sub_u32 s53, s53, s65
    s_mul_i32 s53, s53, 36864
    v_bfe_i32 v8, v1, 2, 1
    v_and_b32 v8, s53, v8
    v_and_b32 v9, 3, v1
    v_lshl_add_u32 v8, v9, 11, v8
    s_mul_i32 s53, s65, 36
    s_mul_i32 s54, s46, 9
    s_add_u32 s53, s53, s54
    s_add_u32 s53, s53, 1
    s_lshl_b32 s53, s53, 10
    s_add_u32 s53, s53, 0xf00000
    v_add_u32 v4, s53, v8
    s_lshr_b32 s53, s46, 1
    s_add_u32 s53, s53, 1
    s_sub_u32 s54, 0, s53
    s_bitcmp1_b32 s46, 0
    s_cselect_b32 s53, s53, s54
    s_lshl_b32 s54, s65, 5
    s_add_u32 s53, s53, s54
    v_and_b32 v8, 31, v1
    v_add_u32 v8, s53, v8
    v_lshrrev_b32 v9, 5, v8
    v_mul_u32_u24 v9, 36864, v9
    v_and_b32 v10, 31, v8
    v_lshl_add_u32 v9, v10, 4, v9
    v_lshrrev_b32 v10, 5, v1
    v_lshl_add_u32 v9, v10, 9, v9
    v_mov_b32 v10, 0x8000000
    v_cmp_gt_u32 vcc, 2048, v8
    s_nop 1
    v_cndmask_b32 v5, v10, v9, vcc
    s_mul_i32 s52, s46, 9216
    s_add_u32 s52, s52, 0xf00000
    s_mov_b32 s64, 0
    s_mul_i32 s53, s46, 9216
    s_add_u32 m0, s53, 110592
    s_add_u32 s54, s52, 0
    buffer_load_dwordx4 v5, s[28:31], s54 offen offset:0 sc1 lds
    buffer_load_dwordx4 v5, s[28:31], s54 offen offset:1024 sc1 lds
    buffer_load_dwordx4 v5, s[28:31], s54 offen offset:2048 sc1 lds
    buffer_load_dwordx4 v5, s[28:31], s54 offen offset:3072 sc1 lds
    s_add_u32 m0, s53, 114688
    s_add_u32 s54, s52, 4096
    buffer_load_dwordx4 v5, s[28:31], s54 offen offset:0 sc1 lds
    buffer_load_dwordx4 v5, s[28:31], s54 offen offset:1024 sc1 lds
    buffer_load_dwordx4 v5, s[28:31], s54 offen offset:2048 sc1 lds
    buffer_load_dwordx4 v5, s[28:31], s54 offen offset:3072 sc1 lds
    s_add_u32 m0, s53, 118784
    s_add_u32 s54, s52, 8192
    buffer_load_dwordx4 v5, s[28:31], s54 offen offset:0 sc1 lds
    s_branch L_go_29
L_again_28:
    s_mov_b64 exec, 0xff
    s_mov_b32 s69, 0
L_pd_30:
    buffer_load_dword v8, v4, s[28:31], 0 offen sc1
    s_add_u32 s69, s69, 1
    s_cmp_gt_u32 s69, 400000
    s_waitcnt vmcnt(0)
    s_cbranch_scc1 L_pdout_31
    v_cmp_eq_u32 vcc, -1, v8
    s_nop 1
    s_cbranch_vccnz L_pd_30
L_pdout_31:
    s_mov_b64 exec, -1
    s_mul_i32 s53, s46, 9216
    s_add_u32 m0, s53, 110592
    s_add_u32 s54, s52, 0
    buffer_load_dwordx4 v5, s[28:31], s54 offen offset:0 sc1 lds
    buffer_load_dwordx4 v5, s[28:31], s54 offen offset:1024 sc1 lds
    buffer_load_dwordx4 v5, s[28:31], s54 offen offset:2048 sc1 lds
    buffer_load_dwordx4 v5, s[28:31], s54 offen offset:3072 sc1 lds
    s_add_u32 m0, s53, 114688
    s_add_u32 s54, s52, 4096
    buffer_load_dwordx4 v5, s[28:31], s54 offen offset:0 sc1 lds
    buffer_load_dwordx4 v5, s[28:31], s54 offen offset:1024 sc1 lds
    buffer_load_dwordx4 v5, s[28:31], s54 offen offset:2048 sc1 lds
    buffer_load_dwordx4 v5, s[28:31], s54 offen offset:3072 sc1 lds
    s_add_u32 m0, s53, 118784
    s_add_u32 s54, s52, 8192
    buffer_load_dwordx4 v5, s[28:31], s54 offen offset:0 sc1 lds
    s_waitcnt vmcnt(0)
L_go_29:
    s_waitcnt vmcnt(0)
    ds_read_b128 v[96:99], v3 offset:0
    ds_read_b128 v[100:103], v3 offset:1024
    ds_read_b128 v[104:107], v3 offset:2048
    ds_read_b128 v[108:111], v3 offset:3072
    ds_read_b128 v[112:115], v3 offset:4096
    v_mov_b32 v7, 0
    s_waitcnt lgkmcnt(3)
    v_mfma_f32_32x32x16_bf16 v[48:63], a[180:183], v[96:99], 0
    v_max_u32 v7, v96, v7
    ds_read_b128 v[116:119], v3 offset:5120
    v_lshlrev_b32 v64, 16, v130
    v_mfma_f32_32x32x16_bf16 v[48:63], a[184:187], v[100:103], v[48:63]
    v_max_u32 v7, v100, v7
    ds_read_b128 v[96:99], v3 offset:6144
    v_and_b32 v65, 0xffff0000, v130
    v_lshlrev_b32 v66, 16, v131
    s_waitcnt lgkmcnt(3)
    v_mfma_f32_32x32x16_bf16 v[48:63], a[188:191], v[104:107], v[48:63]
    v_max_u32 v7, v104, v7
    ds_read_b128 v[100:103], v3 offset:7168
    v_and_b32 v67, 0xffff0000, v131
    v_mfma_f32_32x32x16_bf16 v[48:63], a[192:195], v[108:111], v[48:63]
    v_max_u32 v7, v108, v7
    ds_read_b128 v[104:107], v3 offset:8192
    v_lshlrev_b32 v68, 16, v132
    v_and_b32 v69, 0xffff0000, v132
    s_waitcnt lgkmcnt(3)
    v_mfma_f32_32x32x16_bf16 v[48:63], a[196:199], v[112:115], v[48:63]
    v_max_u32 v7, v112, v7
    v_lshlrev_b32 v70, 16, v133
    v_mfma_f32_32x32x16_bf16 v[48:63], a[200:203], v[116:119], v[48:63]
    v_max_u32 v7, v116, v7
    s_waitcnt lgkmcnt(2)
    v_max_u32 v7, v96, v7
    s_waitcnt lgkmcnt(1)
    v_max_u32 v7, v100, v7
    s_waitcnt lgkmcnt(0)
    v_max3_u32 v7, v104, v105, v7
    v_max3_u32 v7, v106, v107, v7
    v_cmp_eq_u32 vcc, -1, v7
    s_nop 1
    s_cbranch_vccz L_good_32
    s_add_u32 s64, s64, 1
    s_cmp_gt_u32 s64, 400000
    s_cbranch_scc1 L_good_32
    s_waitcnt vmcnt(0) lgkmcnt(0)
    s_nop 15
    s_branch L_again_28
L_good_32:
    s_barrier
    ds_read_b128 v[108:111], v6 offset:0
    ds_read_b128 v[112:115], v6 offset:1024
    v_and_b32 v71, 0xffff0000, v133
    v_lshlrev_b32 v72, 16, v134
    v_mfma_f32_32x32x16_bf16 v[48:63], a[204:207], v[96:99], v[48:63]
    ds_read_b128 v[116:119], v6 offset:2048
    v_and_b32 v73, 0xffff0000, v134
    v_mfma_f32_32x32x16_bf16 v[48:63], a[208:211], v[100:103], v[48:63]
    ds_read_b128 v[96:99], v6 offset:3072
    v_lshlrev_b32 v74, 16, v135
    v_and_b32 v75, 0xffff0000, v135
    s_waitcnt lgkmcnt(3)
    v_mfma_f32_32x32x16_bf16 v[48:63], a[212:215], v[104:107], v[48:63]
    ds_read_b128 v[100:103], v6 offset:4096
    v_lshlrev_b32 v29, 7, v0
    v_cmp_gt_u32 vcc, 162, v0
    v_mov_b32 v30, 0x8000000
    s_nop 0
    v_cndmask_b32 v29, v30, v29, vcc
    s_mul_i32 s0, s45, 20736
    s_mov_b32 s40, s16
    s_mov_b32 s41, s17
    s_mov_b32 s42, 0x510000
    s_mov_b32 s43, 0x20000
    v_mul_u32_u24 v28, 57, v0
    v_lshrrev_b32 v28, 9, v28
    v_mul_u32_u24 v28, 8064, v28
    v_add_u32 v28, v28, v29
    s_mul_i32 s1, s45, 165888
    s_mul_i32 s69, s44, 1152
    s_add_u32 s1, s1, s69
    buffer_load_dword v30, v28, s[40:43], s1 offen
    v_lshlrev_b32 v76, 16, v136
    v_mfma_f32_32x32x16_bf16 v[32:47], a[216:219], v[108:111], 0
    ds_read_b128 v[104:107], v6 offset:5120
    v_and_b32 v77, 0xffff0000, v136
    v_lshlrev_b32 v78, 16, v137
    s_waitcnt lgkmcnt(3)
    v_mfma_f32_32x32x16_bf16 v[32:47], a[220:223], v[112:115], v[32:47]
    ds_read_b128 v[108:111], v6 offset:6144
    v_and_b32 v79, 0xffff0000, v137
    v_mfma_f32_32x32x16_bf16 v[32:47], a[224:227], v[116:119], v[32:47]
    ds_read_b128 v[112:115], v6 offset:7168
    v_lshlrev_b32 v80, 16, v138
    v_and_b32 v81, 0xffff0000, v138
    s_waitcnt lgkmcnt(3)
    v_mfma_f32_32x32x16_bf16 v[32:47], a[228:231], v[96:99], v[32:47]
    ds_read_b128 v[116:119], v6 offset:8192
    v_mul_f32 v14, v139, v140
    v_mfma_f32_32x32x16_bf16 v[32:47], a[232:235], v[100:103], v[32:47]
    ds_read_b128 v[96:99], v6 offset:9216
    v_fma_f32 v64, v64, v140, v14
    v_fma_f32 v65, v65, v140, v14
    s_waitcnt lgkmcnt(3)
    v_mfma_f32_32x32x16_bf16 v[32:47], a[236:239], v[104:107], v[32:47]
    ds_read_b128 v[100:103], v6 offset:10240
    s_mul_i32 s53, s46, 2560
    s_add_u32 s53, s53, 151552
    v_lshlrev_b32 v8, 3, v1
    v_add_u32 v9, s53, v8
    ds_write_b64 v9, v[48:49] offset:0
    ds_write_b64 v9, v[50:51] offset:512
    ds_write_b64 v9, v[52:53] offset:1024
    ds_write_b64 v9, v[54:55] offset:1536
    ds_write_b64 v9, v[56:57] offset:2048
    s_and_b32 s49, s45, 1
    s_and_b32 s27, s44, 7
    s_lshl_b32 s27, s27, 1
    s_add_u32 s49, s49, s27
    s_lshr_b32 s48, s45, 1
    s_lshr_b32 s27, s44, 3
    s_lshl_b32 s27, s27, 4
    s_add_u32 s48, s48, s27
    s_lshr_b32 s50, s49, 1
    s_mul_i32 s51, s49, 288
    s_bitcmp1_b32 s49, 0
    s_cselect_b32 s27, 0, 256
    s_cselect_b32 s3, 32, 0
    s_add_u32 s26, s51, s27
    s_add_u32 s51, s51, s3
    s_and_b32 s62, s49, 0
    s_mul_i32 s10, s46, 9216
    s_mov_b32 s32, s16
    s_mov_b32 s33, s17
    s_mov_b32 s34, 0x510000
    s_mov_b32 s35, 0x20000
    s_mov_b32 s36, s18
    s_mov_b32 s37, s19
    s_mov_b32 s38, 0x510000
    s_mov_b32 s39, 0x20000
    v_fma_f32 v66, v66, v140, v14
    v_mfma_f32_32x32x16_bf16 v[32:47], a[240:243], v[108:111], v[32:47]
    ds_read_b128 v[104:107], v6 offset:11264
    v_fma_f32 v67, v67, v140, v14
    v_fma_f32 v68, v68, v140, v14
    s_waitcnt lgkmcnt(8)
    v_mfma_f32_32x32x16_bf16 v[32:47], a[244:247], v[112:115], v[32:47]
    ds_read_b128 v[108:111], v6 offset:12288
    v_fma_f32 v69, v69, v140, v14
    v_mfma_f32_32x32x16_bf16 v[32:47], a[248:251], v[116:119], v[32:47]
    ds_read_b128 v[112:115], v6 offset:13312
    v_fma_f32 v70, v70, v140, v14
    v_fma_f32 v71, v71, v140, v14
    s_waitcnt lgkmcnt(8)
    v_mfma_f32_32x32x16_bf16 v[32:47], a[252:255], v[96:99], v[32:47]
    ds_read_b128 v[116:119], v6 offset:14336
    v_fma_f32 v72, v72, v140, v14
    v_mfma_f32_32x32x16_bf16 v[32:47], v[152:155], v[100:103], v[32:47]
    ds_read_b128 v[96:99], v6 offset:15360
    s_waitcnt lgkmcnt(5)
    s_barrier
    s_lshl_b32 s53, s46, 9
    s_add_u32 s53, s53, 151552
    v_lshlrev_b32 v8, 3, v1
    v_add_u32 v9, 151552, v8
    v_add_u32 v8, s53, v8
    ds_read_b64 v[144:145], v8 offset:0
    ds_read_b64 v[146:147], v8 offset:2560
    ds_read_b64 v[148:149], v8 offset:5120
    ds_read_b64 v[150:151], v8 offset:7680
    ds_read_b64 v[84:85], v9 offset:2048
    ds_read_b64 v[86:87], v9 offset:4608
    ds_read_b64 v[88:89], v9 offset:7168
    ds_read_b64 v[90:91], v9 offset:9728
    v_lshrrev_b32 v27, 2, v1
    v_mul_u32_u24 v27, 9216, v27
    v_and_b32 v28, 3, v1
    v_lshl_add_u32 v16, v28, 4, v27
    v_add_u32 v17, 146432, v16
    v_add_u32 v18, 292864, v16
    v_add_u32 v19, 439296, v16
    v_add_u32 v20, 589824, v16
    v_add_u32 v21, 736256, v16
    v_add_u32 v22, 882688, v16
    v_add_u32 v23, 1029120, v16
    v_add_u32 v24, 1179648, v16
    v_fma_f32 v73, v73, v140, v14
    v_fma_f32 v74, v74, v140, v14
    s_waitcnt lgkmcnt(11)
    v_mfma_f32_32x32x16_bf16 v[32:47], v[156:159], v[104:107], v[32:47]
    ds_read_b128 v[100:103], v6 offset:16384
    v_fma_f32 v75, v75, v140, v14
    v_mfma_f32_32x32x16_bf16 v[32:47], v[160:163], v[108:111], v[32:47]
    ds_read_b128 v[104:107], v6 offset:17408
    v_fma_f32 v76, v76, v140, v14
    v_fma_f32 v77, v77, v140, v14
    s_waitcnt lgkmcnt(11)
    v_mfma_f32_32x32x16_bf16 v[32:47], v[164:167], v[112:115], v[32:47]
    ds_read_b128 v[108:111], v6 offset:18432
    v_fma_f32 v78, v78, v140, v14
    v_mfma_f32_32x32x16_bf16 v[32:47], v[168:171], v[116:119], v[32:47]
    ds_read_b128 v[112:115], v6 offset:19456
    v_fma_f32 v79, v79, v140, v14
    v_fma_f32 v80, v80, v140, v14
    s_waitcnt lgkmcnt(3)
    v_mfma_f32_32x32x16_bf16 v[32:47], v[172:175], v[96:99], v[32:47]
    ds_read_b128 v[116:119], v6 offset:20480
    v_add_f32 v144, v144, v146
    v_add_f32 v145, v145, v147
    v_add_f32 v148, v148, v150
    v_add_f32 v149, v149, v151
    v_add_f32 v48, v144, v148
    v_add_f32 v49, v145, v149
    v_fma_f32 v81, v81, v140, v14
    v_mfma_f32_32x32x16_bf16 v[32:47], v[176:179], v[100:103], v[32:47]
    ds_read_b128 v[96:99], v6 offset:21504
    v_add_f32 v84, v84, v88
    s_waitcnt lgkmcnt(3)
    v_mfma_f32_32x32x16_bf16 v[32:47], v[180:183], v[104:107], v[32:47]
    ds_read_b128 v[100:103], v6 offset:22528
    v_add_f32 v85, v85, v89
    v_add_f32 v86, v86, v90
    v_mfma_f32_32x32x16_bf16 v[32:47], v[184:187], v[108:111], v[32:47]
    ds_read_b128 v[104:107], v6 offset:23552
    v_add_f32 v87, v87, v91
    s_waitcnt lgkmcnt(3)
    v_mfma_f32_32x32x16_bf16 v[32:47], v[188:191], v[112:115], v[32:47]
    ds_read_b128 v[108:111], v6 offset:24576
    v_add_f32 v84, v84, v86
    v_mfma_f32_32x32x16_bf16 v[32:47], v[192:195], v[116:119], v[32:47]
    ds_read_b128 v[112:115], v6 offset:25600
    v_add_f32 v85, v85, v87
    v_add_f32 v84, v84, v85
    s_waitcnt lgkmcnt(3)
    v_mfma_f32_32x32x16_bf16 v[32:47], v[196:199], v[96:99], v[32:47]
    ds_read_b128 v[116:119], v6 offset:26624
    v_sub_f32 v64, v64, v84
    v_mfma_f32_32x32x16_bf16 v[32:47], v[200:203], v[100:103], v[32:47]
    ds_read_b128 v[96:99], v6 offset:27648
    v_sub_f32 v65, v65, v84
    s_waitcnt lgkmcnt(3)
    v_mfma_f32_32x32x16_bf16 v[32:47], v[204:207], v[104:107], v[32:47]
    ds_read_b128 v[100:103], v6 offset:28672
    v_sub_f32 v66, v66, v84
    v_sub_f32 v67, v67, v84
    v_mfma_f32_32x32x16_bf16 v[32:47], v[208:211], v[108:111], v[32:47]
    ds_read_b128 v[104:107], v6 offset:29696
    v_sub_f32 v68, v68, v84
    s_waitcnt lgkmcnt(3)
    v_mfma_f32_32x32x16_bf16 v[32:47], v[212:215], v[112:115], v[32:47]
    ds_read_b128 v[108:111], v6 offset:30720
    v_sub_f32 v69, v69, v84
    v_mfma_f32_32x32x16_bf16 v[32:47], v[216:219], v[116:119], v[32:47]
    ds_read_b128 v[112:115], v6 offset:31744
    v_sub_f32 v70, v70, v84
    s_waitcnt lgkmcnt(3)
    v_mfma_f32_32x32x16_bf16 v[32:47], v[220:223], v[96:99], v[32:47]
    ds_read_b128 v[116:119], v6 offset:32768
    v_sub_f32 v71, v71, v84
    v_sub_f32 v72, v72, v84
    v_mfma_f32_32x32x16_bf16 v[32:47], v[224:227], v[100:103], v[32:47]
    ds_read_b128 v[96:99], v6 offset:33792
    v_sub_f32 v73, v73, v84
    s_waitcnt lgkmcnt(3)
    v_mfma_f32_32x32x16_bf16 v[32:47], v[228:231], v[104:107], v[32:47]
    ds_read_b128 v[100:103], v6 offset:34816
    v_sub_f32 v74, v74, v84
    v_mfma_f32_32x32x16_bf16 v[32:47], v[232:235], v[108:111], v[32:47]
    ds_read_b128 v[104:107], v6 offset:35840
    v_sub_f32 v75, v75, v84
    v_sub_f32 v76, v76, v84
    s_waitcnt lgkmcnt(3)
    v_mfma_f32_32x32x16_bf16 v[32:47], v[236:239], v[112:115], v[32:47]
    v_sub_f32 v77, v77, v84
    v_mfma_f32_32x32x16_bf16 v[32:47], v[240:243], v[116:119], v[32:47]
    v_sub_f32 v78, v78, v84
    s_waitcnt lgkmcnt(1)
    v_mfma_f32_32x32x16_bf16 v[32:47], v[244:247], v[96:99], v[32:47]
    v_sub_f32 v79, v79, v84
    v_sub_f32 v80, v80, v84
    v_mfma_f32_32x32x16_bf16 v[32:47], v[248:251], v[100:103], v[32:47]
    v_sub_f32 v81, v81, v84
    s_waitcnt lgkmcnt(0)
    v_mfma_f32_32x32x16_bf16 v[32:47], v[252:255], v[104:107], v[32:47]
    s_barrier
    s_mul_i32 s53, s65, 36
    s_mul_i32 s54, s66, 9
    s_add_u32 s53, s53, s54
    s_lshl_b32 s53, s53, 10
    s_add_u32 s53, s53, 0x1200000
    s_lshl_b32 s54, s46, 11
    s_lshl_b32 s55, s46, 2
    s_add_u32 s54, s54, s53
    s_add_u32 s55, s55, s53
    s_add_u32 s55, s55, 8192
    v_add_f32 v48, v48, v80
    v_add_f32 v49, v49, v81
    v_cvt_pk_bf16_f32 v128, v48, v49
    v_min_u32 v128, 0xfffffffe, v128
    buffer_store_dword v128, v2, s[28:31], s55 offen sc1
    v_add_f32 v32, v32, v64
    v_add_f32 v33, v33, v65
    v_add_f32 v34, v34, v66
    v_add_f32 v35, v35, v67
    v_add_f32 v36, v36, v68
    v_add_f32 v37, v37, v69
    v_add_f32 v38, v38, v70
    v_add_f32 v39, v39, v71
    v_cvt_pk_bf16_f32 v120, v32, v33
    v_cvt_pk_bf16_f32 v121, v34, v35
    v_cvt_pk_bf16_f32 v122, v36, v37
    v_cvt_pk_bf16_f32 v123, v38, v39
    v_min_u32 v120, 0xfffffffe, v120
    buffer_store_dwordx4 v[120:123], v2, s[28:31], s54 offen sc1
    v_add_f32 v40, v40, v72
    v_add_f32 v41, v41, v73
    v_add_f32 v42, v42, v74
    v_add_f32 v43, v43, v75
    v_add_f32 v44, v44, v76
    v_add_f32 v45, v45, v77
    v_add_f32 v46, v46, v78
    v_add_f32 v47, v47, v79
    v_cvt_pk_bf16_f32 v124, v40, v41
    v_cvt_pk_bf16_f32 v125, v42, v43
    v_cvt_pk_bf16_f32 v126, v44, v45
    v_cvt_pk_bf16_f32 v127, v46, v47
    v_min_u32 v124, 0xfffffffe, v124
    buffer_store_dwordx4 v[124:127], v2, s[28:31], s54 offen offset:1024 sc1
    v_mul_f32 v11, v32, v32
    v_mul_f32 v13, v33, v33
    v_fmac_f32 v11, v34, v34
    v_fmac_f32 v13, v35, v35
    v_fmac_f32 v11, v36, v36
    v_fmac_f32 v13, v37, v37
    v_fmac_f32 v11, v38, v38
    v_fmac_f32 v13, v39, v39
    v_fmac_f32 v11, v40, v40
    v_fmac_f32 v13, v41, v41
    v_fmac_f32 v11, v42, v42
    v_fmac_f32 v13, v43, v43
    v_fmac_f32 v11, v44, v44
    v_fmac_f32 v13, v45, v45
    v_fmac_f32 v11, v46, v46
    v_fmac_f32 v13, v47, v47
    v_fmac_f32 v11, v48, v48
    v_fmac_f32 v13, v49, v49
    v_add_f32 v11, v11, v13
    v_mov_b32 v13, v11
    v_lshlrev_b32 v8, 3, v1
    s_lshl_b32 s53, s65, 4
    v_permlane32_swap_b32 v11, v13
    s_lshl_b32 s54, s66, 2
    s_add_u32 s53, s53, s54
    s_add_u32 s53, s53, s46
    s_lshl_b32 s53, s53, 8
    s_add_u32 s53, s53, 0x1580000
    v_add_f32 v11, v11, v13
    v_min_u32 v10, 0xfffffffe, v84
    s_mov_b32 exec_hi, 0
    buffer_store_dwordx2 v[10:11], v8, s[28:31], s53 offen sc1
    s_mov_b64 exec, -1
    s_lshl_b32 s56, s62, 1
    s_add_u32 s56, s56, s46
    s_and_b32 s56, s56, 3
    s_mul_i32 s56, s56, 1327104
    s_lshl_b32 s27, s26, 1
    s_add_u32 s56, s56, s27
    s_add_u32 m0, s10, 0
    s_nop 0
    buffer_load_dwordx4 v16, s[32:35], s56 offen offset:0 lds
    buffer_load_dwordx4 v17, s[32:35], s56 offen offset:1024 lds
    buffer_load_dwordx4 v18, s[32:35], s56 offen offset:2048 lds
    buffer_load_dwordx4 v19, s[32:35], s56 offen offset:3072 lds
    s_add_u32 m0, s10, 4096
    s_nop 0
    buffer_load_dwordx4 v20, s[32:35], s56 offen offset:0 lds
    buffer_load_dwordx4 v21, s[32:35], s56 offen offset:1024 lds
    buffer_load_dwordx4 v22, s[32:35], s56 offen offset:2048 lds
    buffer_load_dwordx4 v23, s[32:35], s56 offen offset:3072 lds
    s_add_u32 m0, s10, 8192
    s_nop 0
    buffer_load_dwordx4 v24, s[32:35], s56 offen offset:0 lds
    v_lshrrev_b32 v27, 3, v1
    v_mul_u32_u24 v27, 9216, v27
    v_bfe_u32 v28, v1, 4, 1
    v_lshlrev_b32 v28, 2, v28
    v_xor_b32 v28, v28, v1
    v_and_b32 v28, 7, v28
    v_lshl_add_u32 v16, v28, 4, v27
    v_add_u32 v17, 72704, v16
    v_add_u32 v18, 145408, v16
    v_add_u32 v19, 218112, v16
    v_add_u32 v20, 294912, v16
    v_add_u32 v21, 367616, v16
    v_add_u32 v22, 440320, v16
    v_add_u32 v23, 513024, v16
    v_add_u32 v24, 589824, v16
    s_xor_b32 s56, s62, 0
    s_lshl_b32 s56, s56, 2
    s_add_u32 s56, s56, s46
    s_mul_i32 s56, s56, 663552
    s_lshl_b32 s27, s51, 1
    s_add_u32 s56, s56, s27
    s_add_u32 m0, s10, 36864
    s_nop 0
    buffer_load_dwordx4 v16, s[32:35], s56 offen offset:0 lds
    buffer_load_dwordx4 v17, s[32:35], s56 offen offset:1024 lds
    buffer_load_dwordx4 v18, s[32:35], s56 offen offset:2048 lds
    buffer_load_dwordx4 v19, s[32:35], s56 offen offset:3072 lds
    s_add_u32 m0, s10, 40960
    s_nop 0
    buffer_load_dwordx4 v20, s[32:35], s56 offen offset:0 lds
    buffer_load_dwordx4 v21, s[32:35], s56 offen offset:1024 lds
    buffer_load_dwordx4 v22, s[32:35], s56 offen offset:2048 lds
    buffer_load_dwordx4 v23, s[32:35], s56 offen offset:3072 lds
    s_add_u32 m0, s10, 45056
    s_nop 0
    buffer_load_dwordx4 v24, s[32:35], s56 offen offset:0 lds
    s_xor_b32 s56, s62, 1
    s_lshl_b32 s56, s56, 2
    s_add_u32 s56, s56, s46
    s_mul_i32 s56, s56, 663552
    s_lshl_b32 s27, s51, 1
    s_add_u32 s56, s56, s27
    s_add_u32 m0, s10, 73728
    s_nop 0
    buffer_load_dwordx4 v16, s[32:35], s56 offen offset:0 lds
    buffer_load_dwordx4 v17, s[32:35], s56 offen offset:1024 lds
    buffer_load_dwordx4 v18, s[32:35], s56 offen offset:2048 lds
    buffer_load_dwordx4 v19, s[32:35], s56 offen offset:3072 lds
    s_add_u32 m0, s10, 77824
    s_nop 0
    buffer_load_dwordx4 v20, s[32:35], s56 offen offset:0 lds
    buffer_load_dwordx4 v21, s[32:35], s56 offen offset:1024 lds
    buffer_load_dwordx4 v22, s[32:35], s56 offen offset:2048 lds
    buffer_load_dwordx4 v23, s[32:35], s56 offen offset:3072 lds
    s_add_u32 m0, s10, 81920
    s_nop 0
    buffer_load_dwordx4 v24, s[32:35], s56 offen offset:0 lds
    s_mov_b32 s61, 0
    s_lshl_b32 s27, s48, 2
    s_add_u32 s27, s27, s46
    s_mul_i32 s55, s27, 36864
    s_add_u32 s55, s55, 0x1200000
    s_mul_i32 s27, s62, 18432
    s_sub_u32 s63, s55, s27
    s_add_u32 s55, s55, s27
    s_waitcnt vmcnt(18)
    s_barrier
L_again6_33:
    s_add_u32 s52, s55, 0
    buffer_load_dwordx4 a[0:3], v2, s[28:31], s52 offen offset:0 sc1
    buffer_load_dwordx4 a[4:7], v2, s[28:31], s52 offen offset:1024 sc1
    buffer_load_dwordx4 a[8:11], v2, s[28:31], s52 offen offset:2048 sc1
    buffer_load_dwordx4 a[12:15], v2, s[28:31], s52 offen offset:3072 sc1
    s_add_u32 s52, s55, 4096
    buffer_load_dwordx4 a[16:19], v2, s[28:31], s52 offen offset:0 sc1
    buffer_load_dwordx4 a[20:23], v2, s[28:31], s52 offen offset:1024 sc1
    buffer_load_dwordx4 a[24:27], v2, s[28:31], s52 offen offset:2048 sc1
    buffer_load_dwordx4 a[28:31], v2, s[28:31], s52 offen offset:3072 sc1
    s_add_u32 s52, s55, 8192
    buffer_load_dwordx4 a[32:35], v2, s[28:31], s52 offen offset:0 sc1
    buffer_load_dwordx4 a[36:39], v2, s[28:31], s52 offen offset:1024 sc1
    buffer_load_dwordx4 a[40:43], v2, s[28:31], s52 offen offset:2048 sc1
    buffer_load_dwordx4 a[44:47], v2, s[28:31], s52 offen offset:3072 sc1
    s_lshl_b32 s27, s48, 2
    s_add_u32 s27, s27, s46
    s_lshl_b32 s3, s27, 12
    s_add_u32 s3, s3, 0x1580000
    v_and_b32 v27, 31, v1
    v_lshlrev_b32 v27, 3, v27
    v_lshrrev_b32 v28, 5, v1
    v_lshl_add_u32 v27, v28, 11, v27
    buffer_load_dwordx2 v[46:47], v27, s[28:31], s3 offen offset:0 sc1
    buffer_load_dwordx2 v[48:49], v27, s[28:31], s3 offen offset:256 sc1
    buffer_load_dwordx2 v[50:51], v27, s[28:31], s3 offen offset:512 sc1
    buffer_load_dwordx2 v[52:53], v27, s[28:31], s3 offen offset:768 sc1
    buffer_load_dwordx2 v[54:55], v27, s[28:31], s3 offen offset:1024 sc1
    buffer_load_dwordx2 v[56:57], v27, s[28:31], s3 offen offset:1280 sc1
    buffer_load_dwordx2 v[58:59], v27, s[28:31], s3 offen offset:1536 sc1
    buffer_load_dwordx2 v[60:61], v27, s[28:31], s3 offen offset:1792 sc1
    v_bfe_u32 v27, v1, 4, 1
    v_lshlrev_b32 v27, 5, v27
    v_and_b32 v28, 1, v1
    v_lshl_add_u32 v27, v28, 4, v27
    v_bfe_u32 v28, v1, 1, 1
    v_lshl_add_u32 v27, v28, 3, v27
    v_bfe_u32 v28, v1, 2, 2
    v_lshrrev_b32 v29, 5, v1
    v_lshl_add_u32 v28, v29, 3, v28
    v_lshl_add_u32 v5, v28, 6, v27
    v_lshl_add_u32 v27, v28, 7, v27
    v_bfe_u32 v28, v1, 3, 1
    v_lshl_add_u32 v8, v28, 6, v27
    v_xor_b32 v9, 64, v8
    v_add_u32 v10, 36864, v8
    v_add_u32 v11, 36864, v9
    v_add_u32 v12, 73728, v8
    v_add_u32 v13, 73728, v9
    v_add_u32 v14, 110592, v8
    v_add_u32 v15, 110592, v9
    v_min_u32 v28, 18, v1
    s_lshl_b32 s59, s48, 6
    s_add_u32 s59, s59, s46
    s_lshl_b32 s59, s59, 7
    s_add_u32 s59, s59, 29360128
    s_lshl_b32 s68, s49, 2
    s_add_u32 s68, s68, s59
    s_lshl_b32 s60, s49, 9
    s_add_u32 s27, s59, s60
    v_lshl_add_u32 v3, v28, 2, s27
    v_lshlrev_b32 v7, 9, v1
    v_lshrrev_b32 v28, 1, v1
    v_sub_u32 v27, s50, v28
    v_add_u32 v27, 7, v27
    v_and_b32 v27, 7, v27
    v_lshlrev_b32 v27, 10, v27
    v_lshl_add_u32 v27, v28, 3, v27
    v_and_b32 v28, 1, v1
    v_lshl_add_u32 v27, v28, 9, v27
    s_and_b32 s3, s49, 1
    s_lshl_b32 s3, s3, 2
    s_add_u32 s3, s3, 68
    v_add_u32 v6, s3, v27
    s_xor_b32 s60, s60, 512
    s_add_u32 s60, s60, 64
    v_writelane_b32 v6, s60, 2
    s_lshl_b32 s27, s46, 1
    s_xor_b32 s27, s27, s48
    s_and_b32 s27, s27, 7
    s_lshl_b32 s67, s27, 12
    s_mul_i32 s58, s48, 72
    s_add_u32 s58, s58, s46
    s_lshl_b32 s58, s58, 15
    s_add_u32 s58, s58, 0x2000000
    s_lshl_b32 s27, s49, 11
    s_xor_b32 s27, s27, s67
    s_add_u32 s27, s27, s58
    s_and_b32 s3, s49, 1
    s_lshl_b32 s3, s3, 17
    s_add_u32 s13, s27, s3
    s_xor_b32 s3, s3, 131072
    s_add_u32 s12, s27, s3
    s_lshl_b32 s27, s49, 17
    s_add_u32 s58, s58, s27
    v_mov_b32 v31, 1
    ds_read_b64_tr_b16 a[144:145], v5 offset:0
    ds_read_b64_tr_b16 a[146:147], v5 offset:256
    ds_read_b64_tr_b16 a[148:149], v5 offset:1024
    ds_read_b64_tr_b16 a[150:151], v5 offset:1280
    ds_read_b64_tr_b16 a[152:153], v5 offset:2048
    ds_read_b64_tr_b16 a[154:155], v5 offset:2304
    ds_read_b64_tr_b16 a[156:157], v5 offset:3072
    ds_read_b64_tr_b16 a[158:159], v5 offset:3328
    ds_read_b64_tr_b16 a[160:161], v5 offset:4096
    ds_read_b64_tr_b16 a[162:163], v5 offset:4352
    ds_read_b64_tr_b16 a[164:165], v5 offset:5120
    ds_read_b64_tr_b16 a[166:167], v5 offset:5376
    v_mov_b32 v63, 0
    s_waitcnt vmcnt(19)
    v_accvgpr_read_b32 v27, a0
    v_max_u32 v63, v27, v63
    s_waitcnt lgkmcnt(8)
    v_mfma_f32_32x32x16_bf16 v[80:95], a[144:147], a[0:3], 0
    s_add_u32 s52, s55, 12288
    buffer_load_dwordx4 a[48:51], v2, s[28:31], s52 offen offset:0 sc1
    s_waitcnt vmcnt(19)
    v_accvgpr_read_b32 v27, a4
    v_max_u32 v63, v27, v63
    ds_read_b64_tr_b16 a[168:169], v5 offset:6144
    ds_read_b64_tr_b16 a[170:171], v5 offset:6400
    v_mfma_f32_32x32x16_bf16 v[80:95], a[148:151], a[4:7], v[80:95]
    buffer_load_dwordx4 a[52:55], v2, s[28:31], s52 offen offset:1024 sc1
    s_waitcnt vmcnt(19)
    v_accvgpr_read_b32 v27, a8
    v_max_u32 v63, v27, v63
    ds_read_b64_tr_b16 a[144:145], v5 offset:7168
    ds_read_b64_tr_b16 a[146:147], v5 offset:7424
    s_waitcnt lgkmcnt(8)
    v_mfma_f32_32x32x16_bf16 v[80:95], a[152:155], a[8:11], v[80:95]
    buffer_load_dwordx4 a[56:59], v2, s[28:31], s52 offen offset:2048 sc1
    s_waitcnt vmcnt(19)
    v_accvgpr_read_b32 v27, a12
    v_max_u32 v63, v27, v63
    s_waitcnt vmcnt(9)
    v_max3_u32 v63, v46, v48, v63
    s_waitcnt vmcnt(8)
    v_max_u32 v63, v50, v63
    s_waitcnt vmcnt(6)
    v_max3_u32 v63, v52, v54, v63
    s_waitcnt vmcnt(4)
    v_max3_u32 v63, v56, v58, v63
    s_waitcnt vmcnt(3)
    v_max_u32 v63, v60, v63
    v_cmp_eq_u32 vcc, -1, v63
    s_nop 1
    s_cbranch_vccz L_statok_34
    s_add_u32 s61, s61, 1
    s_cmp_gt_u32 s61, 400000
    s_cbranch_scc1 L_statok_34
    s_waitcnt vmcnt(0) lgkmcnt(0)
    s_nop 15
    s_lshl_b32 s27, s48, 2
    s_add_u32 s27, s27, s46
    s_lshl_b32 s3, s27, 12
    s_add_u32 s3, s3, 0x1580000
    v_lshlrev_b32 v27, 8, v1
    s_mov_b64 exec, 0xffff
    s_mov_b32 s69, 0
L_pd_35:
    buffer_load_dword v28, v27, s[28:31], s3 offen sc1
    s_add_u32 s69, s69, 1
    s_cmp_gt_u32 s69, 400000
    s_waitcnt vmcnt(0)
    s_cbranch_scc1 L_pdout_36
    v_cmp_eq_u32 vcc, -1, v28
    s_nop 1
    s_cbranch_vccnz L_pd_35
L_pdout_36:
    s_mov_b64 exec, -1
    s_branch L_again6_33
L_statok_34:
    v_add_f32 v47, v47, v55
    v_add_f32 v49, v49, v57
    v_add_f32 v51, v51, v59
    v_add_f32 v53, v53, v61
    v_add_f32 v47, v47, v51
    v_add_f32 v49, v49, v53
    v_add_f32 v47, v47, v49
    v_mov_b32 v49, v47
    s_nop 1
    v_permlane32_swap_b32 v47, v49
    v_add_f32 v47, v47, v49
    v_mov_b32 v48, 0x3727c5ac
    v_fmac_f32 v48, 0x3ae38e39, v47
    v_rsq_f32 v47, v48
    s_nop 0
    v_mul_f32 v4, v48, v47
    v_mul_f32 v25, 0xc0135761, v47
    v_mul_f32 v47, v47, v47
    v_mul_f32 v26, 0x3d372713, v25
    v_mul_f32 v26, v26, v47
    ds_read_b64_tr_b16 a[148:149], v5 offset:8192
    ds_read_b64_tr_b16 a[150:151], v5 offset:8448
    v_mfma_f32_32x32x16_bf16 v[80:95], a[156:159], a[12:15], v[80:95]
    buffer_load_dwordx4 a[60:63], v2, s[28:31], s52 offen offset:3072 sc1
    v_accvgpr_read_b32 v27, a16
    v_max_u32 v63, v27, v63
    ds_read_b64_tr_b16 a[152:153], v5 offset:9216
    ds_read_b64_tr_b16 a[154:155], v5 offset:9472
    s_waitcnt lgkmcnt(8)
    v_mfma_f32_32x32x16_bf16 v[80:95], a[160:163], a[16:19], v[80:95]
    s_add_u32 s52, s55, 16384
    buffer_load_dwordx4 a[64:67], v2, s[28:31], s52 offen offset:0 sc1
    v_accvgpr_read_b32 v27, a20
    v_max_u32 v63, v27, v63
    ds_read_b64_tr_b16 a[156:157], v5 offset:10240
    ds_read_b64_tr_b16 a[158:159], v5 offset:10496
    v_mfma_f32_32x32x16_bf16 v[80:95], a[164:167], a[20:23], v[80:95]
    buffer_load_dwordx4 a[68:71], v2, s[28:31], s52 offen offset:1024 sc1
    v_accvgpr_read_b32 v27, a24
    v_max_u32 v63, v27, v63
    ds_read_b64_tr_b16 a[160:161], v5 offset:11264
    ds_read_b64_tr_b16 a[162:163], v5 offset:11520
    s_waitcnt lgkmcnt(8)
    v_mfma_f32_32x32x16_bf16 v[80:95], a[168:171], a[24:27], v[80:95]
    s_add_u32 s52, s63, 18432
    buffer_load_dwordx4 a[72:75], v2, s[28:31], s52 offen offset:0 sc1
    v_accvgpr_read_b32 v27, a28
    v_max_u32 v63, v27, v63
    ds_read_b64_tr_b16 a[164:165], v5 offset:12288
    ds_read_b64_tr_b16 a[166:167], v5 offset:12544
    v_mfma_f32_32x32x16_bf16 v[80:95], a[144:147], a[28:31], v[80:95]
    buffer_load_dwordx4 a[76:79], v2, s[28:31], s52 offen offset:1024 sc1
    v_accvgpr_read_b32 v27, a32
    v_accvgpr_read_b32 v28, a33
    v_accvgpr_read_b32 v29, a34
    v_accvgpr_read_b32 v30, a35
    v_max3_u32 v63, v27, v28, v63
    v_max3_u32 v63, v29, v30, v63
    ds_read_b64_tr_b16 a[168:169], v5 offset:13312
    ds_read_b64_tr_b16 a[170:171], v5 offset:13568
    s_waitcnt lgkmcnt(8)
    v_mfma_f32_32x32x16_bf16 v[80:95], a[148:151], a[32:35], v[80:95]
    buffer_load_dwordx4 a[80:83], v2, s[28:31], s52 offen offset:2048 sc1
    v_accvgpr_read_b32 v27, a36
    v_max_u32 v63, v27, v63
    ds_read_b64_tr_b16 a[144:145], v5 offset:14336
    ds_read_b64_tr_b16 a[146:147], v5 offset:14592
    v_mfma_f32_32x32x16_bf16 v[80:95], a[152:155], a[36:39], v[80:95]
    buffer_load_dwordx4 a[84:87], v2, s[28:31], s52 offen offset:3072 sc1
    v_accvgpr_read_b32 v27, a40
    v_max_u32 v63, v27, v63
    ds_read_b64_tr_b16 a[148:149], v5 offset:15360
    ds_read_b64_tr_b16 a[150:151], v5 offset:15616
    s_waitcnt lgkmcnt(8)
    v_mfma_f32_32x32x16_bf16 v[80:95], a[156:159], a[40:43], v[80:95]
    s_add_u32 s52, s63, 22528
    buffer_load_dwordx4 a[88:91], v2, s[28:31], s52 offen offset:0 sc1
    v_accvgpr_read_b32 v27, a44
    v_max_u32 v63, v27, v63
    ds_read_b64_tr_b16 a[152:153], v5 offset:16384
    ds_read_b64_tr_b16 a[154:155], v5 offset:16640
    v_mfma_f32_32x32x16_bf16 v[80:95], a[160:163], a[44:47], v[80:95]
    buffer_load_dwordx4 a[92:95], v2, s[28:31], s52 offen offset:1024 sc1
    s_waitcnt vmcnt(11)
    v_accvgpr_read_b32 v27, a48
    v_max_u32 v63, v27, v63
    ds_read_b64_tr_b16 a[156:157], v5 offset:17408
    ds_read_b64_tr_b16 a[158:159], v5 offset:17664
    s_waitcnt lgkmcnt(8)
    v_mfma_f32_32x32x16_bf16 v[80:95], a[164:167], a[48:51], v[80:95]
    buffer_load_dwordx4 a[96:99], v2, s[28:31], s52 offen offset:2048 sc1
    s_waitcnt vmcnt(11)
    v_accvgpr_read_b32 v27, a52
    v_max_u32 v63, v27, v63
    ds_read_b64_tr_b16 a[160:161], v5 offset:18432
    ds_read_b64_tr_b16 a[162:163], v5 offset:18688
    v_mfma_f32_32x32x16_bf16 v[80:95], a[168:171], a[52:55], v[80:95]
    buffer_load_dwordx4 a[100:103], v2, s[28:31], s52 offen offset:3072 sc1
    s_waitcnt vmcnt(11)
    v_accvgpr_read_b32 v27, a56
    v_max_u32 v63, v27, v63
    ds_read_b64_tr_b16 a[164:165], v5 offset:19456
    ds_read_b64_tr_b16 a[166:167], v5 offset:19712
    s_waitcnt lgkmcnt(8)
    v_mfma_f32_32x32x16_bf16 v[80:95], a[144:147], a[56:59], v[80:95]
    s_add_u32 s52, s63, 26624
    buffer_load_dwordx4 a[104:107], v2, s[28:31], s52 offen offset:0 sc1
    s_waitcnt vmcnt(11)
    v_accvgpr_read_b32 v27, a60
    v_max_u32 v63, v27, v63
    ds_read_b64_tr_b16 a[168:169], v5 offset:20480
    ds_read_b64_tr_b16 a[170:171], v5 offset:20736
    v_mfma_f32_32x32x16_bf16 v[80:95], a[148:151], a[60:63], v[80:95]
    buffer_load_dwordx4 a[108:111], v2, s[28:31], s52 offen offset:1024 sc1
    s_waitcnt vmcnt(11)
    v_accvgpr_read_b32 v27, a64
    v_max_u32 v63, v27, v63
    ds_read_b64_tr_b16 a[144:145], v5 offset:21504
    ds_read_b64_tr_b16 a[146:147], v5 offset:21760
    s_waitcnt lgkmcnt(8)
    v_mfma_f32_32x32x16_bf16 v[80:95], a[152:155], a[64:67], v[80:95]
    buffer_load_dwordx4 a[112:115], v2, s[28:31], s52 offen offset:2048 sc1
    s_waitcnt vmcnt(11)
    v_accvgpr_read_b32 v27, a68
    v_accvgpr_read_b32 v28, a69
    v_accvgpr_read_b32 v29, a70
    v_accvgpr_read_b32 v30, a71
    v_max3_u32 v63, v27, v28, v63
    v_max3_u32 v63, v29, v30, v63
    ds_read_b64_tr_b16 a[148:149], v5 offset:22528
    ds_read_b64_tr_b16 a[150:151], v5 offset:22784
    v_mfma_f32_32x32x16_bf16 v[80:95], a[156:159], a[68:71], v[80:95]
    buffer_load_dwordx4 a[116:119], v2, s[28:31], s52 offen offset:3072 sc1
    s_waitcnt vmcnt(11)
    v_accvgpr_read_b32 v27, a72
    v_max_u32 v63, v27, v63
    ds_read_b64_tr_b16 a[152:153], v5 offset:23552
    ds_read_b64_tr_b16 a[154:155], v5 offset:23808
    s_waitcnt lgkmcnt(8)
    v_mfma_f32_32x32x16_bf16 v[80:95], a[160:163], a[72:75], v[80:95]
    s_add_u32 s52, s63, 30720
    buffer_load_dwordx4 a[120:123], v2, s[28:31], s52 offen offset:0 sc1
    s_waitcnt vmcnt(11)
    v_accvgpr_read_b32 v27, a76
    v_max_u32 v63, v27, v63
    ds_read_b64_tr_b16 a[156:157], v5 offset:24576
    ds_read_b64_tr_b16 a[158:159], v5 offset:24832
    v_mfma_f32_32x32x16_bf16 v[80:95], a[164:167], a[76:79], v[80:95]
    buffer_load_dwordx4 a[124:127], v2, s[28:31], s52 offen offset:1024 sc1
    s_waitcnt vmcnt(11)
    v_accvgpr_read_b32 v27, a80
    v_max_u32 v63, v27, v63
    ds_read_b64_tr_b16 a[160:161], v5 offset:25600
    ds_read_b64_tr_b16 a[162:163], v5 offset:25856
    s_waitcnt lgkmcnt(8)
    v_mfma_f32_32x32x16_bf16 v[80:95], a[168:171], a[80:83], v[80:95]
    buffer_load_dwordx4 a[128:131], v2, s[28:31], s52 offen offset:2048 sc1
    s_waitcnt vmcnt(11)
    v_accvgpr_read_b32 v27, a84
    v_max_u32 v63, v27, v63
    ds_read_b64_tr_b16 a[164:165], v5 offset:26624
    ds_read_b64_tr_b16 a[166:167], v5 offset:26880
    v_mfma_f32_32x32x16_bf16 v[80:95], a[144:147], a[84:87], v[80:95]
    buffer_load_dwordx4 a[132:135], v2, s[28:31], s52 offen offset:3072 sc1
    s_waitcnt vmcnt(11)
    v_accvgpr_read_b32 v27, a88
    v_max_u32 v63, v27, v63
    ds_read_b64_tr_b16 a[168:169], v5 offset:27648
    ds_read_b64_tr_b16 a[170:171], v5 offset:27904
    s_waitcnt lgkmcnt(8)
    v_mfma_f32_32x32x16_bf16 v[80:95], a[148:151], a[88:91], v[80:95]
    s_add_u32 s52, s63, 34816
    buffer_load_dwordx4 a[136:139], v2, s[28:31], s52 offen offset:0 sc1
    s_waitcnt vmcnt(11)
    v_accvgpr_read_b32 v27, a92
    v_max_u32 v63, v27, v63
    ds_read_b64_tr_b16 a[144:145], v5 offset:28672
    ds_read_b64_tr_b16 a[146:147], v5 offset:28928
    v_mfma_f32_32x32x16_bf16 v[80:95], a[152:155], a[92:95], v[80:95]
    buffer_load_dwordx4 a[140:143], v2, s[28:31], s52 offen offset:1024 sc1
    s_waitcnt vmcnt(11)
    v_accvgpr_read_b32 v27, a96
    v_max_u32 v63, v27, v63
    ds_read_b64_tr_b16 a[148:149], v5 offset:29696
    ds_read_b64_tr_b16 a[150:151], v5 offset:29952
    s_waitcnt lgkmcnt(8)
    v_mfma_f32_32x32x16_bf16 v[80:95], a[156:159], a[96:99], v[80:95]
    s_waitcnt vmcnt(10)
    v_accvgpr_read_b32 v27, a100
    v_max_u32 v63, v27, v63
    ds_read_b64_tr_b16 a[152:153], v5 offset:30720
    ds_read_b64_tr_b16 a[154:155], v5 offset:30976
    s_xor_b32 s56, s62, 0
    s_lshl_b32 s56, s56, 2
    s_add_u32 s56, s56, s46
    s_mul_i32 s56, s56, 663552
    s_lshl_b32 s27, s51, 1
    s_add_u32 s56, s56, s27
    s_add_u32 s56, s56, 128
    v_mfma_f32_32x32x16_bf16 v[80:95], a[160:163], a[100:103], v[80:95]
    s_waitcnt vmcnt(9)
    v_accvgpr_read_b32 v27, a104
    v_accvgpr_read_b32 v28, a105
    v_accvgpr_read_b32 v29, a106
    v_accvgpr_read_b32 v30, a107
    v_max3_u32 v63, v27, v28, v63
    v_max3_u32 v63, v29, v30, v63
    ds_read_b64_tr_b16 a[156:157], v5 offset:31744
    ds_read_b64_tr_b16 a[158:159], v5 offset:32000
    s_add_u32 m0, s10, 110592
    s_nop 0
    buffer_load_dwordx4 v16, s[32:35], s56 offen offset:0 lds
    s_waitcnt lgkmcnt(8)
    v_mfma_f32_32x32x16_bf16 v[80:95], a[164:167], a[104:107], v[80:95]
    s_waitcnt vmcnt(9)
    v_accvgpr_read_b32 v27, a108
    v_max_u32 v63, v27, v63
    ds_read_b64_tr_b16 a[160:161], v5 offset:32768
    ds_read_b64_tr_b16 a[162:163], v5 offset:33024
    buffer_load_dwordx4 v17, s[32:35], s56 offen offset:1024 lds
    buffer_load_dwordx4 v18, s[32:35], s56 offen offset:2048 lds
    v_mfma_f32_32x32x16_bf16 v[80:95], a[168:171], a[108:111], v[80:95]
    s_waitcnt vmcnt(10)
    v_accvgpr_read_b32 v27, a112
    v_max_u32 v63, v27, v63
    ds_read_b64_tr_b16 a[164:165], v5 offset:33792
    ds_read_b64_tr_b16 a[166:167], v5 offset:34048
    buffer_load_dwordx4 v19, s[32:35], s56 offen offset:3072 lds
    s_waitcnt lgkmcnt(8)
    v_mfma_f32_32x32x16_bf16 v[80:95], a[144:147], a[112:115], v[80:95]
    s_waitcnt vmcnt(10)
    v_accvgpr_read_b32 v27, a116
    v_max_u32 v63, v27, v63
    ds_read_b64_tr_b16 a[168:169], v5 offset:34816
    ds_read_b64_tr_b16 a[170:171], v5 offset:35072
    s_add_u32 m0, s10, 114688
    s_nop 0
    buffer_load_dwordx4 v20, s[32:35], s56 offen offset:0 lds
    v_mfma_f32_32x32x16_bf16 v[80:95], a[148:151], a[116:119], v[80:95]
    s_waitcnt vmcnt(10)
    v_accvgpr_read_b32 v27, a120
    v_max_u32 v63, v27, v63
    ds_read_b64_tr_b16 a[144:145], v5 offset:35840
    ds_read_b64_tr_b16 a[146:147], v5 offset:36096
    buffer_load_dwordx4 v21, s[32:35], s56 offen offset:1024 lds
    s_waitcnt lgkmcnt(8)
    v_mfma_f32_32x32x16_bf16 v[80:95], a[152:155], a[120:123], v[80:95]
    s_waitcnt vmcnt(10)
    v_accvgpr_read_b32 v27, a124
    v_max_u32 v63, v27, v63
    buffer_load_dwordx4 v22, s[32:35], s56 offen offset:2048 lds
    buffer_load_dwordx4 v23, s[32:35], s56 offen offset:3072 lds
    v_mfma_f32_32x32x16_bf16 v[80:95], a[156:159], a[124:127], v[80:95]
    s_waitcnt vmcnt(11)
    v_accvgpr_read_b32 v27, a128
    v_max_u32 v63, v27, v63
    s_waitcnt vmcnt(10)
    v_accvgpr_read_b32 v27, a132
    v_max_u32 v63, v27, v63
    s_waitcnt vmcnt(9)
    v_accvgpr_read_b32 v27, a136
    v_max_u32 v63, v27, v63
    s_waitcnt vmcnt(8)
    v_accvgpr_read_b32 v27, a140
    v_accvgpr_read_b32 v28, a141
    v_accvgpr_read_b32 v29, a142
    v_accvgpr_read_b32 v30, a143
    v_max3_u32 v63, v27, v28, v63
    v_max3_u32 v63, v29, v30, v63
    v_cmp_eq_u32 vcc, -1, v63
    s_nop 1
    s_cbranch_vccz L_good_37
    s_add_u32 s61, s61, 1
    s_cmp_gt_u32 s61, 400000
    s_cbranch_scc1 L_good_37
    s_waitcnt vmcnt(0) lgkmcnt(0)
    s_nop 15
    s_branch L_again6_33
L_good_37:
    s_add_u32 m0, s10, 118784
    s_nop 0
    buffer_load_dwordx4 v24, s[32:35], s56 offen offset:0 lds
    s_waitcnt lgkmcnt(4)
    v_mfma_f32_32x32x16_bf16 v[80:95], a[160:163], a[128:131], v[80:95]
    s_waitcnt lgkmcnt(0)
    s_barrier
    ds_read_b64_tr_b16 a[148:149], v10 offset:0
    ds_read_b64_tr_b16 a[150:151], v10 offset:512
    ds_read_b64_tr_b16 a[152:153], v10 offset:2048
    ds_read_b64_tr_b16 a[154:155], v10 offset:2560
    ds_read_b64_tr_b16 a[156:157], v10 offset:4096
    ds_read_b64_tr_b16 a[158:159], v10 offset:4608
    v_mfma_f32_32x32x16_bf16 v[80:95], a[164:167], a[132:135], v[80:95]
    ds_read_b64_tr_b16 a[160:161], v10 offset:6144
    ds_read_b64_tr_b16 a[162:163], v10 offset:6656
    v_mfma_f32_32x32x16_bf16 v[80:95], a[168:171], a[136:139], v[80:95]
    ds_read_b64_tr_b16 a[164:165], v10 offset:8192
    ds_read_b64_tr_b16 a[166:167], v10 offset:8704
    v_mfma_f32_32x32x16_bf16 v[80:95], a[144:147], a[140:143], v[80:95]
    ds_read_b64_tr_b16 a[168:169], v10 offset:10240
    ds_read_b64_tr_b16 a[170:171], v10 offset:10752
    s_waitcnt lgkmcnt(8)
    v_mfma_f32_32x32x16_bf16 v[96:111], a[148:151], a[0:3], 0
    ds_read_b64_tr_b16 a[144:145], v10 offset:12288
    ds_read_b64_tr_b16 a[146:147], v10 offset:12800
    s_xor_b32 s56, s62, 1
    s_lshl_b32 s56, s56, 2
    s_add_u32 s56, s56, s46
    s_mul_i32 s56, s56, 663552
    s_lshl_b32 s27, s51, 1
    s_add_u32 s56, s56, s27
    s_add_u32 s56, s56, 128
    v_mfma_f32_32x32x16_bf16 v[96:111], a[152:155], a[4:7], v[96:111]
    ds_read_b64_tr_b16 a[148:149], v10 offset:14336
    ds_read_b64_tr_b16 a[150:151], v10 offset:14848
    s_waitcnt lgkmcnt(8)
    v_mfma_f32_32x32x16_bf16 v[96:111], a[156:159], a[8:11], v[96:111]
    ds_read_b64_tr_b16 a[152:153], v10 offset:16384
    ds_read_b64_tr_b16 a[154:155], v10 offset:16896
    v_mul_f32 v27, v80, v80
    v_mul_f32 v28, v81, v81
    v_fma_f32 v27, v27, v26, v25
    v_fma_f32 v28, v28, v26, v25
    v_mul_f32 v27, v27, v80
    v_mfma_f32_32x32x16_bf16 v[96:111], a[160:163], a[12:15], v[96:111]
    ds_read_b64_tr_b16 a[156:157], v10 offset:18432
    ds_read_b64_tr_b16 a[158:159], v10 offset:18944
    v_mul_f32 v28, v28, v81
    v_exp_f32 v27, v27
    v_exp_f32 v28, v28
    s_waitcnt lgkmcnt(8)
    v_mfma_f32_32x32x16_bf16 v[96:111], a[164:167], a[16:19], v[96:111]
    ds_read_b64_tr_b16 a[160:161], v10 offset:20480
    ds_read_b64_tr_b16 a[162:163], v10 offset:20992
    v_fma_f32 v27, v27, v4, v4
    s_add_u32 m0, s10, 0
    v_mov_b32 v72, -1
    v_fma_f32 v28, v28, v4, v4
    v_rcp_f32 v27, v27
    v_mfma_f32_32x32x16_bf16 v[96:111], a[168:171], a[20:23], v[96:111]
    ds_read_b64_tr_b16 a[164:165], v10 offset:22528
    ds_read_b64_tr_b16 a[166:167], v10 offset:23040
    v_rcp_f32 v28, v28
    v_mul_f32 v80, v80, v27
    v_mul_f32 v81, v81, v28
    s_waitcnt lgkmcnt(8)
    v_mfma_f32_32x32x16_bf16 v[96:111], a[144:147], a[24:27], v[96:111]
    ds_read_b64_tr_b16 a[168:169], v10 offset:24576
    ds_read_b64_tr_b16 a[170:171], v10 offset:25088
    v_cvt_pk_bf16_f32 v112, v80, v81
    v_mov_b32 v73, -1
    v_mul_f32 v29, v82, v82
    v_mul_f32 v30, v83, v83
    v_fma_f32 v29, v29, v26, v25
    v_fma_f32 v30, v30, v26, v25
    v_mfma_f32_32x32x16_bf16 v[96:111], a[148:151], a[28:31], v[96:111]
    ds_read_b64_tr_b16 a[144:145], v10 offset:26624
    ds_read_b64_tr_b16 a[146:147], v10 offset:27136
    v_mul_f32 v29, v29, v82
    buffer_load_dwordx4 v16, s[32:35], s56 offen offset:0 lds
    v_mul_f32 v30, v30, v83
    v_exp_f32 v29, v29
    s_waitcnt lgkmcnt(8)
    v_mfma_f32_32x32x16_bf16 v[96:111], a[152:155], a[32:35], v[96:111]
    ds_read_b64_tr_b16 a[148:149], v10 offset:28672
    ds_read_b64_tr_b16 a[150:151], v10 offset:29184
    v_exp_f32 v30, v30
    v_mov_b32 v74, -1
    v_fma_f32 v29, v29, v4, v4
    v_fma_f32 v30, v30, v4, v4
    v_rcp_f32 v29, v29
    v_mfma_f32_32x32x16_bf16 v[96:111], a[156:159], a[36:39], v[96:111]
    ds_read_b64_tr_b16 a[152:153], v10 offset:30720
    ds_read_b64_tr_b16 a[154:155], v10 offset:31232
    v_rcp_f32 v30, v30
    v_mov_b32 v75, -1
    v_mul_f32 v82, v82, v29
    v_mul_f32 v83, v83, v30
    s_waitcnt lgkmcnt(8)
    v_mfma_f32_32x32x16_bf16 v[96:111], a[160:163], a[40:43], v[96:111]
    ds_read_b64_tr_b16 a[156:157], v10 offset:32768
    ds_read_b64_tr_b16 a[158:159], v10 offset:33280
    v_cvt_pk_bf16_f32 v113, v82, v83
    v_mul_f32 v27, v84, v84
    v_mul_f32 v28, v85, v85
    v_fma_f32 v27, v27, v26, v25
    v_mfma_f32_32x32x16_bf16 v[96:111], a[164:167], a[44:47], v[96:111]
    ds_read_b64_tr_b16 a[160:161], v10 offset:34816
    ds_read_b64_tr_b16 a[162:163], v10 offset:35328
    v_fma_f32 v28, v28, v26, v25
    v_mul_f32 v27, v27, v84
    v_mul_f32 v28, v28, v85
    v_exp_f32 v27, v27
    s_waitcnt lgkmcnt(8)
    v_mfma_f32_32x32x16_bf16 v[96:111], a[168:171], a[48:51], v[96:111]
    ds_read_b64_tr_b16 a[164:165], v12 offset:0
    ds_read_b64_tr_b16 a[166:167], v12 offset:512
    v_exp_f32 v28, v28
    buffer_load_dwordx4 v17, s[32:35], s56 offen offset:1024 lds
    v_fma_f32 v27, v27, v4, v4
    v_fma_f32 v28, v28, v4, v4
    v_mfma_f32_32x32x16_bf16 v[96:111], a[144:147], a[52:55], v[96:111]
    ds_read_b64_tr_b16 a[168:169], v12 offset:2048
    ds_read_b64_tr_b16 a[170:171], v12 offset:2560
    v_rcp_f32 v27, v27
    s_add_u32 s0, s50, 7
    s_and_b32 s0, s0, 7
    s_lshl_b32 s0, s0, 18
    s_add_u32 s0, s0, s12
    v_rcp_f32 v28, v28
    v_mul_f32 v84, v84, v27
    s_waitcnt lgkmcnt(8)
    v_mfma_f32_32x32x16_bf16 v[96:111], a[148:151], a[56:59], v[96:111]
    ds_read_b64_tr_b16 a[144:145], v12 offset:4096
    ds_read_b64_tr_b16 a[146:147], v12 offset:4608
    v_mul_f32 v85, v85, v28
    v_cvt_pk_bf16_f32 v114, v84, v85
    v_mul_f32 v29, v86, v86
    v_mul_f32 v30, v87, v87
    v_fma_f32 v29, v29, v26, v25
    v_mfma_f32_32x32x16_bf16 v[96:111], a[152:155], a[60:63], v[96:111]
    ds_read_b64_tr_b16 a[148:149], v12 offset:6144
    ds_read_b64_tr_b16 a[150:151], v12 offset:6656
    v_fma_f32 v30, v30, v26, v25
    v_mul_f32 v29, v29, v86
    v_mul_f32 v30, v30, v87
    v_exp_f32 v29, v29
    s_waitcnt lgkmcnt(8)
    v_mfma_f32_32x32x16_bf16 v[96:111], a[156:159], a[64:67], v[96:111]
    ds_read_b64_tr_b16 a[152:153], v12 offset:8192
    ds_read_b64_tr_b16 a[154:155], v12 offset:8704
    v_exp_f32 v30, v30
    v_fma_f32 v29, v29, v4, v4
    v_fma_f32 v30, v30, v4, v4
    v_mfma_f32_32x32x16_bf16 v[96:111], a[160:163], a[68:71], v[96:111]
    ds_read_b64_tr_b16 a[156:157], v12 offset:10240
    ds_read_b64_tr_b16 a[158:159], v12 offset:10752
    v_rcp_f32 v29, v29
    buffer_load_dwordx4 v18, s[32:35], s56 offen offset:2048 lds
    v_rcp_f32 v30, v30
    v_mul_f32 v86, v86, v29
    s_waitcnt lgkmcnt(8)
    v_mfma_f32_32x32x16_bf16 v[96:111], a[164:167], a[72:75], v[96:111]
    ds_read_b64_tr_b16 a[160:161], v12 offset:12288
    ds_read_b64_tr_b16 a[162:163], v12 offset:12800
    v_mul_f32 v87, v87, v30
    v_cvt_pk_bf16_f32 v115, v86, v87
    v_mul_f32 v27, v88, v88
    v_mul_f32 v28, v89, v89
    v_mfma_f32_32x32x16_bf16 v[96:111], a[168:171], a[76:79], v[96:111]
    ds_read_b64_tr_b16 a[164:165], v12 offset:14336
    ds_read_b64_tr_b16 a[166:167], v12 offset:14848
    v_fma_f32 v27, v27, v26, v25
    v_fma_f32 v28, v28, v26, v25
    v_mul_f32 v27, v27, v88
    v_mul_f32 v28, v28, v89
    s_waitcnt lgkmcnt(8)
    v_mfma_f32_32x32x16_bf16 v[96:111], a[144:147], a[80:83], v[96:111]
    ds_read_b64_tr_b16 a[168:169], v12 offset:16384
    ds_read_b64_tr_b16 a[170:171], v12 offset:16896
    v_exp_f32 v27, v27
    buffer_store_dwordx4 v[72:75], v2, s[28:31], s0 offen offset:0 sc1
    v_exp_f32 v28, v28
    v_fma_f32 v27, v27, v4, v4
    v_fma_f32 v28, v28, v4, v4
    v_mfma_f32_32x32x16_bf16 v[96:111], a[148:151], a[84:87], v[96:111]
    ds_read_b64_tr_b16 a[144:145], v12 offset:18432
    ds_read_b64_tr_b16 a[146:147], v12 offset:18944
    v_rcp_f32 v27, v27
    v_rcp_f32 v28, v28
    s_waitcnt lgkmcnt(8)
    v_mfma_f32_32x32x16_bf16 v[96:111], a[152:155], a[88:91], v[96:111]
    ds_read_b64_tr_b16 a[148:149], v12 offset:20480
    ds_read_b64_tr_b16 a[150:151], v12 offset:20992
    v_mul_f32 v88, v88, v27
    buffer_load_dwordx4 v19, s[32:35], s56 offen offset:3072 lds
    v_mul_f32 v89, v89, v28
    v_cvt_pk_bf16_f32 v116, v88, v89
    v_mul_f32 v29, v90, v90
    v_mul_f32 v30, v91, v91
    v_mfma_f32_32x32x16_bf16 v[96:111], a[156:159], a[92:95], v[96:111]
    ds_read_b64_tr_b16 a[152:153], v12 offset:22528
    ds_read_b64_tr_b16 a[154:155], v12 offset:23040
    v_fma_f32 v29, v29, v26, v25
    v_fma_f32 v30, v30, v26, v25
    v_mul_f32 v29, v29, v90
    v_mul_f32 v30, v30, v91
    s_waitcnt lgkmcnt(8)
    v_mfma_f32_32x32x16_bf16 v[96:111], a[160:163], a[96:99], v[96:111]
    ds_read_b64_tr_b16 a[156:157], v12 offset:24576
    ds_read_b64_tr_b16 a[158:159], v12 offset:25088
    v_exp_f32 v29, v29
    s_add_u32 m0, s10, 4096
    v_exp_f32 v30, v30
    v_fma_f32 v29, v29, v4, v4
    v_mfma_f32_32x32x16_bf16 v[96:111], a[164:167], a[100:103], v[96:111]
    ds_read_b64_tr_b16 a[160:161], v12 offset:26624
    ds_read_b64_tr_b16 a[162:163], v12 offset:27136
    v_fma_f32 v30, v30, v4, v4
    v_rcp_f32 v29, v29
    v_rcp_f32 v30, v30
    s_waitcnt lgkmcnt(8)
    v_mfma_f32_32x32x16_bf16 v[96:111], a[168:171], a[104:107], v[96:111]
    ds_read_b64_tr_b16 a[164:165], v12 offset:28672
    ds_read_b64_tr_b16 a[166:167], v12 offset:29184
    v_mul_f32 v90, v90, v29
    buffer_store_dwordx4 v[72:75], v2, s[28:31], s0 offen offset:1024 sc1
    v_mul_f32 v91, v91, v30
    v_cvt_pk_bf16_f32 v117, v90, v91
    v_mul_f32 v27, v92, v92
    v_mfma_f32_32x32x16_bf16 v[96:111], a[144:147], a[108:111], v[96:111]
    ds_read_b64_tr_b16 a[168:169], v12 offset:30720
    ds_read_b64_tr_b16 a[170:171], v12 offset:31232
    v_mul_f32 v28, v93, v93
    buffer_load_dwordx4 v20, s[32:35], s56 offen offset:0 lds
    v_fma_f32 v27, v27, v26, v25
    v_fma_f32 v28, v28, v26, v25
    v_mul_f32 v27, v27, v92
    v_mul_f32 v28, v28, v93
    s_waitcnt lgkmcnt(8)
    v_mfma_f32_32x32x16_bf16 v[96:111], a[148:151], a[112:115], v[96:111]
    ds_read_b64_tr_b16 a[144:145], v12 offset:32768
    ds_read_b64_tr_b16 a[146:147], v12 offset:33280
    v_exp_f32 v27, v27
    v_exp_f32 v28, v28
    v_mfma_f32_32x32x16_bf16 v[96:111], a[152:155], a[116:119], v[96:111]
    ds_read_b64_tr_b16 a[148:149], v12 offset:34816
    ds_read_b64_tr_b16 a[150:151], v12 offset:35328
    v_fma_f32 v27, v27, v4, v4
    v_fma_f32 v28, v28, v4, v4
    v_rcp_f32 v27, v27
    s_waitcnt lgkmcnt(8)
    v_mfma_f32_32x32x16_bf16 v[96:111], a[156:159], a[120:123], v[96:111]
    ds_read_b64_tr_b16 a[152:153], v11 offset:0
    ds_read_b64_tr_b16 a[154:155], v11 offset:512
    v_rcp_f32 v28, v28
    v_mul_f32 v92, v92, v27
    v_mul_f32 v93, v93, v28
    v_cvt_pk_bf16_f32 v118, v92, v93
    v_mul_f32 v29, v94, v94
    v_mfma_f32_32x32x16_bf16 v[96:111], a[160:163], a[124:127], v[96:111]
    ds_read_b64_tr_b16 a[156:157], v11 offset:2048
    ds_read_b64_tr_b16 a[158:159], v11 offset:2560
    v_mul_f32 v30, v95, v95
    v_fma_f32 v29, v29, v26, v25
    v_fma_f32 v30, v30, v26, v25
    v_mul_f32 v29, v29, v94
    s_waitcnt lgkmcnt(8)
    v_mfma_f32_32x32x16_bf16 v[96:111], a[164:167], a[128:131], v[96:111]
    ds_read_b64_tr_b16 a[160:161], v11 offset:4096
    ds_read_b64_tr_b16 a[162:163], v11 offset:4608
    v_mul_f32 v30, v30, v95
    buffer_load_dwordx4 v21, s[32:35], s56 offen offset:1024 lds
    v_exp_f32 v29, v29
    v_exp_f32 v30, v30
    v_mfma_f32_32x32x16_bf16 v[96:111], a[168:171], a[132:135], v[96:111]
    ds_read_b64_tr_b16 a[164:165], v11 offset:6144
    ds_read_b64_tr_b16 a[166:167], v11 offset:6656
    v_fma_f32 v29, v29, v4, v4
    s_add_u32 s0, s50, 7
    s_and_b32 s0, s0, 7
    s_lshl_b32 s0, s0, 18
    s_add_u32 s0, s0, s13
    v_fma_f32 v30, v30, v4, v4
    v_rcp_f32 v29, v29
    s_waitcnt lgkmcnt(8)
    v_mfma_f32_32x32x16_bf16 v[96:111], a[144:147], a[136:139], v[96:111]
    ds_read_b64_tr_b16 a[168:169], v11 offset:8192
    ds_read_b64_tr_b16 a[170:171], v11 offset:8704
    v_rcp_f32 v30, v30
    v_mul_f32 v94, v94, v29
    v_mul_f32 v95, v95, v30
    v_cvt_pk_bf16_f32 v119, v94, v95
    v_mfma_f32_32x32x16_bf16 v[96:111], a[148:151], a[140:143], v[96:111]
    ds_read_b64_tr_b16 a[144:145], v11 offset:10240
    ds_read_b64_tr_b16 a[146:147], v11 offset:10752
    s_waitcnt lgkmcnt(8)
    v_mfma_f32_32x32x16_bf16 v[80:95], a[152:155], a[0:3], 0
    ds_read_b64_tr_b16 a[148:149], v11 offset:12288
    ds_read_b64_tr_b16 a[150:151], v11 offset:12800
    v_mfma_f32_32x32x16_bf16 v[80:95], a[156:159], a[4:7], v[80:95]
    ds_read_b64_tr_b16 a[152:153], v11 offset:14336
    ds_read_b64_tr_b16 a[154:155], v11 offset:14848
    buffer_load_dwordx4 v22, s[32:35], s56 offen offset:2048 lds
    s_waitcnt lgkmcnt(8)
    v_mfma_f32_32x32x16_bf16 v[80:95], a[160:163], a[8:11], v[80:95]
    ds_read_b64_tr_b16 a[156:157], v11 offset:16384
    ds_read_b64_tr_b16 a[158:159], v11 offset:16896
    v_mul_f32 v27, v96, v96
    v_mul_f32 v28, v97, v97
    v_fma_f32 v27, v27, v26, v25
    v_fma_f32 v28, v28, v26, v25
    v_mul_f32 v27, v27, v96
    v_mfma_f32_32x32x16_bf16 v[80:95], a[164:167], a[12:15], v[80:95]
    ds_read_b64_tr_b16 a[160:161], v11 offset:18432
    ds_read_b64_tr_b16 a[162:163], v11 offset:18944
    buffer_store_dwordx4 v[72:75], v2, s[28:31], s0 offen offset:0 sc1
    v_mul_f32 v28, v28, v97
    v_exp_f32 v27, v27
    v_exp_f32 v28, v28
    s_waitcnt lgkmcnt(8)
    v_mfma_f32_32x32x16_bf16 v[80:95], a[168:171], a[16:19], v[80:95]
    ds_read_b64_tr_b16 a[164:165], v11 offset:20480
    ds_read_b64_tr_b16 a[166:167], v11 offset:20992
    v_fma_f32 v27, v27, v4, v4
    v_fma_f32 v28, v28, v4, v4
    v_rcp_f32 v27, v27
    v_mfma_f32_32x32x16_bf16 v[80:95], a[144:147], a[20:23], v[80:95]
    ds_read_b64_tr_b16 a[168:169], v11 offset:22528
    ds_read_b64_tr_b16 a[170:171], v11 offset:23040
    v_rcp_f32 v28, v28
    v_mul_f32 v96, v96, v27
    v_mul_f32 v97, v97, v28
    s_waitcnt lgkmcnt(8)
    v_mfma_f32_32x32x16_bf16 v[80:95], a[148:151], a[24:27], v[80:95]
    ds_read_b64_tr_b16 a[144:145], v11 offset:24576
    ds_read_b64_tr_b16 a[146:147], v11 offset:25088
    buffer_load_dwordx4 v23, s[32:35], s56 offen offset:3072 lds
    v_cvt_pk_bf16_f32 v120, v96, v97
    v_mul_f32 v29, v98, v98
    v_mul_f32 v30, v99, v99
    v_fma_f32 v29, v29, v26, v25
    v_fma_f32 v30, v30, v26, v25
    v_mfma_f32_32x32x16_bf16 v[80:95], a[152:155], a[28:31], v[80:95]
    ds_read_b64_tr_b16 a[148:149], v11 offset:26624
    ds_read_b64_tr_b16 a[150:151], v11 offset:27136
    v_mul_f32 v29, v29, v98
    v_mul_f32 v30, v30, v99
    v_exp_f32 v29, v29
    s_waitcnt lgkmcnt(8)
    v_mfma_f32_32x32x16_bf16 v[80:95], a[156:159], a[32:35], v[80:95]
    ds_read_b64_tr_b16 a[152:153], v11 offset:28672
    ds_read_b64_tr_b16 a[154:155], v11 offset:29184
    v_exp_f32 v30, v30
    v_fma_f32 v29, v29, v4, v4
    v_fma_f32 v30, v30, v4, v4
    v_rcp_f32 v29, v29
    v_mfma_f32_32x32x16_bf16 v[80:95], a[160:163], a[36:39], v[80:95]
    ds_read_b64_tr_b16 a[156:157], v11 offset:30720
    ds_read_b64_tr_b16 a[158:159], v11 offset:31232
    s_add_u32 m0, s10, 8192
    v_rcp_f32 v30, v30
    v_mul_f32 v98, v98, v29
    v_mul_f32 v99, v99, v30
    s_waitcnt lgkmcnt(8)
    v_mfma_f32_32x32x16_bf16 v[80:95], a[164:167], a[40:43], v[80:95]
    ds_read_b64_tr_b16 a[160:161], v11 offset:32768
    ds_read_b64_tr_b16 a[162:163], v11 offset:33280
    buffer_store_dwordx4 v[72:75], v2, s[28:31], s0 offen offset:1024 sc1
    v_cvt_pk_bf16_f32 v121, v98, v99
    v_mul_f32 v27, v100, v100
    v_mul_f32 v28, v101, v101
    v_fma_f32 v27, v27, v26, v25
    v_mfma_f32_32x32x16_bf16 v[80:95], a[168:171], a[44:47], v[80:95]
    ds_read_b64_tr_b16 a[164:165], v11 offset:34816
    ds_read_b64_tr_b16 a[166:167], v11 offset:35328
    v_fma_f32 v28, v28, v26, v25
    v_mul_f32 v27, v27, v100
    v_mul_f32 v28, v28, v101
    v_exp_f32 v27, v27
    s_waitcnt lgkmcnt(8)
    v_mfma_f32_32x32x16_bf16 v[80:95], a[144:147], a[48:51], v[80:95]
    ds_read_b64_tr_b16 a[168:169], v13 offset:0
    ds_read_b64_tr_b16 a[170:171], v13 offset:512
    buffer_load_dwordx4 v24, s[32:35], s56 offen offset:0 lds
    v_exp_f32 v28, v28
    v_fma_f32 v27, v27, v4, v4
    v_fma_f32 v28, v28, v4, v4
    v_mfma_f32_32x32x16_bf16 v[80:95], a[148:151], a[52:55], v[80:95]
    ds_read_b64_tr_b16 a[144:145], v13 offset:2048
    ds_read_b64_tr_b16 a[146:147], v13 offset:2560
    v_rcp_f32 v27, v27
    v_rcp_f32 v28, v28
    v_mul_f32 v100, v100, v27
    s_waitcnt lgkmcnt(8)
    v_mfma_f32_32x32x16_bf16 v[80:95], a[152:155], a[56:59], v[80:95]
    ds_read_b64_tr_b16 a[148:149], v13 offset:4096
    ds_read_b64_tr_b16 a[150:151], v13 offset:4608
    v_mul_f32 v101, v101, v28
    v_cvt_pk_bf16_f32 v122, v100, v101
    v_mul_f32 v29, v102, v102
    v_mul_f32 v30, v103, v103
    v_fma_f32 v29, v29, v26, v25
    v_mfma_f32_32x32x16_bf16 v[80:95], a[156:159], a[60:63], v[80:95]
    ds_read_b64_tr_b16 a[152:153], v13 offset:6144
    ds_read_b64_tr_b16 a[154:155], v13 offset:6656
    v_fma_f32 v30, v30, v26, v25
    v_mul_f32 v29, v29, v102
    v_mul_f32 v30, v30, v103
    v_exp_f32 v29, v29
    s_waitcnt lgkmcnt(8)
    v_mfma_f32_32x32x16_bf16 v[80:95], a[160:163], a[64:67], v[80:95]
    ds_read_b64_tr_b16 a[156:157], v13 offset:8192
    ds_read_b64_tr_b16 a[158:159], v13 offset:8704
    s_add_u32 s0, s50, 8
    s_and_b32 s0, s0, 7
    s_lshl_b32 s0, s0, 18
    s_add_u32 s0, s0, s12
    v_exp_f32 v30, v30
    v_fma_f32 v29, v29, v4, v4
    v_fma_f32 v30, v30, v4, v4
    v_mfma_f32_32x32x16_bf16 v[80:95], a[164:167], a[68:71], v[80:95]
    ds_read_b64_tr_b16 a[160:161], v13 offset:10240
    ds_read_b64_tr_b16 a[162:163], v13 offset:10752
    v_rcp_f32 v29, v29
    v_rcp_f32 v30, v30
    v_mul_f32 v102, v102, v29
    s_waitcnt lgkmcnt(8)
    v_mfma_f32_32x32x16_bf16 v[80:95], a[168:171], a[72:75], v[80:95]
    ds_read_b64_tr_b16 a[164:165], v13 offset:12288
    ds_read_b64_tr_b16 a[166:167], v13 offset:12800
    v_mul_f32 v103, v103, v30
    v_cvt_pk_bf16_f32 v123, v102, v103
    v_mul_f32 v27, v104, v104
    v_mul_f32 v28, v105, v105
    v_mfma_f32_32x32x16_bf16 v[80:95], a[144:147], a[76:79], v[80:95]
    ds_read_b64_tr_b16 a[168:169], v13 offset:14336
    ds_read_b64_tr_b16 a[170:171], v13 offset:14848
    v_fma_f32 v27, v27, v26, v25
    v_fma_f32 v28, v28, v26, v25
    v_mul_f32 v27, v27, v104
    v_mul_f32 v28, v28, v105
    s_waitcnt lgkmcnt(8)
    v_mfma_f32_32x32x16_bf16 v[80:95], a[148:151], a[80:83], v[80:95]
    ds_read_b64_tr_b16 a[144:145], v13 offset:16384
    ds_read_b64_tr_b16 a[146:147], v13 offset:16896
    v_exp_f32 v27, v27
    v_exp_f32 v28, v28
    v_fma_f32 v27, v27, v4, v4
    v_fma_f32 v28, v28, v4, v4
    v_mfma_f32_32x32x16_bf16 v[80:95], a[152:155], a[84:87], v[80:95]
    ds_read_b64_tr_b16 a[148:149], v13 offset:18432
    ds_read_b64_tr_b16 a[150:151], v13 offset:18944
    v_rcp_f32 v27, v27
    v_rcp_f32 v28, v28
    s_waitcnt lgkmcnt(8)
    v_mfma_f32_32x32x16_bf16 v[80:95], a[156:159], a[88:91], v[80:95]
    ds_read_b64_tr_b16 a[152:153], v13 offset:20480
    ds_read_b64_tr_b16 a[154:155], v13 offset:20992
    v_mul_f32 v104, v104, v27
    v_mul_f32 v105, v105, v28
    v_cvt_pk_bf16_f32 v124, v104, v105
    v_mul_f32 v29, v106, v106
    v_mul_f32 v30, v107, v107
    v_mfma_f32_32x32x16_bf16 v[80:95], a[160:163], a[92:95], v[80:95]
    ds_read_b64_tr_b16 a[156:157], v13 offset:22528
    ds_read_b64_tr_b16 a[158:159], v13 offset:23040
    buffer_store_dwordx4 v[72:75], v2, s[28:31], s0 offen offset:0 sc1
    v_fma_f32 v29, v29, v26, v25
    v_fma_f32 v30, v30, v26, v25
    v_mul_f32 v29, v29, v106
    v_mul_f32 v30, v30, v107
    s_waitcnt lgkmcnt(8)
    v_mfma_f32_32x32x16_bf16 v[80:95], a[164:167], a[96:99], v[80:95]
    ds_read_b64_tr_b16 a[160:161], v13 offset:24576
    ds_read_b64_tr_b16 a[162:163], v13 offset:25088
    v_exp_f32 v29, v29
    v_exp_f32 v30, v30
    v_fma_f32 v29, v29, v4, v4
    v_mfma_f32_32x32x16_bf16 v[80:95], a[168:171], a[100:103], v[80:95]
    ds_read_b64_tr_b16 a[164:165], v13 offset:26624
    ds_read_b64_tr_b16 a[166:167], v13 offset:27136
    v_fma_f32 v30, v30, v4, v4
    v_rcp_f32 v29, v29
    v_rcp_f32 v30, v30
    s_waitcnt lgkmcnt(8)
    v_mfma_f32_32x32x16_bf16 v[80:95], a[144:147], a[104:107], v[80:95]
    ds_read_b64_tr_b16 a[168:169], v13 offset:28672
    ds_read_b64_tr_b16 a[170:171], v13 offset:29184
    v_mul_f32 v106, v106, v29
    v_mul_f32 v107, v107, v30
    v_cvt_pk_bf16_f32 v125, v106, v107
    v_mul_f32 v27, v108, v108
    v_mfma_f32_32x32x16_bf16 v[80:95], a[148:151], a[108:111], v[80:95]
    ds_read_b64_tr_b16 a[144:145], v13 offset:30720
    ds_read_b64_tr_b16 a[146:147], v13 offset:31232
    v_mul_f32 v28, v109, v109
    v_fma_f32 v27, v27, v26, v25
    v_fma_f32 v28, v28, v26, v25
    v_mul_f32 v27, v27, v108
    v_mul_f32 v28, v28, v109
    s_waitcnt lgkmcnt(8)
    v_mfma_f32_32x32x16_bf16 v[80:95], a[152:155], a[112:115], v[80:95]
    ds_read_b64_tr_b16 a[148:149], v13 offset:32768
    ds_read_b64_tr_b16 a[150:151], v13 offset:33280
    v_exp_f32 v27, v27
    v_exp_f32 v28, v28
    v_mfma_f32_32x32x16_bf16 v[80:95], a[156:159], a[116:119], v[80:95]
    ds_read_b64_tr_b16 a[152:153], v13 offset:34816
    ds_read_b64_tr_b16 a[154:155], v13 offset:35328
    buffer_store_dwordx4 v[72:75], v2, s[28:31], s0 offen offset:1024 sc1
    v_fma_f32 v27, v27, v4, v4
    v_fma_f32 v28, v28, v4, v4
    v_rcp_f32 v27, v27
    s_waitcnt lgkmcnt(8)
    v_mfma_f32_32x32x16_bf16 v[80:95], a[160:163], a[120:123], v[80:95]
    v_rcp_f32 v28, v28
    v_mul_f32 v108, v108, v27
    v_mul_f32 v109, v109, v28
    v_cvt_pk_bf16_f32 v126, v108, v109
    v_mul_f32 v29, v110, v110
    v_mfma_f32_32x32x16_bf16 v[80:95], a[164:167], a[124:127], v[80:95]
    v_mul_f32 v30, v111, v111
    v_fma_f32 v29, v29, v26, v25
    v_fma_f32 v30, v30, v26, v25
    v_mul_f32 v29, v29, v110
    s_waitcnt lgkmcnt(4)
    v_mfma_f32_32x32x16_bf16 v[80:95], a[168:171], a[128:131], v[80:95]
    s_waitcnt lgkmcnt(0)
    s_waitcnt vmcnt(15)
    s_waitcnt vmcnt(2)
    s_barrier
    ds_read_b64_tr_b16 a[156:157], v14 offset:0
    ds_read_b64_tr_b16 a[158:159], v14 offset:512
    ds_read_b64_tr_b16 a[160:161], v14 offset:2048
    ds_read_b64_tr_b16 a[162:163], v14 offset:2560
    ds_read_b64_tr_b16 a[164:165], v14 offset:4096
    ds_read_b64_tr_b16 a[166:167], v14 offset:4608
    v_mul_f32 v30, v30, v111
    v_exp_f32 v29, v29
    v_exp_f32 v30, v30
    v_mfma_f32_32x32x16_bf16 v[80:95], a[144:147], a[132:135], v[80:95]
    ds_read_b64_tr_b16 a[168:169], v14 offset:6144
    ds_read_b64_tr_b16 a[170:171], v14 offset:6656
    v_fma_f32 v29, v29, v4, v4
    v_fma_f32 v30, v30, v4, v4
    v_rcp_f32 v29, v29
    v_mfma_f32_32x32x16_bf16 v[80:95], a[148:151], a[136:139], v[80:95]
    ds_read_b64_tr_b16 a[144:145], v14 offset:8192
    ds_read_b64_tr_b16 a[146:147], v14 offset:8704
    v_rcp_f32 v30, v30
    s_xor_b32 s56, s62, 0
    s_lshl_b32 s56, s56, 2
    s_add_u32 s56, s56, s46
    s_mul_i32 s56, s56, 663552
    s_lshl_b32 s27, s51, 1
    s_add_u32 s56, s56, s27
    s_add_u32 s56, s56, 256
    v_mul_f32 v110, v110, v29
    v_mul_f32 v111, v111, v30
    v_cvt_pk_bf16_f32 v127, v110, v111
    v_mfma_f32_32x32x16_bf16 v[80:95], a[152:155], a[140:143], v[80:95]
    ds_read_b64_tr_b16 a[148:149], v14 offset:10240
    ds_read_b64_tr_b16 a[150:151], v14 offset:10752
    s_waitcnt lgkmcnt(8)
    v_mfma_f32_32x32x16_bf16 v[96:111], a[156:159], a[0:3], 0
    ds_read_b64_tr_b16 a[152:153], v14 offset:12288
    ds_read_b64_tr_b16 a[154:155], v14 offset:12800
    s_add_u32 m0, s10, 36864
    v_mfma_f32_32x32x16_bf16 v[96:111], a[160:163], a[4:7], v[96:111]
    ds_read_b64_tr_b16 a[156:157], v14 offset:14336
    ds_read_b64_tr_b16 a[158:159], v14 offset:14848
    s_waitcnt lgkmcnt(8)
    v_mfma_f32_32x32x16_bf16 v[96:111], a[164:167], a[8:11], v[96:111]
    ds_read_b64_tr_b16 a[160:161], v14 offset:16384
    ds_read_b64_tr_b16 a[162:163], v14 offset:16896
    v_mul_f32 v27, v80, v80
    buffer_load_dwordx4 v16, s[32:35], s56 offen offset:0 lds
    v_mul_f32 v28, v81, v81
    v_fma_f32 v27, v27, v26, v25
    v_fma_f32 v28, v28, v26, v25
    v_mul_f32 v27, v27, v80
    v_mfma_f32_32x32x16_bf16 v[96:111], a[168:171], a[12:15], v[96:111]
    ds_read_b64_tr_b16 a[164:165], v14 offset:18432
    ds_read_b64_tr_b16 a[166:167], v14 offset:18944
    v_mul_f32 v28, v28, v81
    v_exp_f32 v27, v27
    v_exp_f32 v28, v28
    s_waitcnt lgkmcnt(8)
    v_mfma_f32_32x32x16_bf16 v[96:111], a[144:147], a[16:19], v[96:111]
    ds_read_b64_tr_b16 a[168:169], v14 offset:20480
    ds_read_b64_tr_b16 a[170:171], v14 offset:20992
    v_fma_f32 v27, v27, v4, v4
    buffer_load_dwordx4 v17, s[32:35], s56 offen offset:1024 lds
    v_fma_f32 v28, v28, v4, v4
    v_rcp_f32 v27, v27
    v_mfma_f32_32x32x16_bf16 v[96:111], a[148:151], a[20:23], v[96:111]
    ds_read_b64_tr_b16 a[144:145], v14 offset:22528
    ds_read_b64_tr_b16 a[146:147], v14 offset:23040
    v_rcp_f32 v28, v28
    v_mul_f32 v80, v80, v27
    v_mul_f32 v81, v81, v28
    s_waitcnt lgkmcnt(8)
    v_mfma_f32_32x32x16_bf16 v[96:111], a[152:155], a[24:27], v[96:111]
    ds_read_b64_tr_b16 a[148:149], v14 offset:24576
    ds_read_b64_tr_b16 a[150:151], v14 offset:25088
    v_cvt_pk_bf16_f32 v128, v80, v81
    v_mul_f32 v29, v82, v82
    v_mul_f32 v30, v83, v83
    v_fma_f32 v29, v29, v26, v25
    v_fma_f32 v30, v30, v26, v25
    v_mfma_f32_32x32x16_bf16 v[96:111], a[156:159], a[28:31], v[96:111]
    ds_read_b64_tr_b16 a[152:153], v14 offset:26624
    ds_read_b64_tr_b16 a[154:155], v14 offset:27136
    v_mul_f32 v29, v29, v82
    buffer_load_dwordx4 v18, s[32:35], s56 offen offset:2048 lds
    v_mul_f32 v30, v30, v83
    v_exp_f32 v29, v29
    s_waitcnt lgkmcnt(8)
    v_mfma_f32_32x32x16_bf16 v[96:111], a[160:163], a[32:35], v[96:111]
    ds_read_b64_tr_b16 a[156:157], v14 offset:28672
    ds_read_b64_tr_b16 a[158:159], v14 offset:29184
    v_exp_f32 v30, v30
    v_fma_f32 v29, v29, v4, v4
    v_fma_f32 v30, v30, v4, v4
    v_rcp_f32 v29, v29
    v_mfma_f32_32x32x16_bf16 v[96:111], a[164:167], a[36:39], v[96:111]
    ds_read_b64_tr_b16 a[160:161], v14 offset:30720
    ds_read_b64_tr_b16 a[162:163], v14 offset:31232
    v_rcp_f32 v30, v30
    buffer_load_dwordx4 v19, s[32:35], s56 offen offset:3072 lds
    v_mul_f32 v82, v82, v29
    v_mul_f32 v83, v83, v30
    s_waitcnt lgkmcnt(8)
    v_mfma_f32_32x32x16_bf16 v[96:111], a[168:171], a[40:43], v[96:111]
    ds_read_b64_tr_b16 a[164:165], v14 offset:32768
    ds_read_b64_tr_b16 a[166:167], v14 offset:33280
    v_cvt_pk_bf16_f32 v129, v82, v83
    s_add_u32 m0, s10, 40960
    v_mul_f32 v27, v84, v84
    v_mul_f32 v28, v85, v85
    v_fma_f32 v27, v27, v26, v25
    v_mfma_f32_32x32x16_bf16 v[96:111], a[144:147], a[44:47], v[96:111]
    ds_read_b64_tr_b16 a[168:169], v14 offset:34816
    ds_read_b64_tr_b16 a[170:171], v14 offset:35328
    v_fma_f32 v28, v28, v26, v25
    v_mul_f32 v27, v27, v84
    v_mul_f32 v28, v28, v85
    v_exp_f32 v27, v27
    s_waitcnt lgkmcnt(8)
    v_mfma_f32_32x32x16_bf16 v[96:111], a[148:151], a[48:51], v[96:111]
    ds_read_b64_tr_b16 a[144:145], v8 offset:0
    ds_read_b64_tr_b16 a[146:147], v8 offset:512
    v_exp_f32 v28, v28
    buffer_load_dwordx4 v20, s[32:35], s56 offen offset:0 lds
    v_fma_f32 v27, v27, v4, v4
    v_fma_f32 v28, v28, v4, v4
    v_mfma_f32_32x32x16_bf16 v[96:111], a[152:155], a[52:55], v[96:111]
    ds_read_b64_tr_b16 a[148:149], v8 offset:2048
    ds_read_b64_tr_b16 a[150:151], v8 offset:2560
    v_rcp_f32 v27, v27
    v_rcp_f32 v28, v28
    v_mul_f32 v84, v84, v27
    s_waitcnt lgkmcnt(8)
    v_mfma_f32_32x32x16_bf16 v[96:111], a[156:159], a[56:59], v[96:111]
    ds_read_b64_tr_b16 a[152:153], v8 offset:4096
    ds_read_b64_tr_b16 a[154:155], v8 offset:4608
    v_mul_f32 v85, v85, v28
    buffer_load_dwordx4 v21, s[32:35], s56 offen offset:1024 lds
    v_cvt_pk_bf16_f32 v130, v84, v85
    v_mul_f32 v29, v86, v86
    v_mul_f32 v30, v87, v87
    v_fma_f32 v29, v29, v26, v25
    v_mfma_f32_32x32x16_bf16 v[96:111], a[160:163], a[60:63], v[96:111]
    ds_read_b64_tr_b16 a[156:157], v8 offset:6144
    ds_read_b64_tr_b16 a[158:159], v8 offset:6656
    v_fma_f32 v30, v30, v26, v25
    v_mul_f32 v29, v29, v86
    v_mul_f32 v30, v30, v87
    v_exp_f32 v29, v29
    s_waitcnt lgkmcnt(8)
    v_mfma_f32_32x32x16_bf16 v[96:111], a[164:167], a[64:67], v[96:111]
    ds_read_b64_tr_b16 a[160:161], v8 offset:8192
    ds_read_b64_tr_b16 a[162:163], v8 offset:8704
    v_exp_f32 v30, v30
    v_fma_f32 v29, v29, v4, v4
    v_fma_f32 v30, v30, v4, v4
    v_mfma_f32_32x32x16_bf16 v[96:111], a[168:171], a[68:71], v[96:111]
    ds_read_b64_tr_b16 a[164:165], v8 offset:10240
    ds_read_b64_tr_b16 a[166:167], v8 offset:10752
    v_rcp_f32 v29, v29
    buffer_load_dwordx4 v22, s[32:35], s56 offen offset:2048 lds
    v_rcp_f32 v30, v30
    v_mul_f32 v86, v86, v29
    s_waitcnt lgkmcnt(8)
    v_mfma_f32_32x32x16_bf16 v[96:111], a[144:147], a[72:75], v[96:111]
    ds_read_b64_tr_b16 a[168:169], v8 offset:12288
    ds_read_b64_tr_b16 a[170:171], v8 offset:12800
    v_mul_f32 v87, v87, v30
    v_cvt_pk_bf16_f32 v131, v86, v87
    v_mul_f32 v27, v88, v88
    v_mul_f32 v28, v89, v89
    v_mfma_f32_32x32x16_bf16 v[96:111], a[148:151], a[76:79], v[96:111]
    ds_read_b64_tr_b16 a[144:145], v8 offset:14336
    ds_read_b64_tr_b16 a[146:147], v8 offset:14848
    v_fma_f32 v27, v27, v26, v25
    buffer_load_dwordx4 v23, s[32:35], s56 offen offset:3072 lds
    v_fma_f32 v28, v28, v26, v25
    v_mul_f32 v27, v27, v88
    v_mul_f32 v28, v28, v89
    s_waitcnt lgkmcnt(8)
    v_mfma_f32_32x32x16_bf16 v[96:111], a[152:155], a[80:83], v[96:111]
    ds_read_b64_tr_b16 a[148:149], v8 offset:16384
    ds_read_b64_tr_b16 a[150:151], v8 offset:16896
    v_exp_f32 v27, v27
    v_exp_f32 v28, v28
    v_fma_f32 v27, v27, v4, v4
    v_fma_f32 v28, v28, v4, v4
    v_mfma_f32_32x32x16_bf16 v[96:111], a[156:159], a[84:87], v[96:111]
    ds_read_b64_tr_b16 a[152:153], v8 offset:18432
    ds_read_b64_tr_b16 a[154:155], v8 offset:18944
    v_rcp_f32 v27, v27
    s_add_u32 m0, s10, 45056
    v_rcp_f32 v28, v28
    s_waitcnt lgkmcnt(8)
    v_mfma_f32_32x32x16_bf16 v[96:111], a[160:163], a[88:91], v[96:111]
    ds_read_b64_tr_b16 a[156:157], v8 offset:20480
    ds_read_b64_tr_b16 a[158:159], v8 offset:20992
    v_mul_f32 v88, v88, v27
    buffer_load_dwordx4 v24, s[32:35], s56 offen offset:0 lds
    v_mul_f32 v89, v89, v28
    v_cvt_pk_bf16_f32 v132, v88, v89
    v_mul_f32 v29, v90, v90
    v_mul_f32 v30, v91, v91
    v_mfma_f32_32x32x16_bf16 v[96:111], a[164:167], a[92:95], v[96:111]
    ds_read_b64_tr_b16 a[160:161], v8 offset:22528
    ds_read_b64_tr_b16 a[162:163], v8 offset:23040
    v_fma_f32 v29, v29, v26, v25
    v_fma_f32 v30, v30, v26, v25
    v_mul_f32 v29, v29, v90
    v_mul_f32 v30, v30, v91
    s_waitcnt lgkmcnt(8)
    v_mfma_f32_32x32x16_bf16 v[96:111], a[168:171], a[96:99], v[96:111]
    ds_read_b64_tr_b16 a[164:165], v8 offset:24576
    ds_read_b64_tr_b16 a[166:167], v8 offset:25088
    v_exp_f32 v29, v29
    v_exp_f32 v30, v30
    v_fma_f32 v29, v29, v4, v4
    v_mfma_f32_32x32x16_bf16 v[96:111], a[144:147], a[100:103], v[96:111]
    ds_read_b64_tr_b16 a[168:169], v8 offset:26624
    ds_read_b64_tr_b16 a[170:171], v8 offset:27136
    v_fma_f32 v30, v30, v4, v4
    s_xor_b32 s56, s62, 1
    s_lshl_b32 s56, s56, 2
    s_add_u32 s56, s56, s46
    s_mul_i32 s56, s56, 663552
    s_lshl_b32 s27, s51, 1
    s_add_u32 s56, s56, s27
    s_add_u32 s56, s56, 256
    v_rcp_f32 v29, v29
    v_rcp_f32 v30, v30
    s_waitcnt lgkmcnt(8)
    v_mfma_f32_32x32x16_bf16 v[96:111], a[148:151], a[104:107], v[96:111]
    ds_read_b64_tr_b16 a[144:145], v8 offset:28672
    ds_read_b64_tr_b16 a[146:147], v8 offset:29184
    v_mul_f32 v90, v90, v29
    v_mul_f32 v91, v91, v30
    v_cvt_pk_bf16_f32 v133, v90, v91
    v_mul_f32 v27, v92, v92
    v_mfma_f32_32x32x16_bf16 v[96:111], a[152:155], a[108:111], v[96:111]
    ds_read_b64_tr_b16 a[148:149], v8 offset:30720
    ds_read_b64_tr_b16 a[150:151], v8 offset:31232
    v_mul_f32 v28, v93, v93
    s_add_u32 m0, s10, 73728
    v_fma_f32 v27, v27, v26, v25
    v_fma_f32 v28, v28, v26, v25
    v_mul_f32 v27, v27, v92
    v_mul_f32 v28, v28, v93
    s_waitcnt lgkmcnt(8)
    v_mfma_f32_32x32x16_bf16 v[96:111], a[156:159], a[112:115], v[96:111]
    ds_read_b64_tr_b16 a[152:153], v8 offset:32768
    ds_read_b64_tr_b16 a[154:155], v8 offset:33280
    v_exp_f32 v27, v27
    v_exp_f32 v28, v28
    v_mfma_f32_32x32x16_bf16 v[96:111], a[160:163], a[116:119], v[96:111]
    ds_read_b64_tr_b16 a[156:157], v8 offset:34816
    ds_read_b64_tr_b16 a[158:159], v8 offset:35328
    v_fma_f32 v27, v27, v4, v4
    buffer_load_dwordx4 v16, s[32:35], s56 offen offset:0 lds
    v_fma_f32 v28, v28, v4, v4
    v_rcp_f32 v27, v27
    s_waitcnt lgkmcnt(8)
    v_mfma_f32_32x32x16_bf16 v[96:111], a[164:167], a[120:123], v[96:111]
    ds_read_b64_tr_b16 a[160:161], v15 offset:0
    ds_read_b64_tr_b16 a[162:163], v15 offset:512
    v_rcp_f32 v28, v28
    v_mul_f32 v92, v92, v27
    v_mul_f32 v93, v93, v28
    v_cvt_pk_bf16_f32 v134, v92, v93
    v_mul_f32 v29, v94, v94
    v_mfma_f32_32x32x16_bf16 v[96:111], a[168:171], a[124:127], v[96:111]
    ds_read_b64_tr_b16 a[164:165], v15 offset:2048
    ds_read_b64_tr_b16 a[166:167], v15 offset:2560
    v_mul_f32 v30, v95, v95
    buffer_load_dwordx4 v17, s[32:35], s56 offen offset:1024 lds
    v_fma_f32 v29, v29, v26, v25
    v_fma_f32 v30, v30, v26, v25
    v_mul_f32 v29, v29, v94
    s_waitcnt lgkmcnt(8)
    v_mfma_f32_32x32x16_bf16 v[96:111], a[144:147], a[128:131], v[96:111]
    ds_read_b64_tr_b16 a[168:169], v15 offset:4096
    ds_read_b64_tr_b16 a[170:171], v15 offset:4608
    v_mul_f32 v30, v30, v95
    v_exp_f32 v29, v29
    v_exp_f32 v30, v30
    v_mfma_f32_32x32x16_bf16 v[96:111], a[148:151], a[132:135], v[96:111]
    ds_read_b64_tr_b16 a[144:145], v15 offset:6144
    ds_read_b64_tr_b16 a[146:147], v15 offset:6656
    v_fma_f32 v29, v29, v4, v4
    v_fma_f32 v30, v30, v4, v4
    v_rcp_f32 v29, v29
    s_waitcnt lgkmcnt(8)
    v_mfma_f32_32x32x16_bf16 v[96:111], a[152:155], a[136:139], v[96:111]
    ds_read_b64_tr_b16 a[148:149], v15 offset:8192
    ds_read_b64_tr_b16 a[150:151], v15 offset:8704
    v_rcp_f32 v30, v30
    buffer_load_dwordx4 v18, s[32:35], s56 offen offset:2048 lds
    v_mul_f32 v94, v94, v29
    v_mul_f32 v95, v95, v30
    v_cvt_pk_bf16_f32 v135, v94, v95
    v_mfma_f32_32x32x16_bf16 v[96:111], a[156:159], a[140:143], v[96:111]
    ds_read_b64_tr_b16 a[152:153], v15 offset:10240
    ds_read_b64_tr_b16 a[154:155], v15 offset:10752
    s_waitcnt lgkmcnt(8)
    v_mfma_f32_32x32x16_bf16 v[80:95], a[160:163], a[0:3], 0
    ds_read_b64_tr_b16 a[156:157], v15 offset:12288
    ds_read_b64_tr_b16 a[158:159], v15 offset:12800
    buffer_load_dwordx4 v19, s[32:35], s56 offen offset:3072 lds
    v_mfma_f32_32x32x16_bf16 v[80:95], a[164:167], a[4:7], v[80:95]
    ds_read_b64_tr_b16 a[160:161], v15 offset:14336
    ds_read_b64_tr_b16 a[162:163], v15 offset:14848
    s_add_u32 m0, s10, 77824
    s_waitcnt lgkmcnt(8)
    v_mfma_f32_32x32x16_bf16 v[80:95], a[168:171], a[8:11], v[80:95]
    ds_read_b64_tr_b16 a[164:165], v15 offset:16384
    ds_read_b64_tr_b16 a[166:167], v15 offset:16896
    v_mul_f32 v27, v96, v96
    v_mul_f32 v28, v97, v97
    v_fma_f32 v27, v27, v26, v25
    v_fma_f32 v28, v28, v26, v25
    v_mul_f32 v27, v27, v96
    v_mfma_f32_32x32x16_bf16 v[80:95], a[144:147], a[12:15], v[80:95]
    ds_read_b64_tr_b16 a[168:169], v15 offset:18432
    ds_read_b64_tr_b16 a[170:171], v15 offset:18944
    buffer_load_dwordx4 v20, s[32:35], s56 offen offset:0 lds
    v_mul_f32 v28, v28, v97
    v_exp_f32 v27, v27
    v_exp_f32 v28, v28
    s_waitcnt lgkmcnt(8)
    v_mfma_f32_32x32x16_bf16 v[80:95], a[148:151], a[16:19], v[80:95]
    ds_read_b64_tr_b16 a[144:145], v15 offset:20480
    ds_read_b64_tr_b16 a[146:147], v15 offset:20992
    v_fma_f32 v27, v27, v4, v4
    v_fma_f32 v28, v28, v4, v4
    v_rcp_f32 v27, v27
    v_mfma_f32_32x32x16_bf16 v[80:95], a[152:155], a[20:23], v[80:95]
    ds_read_b64_tr_b16 a[148:149], v15 offset:22528
    ds_read_b64_tr_b16 a[150:151], v15 offset:23040
    buffer_load_dwordx4 v21, s[32:35], s56 offen offset:1024 lds
    v_rcp_f32 v28, v28
    v_mul_f32 v96, v96, v27
    v_mul_f32 v97, v97, v28
    s_waitcnt lgkmcnt(8)
    v_mfma_f32_32x32x16_bf16 v[80:95], a[156:159], a[24:27], v[80:95]
    ds_read_b64_tr_b16 a[152:153], v15 offset:24576
    ds_read_b64_tr_b16 a[154:155], v15 offset:25088
    v_cvt_pk_bf16_f32 v136, v96, v97
    v_mul_f32 v29, v98, v98
    v_mul_f32 v30, v99, v99
    v_fma_f32 v29, v29, v26, v25
    v_fma_f32 v30, v30, v26, v25
    v_mfma_f32_32x32x16_bf16 v[80:95], a[160:163], a[28:31], v[80:95]
    ds_read_b64_tr_b16 a[156:157], v15 offset:26624
    ds_read_b64_tr_b16 a[158:159], v15 offset:27136
    v_mul_f32 v29, v29, v98
    v_mul_f32 v30, v30, v99
    v_exp_f32 v29, v29
    s_waitcnt lgkmcnt(8)
    v_mfma_f32_32x32x16_bf16 v[80:95], a[164:167], a[32:35], v[80:95]
    ds_read_b64_tr_b16 a[160:161], v15 offset:28672
    ds_read_b64_tr_b16 a[162:163], v15 offset:29184
    buffer_load_dwordx4 v22, s[32:35], s56 offen offset:2048 lds
    v_exp_f32 v30, v30
    v_fma_f32 v29, v29, v4, v4
    v_fma_f32 v30, v30, v4, v4
    v_rcp_f32 v29, v29
    v_mfma_f32_32x32x16_bf16 v[80:95], a[168:171], a[36:39], v[80:95]
    ds_read_b64_tr_b16 a[164:165], v15 offset:30720
    ds_read_b64_tr_b16 a[166:167], v15 offset:31232
    v_rcp_f32 v30, v30
    v_mul_f32 v98, v98, v29
    v_mul_f32 v99, v99, v30
    s_waitcnt lgkmcnt(8)
    v_mfma_f32_32x32x16_bf16 v[80:95], a[144:147], a[40:43], v[80:95]
    ds_read_b64_tr_b16 a[168:169], v15 offset:32768
    ds_read_b64_tr_b16 a[170:171], v15 offset:33280
    buffer_load_dwordx4 v23, s[32:35], s56 offen offset:3072 lds
    v_cvt_pk_bf16_f32 v137, v98, v99
    v_mul_f32 v27, v100, v100
    v_mul_f32 v28, v101, v101
    v_fma_f32 v27, v27, v26, v25
    v_mfma_f32_32x32x16_bf16 v[80:95], a[148:151], a[44:47], v[80:95]
    ds_read_b64_tr_b16 a[144:145], v15 offset:34816
    ds_read_b64_tr_b16 a[146:147], v15 offset:35328
    v_fma_f32 v28, v28, v26, v25
    v_mul_f32 v27, v27, v100
    v_mul_f32 v28, v28, v101
    v_exp_f32 v27, v27
    s_waitcnt lgkmcnt(8)
    v_mfma_f32_32x32x16_bf16 v[80:95], a[152:155], a[48:51], v[80:95]
    ds_read_b64_tr_b16 a[148:149], v9 offset:0
    ds_read_b64_tr_b16 a[150:151], v9 offset:512
    s_add_u32 m0, s10, 81920
    v_exp_f32 v28, v28
    v_fma_f32 v27, v27, v4, v4
    v_fma_f32 v28, v28, v4, v4
    v_mfma_f32_32x32x16_bf16 v[80:95], a[156:159], a[52:55], v[80:95]
    ds_read_b64_tr_b16 a[152:153], v9 offset:2048
    ds_read_b64_tr_b16 a[154:155], v9 offset:2560
    buffer_load_dwordx4 v24, s[32:35], s56 offen offset:0 lds
    v_rcp_f32 v27, v27
    v_rcp_f32 v28, v28
    v_mul_f32 v100, v100, v27
    s_waitcnt lgkmcnt(8)
    v_mfma_f32_32x32x16_bf16 v[80:95], a[160:163], a[56:59], v[80:95]
    ds_read_b64_tr_b16 a[156:157], v9 offset:4096
    ds_read_b64_tr_b16 a[158:159], v9 offset:4608
    v_mul_f32 v101, v101, v28
    v_cvt_pk_bf16_f32 v138, v100, v101
    v_mul_f32 v29, v102, v102
    v_mul_f32 v30, v103, v103
    v_fma_f32 v29, v29, v26, v25
    v_mfma_f32_32x32x16_bf16 v[80:95], a[164:167], a[60:63], v[80:95]
    ds_read_b64_tr_b16 a[160:161], v9 offset:6144
    ds_read_b64_tr_b16 a[162:163], v9 offset:6656
    v_fma_f32 v30, v30, v26, v25
    v_mul_f32 v29, v29, v102
    v_mul_f32 v30, v30, v103
    v_exp_f32 v29, v29
    s_waitcnt lgkmcnt(8)
    v_mfma_f32_32x32x16_bf16 v[80:95], a[168:171], a[64:67], v[80:95]
    ds_read_b64_tr_b16 a[164:165], v9 offset:8192
    ds_read_b64_tr_b16 a[166:167], v9 offset:8704
    v_exp_f32 v30, v30
    v_fma_f32 v29, v29, v4, v4
    v_fma_f32 v30, v30, v4, v4
    v_mfma_f32_32x32x16_bf16 v[80:95], a[144:147], a[68:71], v[80:95]
    ds_read_b64_tr_b16 a[168:169], v9 offset:10240
    ds_read_b64_tr_b16 a[170:171], v9 offset:10752
    v_rcp_f32 v29, v29
    v_rcp_f32 v30, v30
    v_mul_f32 v102, v102, v29
    s_waitcnt lgkmcnt(8)
    v_mfma_f32_32x32x16_bf16 v[80:95], a[148:151], a[72:75], v[80:95]
    ds_read_b64_tr_b16 a[144:145], v9 offset:12288
    ds_read_b64_tr_b16 a[146:147], v9 offset:12800
    v_mul_f32 v103, v103, v30
    v_cvt_pk_bf16_f32 v139, v102, v103
    v_mul_f32 v27, v104, v104
    v_mul_f32 v28, v105, v105
    v_mfma_f32_32x32x16_bf16 v[80:95], a[152:155], a[76:79], v[80:95]
    ds_read_b64_tr_b16 a[148:149], v9 offset:14336
    ds_read_b64_tr_b16 a[150:151], v9 offset:14848
    v_fma_f32 v27, v27, v26, v25
    v_fma_f32 v28, v28, v26, v25
    v_mul_f32 v27, v27, v104
    v_mul_f32 v28, v28, v105
    s_waitcnt lgkmcnt(8)
    v_mfma_f32_32x32x16_bf16 v[80:95], a[156:159], a[80:83], v[80:95]
    ds_read_b64_tr_b16 a[152:153], v9 offset:16384
    ds_read_b64_tr_b16 a[154:155], v9 offset:16896
    v_exp_f32 v27, v27
    v_exp_f32 v28, v28
    v_fma_f32 v27, v27, v4, v4
    v_fma_f32 v28, v28, v4, v4
    v_mfma_f32_32x32x16_bf16 v[80:95], a[160:163], a[84:87], v[80:95]
    ds_read_b64_tr_b16 a[156:157], v9 offset:18432
    ds_read_b64_tr_b16 a[158:159], v9 offset:18944
    v_lshlrev_b32 v69, 7, v0
    v_cmp_gt_u32 vcc, 162, v0
    v_mov_b32 v70, 0x8000000
    s_nop 0
    v_cndmask_b32 v69, v70, v69, vcc
    s_mul_i32 s0, s45, 20736
    s_mov_b32 s40, s18
    s_mov_b32 s41, s19
    s_mov_b32 s42, 0x510000
    s_mov_b32 s43, 0x20000
    s_mul_i32 s1, s44, 663552
    s_add_u32 s1, s1, s0
    buffer_load_dword v67, v69, s[40:43], s1 offen
    v_rcp_f32 v27, v27
    v_rcp_f32 v28, v28
    s_waitcnt lgkmcnt(8)
    v_mfma_f32_32x32x16_bf16 v[80:95], a[164:167], a[88:91], v[80:95]
    ds_read_b64_tr_b16 a[160:161], v9 offset:20480
    ds_read_b64_tr_b16 a[162:163], v9 offset:20992
    v_mul_f32 v104, v104, v27
    v_mul_f32 v105, v105, v28
    v_cvt_pk_bf16_f32 v140, v104, v105
    v_mul_f32 v29, v106, v106
    v_mul_f32 v30, v107, v107
    v_mfma_f32_32x32x16_bf16 v[80:95], a[168:171], a[92:95], v[80:95]
    ds_read_b64_tr_b16 a[164:165], v9 offset:22528
    ds_read_b64_tr_b16 a[166:167], v9 offset:23040
    v_fma_f32 v29, v29, v26, v25
    v_fma_f32 v30, v30, v26, v25
    v_mul_f32 v29, v29, v106
    v_mul_f32 v30, v30, v107
    s_waitcnt lgkmcnt(8)
    v_mfma_f32_32x32x16_bf16 v[80:95], a[144:147], a[96:99], v[80:95]
    ds_read_b64_tr_b16 a[168:169], v9 offset:24576
    ds_read_b64_tr_b16 a[170:171], v9 offset:25088
    v_exp_f32 v29, v29
    v_exp_f32 v30, v30
    v_fma_f32 v29, v29, v4, v4
    v_mfma_f32_32x32x16_bf16 v[80:95], a[148:151], a[100:103], v[80:95]
    ds_read_b64_tr_b16 a[144:145], v9 offset:26624
    ds_read_b64_tr_b16 a[146:147], v9 offset:27136
    v_fma_f32 v30, v30, v4, v4
    v_rcp_f32 v29, v29
    v_rcp_f32 v30, v30
    s_waitcnt lgkmcnt(8)
    v_mfma_f32_32x32x16_bf16 v[80:95], a[152:155], a[104:107], v[80:95]
    ds_read_b64_tr_b16 a[148:149], v9 offset:28672
    ds_read_b64_tr_b16 a[150:151], v9 offset:29184
    v_mul_f32 v106, v106, v29
    v_mul_f32 v107, v107, v30
    v_cvt_pk_bf16_f32 v141, v106, v107
    v_mul_f32 v27, v108, v108
    v_mfma_f32_32x32x16_bf16 v[80:95], a[156:159], a[108:111], v[80:95]
    ds_read_b64_tr_b16 a[152:153], v9 offset:30720
    ds_read_b64_tr_b16 a[154:155], v9 offset:31232
    v_mul_f32 v28, v109, v109
    v_fma_f32 v27, v27, v26, v25
    v_fma_f32 v28, v28, v26, v25
    v_mul_f32 v27, v27, v108
    v_mul_f32 v28, v28, v109
    s_waitcnt lgkmcnt(8)
    v_mfma_f32_32x32x16_bf16 v[80:95], a[160:163], a[112:115], v[80:95]
    ds_read_b64_tr_b16 a[156:157], v9 offset:32768
    ds_read_b64_tr_b16 a[158:159], v9 offset:33280
    v_exp_f32 v27, v27
    v_exp_f32 v28, v28
    v_mfma_f32_32x32x16_bf16 v[80:95], a[164:167], a[116:119], v[80:95]
    ds_read_b64_tr_b16 a[160:161], v9 offset:34816
    ds_read_b64_tr_b16 a[162:163], v9 offset:35328
    v_fma_f32 v27, v27, v4, v4
    v_fma_f32 v28, v28, v4, v4
    v_rcp_f32 v27, v27
    s_waitcnt lgkmcnt(8)
    v_mfma_f32_32x32x16_bf16 v[80:95], a[168:171], a[120:123], v[80:95]
    v_rcp_f32 v28, v28
    v_mul_f32 v108, v108, v27
    v_mul_f32 v109, v109, v28
    v_cvt_pk_bf16_f32 v142, v108, v109
    v_mul_f32 v29, v110, v110
    v_mfma_f32_32x32x16_bf16 v[80:95], a[144:147], a[124:127], v[80:95]
    v_mul_f32 v30, v111, v111
    v_fma_f32 v29, v29, v26, v25
    v_fma_f32 v30, v30, v26, v25
    v_mul_f32 v29, v29, v110
    s_waitcnt lgkmcnt(4)
    v_mfma_f32_32x32x16_bf16 v[80:95], a[148:151], a[128:131], v[80:95]
    s_waitcnt lgkmcnt(0)
    s_waitcnt vmcnt(10)
    s_waitcnt vmcnt(1)
    s_barrier
    ds_read_b64_tr_b16 a[164:165], v10 offset:0
    ds_read_b64_tr_b16 a[166:167], v10 offset:512
    ds_read_b64_tr_b16 a[168:169], v10 offset:2048
    ds_read_b64_tr_b16 a[170:171], v10 offset:2560
    ds_read_b64_tr_b16 a[144:145], v10 offset:4096
    ds_read_b64_tr_b16 a[146:147], v10 offset:4608
    v_mul_f32 v30, v30, v111
    v_exp_f32 v29, v29
    v_exp_f32 v30, v30
    v_mfma_f32_32x32x16_bf16 v[80:95], a[152:155], a[132:135], v[80:95]
    ds_read_b64_tr_b16 a[148:149], v10 offset:6144
    ds_read_b64_tr_b16 a[150:151], v10 offset:6656
    v_fma_f32 v29, v29, v4, v4
    v_fma_f32 v30, v30, v4, v4
    v_rcp_f32 v29, v29
    v_mfma_f32_32x32x16_bf16 v[80:95], a[156:159], a[136:139], v[80:95]
    ds_read_b64_tr_b16 a[152:153], v10 offset:8192
    ds_read_b64_tr_b16 a[154:155], v10 offset:8704
    v_rcp_f32 v30, v30
    s_xor_b32 s56, s62, 0
    s_lshl_b32 s56, s56, 2
    s_add_u32 s56, s56, s46
    s_mul_i32 s56, s56, 663552
    s_lshl_b32 s27, s51, 1
    s_add_u32 s56, s56, s27
    s_add_u32 s56, s56, 384
    v_mul_f32 v110, v110, v29
    v_mul_f32 v111, v111, v30
    v_cvt_pk_bf16_f32 v143, v110, v111
    v_mfma_f32_32x32x16_bf16 v[80:95], a[160:163], a[140:143], v[80:95]
    ds_read_b64_tr_b16 a[156:157], v10 offset:10240
    ds_read_b64_tr_b16 a[158:159], v10 offset:10752
    s_waitcnt lgkmcnt(8)
    v_mfma_f32_32x32x16_bf16 v[96:111], a[164:167], a[0:3], 0
    ds_read_b64_tr_b16 a[160:161], v10 offset:12288
    ds_read_b64_tr_b16 a[162:163], v10 offset:12800
    s_add_u32 m0, s10, 110592
    v_mfma_f32_32x32x16_bf16 v[96:111], a[168:171], a[4:7], v[96:111]
    ds_read_b64_tr_b16 a[164:165], v10 offset:14336
    ds_read_b64_tr_b16 a[166:167], v10 offset:14848
    s_waitcnt lgkmcnt(8)
    v_mfma_f32_32x32x16_bf16 v[96:111], a[144:147], a[8:11], v[96:111]
    ds_read_b64_tr_b16 a[168:169], v10 offset:16384
    ds_read_b64_tr_b16 a[170:171], v10 offset:16896
    v_mul_f32 v27, v80, v80
    buffer_load_dwordx4 v16, s[32:35], s56 offen offset:0 lds
    v_mul_f32 v28, v81, v81
    v_fma_f32 v27, v27, v26, v25
    v_fma_f32 v28, v28, v26, v25
    v_mul_f32 v27, v27, v80
    v_mfma_f32_32x32x16_bf16 v[96:111], a[148:151], a[12:15], v[96:111]
    ds_read_b64_tr_b16 a[144:145], v10 offset:18432
    ds_read_b64_tr_b16 a[146:147], v10 offset:18944
    v_mul_f32 v28, v28, v81
    v_exp_f32 v27, v27
    v_exp_f32 v28, v28
    s_waitcnt lgkmcnt(8)
    v_mfma_f32_32x32x16_bf16 v[96:111], a[152:155], a[16:19], v[96:111]
    ds_read_b64_tr_b16 a[148:149], v10 offset:20480
    ds_read_b64_tr_b16 a[150:151], v10 offset:20992
    v_fma_f32 v27, v27, v4, v4
    buffer_load_dwordx4 v17, s[32:35], s56 offen offset:1024 lds
    v_fma_f32 v28, v28, v4, v4
    v_rcp_f32 v27, v27
    v_mfma_f32_32x32x16_bf16 v[96:111], a[156:159], a[20:23], v[96:111]
    ds_read_b64_tr_b16 a[152:153], v10 offset:22528
    ds_read_b64_tr_b16 a[154:155], v10 offset:23040
    v_rcp_f32 v28, v28
    v_mul_f32 v80, v80, v27
    v_mul_f32 v81, v81, v28
    s_waitcnt lgkmcnt(8)
    v_mfma_f32_32x32x16_bf16 v[96:111], a[160:163], a[24:27], v[96:111]
    ds_read_b64_tr_b16 a[156:157], v10 offset:24576
    ds_read_b64_tr_b16 a[158:159], v10 offset:25088
    v_cvt_pk_bf16_f32 v144, v80, v81
    v_mul_f32 v29, v82, v82
    v_mul_f32 v30, v83, v83
    v_fma_f32 v29, v29, v26, v25
    v_fma_f32 v30, v30, v26, v25
    v_mfma_f32_32x32x16_bf16 v[96:111], a[164:167], a[28:31], v[96:111]
    ds_read_b64_tr_b16 a[160:161], v10 offset:26624
    ds_read_b64_tr_b16 a[162:163], v10 offset:27136
    v_mul_f32 v29, v29, v82
    buffer_load_dwordx4 v18, s[32:35], s56 offen offset:2048 lds
    v_mul_f32 v30, v30, v83
    v_exp_f32 v29, v29
    s_waitcnt lgkmcnt(8)
    v_mfma_f32_32x32x16_bf16 v[96:111], a[168:171], a[32:35], v[96:111]
    ds_read_b64_tr_b16 a[164:165], v10 offset:28672
    ds_read_b64_tr_b16 a[166:167], v10 offset:29184
    v_exp_f32 v30, v30
    v_fma_f32 v29, v29, v4, v4
    v_fma_f32 v30, v30, v4, v4
    v_rcp_f32 v29, v29
    v_mfma_f32_32x32x16_bf16 v[96:111], a[144:147], a[36:39], v[96:111]
    ds_read_b64_tr_b16 a[168:169], v10 offset:30720
    ds_read_b64_tr_b16 a[170:171], v10 offset:31232
    v_rcp_f32 v30, v30
    buffer_load_dwordx4 v19, s[32:35], s56 offen offset:3072 lds
    v_mul_f32 v82, v82, v29
    v_mul_f32 v83, v83, v30
    s_waitcnt lgkmcnt(8)
    v_mfma_f32_32x32x16_bf16 v[96:111], a[148:151], a[40:43], v[96:111]
    ds_read_b64_tr_b16 a[144:145], v10 offset:32768
    ds_read_b64_tr_b16 a[146:147], v10 offset:33280
    v_cvt_pk_bf16_f32 v145, v82, v83
    s_add_u32 m0, s10, 114688
    v_mul_f32 v27, v84, v84
    v_mul_f32 v28, v85, v85
    v_fma_f32 v27, v27, v26, v25
    v_mfma_f32_32x32x16_bf16 v[96:111], a[152:155], a[44:47], v[96:111]
    ds_read_b64_tr_b16 a[148:149], v10 offset:34816
    ds_read_b64_tr_b16 a[150:151], v10 offset:35328
    v_fma_f32 v28, v28, v26, v25
    v_mul_f32 v27, v27, v84
    v_mul_f32 v28, v28, v85
    v_exp_f32 v27, v27
    s_waitcnt lgkmcnt(8)
    v_mfma_f32_32x32x16_bf16 v[96:111], a[156:159], a[48:51], v[96:111]
    ds_read_b64_tr_b16 a[152:153], v12 offset:0
    ds_read_b64_tr_b16 a[154:155], v12 offset:512
    v_exp_f32 v28, v28
    buffer_load_dwordx4 v20, s[32:35], s56 offen offset:0 lds
    v_fma_f32 v27, v27, v4, v4
    v_fma_f32 v28, v28, v4, v4
    v_mfma_f32_32x32x16_bf16 v[96:111], a[160:163], a[52:55], v[96:111]
    ds_read_b64_tr_b16 a[156:157], v12 offset:2048
    ds_read_b64_tr_b16 a[158:159], v12 offset:2560
    v_rcp_f32 v27, v27
    v_rcp_f32 v28, v28
    v_mul_f32 v84, v84, v27
    s_waitcnt lgkmcnt(8)
    v_mfma_f32_32x32x16_bf16 v[96:111], a[164:167], a[56:59], v[96:111]
    ds_read_b64_tr_b16 a[160:161], v12 offset:4096
    ds_read_b64_tr_b16 a[162:163], v12 offset:4608
    v_mul_f32 v85, v85, v28
    buffer_load_dwordx4 v21, s[32:35], s56 offen offset:1024 lds
    v_cvt_pk_bf16_f32 v146, v84, v85
    v_mul_f32 v29, v86, v86
    v_mul_f32 v30, v87, v87
    v_fma_f32 v29, v29, v26, v25
    v_mfma_f32_32x32x16_bf16 v[96:111], a[168:171], a[60:63], v[96:111]
    ds_read_b64_tr_b16 a[164:165], v12 offset:6144
    ds_read_b64_tr_b16 a[166:167], v12 offset:6656
    v_fma_f32 v30, v30, v26, v25
    v_mul_f32 v29, v29, v86
    v_mul_f32 v30, v30, v87
    v_exp_f32 v29, v29
    s_waitcnt lgkmcnt(8)
    v_mfma_f32_32x32x16_bf16 v[96:111], a[144:147], a[64:67], v[96:111]
    ds_read_b64_tr_b16 a[168:169], v12 offset:8192
    ds_read_b64_tr_b16 a[170:171], v12 offset:8704
    v_exp_f32 v30, v30
    v_fma_f32 v29, v29, v4, v4
    v_fma_f32 v30, v30, v4, v4
    v_mfma_f32_32x32x16_bf16 v[96:111], a[148:151], a[68:71], v[96:111]
    ds_read_b64_tr_b16 a[144:145], v12 offset:10240
    ds_read_b64_tr_b16 a[146:147], v12 offset:10752
    v_rcp_f32 v29, v29
    buffer_load_dwordx4 v22, s[32:35], s56 offen offset:2048 lds
    v_rcp_f32 v30, v30
    v_mul_f32 v86, v86, v29
    s_waitcnt lgkmcnt(8)
    v_mfma_f32_32x32x16_bf16 v[96:111], a[152:155], a[72:75], v[96:111]
    ds_read_b64_tr_b16 a[148:149], v12 offset:12288
    ds_read_b64_tr_b16 a[150:151], v12 offset:12800
    v_mul_f32 v87, v87, v30
    v_cvt_pk_bf16_f32 v147, v86, v87
    v_mul_f32 v27, v88, v88
    v_mul_f32 v28, v89, v89
    v_mfma_f32_32x32x16_bf16 v[96:111], a[156:159], a[76:79], v[96:111]
    ds_read_b64_tr_b16 a[152:153], v12 offset:14336
    ds_read_b64_tr_b16 a[154:155], v12 offset:14848
    v_fma_f32 v27, v27, v26, v25
    buffer_load_dwordx4 v23, s[32:35], s56 offen offset:3072 lds
    v_fma_f32 v28, v28, v26, v25
    v_mul_f32 v27, v27, v88
    v_mul_f32 v28, v28, v89
    s_waitcnt lgkmcnt(8)
    v_mfma_f32_32x32x16_bf16 v[96:111], a[160:163], a[80:83], v[96:111]
    ds_read_b64_tr_b16 a[156:157], v12 offset:16384
    ds_read_b64_tr_b16 a[158:159], v12 offset:16896
    v_exp_f32 v27, v27
    v_exp_f32 v28, v28
    v_fma_f32 v27, v27, v4, v4
    v_fma_f32 v28, v28, v4, v4
    v_mfma_f32_32x32x16_bf16 v[96:111], a[164:167], a[84:87], v[96:111]
    ds_read_b64_tr_b16 a[160:161], v12 offset:18432
    ds_read_b64_tr_b16 a[162:163], v12 offset:18944
    v_rcp_f32 v27, v27
    s_add_u32 m0, s10, 118784
    v_rcp_f32 v28, v28
    s_waitcnt lgkmcnt(8)
    v_mfma_f32_32x32x16_bf16 v[96:111], a[168:171], a[88:91], v[96:111]
    ds_read_b64_tr_b16 a[164:165], v12 offset:20480
    ds_read_b64_tr_b16 a[166:167], v12 offset:20992
    v_mul_f32 v88, v88, v27
    buffer_load_dwordx4 v24, s[32:35], s56 offen offset:0 lds
    v_mul_f32 v89, v89, v28
    v_cvt_pk_bf16_f32 v148, v88, v89
    v_mul_f32 v29, v90, v90
    v_mul_f32 v30, v91, v91
    v_mfma_f32_32x32x16_bf16 v[96:111], a[144:147], a[92:95], v[96:111]
    ds_read_b64_tr_b16 a[168:169], v12 offset:22528
    ds_read_b64_tr_b16 a[170:171], v12 offset:23040
    v_fma_f32 v29, v29, v26, v25
    v_fma_f32 v30, v30, v26, v25
    v_mul_f32 v29, v29, v90
    v_mul_f32 v30, v30, v91
    s_waitcnt lgkmcnt(8)
    v_mfma_f32_32x32x16_bf16 v[96:111], a[148:151], a[96:99], v[96:111]
    ds_read_b64_tr_b16 a[144:145], v12 offset:24576
    ds_read_b64_tr_b16 a[146:147], v12 offset:25088
    v_exp_f32 v29, v29
    v_exp_f32 v30, v30
    v_fma_f32 v29, v29, v4, v4
    v_mfma_f32_32x32x16_bf16 v[96:111], a[152:155], a[100:103], v[96:111]
    ds_read_b64_tr_b16 a[148:149], v12 offset:26624
    ds_read_b64_tr_b16 a[150:151], v12 offset:27136
    v_fma_f32 v30, v30, v4, v4
    s_xor_b32 s56, s62, 1
    s_lshl_b32 s56, s56, 2
    s_add_u32 s56, s56, s46
    s_mul_i32 s56, s56, 663552
    s_lshl_b32 s27, s51, 1
    s_add_u32 s56, s56, s27
    s_add_u32 s56, s56, 384
    v_rcp_f32 v29, v29
    v_rcp_f32 v30, v30
    s_waitcnt lgkmcnt(8)
    v_mfma_f32_32x32x16_bf16 v[96:111], a[156:159], a[104:107], v[96:111]
    ds_read_b64_tr_b16 a[152:153], v12 offset:28672
    ds_read_b64_tr_b16 a[154:155], v12 offset:29184
    v_mul_f32 v90, v90, v29
    v_mul_f32 v91, v91, v30
    v_cvt_pk_bf16_f32 v149, v90, v91
    v_mul_f32 v27, v92, v92
    v_mfma_f32_32x32x16_bf16 v[96:111], a[160:163], a[108:111], v[96:111]
    ds_read_b64_tr_b16 a[156:157], v12 offset:30720
    ds_read_b64_tr_b16 a[158:159], v12 offset:31232
    v_mul_f32 v28, v93, v93
    s_add_u32 m0, s10, 0
    v_fma_f32 v27, v27, v26, v25
    v_fma_f32 v28, v28, v26, v25
    v_mul_f32 v27, v27, v92
    v_mul_f32 v28, v28, v93
    s_waitcnt lgkmcnt(8)
    v_mfma_f32_32x32x16_bf16 v[96:111], a[164:167], a[112:115], v[96:111]
    ds_read_b64_tr_b16 a[160:161], v12 offset:32768
    ds_read_b64_tr_b16 a[162:163], v12 offset:33280
    v_exp_f32 v27, v27
    v_exp_f32 v28, v28
    v_mfma_f32_32x32x16_bf16 v[96:111], a[168:171], a[116:119], v[96:111]
    ds_read_b64_tr_b16 a[164:165], v12 offset:34816
    ds_read_b64_tr_b16 a[166:167], v12 offset:35328
    v_fma_f32 v27, v27, v4, v4
    buffer_load_dwordx4 v16, s[32:35], s56 offen offset:0 lds
    v_fma_f32 v28, v28, v4, v4
    v_rcp_f32 v27, v27
    s_waitcnt lgkmcnt(8)
    v_mfma_f32_32x32x16_bf16 v[96:111], a[144:147], a[120:123], v[96:111]
    ds_read_b64_tr_b16 a[168:169], v11 offset:0
    ds_read_b64_tr_b16 a[170:171], v11 offset:512
    v_rcp_f32 v28, v28
    v_mul_f32 v92, v92, v27
    v_mul_f32 v93, v93, v28
    v_cvt_pk_bf16_f32 v150, v92, v93
    v_mul_f32 v29, v94, v94
    v_mfma_f32_32x32x16_bf16 v[96:111], a[148:151], a[124:127], v[96:111]
    ds_read_b64_tr_b16 a[144:145], v11 offset:2048
    ds_read_b64_tr_b16 a[146:147], v11 offset:2560
    v_mul_f32 v30, v95, v95
    buffer_load_dwordx4 v17, s[32:35], s56 offen offset:1024 lds
    v_fma_f32 v29, v29, v26, v25
    v_fma_f32 v30, v30, v26, v25
    v_mul_f32 v29, v29, v94
    s_waitcnt lgkmcnt(8)
    v_mfma_f32_32x32x16_bf16 v[96:111], a[152:155], a[128:131], v[96:111]
    ds_read_b64_tr_b16 a[148:149], v11 offset:4096
    ds_read_b64_tr_b16 a[150:151], v11 offset:4608
    v_mul_f32 v30, v30, v95
    v_exp_f32 v29, v29
    v_exp_f32 v30, v30
    v_mfma_f32_32x32x16_bf16 v[96:111], a[156:159], a[132:135], v[96:111]
    ds_read_b64_tr_b16 a[152:153], v11 offset:6144
    ds_read_b64_tr_b16 a[154:155], v11 offset:6656
    v_fma_f32 v29, v29, v4, v4
    v_fma_f32 v30, v30, v4, v4
    v_rcp_f32 v29, v29
    s_waitcnt lgkmcnt(8)
    v_mfma_f32_32x32x16_bf16 v[96:111], a[160:163], a[136:139], v[96:111]
    ds_read_b64_tr_b16 a[156:157], v11 offset:8192
    ds_read_b64_tr_b16 a[158:159], v11 offset:8704
    v_rcp_f32 v30, v30
    buffer_load_dwordx4 v18, s[32:35], s56 offen offset:2048 lds
    v_mul_f32 v94, v94, v29
    v_mul_f32 v95, v95, v30
    v_cvt_pk_bf16_f32 v151, v94, v95
    v_mfma_f32_32x32x16_bf16 v[96:111], a[164:167], a[140:143], v[96:111]
    ds_read_b64_tr_b16 a[160:161], v11 offset:10240
    ds_read_b64_tr_b16 a[162:163], v11 offset:10752
    s_waitcnt lgkmcnt(8)
    v_mfma_f32_32x32x16_bf16 v[80:95], a[168:171], a[0:3], 0
    ds_read_b64_tr_b16 a[164:165], v11 offset:12288
    ds_read_b64_tr_b16 a[166:167], v11 offset:12800
    buffer_load_dwordx4 v19, s[32:35], s56 offen offset:3072 lds
    v_mfma_f32_32x32x16_bf16 v[80:95], a[144:147], a[4:7], v[80:95]
    ds_read_b64_tr_b16 a[168:169], v11 offset:14336
    ds_read_b64_tr_b16 a[170:171], v11 offset:14848
    s_add_u32 m0, s10, 4096
    s_waitcnt lgkmcnt(8)
    v_mfma_f32_32x32x16_bf16 v[80:95], a[148:151], a[8:11], v[80:95]
    ds_read_b64_tr_b16 a[144:145], v11 offset:16384
    ds_read_b64_tr_b16 a[146:147], v11 offset:16896
    v_mul_f32 v27, v96, v96
    v_mul_f32 v28, v97, v97
    v_fma_f32 v27, v27, v26, v25
    v_fma_f32 v28, v28, v26, v25
    v_mul_f32 v27, v27, v96
    v_mfma_f32_32x32x16_bf16 v[80:95], a[152:155], a[12:15], v[80:95]
    ds_read_b64_tr_b16 a[148:149], v11 offset:18432
    ds_read_b64_tr_b16 a[150:151], v11 offset:18944
    buffer_load_dwordx4 v20, s[32:35], s56 offen offset:0 lds
    v_mul_f32 v28, v28, v97
    v_exp_f32 v27, v27
    v_exp_f32 v28, v28
    s_waitcnt lgkmcnt(8)
    v_mfma_f32_32x32x16_bf16 v[80:95], a[156:159], a[16:19], v[80:95]
    ds_read_b64_tr_b16 a[152:153], v11 offset:20480
    ds_read_b64_tr_b16 a[154:155], v11 offset:20992
    v_fma_f32 v27, v27, v4, v4
    v_fma_f32 v28, v28, v4, v4
    v_rcp_f32 v27, v27
    v_mfma_f32_32x32x16_bf16 v[80:95], a[160:163], a[20:23], v[80:95]
    ds_read_b64_tr_b16 a[156:157], v11 offset:22528
    ds_read_b64_tr_b16 a[158:159], v11 offset:23040
    buffer_load_dwordx4 v21, s[32:35], s56 offen offset:1024 lds
    v_rcp_f32 v28, v28
    v_mul_f32 v96, v96, v27
    v_mul_f32 v97, v97, v28
    s_waitcnt lgkmcnt(8)
    v_mfma_f32_32x32x16_bf16 v[80:95], a[164:167], a[24:27], v[80:95]
    ds_read_b64_tr_b16 a[160:161], v11 offset:24576
    ds_read_b64_tr_b16 a[162:163], v11 offset:25088
    v_cvt_pk_bf16_f32 v152, v96, v97
    v_mul_f32 v29, v98, v98
    v_mul_f32 v30, v99, v99
    v_fma_f32 v29, v29, v26, v25
    v_fma_f32 v30, v30, v26, v25
    v_mfma_f32_32x32x16_bf16 v[80:95], a[168:171], a[28:31], v[80:95]
    ds_read_b64_tr_b16 a[164:165], v11 offset:26624
    ds_read_b64_tr_b16 a[166:167], v11 offset:27136
    v_mul_f32 v29, v29, v98
    v_mul_f32 v30, v30, v99
    v_exp_f32 v29, v29
    s_waitcnt lgkmcnt(8)
    v_mfma_f32_32x32x16_bf16 v[80:95], a[144:147], a[32:35], v[80:95]
    ds_read_b64_tr_b16 a[168:169], v11 offset:28672
    ds_read_b64_tr_b16 a[170:171], v11 offset:29184
    buffer_load_dwordx4 v22, s[32:35], s56 offen offset:2048 lds
    v_exp_f32 v30, v30
    v_fma_f32 v29, v29, v4, v4
    v_fma_f32 v30, v30, v4, v4
    v_rcp_f32 v29, v29
    v_mfma_f32_32x32x16_bf16 v[80:95], a[148:151], a[36:39], v[80:95]
    ds_read_b64_tr_b16 a[144:145], v11 offset:30720
    ds_read_b64_tr_b16 a[146:147], v11 offset:31232
    v_rcp_f32 v30, v30
    v_mul_f32 v98, v98, v29
    v_mul_f32 v99, v99, v30
    s_waitcnt lgkmcnt(8)
    v_mfma_f32_32x32x16_bf16 v[80:95], a[152:155], a[40:43], v[80:95]
    ds_read_b64_tr_b16 a[148:149], v11 offset:32768
    ds_read_b64_tr_b16 a[150:151], v11 offset:33280
    buffer_load_dwordx4 v23, s[32:35], s56 offen offset:3072 lds
    v_cvt_pk_bf16_f32 v153, v98, v99
    v_mul_f32 v27, v100, v100
    v_mul_f32 v28, v101, v101
    v_fma_f32 v27, v27, v26, v25
    v_mfma_f32_32x32x16_bf16 v[80:95], a[156:159], a[44:47], v[80:95]
    ds_read_b64_tr_b16 a[152:153], v11 offset:34816
    ds_read_b64_tr_b16 a[154:155], v11 offset:35328
    v_fma_f32 v28, v28, v26, v25
    v_mul_f32 v27, v27, v100
    v_mul_f32 v28, v28, v101
    v_exp_f32 v27, v27
    s_waitcnt lgkmcnt(8)
    v_mfma_f32_32x32x16_bf16 v[80:95], a[160:163], a[48:51], v[80:95]
    ds_read_b64_tr_b16 a[156:157], v13 offset:0
    ds_read_b64_tr_b16 a[158:159], v13 offset:512
    s_add_u32 m0, s10, 8192
    v_exp_f32 v28, v28
    v_fma_f32 v27, v27, v4, v4
    v_fma_f32 v28, v28, v4, v4
    v_mfma_f32_32x32x16_bf16 v[80:95], a[164:167], a[52:55], v[80:95]
    ds_read_b64_tr_b16 a[160:161], v13 offset:2048
    ds_read_b64_tr_b16 a[162:163], v13 offset:2560
    buffer_load_dwordx4 v24, s[32:35], s56 offen offset:0 lds
    v_rcp_f32 v27, v27
    v_rcp_f32 v28, v28
    v_mul_f32 v100, v100, v27
    s_waitcnt lgkmcnt(8)
    v_mfma_f32_32x32x16_bf16 v[80:95], a[168:171], a[56:59], v[80:95]
    ds_read_b64_tr_b16 a[164:165], v13 offset:4096
    ds_read_b64_tr_b16 a[166:167], v13 offset:4608
    v_mul_f32 v101, v101, v28
    v_cvt_pk_bf16_f32 v154, v100, v101
    v_mul_f32 v29, v102, v102
    v_mul_f32 v30, v103, v103
    v_fma_f32 v29, v29, v26, v25
    v_mfma_f32_32x32x16_bf16 v[80:95], a[144:147], a[60:63], v[80:95]
    ds_read_b64_tr_b16 a[168:169], v13 offset:6144
    ds_read_b64_tr_b16 a[170:171], v13 offset:6656
    v_fma_f32 v30, v30, v26, v25
    v_mul_f32 v29, v29, v102
    v_mul_f32 v30, v30, v103
    v_exp_f32 v29, v29
    s_waitcnt lgkmcnt(8)
    v_mfma_f32_32x32x16_bf16 v[80:95], a[148:151], a[64:67], v[80:95]
    ds_read_b64_tr_b16 a[144:145], v13 offset:8192
    ds_read_b64_tr_b16 a[146:147], v13 offset:8704
    v_exp_f32 v30, v30
    v_fma_f32 v29, v29, v4, v4
    v_fma_f32 v30, v30, v4, v4
    v_mfma_f32_32x32x16_bf16 v[80:95], a[152:155], a[68:71], v[80:95]
    ds_read_b64_tr_b16 a[148:149], v13 offset:10240
    ds_read_b64_tr_b16 a[150:151], v13 offset:10752
    v_rcp_f32 v29, v29
    v_rcp_f32 v30, v30
    v_mul_f32 v102, v102, v29
    s_waitcnt lgkmcnt(8)
    v_mfma_f32_32x32x16_bf16 v[80:95], a[156:159], a[72:75], v[80:95]
    ds_read_b64_tr_b16 a[152:153], v13 offset:12288
    ds_read_b64_tr_b16 a[154:155], v13 offset:12800
    v_mul_f32 v103, v103, v30
    v_cvt_pk_bf16_f32 v155, v102, v103
    v_mul_f32 v27, v104, v104
    v_mul_f32 v28, v105, v105
    v_mfma_f32_32x32x16_bf16 v[80:95], a[160:163], a[76:79], v[80:95]
    ds_read_b64_tr_b16 a[156:157], v13 offset:14336
    ds_read_b64_tr_b16 a[158:159], v13 offset:14848
    v_fma_f32 v27, v27, v26, v25
    v_fma_f32 v28, v28, v26, v25
    v_mul_f32 v27, v27, v104
    v_mul_f32 v28, v28, v105
    s_waitcnt lgkmcnt(8)
    v_mfma_f32_32x32x16_bf16 v[80:95], a[164:167], a[80:83], v[80:95]
    ds_read_b64_tr_b16 a[160:161], v13 offset:16384
    ds_read_b64_tr_b16 a[162:163], v13 offset:16896
    v_exp_f32 v27, v27
    v_exp_f32 v28, v28
    v_fma_f32 v27, v27, v4, v4
    v_fma_f32 v28, v28, v4, v4
    v_mfma_f32_32x32x16_bf16 v[80:95], a[168:171], a[84:87], v[80:95]
    ds_read_b64_tr_b16 a[164:165], v13 offset:18432
    ds_read_b64_tr_b16 a[166:167], v13 offset:18944
    v_rcp_f32 v27, v27
    v_rcp_f32 v28, v28
    s_waitcnt lgkmcnt(8)
    v_mfma_f32_32x32x16_bf16 v[80:95], a[144:147], a[88:91], v[80:95]
    ds_read_b64_tr_b16 a[168:169], v13 offset:20480
    ds_read_b64_tr_b16 a[170:171], v13 offset:20992
    v_mul_f32 v104, v104, v27
    v_mul_f32 v105, v105, v28
    v_cvt_pk_bf16_f32 v156, v104, v105
    v_mul_f32 v29, v106, v106
    v_mul_f32 v30, v107, v107
    v_mfma_f32_32x32x16_bf16 v[80:95], a[148:151], a[92:95], v[80:95]
    ds_read_b64_tr_b16 a[144:145], v13 offset:22528
    ds_read_b64_tr_b16 a[146:147], v13 offset:23040
    v_fma_f32 v29, v29, v26, v25
    v_fma_f32 v30, v30, v26, v25
    v_mul_f32 v29, v29, v106
    v_mul_f32 v30, v30, v107
    s_waitcnt lgkmcnt(8)
    v_mfma_f32_32x32x16_bf16 v[80:95], a[152:155], a[96:99], v[80:95]
    ds_read_b64_tr_b16 a[148:149], v13 offset:24576
    ds_read_b64_tr_b16 a[150:151], v13 offset:25088
    v_exp_f32 v29, v29
    v_exp_f32 v30, v30
    v_fma_f32 v29, v29, v4, v4
    v_mfma_f32_32x32x16_bf16 v[80:95], a[156:159], a[100:103], v[80:95]
    ds_read_b64_tr_b16 a[152:153], v13 offset:26624
    ds_read_b64_tr_b16 a[154:155], v13 offset:27136
    v_fma_f32 v30, v30, v4, v4
    v_rcp_f32 v29, v29
    v_rcp_f32 v30, v30
    s_waitcnt lgkmcnt(8)
    v_mfma_f32_32x32x16_bf16 v[80:95], a[160:163], a[104:107], v[80:95]
    ds_read_b64_tr_b16 a[156:157], v13 offset:28672
    ds_read_b64_tr_b16 a[158:159], v13 offset:29184
    v_mul_f32 v106, v106, v29
    v_mul_f32 v107, v107, v30
    v_cvt_pk_bf16_f32 v157, v106, v107
    v_mul_f32 v27, v108, v108
    v_mfma_f32_32x32x16_bf16 v[80:95], a[164:167], a[108:111], v[80:95]
    ds_read_b64_tr_b16 a[160:161], v13 offset:30720
    ds_read_b64_tr_b16 a[162:163], v13 offset:31232
    v_mul_f32 v28, v109, v109
    v_fma_f32 v27, v27, v26, v25
    v_fma_f32 v28, v28, v26, v25
    v_mul_f32 v27, v27, v108
    v_mul_f32 v28, v28, v109
    s_waitcnt lgkmcnt(8)
    v_mfma_f32_32x32x16_bf16 v[80:95], a[168:171], a[112:115], v[80:95]
    ds_read_b64_tr_b16 a[164:165], v13 offset:32768
    ds_read_b64_tr_b16 a[166:167], v13 offset:33280
    v_exp_f32 v27, v27
    v_exp_f32 v28, v28
    v_mfma_f32_32x32x16_bf16 v[80:95], a[144:147], a[116:119], v[80:95]
    ds_read_b64_tr_b16 a[168:169], v13 offset:34816
    ds_read_b64_tr_b16 a[170:171], v13 offset:35328
    v_fma_f32 v27, v27, v4, v4
    v_fma_f32 v28, v28, v4, v4
    v_rcp_f32 v27, v27
    s_waitcnt lgkmcnt(8)
    v_mfma_f32_32x32x16_bf16 v[80:95], a[148:151], a[120:123], v[80:95]
    v_rcp_f32 v28, v28
    v_mul_f32 v108, v108, v27
    v_mul_f32 v109, v109, v28
    v_cvt_pk_bf16_f32 v158, v108, v109
    v_mul_f32 v29, v110, v110
    v_mfma_f32_32x32x16_bf16 v[80:95], a[152:155], a[124:127], v[80:95]
    v_mul_f32 v30, v111, v111
    v_fma_f32 v29, v29, v26, v25
    v_fma_f32 v30, v30, v26, v25
    v_mul_f32 v29, v29, v110
    s_waitcnt lgkmcnt(4)
    v_mfma_f32_32x32x16_bf16 v[80:95], a[156:159], a[128:131], v[80:95]
    s_waitcnt lgkmcnt(0)
    s_waitcnt vmcnt(9)
    s_waitcnt vmcnt(0)
    s_barrier
    ds_read_b64_tr_b16 a[144:145], v14 offset:0
    ds_read_b64_tr_b16 a[146:147], v14 offset:512
    ds_read_b64_tr_b16 a[148:149], v14 offset:2048
    ds_read_b64_tr_b16 a[150:151], v14 offset:2560
    ds_read_b64_tr_b16 a[152:153], v14 offset:4096
    ds_read_b64_tr_b16 a[154:155], v14 offset:4608
    v_mul_f32 v30, v30, v111
    v_exp_f32 v29, v29
    v_exp_f32 v30, v30
    v_mfma_f32_32x32x16_bf16 v[80:95], a[160:163], a[132:135], v[80:95]
    ds_read_b64_tr_b16 a[156:157], v14 offset:6144
    ds_read_b64_tr_b16 a[158:159], v14 offset:6656
    v_fma_f32 v29, v29, v4, v4
    v_lshrrev_b32 v76, 3, v1
    v_fma_f32 v30, v30, v4, v4
    v_mul_u32_u24 v76, 1152, v76
    v_rcp_f32 v29, v29
    v_mfma_f32_32x32x16_bf16 v[80:95], a[164:167], a[136:139], v[80:95]
    ds_read_b64_tr_b16 a[160:161], v14 offset:8192
    ds_read_b64_tr_b16 a[162:163], v14 offset:8704
    v_rcp_f32 v30, v30
    v_bfe_u32 v77, v1, 4, 1
    v_mul_f32 v110, v110, v29
    v_lshlrev_b32 v77, 2, v77
    v_mul_f32 v111, v111, v30
    v_xor_b32 v77, v77, v1
    v_cvt_pk_bf16_f32 v159, v110, v111
    v_mfma_f32_32x32x16_bf16 v[80:95], a[168:171], a[140:143], v[80:95]
    ds_read_b64_tr_b16 a[164:165], v14 offset:10240
    ds_read_b64_tr_b16 a[166:167], v14 offset:10752
    v_and_b32 v77, 7, v77
    v_lshl_add_u32 v16, v77, 4, v76
    s_waitcnt lgkmcnt(8)
    v_mfma_f32_32x32x16_bf16 v[96:111], a[144:147], a[0:3], 0
    ds_read_b64_tr_b16 a[168:169], v14 offset:12288
    ds_read_b64_tr_b16 a[170:171], v14 offset:12800
    v_add_u32 v17, 8192, v16
    v_add_u32 v18, 16384, v16
    v_mfma_f32_32x32x16_bf16 v[96:111], a[148:151], a[4:7], v[96:111]
    ds_read_b64_tr_b16 a[144:145], v14 offset:14336
    ds_read_b64_tr_b16 a[146:147], v14 offset:14848
    v_add_u32 v19, 24576, v16
    v_add_u32 v20, 0, v16
    v_add_u32 v21, 8192, v16
    s_waitcnt lgkmcnt(8)
    v_mfma_f32_32x32x16_bf16 v[96:111], a[152:155], a[8:11], v[96:111]
    ds_read_b64_tr_b16 a[148:149], v14 offset:16384
    ds_read_b64_tr_b16 a[150:151], v14 offset:16896
    v_mul_f32 v27, v80, v80
    v_add_u32 v22, 16384, v16
    v_mul_f32 v28, v81, v81
    v_add_u32 v23, 24576, v16
    v_fma_f32 v27, v27, v26, v25
    v_fma_f32 v28, v28, v26, v25
    v_mul_f32 v27, v27, v80
    v_mfma_f32_32x32x16_bf16 v[96:111], a[156:159], a[12:15], v[96:111]
    ds_read_b64_tr_b16 a[152:153], v14 offset:18432
    ds_read_b64_tr_b16 a[154:155], v14 offset:18944
    v_mul_f32 v28, v28, v81
    v_add_u32 v24, 36864, v16
    v_exp_f32 v27, v27
    v_exp_f32 v28, v28
    s_waitcnt lgkmcnt(8)
    v_mfma_f32_32x32x16_bf16 v[96:111], a[160:163], a[16:19], v[96:111]
    ds_read_b64_tr_b16 a[156:157], v14 offset:20480
    ds_read_b64_tr_b16 a[158:159], v14 offset:20992
    v_fma_f32 v27, v27, v4, v4
    v_fma_f32 v28, v28, v4, v4
    v_rcp_f32 v27, v27
    v_mfma_f32_32x32x16_bf16 v[96:111], a[164:167], a[20:23], v[96:111]
    ds_read_b64_tr_b16 a[160:161], v14 offset:22528
    ds_read_b64_tr_b16 a[162:163], v14 offset:23040
    v_rcp_f32 v28, v28
    s_sub_u32 s63, s51, 32
    s_cmp_eq_u32 s46, 0
    s_cselect_b32 s62, s26, s63
    s_mul_i32 s27, s46, 72
    s_add_u32 s62, s62, s27
    s_add_u32 s63, s51, s27
    s_mul_i32 s62, s62, 1152
    s_mul_i32 s63, s63, 1152
    v_mul_f32 v80, v80, v27
    v_mul_f32 v81, v81, v28
    s_waitcnt lgkmcnt(8)
    v_mfma_f32_32x32x16_bf16 v[96:111], a[168:171], a[24:27], v[96:111]
    ds_read_b64_tr_b16 a[164:165], v14 offset:24576
    ds_read_b64_tr_b16 a[166:167], v14 offset:25088
    v_cvt_pk_bf16_f32 v160, v80, v81
    v_mul_f32 v29, v82, v82
    v_mul_f32 v30, v83, v83
    v_fma_f32 v29, v29, v26, v25
    v_fma_f32 v30, v30, v26, v25
    v_mfma_f32_32x32x16_bf16 v[96:111], a[144:147], a[28:31], v[96:111]
    ds_read_b64_tr_b16 a[168:169], v14 offset:26624
    ds_read_b64_tr_b16 a[170:171], v14 offset:27136
    v_mul_f32 v29, v29, v82
    s_mov_b32 s27, 1024
    s_add_u32 s56, s62, s27
    s_add_u32 s57, s63, s27
    v_mul_f32 v30, v30, v83
    v_exp_f32 v29, v29
    s_waitcnt lgkmcnt(8)
    v_mfma_f32_32x32x16_bf16 v[96:111], a[148:151], a[32:35], v[96:111]
    ds_read_b64_tr_b16 a[144:145], v14 offset:28672
    ds_read_b64_tr_b16 a[146:147], v14 offset:29184
    v_exp_f32 v30, v30
    s_add_u32 m0, s10, 36864
    v_fma_f32 v29, v29, v4, v4
    v_fma_f32 v30, v30, v4, v4
    v_rcp_f32 v29, v29
    v_mfma_f32_32x32x16_bf16 v[96:111], a[152:155], a[36:39], v[96:111]
    ds_read_b64_tr_b16 a[148:149], v14 offset:30720
    ds_read_b64_tr_b16 a[150:151], v14 offset:31232
    v_rcp_f32 v30, v30
    buffer_load_dwordx4 v16, s[36:39], s56 offen offset:0 lds
    v_mul_f32 v82, v82, v29
    v_mul_f32 v83, v83, v30
    s_waitcnt lgkmcnt(8)
    v_mfma_f32_32x32x16_bf16 v[96:111], a[156:159], a[40:43], v[96:111]
    ds_read_b64_tr_b16 a[152:153], v14 offset:32768
    ds_read_b64_tr_b16 a[154:155], v14 offset:33280
    v_cvt_pk_bf16_f32 v161, v82, v83
    v_mul_f32 v27, v84, v84
    v_mul_f32 v28, v85, v85
    v_fma_f32 v27, v27, v26, v25
    v_mfma_f32_32x32x16_bf16 v[96:111], a[160:163], a[44:47], v[96:111]
    ds_read_b64_tr_b16 a[156:157], v14 offset:34816
    ds_read_b64_tr_b16 a[158:159], v14 offset:35328
    v_fma_f32 v28, v28, v26, v25
    buffer_load_dwordx4 v17, s[36:39], s56 offen offset:1024 lds
    v_mul_f32 v27, v27, v84
    v_mul_f32 v28, v28, v85
    v_exp_f32 v27, v27
    s_waitcnt lgkmcnt(8)
    v_mfma_f32_32x32x16_bf16 v[96:111], a[164:167], a[48:51], v[96:111]
    ds_read_b64_tr_b16 a[160:161], v8 offset:0
    ds_read_b64_tr_b16 a[162:163], v8 offset:512
    v_exp_f32 v28, v28
    v_fma_f32 v27, v27, v4, v4
    v_fma_f32 v28, v28, v4, v4
    v_mfma_f32_32x32x16_bf16 v[96:111], a[168:171], a[52:55], v[96:111]
    ds_read_b64_tr_b16 a[164:165], v8 offset:2048
    ds_read_b64_tr_b16 a[166:167], v8 offset:2560
    v_rcp_f32 v27, v27
    buffer_load_dwordx4 v18, s[36:39], s56 offen offset:2048 lds
    v_rcp_f32 v28, v28
    v_mul_f32 v84, v84, v27
    s_waitcnt lgkmcnt(8)
    v_mfma_f32_32x32x16_bf16 v[96:111], a[144:147], a[56:59], v[96:111]
    ds_read_b64_tr_b16 a[168:169], v8 offset:4096
    ds_read_b64_tr_b16 a[170:171], v8 offset:4608
    v_mul_f32 v85, v85, v28
    v_cvt_pk_bf16_f32 v162, v84, v85
    v_mul_f32 v29, v86, v86
    v_mul_f32 v30, v87, v87
    v_fma_f32 v29, v29, v26, v25
    v_mfma_f32_32x32x16_bf16 v[96:111], a[148:151], a[60:63], v[96:111]
    ds_read_b64_tr_b16 a[144:145], v8 offset:6144
    ds_read_b64_tr_b16 a[146:147], v8 offset:6656
    v_fma_f32 v30, v30, v26, v25
    buffer_load_dwordx4 v19, s[36:39], s56 offen offset:3072 lds
    v_mul_f32 v29, v29, v86
    v_mul_f32 v30, v30, v87
    v_exp_f32 v29, v29
    s_waitcnt lgkmcnt(8)
    v_mfma_f32_32x32x16_bf16 v[96:111], a[152:155], a[64:67], v[96:111]
    ds_read_b64_tr_b16 a[148:149], v8 offset:8192
    ds_read_b64_tr_b16 a[150:151], v8 offset:8704
    v_exp_f32 v30, v30
    v_fma_f32 v29, v29, v4, v4
    v_fma_f32 v30, v30, v4, v4
    v_mfma_f32_32x32x16_bf16 v[96:111], a[156:159], a[68:71], v[96:111]
    ds_read_b64_tr_b16 a[152:153], v8 offset:10240
    ds_read_b64_tr_b16 a[154:155], v8 offset:10752
    v_rcp_f32 v29, v29
    s_add_u32 m0, s10, 40960
    v_rcp_f32 v30, v30
    v_mul_f32 v86, v86, v29
    s_waitcnt lgkmcnt(8)
    v_mfma_f32_32x32x16_bf16 v[96:111], a[160:163], a[72:75], v[96:111]
    ds_read_b64_tr_b16 a[156:157], v8 offset:12288
    ds_read_b64_tr_b16 a[158:159], v8 offset:12800
    v_mul_f32 v87, v87, v30
    buffer_load_dwordx4 v20, s[36:39], s57 offen offset:0 lds
    v_cvt_pk_bf16_f32 v163, v86, v87
    v_mul_f32 v27, v88, v88
    v_mul_f32 v28, v89, v89
    v_mfma_f32_32x32x16_bf16 v[96:111], a[164:167], a[76:79], v[96:111]
    ds_read_b64_tr_b16 a[160:161], v8 offset:14336
    ds_read_b64_tr_b16 a[162:163], v8 offset:14848
    v_fma_f32 v27, v27, v26, v25
    v_fma_f32 v28, v28, v26, v25
    v_mul_f32 v27, v27, v88
    v_mul_f32 v28, v28, v89
    s_waitcnt lgkmcnt(8)
    v_mfma_f32_32x32x16_bf16 v[96:111], a[168:171], a[80:83], v[96:111]
    ds_read_b64_tr_b16 a[164:165], v8 offset:16384
    ds_read_b64_tr_b16 a[166:167], v8 offset:16896
    v_exp_f32 v27, v27
    buffer_load_dwordx4 v21, s[36:39], s57 offen offset:1024 lds
    v_exp_f32 v28, v28
    v_fma_f32 v27, v27, v4, v4
    v_fma_f32 v28, v28, v4, v4
    v_mfma_f32_32x32x16_bf16 v[96:111], a[144:147], a[84:87], v[96:111]
    ds_read_b64_tr_b16 a[168:169], v8 offset:18432
    ds_read_b64_tr_b16 a[170:171], v8 offset:18944
    v_rcp_f32 v27, v27
    v_rcp_f32 v28, v28
    s_waitcnt lgkmcnt(8)
    v_mfma_f32_32x32x16_bf16 v[96:111], a[148:151], a[88:91], v[96:111]
    ds_read_b64_tr_b16 a[144:145], v8 offset:20480
    ds_read_b64_tr_b16 a[146:147], v8 offset:20992
    v_mul_f32 v88, v88, v27
    buffer_load_dwordx4 v22, s[36:39], s57 offen offset:2048 lds
    v_mul_f32 v89, v89, v28
    v_cvt_pk_bf16_f32 v164, v88, v89
    v_mul_f32 v29, v90, v90
    v_mul_f32 v30, v91, v91
    v_mfma_f32_32x32x16_bf16 v[96:111], a[152:155], a[92:95], v[96:111]
    ds_read_b64_tr_b16 a[148:149], v8 offset:22528
    ds_read_b64_tr_b16 a[150:151], v8 offset:23040
    v_fma_f32 v29, v29, v26, v25
    v_fma_f32 v30, v30, v26, v25
    v_mul_f32 v29, v29, v90
    v_mul_f32 v30, v30, v91
    s_waitcnt lgkmcnt(8)
    v_mfma_f32_32x32x16_bf16 v[96:111], a[156:159], a[96:99], v[96:111]
    ds_read_b64_tr_b16 a[152:153], v8 offset:24576
    ds_read_b64_tr_b16 a[154:155], v8 offset:25088
    v_exp_f32 v29, v29
    buffer_load_dwordx4 v23, s[36:39], s57 offen offset:3072 lds
    v_exp_f32 v30, v30
    v_fma_f32 v29, v29, v4, v4
    v_mfma_f32_32x32x16_bf16 v[96:111], a[160:163], a[100:103], v[96:111]
    ds_read_b64_tr_b16 a[156:157], v8 offset:26624
    ds_read_b64_tr_b16 a[158:159], v8 offset:27136
    v_fma_f32 v30, v30, v4, v4
    v_rcp_f32 v29, v29
    v_rcp_f32 v30, v30
    s_waitcnt lgkmcnt(8)
    v_mfma_f32_32x32x16_bf16 v[96:111], a[164:167], a[104:107], v[96:111]
    ds_read_b64_tr_b16 a[160:161], v8 offset:28672
    ds_read_b64_tr_b16 a[162:163], v8 offset:29184
    v_mul_f32 v90, v90, v29
    s_add_u32 m0, s10, 45056
    v_mul_f32 v91, v91, v30
    v_cvt_pk_bf16_f32 v165, v90, v91
    v_mul_f32 v27, v92, v92
    v_mfma_f32_32x32x16_bf16 v[96:111], a[168:171], a[108:111], v[96:111]
    ds_read_b64_tr_b16 a[164:165], v8 offset:30720
    ds_read_b64_tr_b16 a[166:167], v8 offset:31232
    v_mul_f32 v28, v93, v93
    buffer_load_dwordx4 v24, s[36:39], s57 offen offset:0 lds
    v_fma_f32 v27, v27, v26, v25
    v_fma_f32 v28, v28, v26, v25
    v_mul_f32 v27, v27, v92
    v_mul_f32 v28, v28, v93
    s_waitcnt lgkmcnt(8)
    v_mfma_f32_32x32x16_bf16 v[96:111], a[144:147], a[112:115], v[96:111]
    ds_read_b64_tr_b16 a[168:169], v8 offset:32768
    ds_read_b64_tr_b16 a[170:171], v8 offset:33280
    v_exp_f32 v27, v27
    v_exp_f32 v28, v28
    v_mfma_f32_32x32x16_bf16 v[96:111], a[148:151], a[116:119], v[96:111]
    ds_read_b64_tr_b16 a[144:145], v8 offset:34816
    ds_read_b64_tr_b16 a[146:147], v8 offset:35328
    v_fma_f32 v27, v27, v4, v4
    s_add_u32 s27, s50, 1
    s_and_b32 s27, s27, 7
    s_lshl_b32 s27, s27, 7
    s_add_u32 s56, s62, s27
    s_add_u32 s57, s63, s27
    v_fma_f32 v28, v28, v4, v4
    v_rcp_f32 v27, v27
    s_waitcnt lgkmcnt(8)
    v_mfma_f32_32x32x16_bf16 v[96:111], a[152:155], a[120:123], v[96:111]
    ds_read_b64_tr_b16 a[148:149], v15 offset:0
    ds_read_b64_tr_b16 a[150:151], v15 offset:512
    v_rcp_f32 v28, v28
    s_add_u32 m0, s10, 73728
    v_mul_f32 v92, v92, v27
    v_mul_f32 v93, v93, v28
    v_cvt_pk_bf16_f32 v166, v92, v93
    v_mul_f32 v29, v94, v94
    v_mfma_f32_32x32x16_bf16 v[96:111], a[156:159], a[124:127], v[96:111]
    ds_read_b64_tr_b16 a[152:153], v15 offset:2048
    ds_read_b64_tr_b16 a[154:155], v15 offset:2560
    v_mul_f32 v30, v95, v95
    v_fma_f32 v29, v29, v26, v25
    v_fma_f32 v30, v30, v26, v25
    v_mul_f32 v29, v29, v94
    s_waitcnt lgkmcnt(8)
    v_mfma_f32_32x32x16_bf16 v[96:111], a[160:163], a[128:131], v[96:111]
    ds_read_b64_tr_b16 a[156:157], v15 offset:4096
    ds_read_b64_tr_b16 a[158:159], v15 offset:4608
    v_mul_f32 v30, v30, v95
    buffer_load_dwordx4 v16, s[36:39], s56 offen offset:0 lds
    v_exp_f32 v29, v29
    v_exp_f32 v30, v30
    v_mfma_f32_32x32x16_bf16 v[96:111], a[164:167], a[132:135], v[96:111]
    ds_read_b64_tr_b16 a[160:161], v15 offset:6144
    ds_read_b64_tr_b16 a[162:163], v15 offset:6656
    v_fma_f32 v29, v29, v4, v4
    v_fma_f32 v30, v30, v4, v4
    v_rcp_f32 v29, v29
    s_waitcnt lgkmcnt(8)
    v_mfma_f32_32x32x16_bf16 v[96:111], a[168:171], a[136:139], v[96:111]
    ds_read_b64_tr_b16 a[164:165], v15 offset:8192
    ds_read_b64_tr_b16 a[166:167], v15 offset:8704
    v_rcp_f32 v30, v30
    buffer_load_dwordx4 v17, s[36:39], s56 offen offset:1024 lds
    v_mul_f32 v94, v94, v29
    v_mul_f32 v95, v95, v30
    v_cvt_pk_bf16_f32 v167, v94, v95
    v_mfma_f32_32x32x16_bf16 v[96:111], a[144:147], a[140:143], v[96:111]
    ds_read_b64_tr_b16 a[168:169], v15 offset:10240
    ds_read_b64_tr_b16 a[170:171], v15 offset:10752
    s_waitcnt lgkmcnt(8)
    v_mfma_f32_32x32x16_bf16 v[80:95], a[148:151], a[0:3], 0
    ds_read_b64_tr_b16 a[144:145], v15 offset:12288
    ds_read_b64_tr_b16 a[146:147], v15 offset:12800
    buffer_load_dwordx4 v18, s[36:39], s56 offen offset:2048 lds
    v_mfma_f32_32x32x16_bf16 v[80:95], a[152:155], a[4:7], v[80:95]
    ds_read_b64_tr_b16 a[148:149], v15 offset:14336
    ds_read_b64_tr_b16 a[150:151], v15 offset:14848
    s_waitcnt lgkmcnt(8)
    v_mfma_f32_32x32x16_bf16 v[80:95], a[156:159], a[8:11], v[80:95]
    ds_read_b64_tr_b16 a[152:153], v15 offset:16384
    ds_read_b64_tr_b16 a[154:155], v15 offset:16896
    buffer_load_dwordx4 v19, s[36:39], s56 offen offset:3072 lds
    v_mul_f32 v27, v96, v96
    v_mul_f32 v28, v97, v97
    v_fma_f32 v27, v27, v26, v25
    v_fma_f32 v28, v28, v26, v25
    v_mul_f32 v27, v27, v96
    v_mfma_f32_32x32x16_bf16 v[80:95], a[160:163], a[12:15], v[80:95]
    ds_read_b64_tr_b16 a[156:157], v15 offset:18432
    ds_read_b64_tr_b16 a[158:159], v15 offset:18944
    s_add_u32 m0, s10, 77824
    v_mul_f32 v28, v28, v97
    v_exp_f32 v27, v27
    v_exp_f32 v28, v28
    s_waitcnt lgkmcnt(8)
    v_mfma_f32_32x32x16_bf16 v[80:95], a[164:167], a[16:19], v[80:95]
    ds_read_b64_tr_b16 a[160:161], v15 offset:20480
    ds_read_b64_tr_b16 a[162:163], v15 offset:20992
    v_fma_f32 v27, v27, v4, v4
    v_fma_f32 v28, v28, v4, v4
    v_rcp_f32 v27, v27
    v_mfma_f32_32x32x16_bf16 v[80:95], a[168:171], a[20:23], v[80:95]
    ds_read_b64_tr_b16 a[164:165], v15 offset:22528
    ds_read_b64_tr_b16 a[166:167], v15 offset:23040
    buffer_load_dwordx4 v20, s[36:39], s57 offen offset:0 lds
    v_rcp_f32 v28, v28
    v_mul_f32 v96, v96, v27
    v_mul_f32 v97, v97, v28
    s_waitcnt lgkmcnt(8)
    v_mfma_f32_32x32x16_bf16 v[80:95], a[144:147], a[24:27], v[80:95]
    ds_read_b64_tr_b16 a[168:169], v15 offset:24576
    ds_read_b64_tr_b16 a[170:171], v15 offset:25088
    v_cvt_pk_bf16_f32 v168, v96, v97
    v_mul_f32 v29, v98, v98
    v_mul_f32 v30, v99, v99
    v_fma_f32 v29, v29, v26, v25
    v_fma_f32 v30, v30, v26, v25
    v_mfma_f32_32x32x16_bf16 v[80:95], a[148:151], a[28:31], v[80:95]
    ds_read_b64_tr_b16 a[144:145], v15 offset:26624
    ds_read_b64_tr_b16 a[146:147], v15 offset:27136
    buffer_load_dwordx4 v21, s[36:39], s57 offen offset:1024 lds
    v_mul_f32 v29, v29, v98
    v_mul_f32 v30, v30, v99
    v_exp_f32 v29, v29
    s_waitcnt lgkmcnt(8)
    v_mfma_f32_32x32x16_bf16 v[80:95], a[152:155], a[32:35], v[80:95]
    ds_read_b64_tr_b16 a[148:149], v15 offset:28672
    ds_read_b64_tr_b16 a[150:151], v15 offset:29184
    v_exp_f32 v30, v30
    v_fma_f32 v29, v29, v4, v4
    v_fma_f32 v30, v30, v4, v4
    v_rcp_f32 v29, v29
    v_mfma_f32_32x32x16_bf16 v[80:95], a[156:159], a[36:39], v[80:95]
    ds_read_b64_tr_b16 a[152:153], v15 offset:30720
    ds_read_b64_tr_b16 a[154:155], v15 offset:31232
    buffer_load_dwordx4 v22, s[36:39], s57 offen offset:2048 lds
    v_rcp_f32 v30, v30
    v_mul_f32 v98, v98, v29
    v_mul_f32 v99, v99, v30
    s_waitcnt lgkmcnt(8)
    v_mfma_f32_32x32x16_bf16 v[80:95], a[160:163], a[40:43], v[80:95]
    ds_read_b64_tr_b16 a[156:157], v15 offset:32768
    ds_read_b64_tr_b16 a[158:159], v15 offset:33280
    v_cvt_pk_bf16_f32 v169, v98, v99
    v_mul_f32 v27, v100, v100
    v_mul_f32 v28, v101, v101
    v_fma_f32 v27, v27, v26, v25
    v_mfma_f32_32x32x16_bf16 v[80:95], a[164:167], a[44:47], v[80:95]
    ds_read_b64_tr_b16 a[160:161], v15 offset:34816
    ds_read_b64_tr_b16 a[162:163], v15 offset:35328
    buffer_load_dwordx4 v23, s[36:39], s57 offen offset:3072 lds
    v_fma_f32 v28, v28, v26, v25
    v_mul_f32 v27, v27, v100
    v_mul_f32 v28, v28, v101
    v_exp_f32 v27, v27
    s_waitcnt lgkmcnt(8)
    v_mfma_f32_32x32x16_bf16 v[80:95], a[168:171], a[48:51], v[80:95]
    ds_read_b64_tr_b16 a[164:165], v9 offset:0
    ds_read_b64_tr_b16 a[166:167], v9 offset:512
    s_add_u32 m0, s10, 81920
    v_exp_f32 v28, v28
    v_fma_f32 v27, v27, v4, v4
    v_fma_f32 v28, v28, v4, v4
    v_mfma_f32_32x32x16_bf16 v[80:95], a[144:147], a[52:55], v[80:95]
    ds_read_b64_tr_b16 a[168:169], v9 offset:2048
    ds_read_b64_tr_b16 a[170:171], v9 offset:2560
    buffer_load_dwordx4 v24, s[36:39], s57 offen offset:0 lds
    v_rcp_f32 v27, v27
    v_rcp_f32 v28, v28
    v_mul_f32 v100, v100, v27
    s_waitcnt lgkmcnt(8)
    v_mfma_f32_32x32x16_bf16 v[80:95], a[148:151], a[56:59], v[80:95]
    ds_read_b64_tr_b16 a[144:145], v9 offset:4096
    ds_read_b64_tr_b16 a[146:147], v9 offset:4608
    v_mul_f32 v101, v101, v28
    v_cvt_pk_bf16_f32 v170, v100, v101
    v_mul_f32 v29, v102, v102
    v_mul_f32 v30, v103, v103
    v_fma_f32 v29, v29, v26, v25
    v_mfma_f32_32x32x16_bf16 v[80:95], a[152:155], a[60:63], v[80:95]
    ds_read_b64_tr_b16 a[148:149], v9 offset:6144
    ds_read_b64_tr_b16 a[150:151], v9 offset:6656
    v_fma_f32 v30, v30, v26, v25
    v_mul_f32 v29, v29, v102
    v_mul_f32 v30, v30, v103
    v_exp_f32 v29, v29
    s_waitcnt lgkmcnt(8)
    v_mfma_f32_32x32x16_bf16 v[80:95], a[156:159], a[64:67], v[80:95]
    ds_read_b64_tr_b16 a[152:153], v9 offset:8192
    ds_read_b64_tr_b16 a[154:155], v9 offset:8704
    v_exp_f32 v30, v30
    v_fma_f32 v29, v29, v4, v4
    v_fma_f32 v30, v30, v4, v4
    v_mfma_f32_32x32x16_bf16 v[80:95], a[160:163], a[68:71], v[80:95]
    ds_read_b64_tr_b16 a[156:157], v9 offset:10240
    ds_read_b64_tr_b16 a[158:159], v9 offset:10752
    v_rcp_f32 v29, v29
    v_rcp_f32 v30, v30
    v_mul_f32 v102, v102, v29
    s_waitcnt lgkmcnt(8)
    v_mfma_f32_32x32x16_bf16 v[80:95], a[164:167], a[72:75], v[80:95]
    ds_read_b64_tr_b16 a[160:161], v9 offset:12288
    ds_read_b64_tr_b16 a[162:163], v9 offset:12800
    v_mul_f32 v103, v103, v30
    v_cvt_pk_bf16_f32 v171, v102, v103
    v_mul_f32 v27, v104, v104
    v_mul_f32 v28, v105, v105
    v_mfma_f32_32x32x16_bf16 v[80:95], a[168:171], a[76:79], v[80:95]
    ds_read_b64_tr_b16 a[164:165], v9 offset:14336
    ds_read_b64_tr_b16 a[166:167], v9 offset:14848
    v_fma_f32 v27, v27, v26, v25
    v_fma_f32 v28, v28, v26, v25
    v_mul_f32 v27, v27, v104
    v_mul_f32 v28, v28, v105
    s_waitcnt lgkmcnt(8)
    v_mfma_f32_32x32x16_bf16 v[80:95], a[144:147], a[80:83], v[80:95]
    ds_read_b64_tr_b16 a[168:169], v9 offset:16384
    ds_read_b64_tr_b16 a[170:171], v9 offset:16896
    v_exp_f32 v27, v27
    v_exp_f32 v28, v28
    v_fma_f32 v27, v27, v4, v4
    v_fma_f32 v28, v28, v4, v4
    v_mfma_f32_32x32x16_bf16 v[80:95], a[148:151], a[84:87], v[80:95]
    ds_read_b64_tr_b16 a[144:145], v9 offset:18432
    ds_read_b64_tr_b16 a[146:147], v9 offset:18944
    v_rcp_f32 v27, v27
    v_rcp_f32 v28, v28
    s_waitcnt lgkmcnt(8)
    v_mfma_f32_32x32x16_bf16 v[80:95], a[152:155], a[88:91], v[80:95]
    ds_read_b64_tr_b16 a[148:149], v9 offset:20480
    ds_read_b64_tr_b16 a[150:151], v9 offset:20992
    v_mul_f32 v104, v104, v27
    v_mul_f32 v105, v105, v28
    v_cvt_pk_bf16_f32 v172, v104, v105
    v_mul_f32 v29, v106, v106
    v_mul_f32 v30, v107, v107
    v_mfma_f32_32x32x16_bf16 v[80:95], a[156:159], a[92:95], v[80:95]
    ds_read_b64_tr_b16 a[152:153], v9 offset:22528
    ds_read_b64_tr_b16 a[154:155], v9 offset:23040
    v_fma_f32 v29, v29, v26, v25
    v_fma_f32 v30, v30, v26, v25
    v_mul_f32 v29, v29, v106
    v_mul_f32 v30, v30, v107
    s_waitcnt lgkmcnt(8)
    v_mfma_f32_32x32x16_bf16 v[80:95], a[160:163], a[96:99], v[80:95]
    ds_read_b64_tr_b16 a[156:157], v9 offset:24576
    ds_read_b64_tr_b16 a[158:159], v9 offset:25088
    v_exp_f32 v29, v29
    v_exp_f32 v30, v30
    v_fma_f32 v29, v29, v4, v4
    v_mfma_f32_32x32x16_bf16 v[80:95], a[164:167], a[100:103], v[80:95]
    ds_read_b64_tr_b16 a[160:161], v9 offset:26624
    ds_read_b64_tr_b16 a[162:163], v9 offset:27136
    v_fma_f32 v30, v30, v4, v4
    v_rcp_f32 v29, v29
    v_rcp_f32 v30, v30
    s_waitcnt lgkmcnt(8)
    v_mfma_f32_32x32x16_bf16 v[80:95], a[168:171], a[104:107], v[80:95]
    ds_read_b64_tr_b16 a[164:165], v9 offset:28672
    ds_read_b64_tr_b16 a[166:167], v9 offset:29184
    v_mul_f32 v106, v106, v29
    v_mul_f32 v107, v107, v30
    v_cvt_pk_bf16_f32 v173, v106, v107
    v_mul_f32 v27, v108, v108
    v_mfma_f32_32x32x16_bf16 v[80:95], a[144:147], a[108:111], v[80:95]
    ds_read_b64_tr_b16 a[168:169], v9 offset:30720
    ds_read_b64_tr_b16 a[170:171], v9 offset:31232
    v_mul_f32 v28, v109, v109
    v_fma_f32 v27, v27, v26, v25
    v_fma_f32 v28, v28, v26, v25
    v_mul_f32 v27, v27, v108
    v_mul_f32 v28, v28, v109
    s_waitcnt lgkmcnt(8)
    v_mfma_f32_32x32x16_bf16 v[80:95], a[148:151], a[112:115], v[80:95]
    ds_read_b64_tr_b16 a[144:145], v9 offset:32768
    ds_read_b64_tr_b16 a[146:147], v9 offset:33280
    v_exp_f32 v27, v27
    v_exp_f32 v28, v28
    v_mfma_f32_32x32x16_bf16 v[80:95], a[152:155], a[116:119], v[80:95]
    ds_read_b64_tr_b16 a[148:149], v9 offset:34816
    ds_read_b64_tr_b16 a[150:151], v9 offset:35328
    v_fma_f32 v27, v27, v4, v4
    v_fma_f32 v28, v28, v4, v4
    v_rcp_f32 v27, v27
    s_waitcnt lgkmcnt(8)
    v_mfma_f32_32x32x16_bf16 v[80:95], a[156:159], a[120:123], v[80:95]
    v_rcp_f32 v28, v28
    v_mul_f32 v108, v108, v27
    v_mul_f32 v109, v109, v28
    v_cvt_pk_bf16_f32 v174, v108, v109
    v_mul_f32 v29, v110, v110
    v_mfma_f32_32x32x16_bf16 v[80:95], a[160:163], a[124:127], v[80:95]
    v_mul_f32 v30, v111, v111
    v_fma_f32 v29, v29, v26, v25
    v_fma_f32 v30, v30, v26, v25
    v_mul_f32 v29, v29, v110
    s_waitcnt lgkmcnt(4)
    v_mfma_f32_32x32x16_bf16 v[80:95], a[164:167], a[128:131], v[80:95]
    s_waitcnt lgkmcnt(0)
    s_waitcnt vmcnt(9)
    s_barrier
    s_and_b32 s3, s49, 1
    s_xor_b32 s3, s3, 1
    s_lshl_b32 s3, s3, 6
    v_xor_b32 v8, s3, v8
    v_xor_b32 v9, s3, v9
    v_xor_b32 v10, s3, v10
    v_xor_b32 v11, s3, v11
    v_xor_b32 v12, s3, v12
    v_xor_b32 v13, s3, v13
    v_xor_b32 v14, s3, v14
    v_xor_b32 v15, s3, v15
    ds_read_b64_tr_b16 a[152:153], v10 offset:0
    ds_read_b64_tr_b16 a[154:155], v10 offset:512
    ds_read_b64_tr_b16 a[156:157], v11 offset:0
    ds_read_b64_tr_b16 a[158:159], v11 offset:512
    ds_read_b64_tr_b16 a[160:161], v10 offset:2048
    ds_read_b64_tr_b16 a[162:163], v10 offset:2560
    v_mul_f32 v30, v30, v111
    v_exp_f32 v29, v29
    v_exp_f32 v30, v30
    v_mfma_f32_32x32x16_bf16 v[80:95], a[168:171], a[132:135], v[80:95]
    ds_read_b64_tr_b16 a[164:165], v11 offset:2048
    ds_read_b64_tr_b16 a[166:167], v11 offset:2560
    v_fma_f32 v29, v29, v4, v4
    s_add_u32 s27, s50, 2
    s_and_b32 s27, s27, 7
    s_lshl_b32 s27, s27, 7
    s_add_u32 s56, s62, s27
    s_add_u32 s57, s63, s27
    v_fma_f32 v30, v30, v4, v4
    v_rcp_f32 v29, v29
    v_mfma_f32_32x32x16_bf16 v[80:95], a[144:147], a[136:139], v[80:95]
    ds_read_b64_tr_b16 a[168:169], v10 offset:4096
    ds_read_b64_tr_b16 a[170:171], v10 offset:4608
    v_rcp_f32 v30, v30
    s_add_u32 m0, s10, 110592
    v_mul_f32 v110, v110, v29
    v_mul_f32 v111, v111, v30
    v_cvt_pk_bf16_f32 v175, v110, v111
    v_mfma_f32_32x32x16_bf16 v[80:95], a[148:151], a[140:143], v[80:95]
    ds_read_b64_tr_b16 a[144:145], v11 offset:4096
    ds_read_b64_tr_b16 a[146:147], v11 offset:4608
    buffer_load_dwordx4 v16, s[36:39], s56 offen offset:0 lds
    s_waitcnt lgkmcnt(8)
    v_mfma_f32_32x32x16_bf16 v[96:111], a[152:155], v[112:115], 0
    ds_read_b64_tr_b16 a[148:149], v10 offset:6144
    ds_read_b64_tr_b16 a[150:151], v10 offset:6656
    v_mfma_f32_32x32x16_bf16 v[64:79], a[156:159], v[112:115], 0
    ds_read_b64_tr_b16 a[152:153], v11 offset:6144
    ds_read_b64_tr_b16 a[154:155], v11 offset:6656
    buffer_load_dwordx4 v17, s[36:39], s56 offen offset:1024 lds
    s_waitcnt lgkmcnt(8)
    v_mfma_f32_32x32x16_bf16 v[96:111], a[160:163], v[116:119], v[96:111]
    ds_read_b64_tr_b16 a[156:157], v10 offset:8192
    ds_read_b64_tr_b16 a[158:159], v10 offset:8704
    v_mul_f32 v27, v80, v80
    v_mul_f32 v28, v81, v81
    v_fma_f32 v27, v27, v26, v25
    v_fma_f32 v28, v28, v26, v25
    v_mul_f32 v27, v27, v80
    v_mfma_f32_32x32x16_bf16 v[64:79], a[164:167], v[116:119], v[64:79]
    ds_read_b64_tr_b16 a[160:161], v11 offset:8192
    ds_read_b64_tr_b16 a[162:163], v11 offset:8704
    v_mul_f32 v28, v28, v81
    buffer_load_dwordx4 v18, s[36:39], s56 offen offset:2048 lds
    v_exp_f32 v27, v27
    v_exp_f32 v28, v28
    v_fma_f32 v27, v27, v4, v4
    s_waitcnt lgkmcnt(8)
    v_mfma_f32_32x32x16_bf16 v[96:111], a[168:171], v[120:123], v[96:111]
    ds_read_b64_tr_b16 a[164:165], v10 offset:10240
    ds_read_b64_tr_b16 a[166:167], v10 offset:10752
    v_fma_f32 v28, v28, v4, v4
    buffer_load_dwordx4 v19, s[36:39], s56 offen offset:3072 lds
    v_rcp_f32 v27, v27
    v_rcp_f32 v28, v28
    v_mfma_f32_32x32x16_bf16 v[64:79], a[144:147], v[120:123], v[64:79]
    ds_read_b64_tr_b16 a[168:169], v11 offset:10240
    ds_read_b64_tr_b16 a[170:171], v11 offset:10752
    v_mul_f32 v80, v80, v27
    s_add_u32 m0, s10, 114688
    v_mul_f32 v81, v81, v28
    v_cvt_pk_bf16_f32 v176, v80, v81
    v_mul_f32 v29, v82, v82
    v_mul_f32 v30, v83, v83
    v_fma_f32 v29, v29, v26, v25
    s_waitcnt lgkmcnt(8)
    v_mfma_f32_32x32x16_bf16 v[96:111], a[148:151], v[124:127], v[96:111]
    ds_read_b64_tr_b16 a[144:145], v10 offset:12288
    ds_read_b64_tr_b16 a[146:147], v10 offset:12800
    v_fma_f32 v30, v30, v26, v25
    buffer_load_dwordx4 v20, s[36:39], s57 offen offset:0 lds
    v_mul_f32 v29, v29, v82
    v_mul_f32 v30, v30, v83
    v_exp_f32 v29, v29
    v_mfma_f32_32x32x16_bf16 v[64:79], a[152:155], v[124:127], v[64:79]
    ds_read_b64_tr_b16 a[148:149], v11 offset:12288
    ds_read_b64_tr_b16 a[150:151], v11 offset:12800
    v_exp_f32 v30, v30
    v_fma_f32 v29, v29, v4, v4
    v_fma_f32 v30, v30, v4, v4
    v_rcp_f32 v29, v29
    s_waitcnt lgkmcnt(8)
    v_mfma_f32_32x32x16_bf16 v[96:111], a[156:159], v[128:131], v[96:111]
    ds_read_b64_tr_b16 a[152:153], v10 offset:14336
    ds_read_b64_tr_b16 a[154:155], v10 offset:14848
    v_rcp_f32 v30, v30
    buffer_load_dwordx4 v21, s[36:39], s57 offen offset:1024 lds
    v_mul_f32 v82, v82, v29
    v_mul_f32 v83, v83, v30
    v_cvt_pk_bf16_f32 v177, v82, v83
    v_mfma_f32_32x32x16_bf16 v[64:79], a[160:163], v[128:131], v[64:79]
    ds_read_b64_tr_b16 a[156:157], v11 offset:14336
    ds_read_b64_tr_b16 a[158:159], v11 offset:14848
    v_mul_f32 v27, v84, v84
    v_mul_f32 v28, v85, v85
    v_fma_f32 v27, v27, v26, v25
    v_fma_f32 v28, v28, v26, v25
    v_mul_f32 v27, v27, v84
    s_waitcnt lgkmcnt(8)
    v_mfma_f32_32x32x16_bf16 v[96:111], a[164:167], v[132:135], v[96:111]
    ds_read_b64_tr_b16 a[160:161], v10 offset:16384
    ds_read_b64_tr_b16 a[162:163], v10 offset:16896
    v_mul_f32 v28, v28, v85
    buffer_load_dwordx4 v22, s[36:39], s57 offen offset:2048 lds
    v_exp_f32 v27, v27
    v_exp_f32 v28, v28
    v_fma_f32 v27, v27, v4, v4
    v_mfma_f32_32x32x16_bf16 v[64:79], a[168:171], v[132:135], v[64:79]
    ds_read_b64_tr_b16 a[164:165], v11 offset:16384
    ds_read_b64_tr_b16 a[166:167], v11 offset:16896
    v_fma_f32 v28, v28, v4, v4
    buffer_load_dwordx4 v23, s[36:39], s57 offen offset:3072 lds
    v_rcp_f32 v27, v27
    v_rcp_f32 v28, v28
    s_waitcnt lgkmcnt(8)
    v_mfma_f32_32x32x16_bf16 v[96:111], a[144:147], v[136:139], v[96:111]
    ds_read_b64_tr_b16 a[168:169], v10 offset:18432
    ds_read_b64_tr_b16 a[170:171], v10 offset:18944
    v_mul_f32 v84, v84, v27
    s_add_u32 m0, s10, 118784
    v_mul_f32 v85, v85, v28
    v_cvt_pk_bf16_f32 v178, v84, v85
    v_mul_f32 v29, v86, v86
    v_mul_f32 v30, v87, v87
    v_fma_f32 v29, v29, v26, v25
    v_mfma_f32_32x32x16_bf16 v[64:79], a[148:151], v[136:139], v[64:79]
    ds_read_b64_tr_b16 a[144:145], v11 offset:18432
    ds_read_b64_tr_b16 a[146:147], v11 offset:18944
    v_fma_f32 v30, v30, v26, v25
    buffer_load_dwordx4 v24, s[36:39], s57 offen offset:0 lds
    v_mul_f32 v29, v29, v86
    v_mul_f32 v30, v30, v87
    v_exp_f32 v29, v29
    s_waitcnt lgkmcnt(8)
    v_mfma_f32_32x32x16_bf16 v[96:111], a[152:155], v[140:143], v[96:111]
    ds_read_b64_tr_b16 a[148:149], v10 offset:20480
    ds_read_b64_tr_b16 a[150:151], v10 offset:20992
    v_exp_f32 v30, v30
    v_fma_f32 v29, v29, v4, v4
    v_fma_f32 v30, v30, v4, v4
    v_rcp_f32 v29, v29
    v_mfma_f32_32x32x16_bf16 v[64:79], a[156:159], v[140:143], v[64:79]
    ds_read_b64_tr_b16 a[152:153], v11 offset:20480
    ds_read_b64_tr_b16 a[154:155], v11 offset:20992
    v_rcp_f32 v30, v30
    s_add_u32 s27, s50, 3
    s_and_b32 s27, s27, 7
    s_lshl_b32 s27, s27, 7
    s_add_u32 s56, s62, s27
    s_add_u32 s57, s63, s27
    v_mul_f32 v86, v86, v29
    v_mul_f32 v87, v87, v30
    v_cvt_pk_bf16_f32 v179, v86, v87
    s_waitcnt lgkmcnt(8)
    v_mfma_f32_32x32x16_bf16 v[96:111], a[160:163], v[144:147], v[96:111]
    ds_read_b64_tr_b16 a[156:157], v10 offset:22528
    ds_read_b64_tr_b16 a[158:159], v10 offset:23040
    v_mul_f32 v27, v88, v88
    s_add_u32 m0, s10, 0
    v_mul_f32 v28, v89, v89
    v_fma_f32 v27, v27, v26, v25
    v_fma_f32 v28, v28, v26, v25
    v_mul_f32 v27, v27, v88
    v_mfma_f32_32x32x16_bf16 v[64:79], a[164:167], v[144:147], v[64:79]
    ds_read_b64_tr_b16 a[160:161], v11 offset:22528
    ds_read_b64_tr_b16 a[162:163], v11 offset:23040
    v_mul_f32 v28, v28, v89
    buffer_load_dwordx4 v16, s[36:39], s56 offen offset:0 lds
    v_exp_f32 v27, v27
    v_exp_f32 v28, v28
    v_fma_f32 v27, v27, v4, v4
    s_waitcnt lgkmcnt(8)
    v_mfma_f32_32x32x16_bf16 v[96:111], a[168:171], v[148:151], v[96:111]
    ds_read_b64_tr_b16 a[164:165], v10 offset:24576
    ds_read_b64_tr_b16 a[166:167], v10 offset:25088
    v_fma_f32 v28, v28, v4, v4
    buffer_load_dwordx4 v17, s[36:39], s56 offen offset:1024 lds
    v_rcp_f32 v27, v27
    v_rcp_f32 v28, v28
    v_mfma_f32_32x32x16_bf16 v[64:79], a[144:147], v[148:151], v[64:79]
    ds_read_b64_tr_b16 a[168:169], v11 offset:24576
    ds_read_b64_tr_b16 a[170:171], v11 offset:25088
    v_mul_f32 v88, v88, v27
    v_mul_f32 v89, v89, v28
    v_cvt_pk_bf16_f32 v180, v88, v89
    v_mul_f32 v29, v90, v90
    v_mul_f32 v30, v91, v91
    v_fma_f32 v29, v29, v26, v25
    s_waitcnt lgkmcnt(8)
    v_mfma_f32_32x32x16_bf16 v[96:111], a[148:151], v[152:155], v[96:111]
    ds_read_b64_tr_b16 a[144:145], v10 offset:26624
    ds_read_b64_tr_b16 a[146:147], v10 offset:27136
    v_fma_f32 v30, v30, v26, v25
    buffer_load_dwordx4 v18, s[36:39], s56 offen offset:2048 lds
    v_mul_f32 v29, v29, v90
    v_mul_f32 v30, v30, v91
    v_exp_f32 v29, v29
    v_mfma_f32_32x32x16_bf16 v[64:79], a[152:155], v[152:155], v[64:79]
    ds_read_b64_tr_b16 a[148:149], v11 offset:26624
    ds_read_b64_tr_b16 a[150:151], v11 offset:27136
    v_exp_f32 v30, v30
    v_fma_f32 v29, v29, v4, v4
    v_fma_f32 v30, v30, v4, v4
    v_rcp_f32 v29, v29
    s_waitcnt lgkmcnt(8)
    v_mfma_f32_32x32x16_bf16 v[96:111], a[156:159], v[156:159], v[96:111]
    ds_read_b64_tr_b16 a[152:153], v10 offset:28672
    ds_read_b64_tr_b16 a[154:155], v10 offset:29184
    v_rcp_f32 v30, v30
    buffer_load_dwordx4 v19, s[36:39], s56 offen offset:3072 lds
    v_mul_f32 v90, v90, v29
    v_mul_f32 v91, v91, v30
    v_cvt_pk_bf16_f32 v181, v90, v91
    v_mfma_f32_32x32x16_bf16 v[64:79], a[160:163], v[156:159], v[64:79]
    ds_read_b64_tr_b16 a[156:157], v11 offset:28672
    ds_read_b64_tr_b16 a[158:159], v11 offset:29184
    v_mul_f32 v27, v92, v92
    s_add_u32 m0, s10, 4096
    v_mul_f32 v28, v93, v93
    v_fma_f32 v27, v27, v26, v25
    v_fma_f32 v28, v28, v26, v25
    v_mul_f32 v27, v27, v92
    s_waitcnt lgkmcnt(8)
    v_mfma_f32_32x32x16_bf16 v[96:111], a[164:167], v[160:163], v[96:111]
    ds_read_b64_tr_b16 a[160:161], v10 offset:30720
    ds_read_b64_tr_b16 a[162:163], v10 offset:31232
    v_mul_f32 v28, v28, v93
    buffer_load_dwordx4 v20, s[36:39], s57 offen offset:0 lds
    v_exp_f32 v27, v27
    v_exp_f32 v28, v28
    v_fma_f32 v27, v27, v4, v4
    v_mfma_f32_32x32x16_bf16 v[64:79], a[168:171], v[160:163], v[64:79]
    ds_read_b64_tr_b16 a[164:165], v11 offset:30720
    ds_read_b64_tr_b16 a[166:167], v11 offset:31232
    v_fma_f32 v28, v28, v4, v4
    buffer_load_dwordx4 v21, s[36:39], s57 offen offset:1024 lds
    v_rcp_f32 v27, v27
    v_rcp_f32 v28, v28
    s_waitcnt lgkmcnt(8)
    v_mfma_f32_32x32x16_bf16 v[96:111], a[144:147], v[164:167], v[96:111]
    ds_read_b64_tr_b16 a[168:169], v10 offset:32768
    ds_read_b64_tr_b16 a[170:171], v10 offset:33280
    v_mul_f32 v92, v92, v27
    v_mul_f32 v93, v93, v28
    v_cvt_pk_bf16_f32 v182, v92, v93
    v_mul_f32 v29, v94, v94
    v_mul_f32 v30, v95, v95
    v_fma_f32 v29, v29, v26, v25
    v_mfma_f32_32x32x16_bf16 v[64:79], a[148:151], v[164:167], v[64:79]
    ds_read_b64_tr_b16 a[144:145], v11 offset:32768
    ds_read_b64_tr_b16 a[146:147], v11 offset:33280
    v_fma_f32 v30, v30, v26, v25
    buffer_load_dwordx4 v22, s[36:39], s57 offen offset:2048 lds
    v_mul_f32 v29, v29, v94
    v_mul_f32 v30, v30, v95
    v_exp_f32 v29, v29
    s_waitcnt lgkmcnt(8)
    v_mfma_f32_32x32x16_bf16 v[96:111], a[152:155], v[168:171], v[96:111]
    ds_read_b64_tr_b16 a[148:149], v10 offset:34816
    ds_read_b64_tr_b16 a[150:151], v10 offset:35328
    v_exp_f32 v30, v30
    v_fma_f32 v29, v29, v4, v4
    v_fma_f32 v30, v30, v4, v4
    v_rcp_f32 v29, v29
    v_mfma_f32_32x32x16_bf16 v[64:79], a[156:159], v[168:171], v[64:79]
    ds_read_b64_tr_b16 a[152:153], v11 offset:34816
    ds_read_b64_tr_b16 a[154:155], v11 offset:35328
    v_rcp_f32 v30, v30
    buffer_load_dwordx4 v23, s[36:39], s57 offen offset:3072 lds
    v_mul_f32 v94, v94, v29
    v_mul_f32 v95, v95, v30
    v_cvt_pk_bf16_f32 v183, v94, v95
    s_waitcnt lgkmcnt(8)
    v_mfma_f32_32x32x16_bf16 v[96:111], a[160:163], v[172:175], v[96:111]
    s_add_u32 m0, s10, 8192
    v_mfma_f32_32x32x16_bf16 v[64:79], a[164:167], v[172:175], v[64:79]
    buffer_load_dwordx4 v24, s[36:39], s57 offen offset:0 lds
    s_waitcnt lgkmcnt(4)
    v_mfma_f32_32x32x16_bf16 v[96:111], a[168:171], v[176:179], v[96:111]
    s_waitcnt lgkmcnt(0)
    s_waitcnt vmcnt(18)
    s_barrier
    ds_read_b64_tr_b16 a[156:157], v12 offset:0
    ds_read_b64_tr_b16 a[158:159], v12 offset:512
    ds_read_b64_tr_b16 a[160:161], v12 offset:2048
    ds_read_b64_tr_b16 a[162:163], v12 offset:2560
    ds_read_b64_tr_b16 a[164:165], v12 offset:4096
    ds_read_b64_tr_b16 a[166:167], v12 offset:4608
    v_mfma_f32_32x32x16_bf16 v[64:79], a[144:147], v[176:179], v[64:79]
    ds_read_b64_tr_b16 a[168:169], v12 offset:6144
    ds_read_b64_tr_b16 a[170:171], v12 offset:6656
    v_mfma_f32_32x32x16_bf16 v[96:111], a[148:151], v[180:183], v[96:111]
    ds_read_b64_tr_b16 a[144:145], v12 offset:8192
    ds_read_b64_tr_b16 a[146:147], v12 offset:8704
    s_add_u32 s27, s50, 4
    s_and_b32 s27, s27, 7
    s_lshl_b32 s27, s27, 7
    s_add_u32 s56, s62, s27
    s_add_u32 s57, s63, s27
    v_mfma_f32_32x32x16_bf16 v[64:79], a[152:155], v[180:183], v[64:79]
    ds_read_b64_tr_b16 a[148:149], v12 offset:10240
    ds_read_b64_tr_b16 a[150:151], v12 offset:10752
    s_waitcnt lgkmcnt(8)
    v_mfma_f32_32x32x16_bf16 v[80:95], a[156:159], v[112:115], 0
    ds_read_b64_tr_b16 a[152:153], v12 offset:12288
    ds_read_b64_tr_b16 a[154:155], v12 offset:12800
    s_add_u32 m0, s10, 36864
    v_mfma_f32_32x32x16_bf16 v[80:95], a[160:163], v[116:119], v[80:95]
    ds_read_b64_tr_b16 a[156:157], v12 offset:14336
    ds_read_b64_tr_b16 a[158:159], v12 offset:14848
    s_waitcnt lgkmcnt(8)
    v_mfma_f32_32x32x16_bf16 v[80:95], a[164:167], v[120:123], v[80:95]
    ds_read_b64_tr_b16 a[160:161], v12 offset:16384
    ds_read_b64_tr_b16 a[162:163], v12 offset:16896
    v_cvt_pk_bf16_f32 v184, v96, v97
    buffer_load_dwordx4 v16, s[36:39], s56 offen offset:0 lds
    v_cvt_pk_bf16_f32 v185, v98, v99
    v_mfma_f32_32x32x16_bf16 v[80:95], a[168:171], v[124:127], v[80:95]
    ds_read_b64_tr_b16 a[164:165], v12 offset:18432
    ds_read_b64_tr_b16 a[166:167], v12 offset:18944
    v_cvt_pk_bf16_f32 v186, v100, v101
    v_cvt_pk_bf16_f32 v187, v102, v103
    s_waitcnt lgkmcnt(8)
    v_mfma_f32_32x32x16_bf16 v[80:95], a[144:147], v[128:131], v[80:95]
    ds_read_b64_tr_b16 a[168:169], v12 offset:20480
    ds_read_b64_tr_b16 a[170:171], v12 offset:20992
    s_add_u32 s64, s12, 2097152
    v_mfma_f32_32x32x16_bf16 v[80:95], a[148:151], v[132:135], v[80:95]
    ds_read_b64_tr_b16 a[144:145], v12 offset:22528
    ds_read_b64_tr_b16 a[146:147], v12 offset:23040
    buffer_store_dwordx4 v[184:187], v2, s[28:31], s64 offen sc1
    buffer_load_dwordx4 v17, s[36:39], s56 offen offset:1024 lds
    s_waitcnt lgkmcnt(8)
    v_mfma_f32_32x32x16_bf16 v[80:95], a[152:155], v[136:139], v[80:95]
    ds_read_b64_tr_b16 a[148:149], v12 offset:24576
    ds_read_b64_tr_b16 a[150:151], v12 offset:25088
    v_cvt_pk_bf16_f32 v188, v104, v105
    v_cvt_pk_bf16_f32 v189, v106, v107
    v_mfma_f32_32x32x16_bf16 v[80:95], a[156:159], v[140:143], v[80:95]
    ds_read_b64_tr_b16 a[152:153], v12 offset:26624
    ds_read_b64_tr_b16 a[154:155], v12 offset:27136
    v_cvt_pk_bf16_f32 v190, v108, v109
    v_cvt_pk_bf16_f32 v191, v110, v111
    s_waitcnt lgkmcnt(8)
    v_mfma_f32_32x32x16_bf16 v[80:95], a[160:163], v[144:147], v[80:95]
    ds_read_b64_tr_b16 a[156:157], v12 offset:28672
    ds_read_b64_tr_b16 a[158:159], v12 offset:29184
    v_mfma_f32_32x32x16_bf16 v[80:95], a[164:167], v[148:151], v[80:95]
    ds_read_b64_tr_b16 a[160:161], v12 offset:30720
    ds_read_b64_tr_b16 a[162:163], v12 offset:31232
    buffer_store_dwordx4 v[188:191], v2, s[28:31], s64 offen offset:1024 sc1
    buffer_load_dwordx4 v18, s[36:39], s56 offen offset:2048 lds
    s_waitcnt lgkmcnt(8)
    v_mfma_f32_32x32x16_bf16 v[80:95], a[168:171], v[152:155], v[80:95]
    ds_read_b64_tr_b16 a[164:165], v12 offset:32768
    ds_read_b64_tr_b16 a[166:167], v12 offset:33280
    v_cvt_pk_bf16_f32 v192, v64, v65
    s_and_b32 s0, s46, 1
    v_cvt_pk_bf16_f32 v193, v66, v67
    s_lshl_b32 s0, s0, 5
    v_mfma_f32_32x32x16_bf16 v[80:95], a[144:147], v[156:159], v[80:95]
    ds_read_b64_tr_b16 a[168:169], v12 offset:34816
    ds_read_b64_tr_b16 a[170:171], v12 offset:35328
    v_cvt_pk_bf16_f32 v194, v68, v69
    s_lshr_b32 s1, s46, 1
    v_cvt_pk_bf16_f32 v195, v70, v71
    s_lshl_b32 s1, s1, 4
    s_add_u32 s64, s13, 2097152
    s_waitcnt lgkmcnt(8)
    v_mfma_f32_32x32x16_bf16 v[80:95], a[148:151], v[160:163], v[80:95]
    ds_read_b64_tr_b16 a[144:145], v13 offset:0
    ds_read_b64_tr_b16 a[146:147], v13 offset:512
    buffer_store_dwordx4 v[192:195], v2, s[28:31], s64 offen sc1
    s_add_u32 s0, s0, s1
    buffer_load_dwordx4 v19, s[36:39], s56 offen offset:3072 lds
    v_and_b32 v48, 15, v1
    v_mfma_f32_32x32x16_bf16 v[80:95], a[152:155], v[164:167], v[80:95]
    ds_read_b64_tr_b16 a[148:149], v13 offset:2048
    ds_read_b64_tr_b16 a[150:151], v13 offset:2560
    v_cvt_pk_bf16_f32 v196, v72, v73
    v_add_u32 v48, s0, v48
    v_lshlrev_b32 v48, 4, v48
    v_lshrrev_b32 v49, 5, v1
    s_waitcnt lgkmcnt(8)
    v_mfma_f32_32x32x16_bf16 v[80:95], a[156:159], v[168:171], v[80:95]
    ds_read_b64_tr_b16 a[152:153], v13 offset:4096
    ds_read_b64_tr_b16 a[154:155], v13 offset:4608
    v_cvt_pk_bf16_f32 v197, v74, v75
    v_mov_b32 v50, 0x600000
    s_add_u32 m0, s10, 40960
    v_cvt_pk_bf16_f32 v198, v76, v77
    v_mul_lo_u32 v50, v49, v50
    v_mfma_f32_32x32x16_bf16 v[80:95], a[160:163], v[172:175], v[80:95]
    ds_read_b64_tr_b16 a[156:157], v13 offset:6144
    ds_read_b64_tr_b16 a[158:159], v13 offset:6656
    v_cvt_pk_bf16_f32 v199, v78, v79
    v_add_u32 v50, v50, v48
    v_lshl_add_u32 v48, v49, 11, v48
    s_waitcnt lgkmcnt(8)
    v_mfma_f32_32x32x16_bf16 v[80:95], a[164:167], v[176:179], v[80:95]
    ds_read_b64_tr_b16 a[160:161], v13 offset:8192
    ds_read_b64_tr_b16 a[162:163], v13 offset:8704
    buffer_store_dwordx4 v[196:199], v2, s[28:31], s64 offen offset:1024 sc1
    v_bfe_u32 v49, v1, 4, 1
    buffer_load_dwordx4 v20, s[36:39], s57 offen offset:0 lds
    v_lshl_add_u32 v50, v49, 27, v50
    v_mfma_f32_32x32x16_bf16 v[80:95], a[168:171], v[180:183], v[80:95]
    ds_read_b64_tr_b16 a[164:165], v13 offset:10240
    ds_read_b64_tr_b16 a[166:167], v13 offset:10752
    s_lshl_b32 s0, s48, 2
    s_lshr_b32 s1, s49, 2
    s_waitcnt lgkmcnt(8)
    v_mfma_f32_32x32x16_bf16 v[96:111], a[144:147], v[112:115], 0
    ds_read_b64_tr_b16 a[168:169], v13 offset:12288
    ds_read_b64_tr_b16 a[170:171], v13 offset:12800
    s_add_u32 s0, s0, s1
    s_mul_i32 s0, s0, 36
    v_mfma_f32_32x32x16_bf16 v[96:111], a[148:151], v[116:119], v[96:111]
    ds_read_b64_tr_b16 a[144:145], v13 offset:14336
    ds_read_b64_tr_b16 a[146:147], v13 offset:14848
    s_and_b32 s1, s49, 3
    buffer_load_dwordx4 v21, s[36:39], s57 offen offset:1024 lds
    s_add_u32 s0, s0, s1
    s_waitcnt lgkmcnt(8)
    v_mfma_f32_32x32x16_bf16 v[96:111], a[152:155], v[120:123], v[96:111]
    ds_read_b64_tr_b16 a[148:149], v13 offset:16384
    ds_read_b64_tr_b16 a[150:151], v13 offset:16896
    v_cvt_pk_bf16_f32 v184, v80, v81
    s_add_u32 s0, s0, 32
    v_cvt_pk_bf16_f32 v185, v82, v83
    s_lshl_b32 s0, s0, 10
    s_add_u32 s0, s0, 0xc00000
    v_mfma_f32_32x32x16_bf16 v[96:111], a[156:159], v[124:127], v[96:111]
    ds_read_b64_tr_b16 a[152:153], v13 offset:18432
    ds_read_b64_tr_b16 a[154:155], v13 offset:18944
    v_cvt_pk_bf16_f32 v186, v84, v85
    v_cvt_pk_bf16_f32 v187, v86, v87
    s_waitcnt lgkmcnt(8)
    v_mfma_f32_32x32x16_bf16 v[96:111], a[160:163], v[128:131], v[96:111]
    ds_read_b64_tr_b16 a[156:157], v13 offset:20480
    ds_read_b64_tr_b16 a[158:159], v13 offset:20992
    s_add_u32 s64, s50, 1
    buffer_load_dwordx4 a[188:191], v50, s[28:31], s0 offen sc1
    s_and_b32 s64, s64, 7
    s_lshl_b32 s64, s64, 18
    v_mfma_f32_32x32x16_bf16 v[96:111], a[164:167], v[132:135], v[96:111]
    ds_read_b64_tr_b16 a[160:161], v13 offset:22528
    ds_read_b64_tr_b16 a[162:163], v13 offset:23040
    s_add_u32 s64, s64, s12
    v_sub_u32 v49, s50, v49
    buffer_load_dwordx4 v22, s[36:39], s57 offen offset:2048 lds
    s_mul_i32 s0, s48, 18
    s_waitcnt lgkmcnt(8)
    v_mfma_f32_32x32x16_bf16 v[96:111], a[168:171], v[136:139], v[96:111]
    ds_read_b64_tr_b16 a[164:165], v13 offset:24576
    ds_read_b64_tr_b16 a[166:167], v13 offset:25088
    buffer_store_dwordx4 v[184:187], v2, s[28:31], s64 offen sc1
    s_bfe_u32 s1, s49, 0x10001
    s_add_u32 s0, s0, s1
    v_mfma_f32_32x32x16_bf16 v[96:111], a[144:147], v[140:143], v[96:111]
    ds_read_b64_tr_b16 a[168:169], v13 offset:26624
    ds_read_b64_tr_b16 a[170:171], v13 offset:27136
    v_cvt_pk_bf16_f32 v188, v88, v89
    s_add_u32 s0, s0, 16
    s_lshl_b32 s0, s0, 2
    s_waitcnt lgkmcnt(8)
    v_mfma_f32_32x32x16_bf16 v[96:111], a[148:151], v[144:147], v[96:111]
    ds_read_b64_tr_b16 a[144:145], v13 offset:28672
    ds_read_b64_tr_b16 a[146:147], v13 offset:29184
    v_cvt_pk_bf16_f32 v189, v90, v91
    s_lshr_b32 s1, s49, 2
    buffer_load_dwordx4 v23, s[36:39], s57 offen offset:3072 lds
    v_cvt_pk_bf16_f32 v190, v92, v93
    s_add_u32 s0, s0, s1
    v_cvt_pk_bf16_f32 v191, v94, v95
    v_mfma_f32_32x32x16_bf16 v[96:111], a[152:155], v[148:151], v[96:111]
    ds_read_b64_tr_b16 a[148:149], v13 offset:30720
    ds_read_b64_tr_b16 a[150:151], v13 offset:31232
    s_lshl_b32 s0, s0, 15
    s_and_b32 s1, s49, 1
    s_lshl_b32 s1, s1, 10
    s_waitcnt lgkmcnt(8)
    v_mfma_f32_32x32x16_bf16 v[96:111], a[156:159], v[152:155], v[96:111]
    ds_read_b64_tr_b16 a[152:153], v13 offset:32768
    ds_read_b64_tr_b16 a[154:155], v13 offset:33280
    buffer_store_dwordx4 v[188:191], v2, s[28:31], s64 offen offset:1024 sc1
    s_add_u32 s0, s0, s1
    s_add_u32 m0, s10, 45056
    s_add_u32 s65, s0, 0x2000000
    v_mfma_f32_32x32x16_bf16 v[96:111], a[160:163], v[156:159], v[96:111]
    ds_read_b64_tr_b16 a[156:157], v13 offset:34816
    ds_read_b64_tr_b16 a[158:159], v13 offset:35328
    s_lshr_b32 s1, s49, 2
    s_lshl_b32 s1, s1, 1
    s_waitcnt lgkmcnt(8)
    v_mfma_f32_32x32x16_bf16 v[96:111], a[164:167], v[160:163], v[96:111]
    s_xor_b32 s1, s1, s48
    buffer_load_dwordx4 v24, s[36:39], s57 offen offset:0 lds
    s_waitcnt vmcnt(8)
    s_and_b32 s66, s1, 7
    v_mfma_f32_32x32x16_bf16 v[96:111], a[168:171], v[164:167], v[96:111]
    s_waitcnt lgkmcnt(4)
    v_mfma_f32_32x32x16_bf16 v[96:111], a[144:147], v[168:171], v[96:111]
    s_waitcnt lgkmcnt(0)
    s_barrier
    ds_read_b64_tr_b16 a[160:161], v14 offset:0
    ds_read_b64_tr_b16 a[162:163], v14 offset:512
    ds_read_b64_tr_b16 a[164:165], v14 offset:2048
    ds_read_b64_tr_b16 a[166:167], v14 offset:2560
    ds_read_b64_tr_b16 a[168:169], v14 offset:4096
    ds_read_b64_tr_b16 a[170:171], v14 offset:4608
    v_mfma_f32_32x32x16_bf16 v[96:111], a[148:151], v[172:175], v[96:111]
    ds_read_b64_tr_b16 a[144:145], v14 offset:6144
    ds_read_b64_tr_b16 a[146:147], v14 offset:6656
    v_mfma_f32_32x32x16_bf16 v[96:111], a[152:155], v[176:179], v[96:111]
    ds_read_b64_tr_b16 a[148:149], v14 offset:8192
    ds_read_b64_tr_b16 a[150:151], v14 offset:8704
    s_add_u32 s27, s50, 5
    s_and_b32 s27, s27, 7
    s_lshl_b32 s27, s27, 7
    s_add_u32 s56, s62, s27
    s_add_u32 s57, s63, s27
    v_mfma_f32_32x32x16_bf16 v[96:111], a[156:159], v[180:183], v[96:111]
    ds_read_b64_tr_b16 a[152:153], v14 offset:10240
    ds_read_b64_tr_b16 a[154:155], v14 offset:10752
    s_waitcnt lgkmcnt(8)
    v_mfma_f32_32x32x16_bf16 v[80:95], a[160:163], v[112:115], 0
    ds_read_b64_tr_b16 a[156:157], v14 offset:12288
    ds_read_b64_tr_b16 a[158:159], v14 offset:12800
    s_lshl_b32 s0, s48, 2
    s_add_u32 m0, s10, 73728
    v_mfma_f32_32x32x16_bf16 v[80:95], a[164:167], v[116:119], v[80:95]
    ds_read_b64_tr_b16 a[160:161], v14 offset:14336
    ds_read_b64_tr_b16 a[162:163], v14 offset:14848
    s_add_u32 s0, s0, s46
    s_waitcnt lgkmcnt(8)
    v_mfma_f32_32x32x16_bf16 v[80:95], a[168:171], v[120:123], v[80:95]
    ds_read_b64_tr_b16 a[164:165], v14 offset:16384
    ds_read_b64_tr_b16 a[166:167], v14 offset:16896
    v_cvt_pk_bf16_f32 v192, v96, v97
    buffer_load_dwordx4 v16, s[36:39], s56 offen offset:0 lds
    v_cvt_pk_bf16_f32 v193, v98, v99
    v_mfma_f32_32x32x16_bf16 v[80:95], a[144:147], v[124:127], v[80:95]
    ds_read_b64_tr_b16 a[168:169], v14 offset:18432
    ds_read_b64_tr_b16 a[170:171], v14 offset:18944
    v_cvt_pk_bf16_f32 v194, v100, v101
    s_mul_i32 s0, s0, 36
    v_cvt_pk_bf16_f32 v195, v102, v103
    s_waitcnt lgkmcnt(8)
    v_mfma_f32_32x32x16_bf16 v[80:95], a[148:151], v[128:131], v[80:95]
    ds_read_b64_tr_b16 a[144:145], v14 offset:20480
    ds_read_b64_tr_b16 a[146:147], v14 offset:20992
    s_add_u32 s64, s50, 1
    s_lshl_b32 s1, s49, 1
    s_and_b32 s64, s64, 7
    s_lshl_b32 s64, s64, 18
    v_mfma_f32_32x32x16_bf16 v[80:95], a[152:155], v[132:135], v[80:95]
    ds_read_b64_tr_b16 a[148:149], v14 offset:22528
    ds_read_b64_tr_b16 a[150:151], v14 offset:23040
    s_add_u32 s64, s64, s13
    s_add_u32 s0, s0, s1
    buffer_load_dwordx4 v17, s[36:39], s56 offen offset:1024 lds
    s_waitcnt lgkmcnt(8)
    v_mfma_f32_32x32x16_bf16 v[80:95], a[156:159], v[136:139], v[80:95]
    ds_read_b64_tr_b16 a[152:153], v14 offset:24576
    ds_read_b64_tr_b16 a[154:155], v14 offset:25088
    s_mov_b64 exec, 0x7
    buffer_store_dword v31, v6, s[28:31], s59 offen sc1
    s_mov_b64 exec, -1
    buffer_store_dwordx4 v[192:195], v2, s[28:31], s64 offen sc1
    v_mfma_f32_32x32x16_bf16 v[80:95], a[160:163], v[140:143], v[80:95]
    ds_read_b64_tr_b16 a[156:157], v14 offset:26624
    ds_read_b64_tr_b16 a[158:159], v14 offset:27136
    v_cvt_pk_bf16_f32 v196, v104, v105
    s_lshl_b32 s0, s0, 10
    s_waitcnt lgkmcnt(8)
    v_mfma_f32_32x32x16_bf16 v[80:95], a[164:167], v[144:147], v[80:95]
    ds_read_b64_tr_b16 a[160:161], v14 offset:28672
    ds_read_b64_tr_b16 a[162:163], v14 offset:29184
    v_cvt_pk_bf16_f32 v197, v106, v107
    s_add_u32 s1, s0, 0xc00000
    v_cvt_pk_bf16_f32 v198, v108, v109
    v_cvt_pk_bf16_f32 v199, v110, v111
    v_mfma_f32_32x32x16_bf16 v[80:95], a[168:171], v[148:151], v[80:95]
    ds_read_b64_tr_b16 a[164:165], v14 offset:30720
    ds_read_b64_tr_b16 a[166:167], v14 offset:31232
    s_add_u32 s0, s0, 0x1200000
    buffer_load_dwordx4 v18, s[36:39], s56 offen offset:2048 lds
    s_waitcnt lgkmcnt(8)
    v_mfma_f32_32x32x16_bf16 v[80:95], a[144:147], v[152:155], v[80:95]
    ds_read_b64_tr_b16 a[168:169], v14 offset:32768
    ds_read_b64_tr_b16 a[170:171], v14 offset:33280
    buffer_store_dwordx4 v[196:199], v2, s[28:31], s64 offen offset:1024 sc1
    v_mfma_f32_32x32x16_bf16 v[80:95], a[148:151], v[156:159], v[80:95]
    ds_read_b64_tr_b16 a[144:145], v14 offset:34816
    ds_read_b64_tr_b16 a[146:147], v14 offset:35328
    s_waitcnt lgkmcnt(8)
    v_mfma_f32_32x32x16_bf16 v[80:95], a[152:155], v[160:163], v[80:95]
    ds_read_b64_tr_b16 a[148:149], v15 offset:0
    ds_read_b64_tr_b16 a[150:151], v15 offset:512
    buffer_load_dwordx4 a[120:123], v2, s[28:31], s1 offen offset:0 sc1
    buffer_load_dwordx4 v19, s[36:39], s56 offen offset:3072 lds
    v_mfma_f32_32x32x16_bf16 v[80:95], a[156:159], v[164:167], v[80:95]
    ds_read_b64_tr_b16 a[152:153], v15 offset:2048
    ds_read_b64_tr_b16 a[154:155], v15 offset:2560
    s_waitcnt lgkmcnt(8)
    v_mfma_f32_32x32x16_bf16 v[80:95], a[160:163], v[168:171], v[80:95]
    ds_read_b64_tr_b16 a[156:157], v15 offset:4096
    ds_read_b64_tr_b16 a[158:159], v15 offset:4608
    s_add_u32 m0, s10, 77824
    v_mfma_f32_32x32x16_bf16 v[80:95], a[164:167], v[172:175], v[80:95]
    ds_read_b64_tr_b16 a[160:161], v15 offset:6144
    ds_read_b64_tr_b16 a[162:163], v15 offset:6656
    s_waitcnt lgkmcnt(8)
    v_mfma_f32_32x32x16_bf16 v[80:95], a[168:171], v[176:179], v[80:95]
    ds_read_b64_tr_b16 a[164:165], v15 offset:8192
    ds_read_b64_tr_b16 a[166:167], v15 offset:8704
    buffer_load_dwordx4 v20, s[36:39], s57 offen offset:0 lds
    v_mfma_f32_32x32x16_bf16 v[80:95], a[144:147], v[180:183], v[80:95]
    ds_read_b64_tr_b16 a[168:169], v15 offset:10240
    ds_read_b64_tr_b16 a[170:171], v15 offset:10752
    s_waitcnt lgkmcnt(8)
    v_mfma_f32_32x32x16_bf16 v[96:111], a[148:151], v[112:115], 0
    ds_read_b64_tr_b16 a[144:145], v15 offset:12288
    ds_read_b64_tr_b16 a[146:147], v15 offset:12800
    buffer_load_dwordx4 a[124:127], v2, s[28:31], s1 offen offset:1024 sc1
    v_mfma_f32_32x32x16_bf16 v[96:111], a[152:155], v[116:119], v[96:111]
    ds_read_b64_tr_b16 a[148:149], v15 offset:14336
    ds_read_b64_tr_b16 a[150:151], v15 offset:14848
    buffer_load_dwordx4 v21, s[36:39], s57 offen offset:1024 lds
    s_waitcnt lgkmcnt(8)
    v_mfma_f32_32x32x16_bf16 v[96:111], a[156:159], v[120:123], v[96:111]
    ds_read_b64_tr_b16 a[152:153], v15 offset:16384
    ds_read_b64_tr_b16 a[154:155], v15 offset:16896
    v_cvt_pk_bf16_f32 v184, v80, v81
    v_cvt_pk_bf16_f32 v185, v82, v83
    v_mfma_f32_32x32x16_bf16 v[96:111], a[160:163], v[124:127], v[96:111]
    ds_read_b64_tr_b16 a[156:157], v15 offset:18432
    ds_read_b64_tr_b16 a[158:159], v15 offset:18944
    v_cvt_pk_bf16_f32 v186, v84, v85
    v_cvt_pk_bf16_f32 v187, v86, v87
    s_waitcnt lgkmcnt(8)
    v_mfma_f32_32x32x16_bf16 v[96:111], a[164:167], v[128:131], v[96:111]
    ds_read_b64_tr_b16 a[160:161], v15 offset:20480
    ds_read_b64_tr_b16 a[162:163], v15 offset:20992
    s_add_u32 s64, s50, 2
    s_add_u32 s15, s50, 1
    s_and_b32 s64, s64, 7
    s_lshl_b32 s64, s64, 18
    v_mfma_f32_32x32x16_bf16 v[96:111], a[168:171], v[132:135], v[96:111]
    ds_read_b64_tr_b16 a[164:165], v15 offset:22528
    ds_read_b64_tr_b16 a[166:167], v15 offset:23040
    s_add_u32 s64, s64, s12
    buffer_load_dwordx4 a[128:131], v2, s[28:31], s0 offen offset:0 sc1
    buffer_load_dwordx4 v22, s[36:39], s57 offen offset:2048 lds
    s_waitcnt lgkmcnt(8)
    v_mfma_f32_32x32x16_bf16 v[96:111], a[144:147], v[136:139], v[96:111]
    ds_read_b64_tr_b16 a[168:169], v15 offset:24576
    ds_read_b64_tr_b16 a[170:171], v15 offset:25088
    buffer_store_dwordx4 v[184:187], v2, s[28:31], s64 offen sc1
    s_and_b32 s15, s15, 7
    v_mfma_f32_32x32x16_bf16 v[96:111], a[148:151], v[140:143], v[96:111]
    ds_read_b64_tr_b16 a[144:145], v15 offset:26624
    ds_read_b64_tr_b16 a[146:147], v15 offset:27136
    v_cvt_pk_bf16_f32 v188, v88, v89
    s_waitcnt lgkmcnt(8)
    v_mfma_f32_32x32x16_bf16 v[96:111], a[152:155], v[144:147], v[96:111]
    ds_read_b64_tr_b16 a[148:149], v15 offset:28672
    ds_read_b64_tr_b16 a[150:151], v15 offset:29184
    v_cvt_pk_bf16_f32 v189, v90, v91
    s_lshl_b32 s15, s15, 10
    buffer_load_dwordx4 v23, s[36:39], s57 offen offset:3072 lds
    v_cvt_pk_bf16_f32 v190, v92, v93
    v_cvt_pk_bf16_f32 v191, v94, v95
    v_mfma_f32_32x32x16_bf16 v[96:111], a[156:159], v[148:151], v[96:111]
    ds_read_b64_tr_b16 a[152:153], v15 offset:30720
    ds_read_b64_tr_b16 a[154:155], v15 offset:31232
    s_waitcnt lgkmcnt(8)
    v_mfma_f32_32x32x16_bf16 v[96:111], a[160:163], v[152:155], v[96:111]
    ds_read_b64_tr_b16 a[156:157], v15 offset:32768
    ds_read_b64_tr_b16 a[158:159], v15 offset:33280
    buffer_store_dwordx4 v[188:191], v2, s[28:31], s64 offen offset:1024 sc1
    s_add_u32 s15, s15, s68
    buffer_load_dwordx4 a[132:135], v2, s[28:31], s0 offen offset:1024 sc1
    s_add_u32 m0, s10, 81920
    v_mfma_f32_32x32x16_bf16 v[96:111], a[164:167], v[156:159], v[96:111]
    ds_read_b64_tr_b16 a[160:161], v15 offset:34816
    ds_read_b64_tr_b16 a[162:163], v15 offset:35328
    s_waitcnt lgkmcnt(8)
    v_mfma_f32_32x32x16_bf16 v[96:111], a[168:171], v[160:163], v[96:111]
    buffer_load_dwordx4 v24, s[36:39], s57 offen offset:0 lds
    s_waitcnt vmcnt(12)
    s_mov_b64 exec, 3
    buffer_store_dword v31, v7, s[28:31], s15 offen sc1
    s_mov_b64 exec, -1
    v_mfma_f32_32x32x16_bf16 v[96:111], a[144:147], v[164:167], v[96:111]
    s_waitcnt lgkmcnt(4)
    v_mfma_f32_32x32x16_bf16 v[96:111], a[148:151], v[168:171], v[96:111]
    s_waitcnt lgkmcnt(0)
    s_barrier
    ds_read_b64_tr_b16 a[164:165], v8 offset:0
    ds_read_b64_tr_b16 a[166:167], v8 offset:512
    ds_read_b64_tr_b16 a[168:169], v8 offset:2048
    ds_read_b64_tr_b16 a[170:171], v8 offset:2560
    ds_read_b64_tr_b16 a[144:145], v8 offset:4096
    ds_read_b64_tr_b16 a[146:147], v8 offset:4608
    v_mfma_f32_32x32x16_bf16 v[96:111], a[152:155], v[172:175], v[96:111]
    ds_read_b64_tr_b16 a[148:149], v8 offset:6144
    ds_read_b64_tr_b16 a[150:151], v8 offset:6656
    v_mfma_f32_32x32x16_bf16 v[96:111], a[156:159], v[176:179], v[96:111]
    ds_read_b64_tr_b16 a[152:153], v8 offset:8192
    ds_read_b64_tr_b16 a[154:155], v8 offset:8704
    s_add_u32 s27, s50, 6
    s_and_b32 s27, s27, 7
    s_lshl_b32 s27, s27, 7
    s_add_u32 s56, s62, s27
    s_add_u32 s57, s63, s27
    v_mfma_f32_32x32x16_bf16 v[96:111], a[160:163], v[180:183], v[96:111]
    ds_read_b64_tr_b16 a[156:157], v8 offset:10240
    ds_read_b64_tr_b16 a[158:159], v8 offset:10752
    s_waitcnt lgkmcnt(8)
    v_mfma_f32_32x32x16_bf16 v[80:95], a[164:167], v[112:115], 0
    ds_read_b64_tr_b16 a[160:161], v8 offset:12288
    ds_read_b64_tr_b16 a[162:163], v8 offset:12800
    s_mov_b32 s40, s20
    s_mov_b32 s41, s21
    s_add_u32 m0, s10, 110592
    v_mfma_f32_32x32x16_bf16 v[80:95], a[168:171], v[116:119], v[80:95]
    ds_read_b64_tr_b16 a[164:165], v8 offset:14336
    ds_read_b64_tr_b16 a[166:167], v8 offset:14848
    s_waitcnt lgkmcnt(8)
    v_mfma_f32_32x32x16_bf16 v[80:95], a[144:147], v[120:123], v[80:95]
    ds_read_b64_tr_b16 a[168:169], v8 offset:16384
    ds_read_b64_tr_b16 a[170:171], v8 offset:16896
    v_cvt_pk_bf16_f32 v192, v96, v97
    s_mov_b32 s42, 2359296
    s_mov_b32 s43, 0x20000
    buffer_load_dwordx4 v16, s[36:39], s56 offen offset:0 lds
    v_cvt_pk_bf16_f32 v193, v98, v99
    v_mfma_f32_32x32x16_bf16 v[80:95], a[148:151], v[124:127], v[80:95]
    ds_read_b64_tr_b16 a[144:145], v8 offset:18432
    ds_read_b64_tr_b16 a[146:147], v8 offset:18944
    v_cvt_pk_bf16_f32 v194, v100, v101
    v_and_b32 v54, 0x1f0, v48
    v_cvt_pk_bf16_f32 v195, v102, v103
    v_lshrrev_b32 v54, 1, v54
    s_waitcnt lgkmcnt(8)
    v_mfma_f32_32x32x16_bf16 v[80:95], a[152:155], v[128:131], v[80:95]
    ds_read_b64_tr_b16 a[148:149], v8 offset:20480
    ds_read_b64_tr_b16 a[150:151], v8 offset:20992
    s_add_u32 s64, s50, 2
    s_lshl_b32 s0, s48, 2
    s_and_b32 s64, s64, 7
    s_lshl_b32 s64, s64, 18
    v_mfma_f32_32x32x16_bf16 v[80:95], a[156:159], v[132:135], v[80:95]
    ds_read_b64_tr_b16 a[152:153], v8 offset:22528
    ds_read_b64_tr_b16 a[154:155], v8 offset:23040
    s_add_u32 s64, s64, s13
    s_lshr_b32 s1, s49, 2
    buffer_load_dwordx4 v17, s[36:39], s56 offen offset:1024 lds
    s_add_u32 s0, s0, s1
    s_waitcnt lgkmcnt(8)
    v_mfma_f32_32x32x16_bf16 v[80:95], a[160:163], v[136:139], v[80:95]
    ds_read_b64_tr_b16 a[156:157], v8 offset:24576
    ds_read_b64_tr_b16 a[158:159], v8 offset:25088
    buffer_store_dwordx4 v[192:195], v2, s[28:31], s64 offen sc1
    s_lshl_b32 s0, s0, 12
    v_mfma_f32_32x32x16_bf16 v[80:95], a[164:167], v[140:143], v[80:95]
    ds_read_b64_tr_b16 a[160:161], v8 offset:26624
    ds_read_b64_tr_b16 a[162:163], v8 offset:27136
    v_cvt_pk_bf16_f32 v196, v104, v105
    s_add_u32 s0, s0, 0x1580000
    s_waitcnt lgkmcnt(8)
    v_mfma_f32_32x32x16_bf16 v[80:95], a[168:171], v[144:147], v[80:95]
    ds_read_b64_tr_b16 a[164:165], v8 offset:28672
    ds_read_b64_tr_b16 a[166:167], v8 offset:29184
    v_cvt_pk_bf16_f32 v197, v106, v107
    v_cvt_pk_bf16_f32 v198, v108, v109
    v_cvt_pk_bf16_f32 v199, v110, v111
    v_mfma_f32_32x32x16_bf16 v[80:95], a[144:147], v[148:151], v[80:95]
    ds_read_b64_tr_b16 a[168:169], v8 offset:30720
    ds_read_b64_tr_b16 a[170:171], v8 offset:31232
    buffer_load_dword v68, v54, s[28:31], s0 offen sc1
    buffer_load_dwordx4 v18, s[36:39], s56 offen offset:2048 lds
    s_waitcnt lgkmcnt(8)
    v_mfma_f32_32x32x16_bf16 v[80:95], a[148:151], v[152:155], v[80:95]
    ds_read_b64_tr_b16 a[144:145], v8 offset:32768
    ds_read_b64_tr_b16 a[146:147], v8 offset:33280
    buffer_store_dwordx4 v[196:199], v2, s[28:31], s64 offen offset:1024 sc1
    v_and_b32 v52, 15, v1
    v_mfma_f32_32x32x16_bf16 v[80:95], a[152:155], v[156:159], v[80:95]
    ds_read_b64_tr_b16 a[148:149], v8 offset:34816
    ds_read_b64_tr_b16 a[150:151], v8 offset:35328
    v_mul_u32_u24 v52, 1152, v52
    s_waitcnt lgkmcnt(8)
    v_mfma_f32_32x32x16_bf16 v[80:95], a[156:159], v[160:163], v[80:95]
    ds_read_b64_tr_b16 a[152:153], v9 offset:0
    ds_read_b64_tr_b16 a[154:155], v9 offset:512
    buffer_load_dword v62, v3, s[28:31], 0 offen sc1
    v_lshrrev_b32 v54, 5, v1
    buffer_load_dwordx4 v19, s[36:39], s56 offen offset:3072 lds
    v_mfma_f32_32x32x16_bf16 v[80:95], a[160:163], v[164:167], v[80:95]
    ds_read_b64_tr_b16 a[156:157], v9 offset:2048
    ds_read_b64_tr_b16 a[158:159], v9 offset:2560
    v_lshl_add_u32 v52, v54, 3, v52
    v_and_b32 v53, 31, v1
    s_waitcnt lgkmcnt(8)
    v_mfma_f32_32x32x16_bf16 v[80:95], a[164:167], v[168:171], v[80:95]
    ds_read_b64_tr_b16 a[160:161], v9 offset:4096
    ds_read_b64_tr_b16 a[162:163], v9 offset:4608
    v_mul_u32_u24 v53, 1152, v53
    s_add_u32 m0, s10, 114688
    v_mfma_f32_32x32x16_bf16 v[80:95], a[168:171], v[172:175], v[80:95]
    ds_read_b64_tr_b16 a[164:165], v9 offset:6144
    ds_read_b64_tr_b16 a[166:167], v9 offset:6656
    v_lshl_add_u32 v53, v54, 4, v53
    s_lshl_b32 s0, s48, 2
    s_waitcnt lgkmcnt(8)
    v_mfma_f32_32x32x16_bf16 v[80:95], a[144:147], v[176:179], v[80:95]
    ds_read_b64_tr_b16 a[168:169], v9 offset:8192
    ds_read_b64_tr_b16 a[170:171], v9 offset:8704
    s_add_u32 s14, s50, 7
    s_lshr_b32 s1, s49, 2
    buffer_load_dwordx4 v20, s[36:39], s57 offen offset:0 lds
    v_mfma_f32_32x32x16_bf16 v[80:95], a[148:151], v[180:183], v[80:95]
    ds_read_b64_tr_b16 a[144:145], v9 offset:10240
    ds_read_b64_tr_b16 a[146:147], v9 offset:10752
    s_add_u32 s0, s0, s1
    s_lshl_b32 s0, s0, 1
    s_waitcnt lgkmcnt(8)
    v_mfma_f32_32x32x16_bf16 v[96:111], a[152:155], v[112:115], 0
    ds_read_b64_tr_b16 a[148:149], v9 offset:12288
    ds_read_b64_tr_b16 a[150:151], v9 offset:12800
    s_and_b32 s14, s14, 7
    s_lshr_b32 s1, s46, 1
    v_mfma_f32_32x32x16_bf16 v[96:111], a[156:159], v[116:119], v[96:111]
    ds_read_b64_tr_b16 a[152:153], v9 offset:14336
    ds_read_b64_tr_b16 a[154:155], v9 offset:14848
    s_lshl_b32 s11, s14, 1
    s_add_u32 s0, s0, s1
    buffer_load_dwordx4 v21, s[36:39], s57 offen offset:1024 lds
    s_waitcnt lgkmcnt(8)
    v_mfma_f32_32x32x16_bf16 v[96:111], a[160:163], v[120:123], v[96:111]
    ds_read_b64_tr_b16 a[156:157], v9 offset:16384
    ds_read_b64_tr_b16 a[158:159], v9 offset:16896
    v_cvt_pk_bf16_f32 v184, v80, v81
    s_mul_i32 s0, s0, 18432
    v_cvt_pk_bf16_f32 v185, v82, v83
    s_and_b32 s1, s49, 3
    v_mfma_f32_32x32x16_bf16 v[96:111], a[164:167], v[124:127], v[96:111]
    ds_read_b64_tr_b16 a[160:161], v9 offset:18432
    ds_read_b64_tr_b16 a[162:163], v9 offset:18944
    s_lshl_b32 s11, 3, s11
    s_or_b32 s11, s11, 0x70000
    v_cvt_pk_bf16_f32 v186, v84, v85
    s_lshl_b32 s1, s1, 5
    v_cvt_pk_bf16_f32 v187, v86, v87
    s_waitcnt lgkmcnt(8)
    v_mfma_f32_32x32x16_bf16 v[96:111], a[168:171], v[128:131], v[96:111]
    ds_read_b64_tr_b16 a[164:165], v9 offset:20480
    ds_read_b64_tr_b16 a[166:167], v9 offset:20992
    s_add_u32 s64, s50, 3
    s_add_u32 s15, s50, 2
    s_add_u32 s0, s0, s1
    s_and_b32 s64, s64, 7
    s_and_b32 s1, s46, 1
    s_lshl_b32 s64, s64, 18
    v_mfma_f32_32x32x16_bf16 v[96:111], a[144:147], v[132:135], v[96:111]
    ds_read_b64_tr_b16 a[168:169], v9 offset:22528
    ds_read_b64_tr_b16 a[170:171], v9 offset:23040
    s_add_u32 s64, s64, s12
    s_lshl_b32 s1, s1, 4
    buffer_load_dwordx4 v22, s[36:39], s57 offen offset:2048 lds
    s_waitcnt lgkmcnt(8)
    v_mfma_f32_32x32x16_bf16 v[96:111], a[148:151], v[136:139], v[96:111]
    ds_read_b64_tr_b16 a[144:145], v9 offset:24576
    ds_read_b64_tr_b16 a[146:147], v9 offset:25088
    s_lshl_b32 s14, s14, 12
    buffer_store_dwordx4 v[184:187], v2, s[28:31], s64 offen sc1
    s_and_b32 s15, s15, 7
    s_add_u32 s4, s0, s1
    v_mfma_f32_32x32x16_bf16 v[96:111], a[152:155], v[140:143], v[96:111]
    ds_read_b64_tr_b16 a[148:149], v9 offset:26624
    ds_read_b64_tr_b16 a[150:151], v9 offset:27136
    s_xor_b32 s14, s14, s67
    v_cvt_pk_bf16_f32 v188, v88, v89
    s_lshl_b32 s0, s48, 2
    s_add_u32 s0, s0, s46
    s_waitcnt lgkmcnt(8)
    v_mfma_f32_32x32x16_bf16 v[96:111], a[156:159], v[144:147], v[96:111]
    ds_read_b64_tr_b16 a[152:153], v9 offset:28672
    ds_read_b64_tr_b16 a[154:155], v9 offset:29184
    v_cvt_pk_bf16_f32 v189, v90, v91
    s_lshl_b32 s15, s15, 10
    s_mul_i32 s0, s0, 36864
    buffer_load_dwordx4 v23, s[36:39], s57 offen offset:3072 lds
    v_cvt_pk_bf16_f32 v190, v92, v93
    v_cvt_pk_bf16_f32 v191, v94, v95
    v_mfma_f32_32x32x16_bf16 v[96:111], a[160:163], v[148:151], v[96:111]
    ds_read_b64_tr_b16 a[156:157], v9 offset:30720
    ds_read_b64_tr_b16 a[158:159], v9 offset:31232
    s_add_u32 s14, s14, s58
    s_lshl_b32 s1, s49, 6
    s_add_u32 s5, s0, s1
    s_waitcnt lgkmcnt(8)
    v_mfma_f32_32x32x16_bf16 v[96:111], a[164:167], v[152:155], v[96:111]
    ds_read_b64_tr_b16 a[160:161], v9 offset:32768
    ds_read_b64_tr_b16 a[162:163], v9 offset:33280
    buffer_store_dwordx4 v[188:191], v2, s[28:31], s64 offen offset:1024 sc1
    s_waitcnt vmcnt(7)
L_fc_38:
    v_cmp_gt_u32 vcc, 1, v62
    s_nop 1
    s_and_b32 s3, vcc_lo, s11
    s_cbranch_scc0 L_fcok_39
    s_add_u32 s61, s61, 1
    s_cmp_gt_u32 s61, 400000
    s_cbranch_scc1 L_fcok_39
    buffer_load_dword v62, v3, s[28:31], 0 offen sc1
    s_waitcnt vmcnt(0)
    s_branch L_fc_38
L_fcok_39:
    s_add_u32 s15, s15, s68
    s_xor_b32 s0, s49, 1
    s_add_u32 m0, s10, 118784
    v_mfma_f32_32x32x16_bf16 v[96:111], a[168:171], v[156:159], v[96:111]
    ds_read_b64_tr_b16 a[164:165], v9 offset:34816
    ds_read_b64_tr_b16 a[166:167], v9 offset:35328
    s_lshl_b32 s0, s0, 11
    buffer_load_dwordx4 a[0:3], v2, s[28:31], s14 offen offset:0 sc1
    s_xor_b32 s0, s0, s67
    s_waitcnt lgkmcnt(8)
    v_mfma_f32_32x32x16_bf16 v[96:111], a[144:147], v[160:163], v[96:111]
    s_add_u32 s7, s0, s58
    buffer_load_dwordx4 v24, s[36:39], s57 offen offset:0 lds
    s_mov_b64 exec, 3
    buffer_store_dword v31, v7, s[28:31], s15 offen sc1
    s_mov_b64 exec, -1
    v_mfma_f32_32x32x16_bf16 v[96:111], a[148:151], v[164:167], v[96:111]
    buffer_load_dwordx4 a[4:7], v2, s[28:31], s14 offen offset:1024 sc1
    s_waitcnt lgkmcnt(4)
    v_mfma_f32_32x32x16_bf16 v[96:111], a[152:155], v[168:171], v[96:111]
    s_waitcnt lgkmcnt(0)
    s_barrier
    ds_read_b64_tr_b16 a[168:169], v10 offset:0
    ds_read_b64_tr_b16 a[170:171], v10 offset:512
    ds_read_b64_tr_b16 a[144:145], v10 offset:2048
    ds_read_b64_tr_b16 a[146:147], v10 offset:2560
    ds_read_b64_tr_b16 a[148:149], v10 offset:4096
    ds_read_b64_tr_b16 a[150:151], v10 offset:4608
    buffer_load_dwordx4 a[8:11], v2, s[28:31], s14 offen offset:2048 sc1
    v_mfma_f32_32x32x16_bf16 v[96:111], a[156:159], v[172:175], v[96:111]
    ds_read_b64_tr_b16 a[152:153], v10 offset:6144
    ds_read_b64_tr_b16 a[154:155], v10 offset:6656
    v_mfma_f32_32x32x16_bf16 v[96:111], a[160:163], v[176:179], v[96:111]
    ds_read_b64_tr_b16 a[156:157], v10 offset:8192
    ds_read_b64_tr_b16 a[158:159], v10 offset:8704
    buffer_load_dwordx4 a[12:15], v2, s[28:31], s14 offen offset:3072 sc1
    s_add_u32 s27, s50, 7
    s_and_b32 s27, s27, 7
    s_lshl_b32 s27, s27, 7
    s_add_u32 s56, s62, s27
    s_add_u32 s57, s63, s27
    v_mfma_f32_32x32x16_bf16 v[96:111], a[164:167], v[180:183], v[96:111]
    ds_read_b64_tr_b16 a[160:161], v10 offset:10240
    ds_read_b64_tr_b16 a[162:163], v10 offset:10752
    v_add_u32 v50, 9, v49
    v_and_b32 v50, 7, v50
    v_xor_b32 v50, s66, v50
    s_waitcnt lgkmcnt(8)
    v_mfma_f32_32x32x16_bf16 v[80:95], a[168:171], v[112:115], 0
    ds_read_b64_tr_b16 a[164:165], v10 offset:12288
    ds_read_b64_tr_b16 a[166:167], v10 offset:12800
    v_lshl_add_u32 v50, v50, 12, v48
    s_add_u32 m0, s10, 0
    v_mfma_f32_32x32x16_bf16 v[80:95], a[144:147], v[116:119], v[80:95]
    ds_read_b64_tr_b16 a[168:169], v10 offset:14336
    ds_read_b64_tr_b16 a[170:171], v10 offset:14848
    buffer_load_dwordx4 a[184:187], v50, s[28:31], s65 offen sc1
    s_waitcnt lgkmcnt(8)
    v_mfma_f32_32x32x16_bf16 v[80:95], a[148:151], v[120:123], v[80:95]
    ds_read_b64_tr_b16 a[144:145], v10 offset:16384
    ds_read_b64_tr_b16 a[146:147], v10 offset:16896
    v_cvt_pk_bf16_f32 v192, v96, v97
    buffer_load_dwordx4 v16, s[36:39], s56 offen offset:0 lds
    v_cvt_pk_bf16_f32 v193, v98, v99
    v_mfma_f32_32x32x16_bf16 v[80:95], a[152:155], v[124:127], v[80:95]
    ds_read_b64_tr_b16 a[148:149], v10 offset:18432
    ds_read_b64_tr_b16 a[150:151], v10 offset:18944
    v_cvt_pk_bf16_f32 v194, v100, v101
    v_cvt_pk_bf16_f32 v195, v102, v103
    s_waitcnt lgkmcnt(8)
    v_mfma_f32_32x32x16_bf16 v[80:95], a[156:159], v[128:131], v[80:95]
    ds_read_b64_tr_b16 a[152:153], v10 offset:20480
    ds_read_b64_tr_b16 a[154:155], v10 offset:20992
    s_add_u32 s64, s50, 3
    s_and_b32 s64, s64, 7
    s_lshl_b32 s64, s64, 18
    v_mfma_f32_32x32x16_bf16 v[80:95], a[160:163], v[132:135], v[80:95]
    ds_read_b64_tr_b16 a[156:157], v10 offset:22528
    ds_read_b64_tr_b16 a[158:159], v10 offset:23040
    s_add_u32 s64, s64, s13
    buffer_load_dwordx4 v17, s[36:39], s56 offen offset:1024 lds
    s_waitcnt lgkmcnt(8)
    v_mfma_f32_32x32x16_bf16 v[80:95], a[164:167], v[136:139], v[80:95]
    ds_read_b64_tr_b16 a[160:161], v10 offset:24576
    ds_read_b64_tr_b16 a[162:163], v10 offset:25088
    buffer_store_dwordx4 v[192:195], v2, s[28:31], s64 offen sc1
    v_mfma_f32_32x32x16_bf16 v[80:95], a[168:171], v[140:143], v[80:95]
    ds_read_b64_tr_b16 a[164:165], v10 offset:26624
    ds_read_b64_tr_b16 a[166:167], v10 offset:27136
    v_cvt_pk_bf16_f32 v196, v104, v105
    s_waitcnt lgkmcnt(8)
    v_mfma_f32_32x32x16_bf16 v[80:95], a[144:147], v[144:147], v[80:95]
    ds_read_b64_tr_b16 a[168:169], v10 offset:28672
    ds_read_b64_tr_b16 a[170:171], v10 offset:29184
    v_cvt_pk_bf16_f32 v197, v106, v107
    v_cvt_pk_bf16_f32 v198, v108, v109
    v_cvt_pk_bf16_f32 v199, v110, v111
    v_mfma_f32_32x32x16_bf16 v[80:95], a[148:151], v[148:151], v[80:95]
    ds_read_b64_tr_b16 a[144:145], v10 offset:30720
    ds_read_b64_tr_b16 a[146:147], v10 offset:31232
    buffer_load_dwordx4 v18, s[36:39], s56 offen offset:2048 lds
    s_waitcnt lgkmcnt(8)
    v_mfma_f32_32x32x16_bf16 v[80:95], a[152:155], v[152:155], v[80:95]
    ds_read_b64_tr_b16 a[148:149], v10 offset:32768
    ds_read_b64_tr_b16 a[150:151], v10 offset:33280
    buffer_store_dwordx4 v[196:199], v2, s[28:31], s64 offen offset:1024 sc1
    v_mfma_f32_32x32x16_bf16 v[80:95], a[156:159], v[156:159], v[80:95]
    ds_read_b64_tr_b16 a[152:153], v10 offset:34816
    ds_read_b64_tr_b16 a[154:155], v10 offset:35328
    s_waitcnt lgkmcnt(8)
    v_mfma_f32_32x32x16_bf16 v[80:95], a[160:163], v[160:163], v[80:95]
    ds_read_b64_tr_b16 a[156:157], v11 offset:0
    ds_read_b64_tr_b16 a[158:159], v11 offset:512
    buffer_load_dword v44, v3, s[28:31], 0 offen sc1
    buffer_load_dwordx4 v19, s[36:39], s56 offen offset:3072 lds
    v_mfma_f32_32x32x16_bf16 v[80:95], a[164:167], v[164:167], v[80:95]
    ds_read_b64_tr_b16 a[160:161], v11 offset:2048
    ds_read_b64_tr_b16 a[162:163], v11 offset:2560
    s_waitcnt lgkmcnt(8)
    v_mfma_f32_32x32x16_bf16 v[80:95], a[168:171], v[168:171], v[80:95]
    ds_read_b64_tr_b16 a[164:165], v11 offset:4096
    ds_read_b64_tr_b16 a[166:167], v11 offset:4608
    s_add_u32 m0, s10, 4096
    v_mfma_f32_32x32x16_bf16 v[80:95], a[144:147], v[172:175], v[80:95]
    ds_read_b64_tr_b16 a[168:169], v11 offset:6144
    ds_read_b64_tr_b16 a[170:171], v11 offset:6656
    s_waitcnt lgkmcnt(8)
    v_mfma_f32_32x32x16_bf16 v[80:95], a[148:151], v[176:179], v[80:95]
    ds_read_b64_tr_b16 a[144:145], v11 offset:8192
    ds_read_b64_tr_b16 a[146:147], v11 offset:8704
    s_add_u32 s14, s50, 6
    buffer_load_dwordx4 v20, s[36:39], s57 offen offset:0 lds
    v_mfma_f32_32x32x16_bf16 v[80:95], a[152:155], v[180:183], v[80:95]
    ds_read_b64_tr_b16 a[148:149], v11 offset:10240
    ds_read_b64_tr_b16 a[150:151], v11 offset:10752
    s_waitcnt lgkmcnt(8)
    v_mfma_f32_32x32x16_bf16 v[96:111], a[156:159], v[112:115], 0
    ds_read_b64_tr_b16 a[152:153], v11 offset:12288
    ds_read_b64_tr_b16 a[154:155], v11 offset:12800
    s_and_b32 s14, s14, 7
    v_mfma_f32_32x32x16_bf16 v[96:111], a[160:163], v[116:119], v[96:111]
    ds_read_b64_tr_b16 a[156:157], v11 offset:14336
    ds_read_b64_tr_b16 a[158:159], v11 offset:14848
    buffer_load_dwordx4 v21, s[36:39], s57 offen offset:1024 lds
    s_waitcnt lgkmcnt(8)
    v_mfma_f32_32x32x16_bf16 v[96:111], a[164:167], v[120:123], v[96:111]
    ds_read_b64_tr_b16 a[160:161], v11 offset:16384
    ds_read_b64_tr_b16 a[162:163], v11 offset:16896
    s_lshl_b32 s11, s14, 1
    v_cvt_pk_bf16_f32 v184, v80, v81
    v_cvt_pk_bf16_f32 v185, v82, v83
    v_mfma_f32_32x32x16_bf16 v[96:111], a[168:171], v[124:127], v[96:111]
    ds_read_b64_tr_b16 a[164:165], v11 offset:18432
    ds_read_b64_tr_b16 a[166:167], v11 offset:18944
    s_lshl_b32 s11, 3, s11
    v_cvt_pk_bf16_f32 v186, v84, v85
    v_cvt_pk_bf16_f32 v187, v86, v87
    s_waitcnt lgkmcnt(8)
    v_mfma_f32_32x32x16_bf16 v[96:111], a[144:147], v[128:131], v[96:111]
    ds_read_b64_tr_b16 a[168:169], v11 offset:20480
    ds_read_b64_tr_b16 a[170:171], v11 offset:20992
    s_add_u32 s64, s50, 4
    s_add_u32 s15, s50, 3
    s_and_b32 s64, s64, 7
    s_lshl_b32 s64, s64, 18
    v_mfma_f32_32x32x16_bf16 v[96:111], a[148:151], v[132:135], v[96:111]
    ds_read_b64_tr_b16 a[144:145], v11 offset:22528
    ds_read_b64_tr_b16 a[146:147], v11 offset:23040
    s_lshl_b32 s14, s14, 12
    s_add_u32 s64, s64, s12
    buffer_load_dwordx4 v22, s[36:39], s57 offen offset:2048 lds
    s_waitcnt lgkmcnt(8)
    v_mfma_f32_32x32x16_bf16 v[96:111], a[152:155], v[136:139], v[96:111]
    ds_read_b64_tr_b16 a[148:149], v11 offset:24576
    ds_read_b64_tr_b16 a[150:151], v11 offset:25088
    buffer_store_dwordx4 v[184:187], v2, s[28:31], s64 offen sc1
    s_and_b32 s15, s15, 7
    v_mfma_f32_32x32x16_bf16 v[96:111], a[156:159], v[140:143], v[96:111]
    ds_read_b64_tr_b16 a[152:153], v11 offset:26624
    ds_read_b64_tr_b16 a[154:155], v11 offset:27136
    s_xor_b32 s14, s14, s67
    v_cvt_pk_bf16_f32 v188, v88, v89
    s_waitcnt lgkmcnt(8)
    v_mfma_f32_32x32x16_bf16 v[96:111], a[160:163], v[144:147], v[96:111]
    ds_read_b64_tr_b16 a[156:157], v11 offset:28672
    ds_read_b64_tr_b16 a[158:159], v11 offset:29184
    v_cvt_pk_bf16_f32 v189, v90, v91
    s_lshl_b32 s15, s15, 10
    buffer_load_dwordx4 v23, s[36:39], s57 offen offset:3072 lds
    v_cvt_pk_bf16_f32 v190, v92, v93
    v_cvt_pk_bf16_f32 v191, v94, v95
    v_mfma_f32_32x32x16_bf16 v[96:111], a[164:167], v[148:151], v[96:111]
    ds_read_b64_tr_b16 a[160:161], v11 offset:30720
    ds_read_b64_tr_b16 a[162:163], v11 offset:31232
    s_add_u32 s14, s14, s58
    s_waitcnt lgkmcnt(8)
    v_mfma_f32_32x32x16_bf16 v[96:111], a[168:171], v[152:155], v[96:111]
    ds_read_b64_tr_b16 a[164:165], v11 offset:32768
    ds_read_b64_tr_b16 a[166:167], v11 offset:33280
    buffer_store_dwordx4 v[188:191], v2, s[28:31], s64 offen offset:1024 sc1
    s_waitcnt vmcnt(7)
L_fc_40:
    v_cmp_gt_u32 vcc, 1, v44
    s_nop 1
    s_and_b32 s3, vcc_lo, s11
    s_cbranch_scc0 L_fcok_41
    s_add_u32 s61, s61, 1
    s_cmp_gt_u32 s61, 400000
    s_cbranch_scc1 L_fcok_41
    buffer_load_dword v44, v3, s[28:31], 0 offen sc1
    s_waitcnt vmcnt(0)
    s_branch L_fc_40
L_fcok_41:
    s_add_u32 s15, s15, s68
    s_add_u32 m0, s10, 8192
    v_mfma_f32_32x32x16_bf16 v[96:111], a[144:147], v[156:159], v[96:111]
    ds_read_b64_tr_b16 a[168:169], v11 offset:34816
    ds_read_b64_tr_b16 a[170:171], v11 offset:35328
    buffer_load_dwordx4 a[16:19], v2, s[28:31], s14 offen offset:0 sc1
    s_waitcnt lgkmcnt(8)
    v_mfma_f32_32x32x16_bf16 v[96:111], a[148:151], v[160:163], v[96:111]
    buffer_load_dwordx4 v24, s[36:39], s57 offen offset:0 lds
    s_mov_b64 exec, 3
    buffer_store_dword v31, v7, s[28:31], s15 offen sc1
    s_mov_b64 exec, -1
    v_mfma_f32_32x32x16_bf16 v[96:111], a[152:155], v[164:167], v[96:111]
    buffer_load_dwordx4 a[20:23], v2, s[28:31], s14 offen offset:1024 sc1
    s_waitcnt lgkmcnt(4)
    v_mfma_f32_32x32x16_bf16 v[96:111], a[156:159], v[168:171], v[96:111]
    s_waitcnt lgkmcnt(0)
    s_barrier
    ds_read_b64_tr_b16 a[144:145], v12 offset:0
    ds_read_b64_tr_b16 a[146:147], v12 offset:512
    ds_read_b64_tr_b16 a[148:149], v12 offset:2048
    ds_read_b64_tr_b16 a[150:151], v12 offset:2560
    ds_read_b64_tr_b16 a[152:153], v12 offset:4096
    ds_read_b64_tr_b16 a[154:155], v12 offset:4608
    buffer_load_dwordx4 a[24:27], v2, s[28:31], s14 offen offset:2048 sc1
    v_mfma_f32_32x32x16_bf16 v[96:111], a[160:163], v[172:175], v[96:111]
    ds_read_b64_tr_b16 a[156:157], v12 offset:6144
    ds_read_b64_tr_b16 a[158:159], v12 offset:6656
    v_mfma_f32_32x32x16_bf16 v[96:111], a[164:167], v[176:179], v[96:111]
    ds_read_b64_tr_b16 a[160:161], v12 offset:8192
    ds_read_b64_tr_b16 a[162:163], v12 offset:8704
    buffer_load_dwordx4 a[28:31], v2, s[28:31], s14 offen offset:3072 sc1
    s_add_u32 s27, s50, 8
    s_and_b32 s27, s27, 7
    s_lshl_b32 s27, s27, 7
    s_add_u32 s56, s62, s27
    s_add_u32 s57, s63, s27
    v_mfma_f32_32x32x16_bf16 v[96:111], a[168:171], v[180:183], v[96:111]
    ds_read_b64_tr_b16 a[164:165], v12 offset:10240
    ds_read_b64_tr_b16 a[166:167], v12 offset:10752
    v_add_u32 v50, 15, v49
    v_and_b32 v50, 7, v50
    v_xor_b32 v50, s66, v50
    s_waitcnt lgkmcnt(8)
    v_mfma_f32_32x32x16_bf16 v[80:95], a[144:147], v[112:115], 0
    ds_read_b64_tr_b16 a[168:169], v12 offset:12288
    ds_read_b64_tr_b16 a[170:171], v12 offset:12800
    v_lshl_add_u32 v50, v50, 12, v48
    s_add_u32 m0, s10, 36864
    v_mfma_f32_32x32x16_bf16 v[80:95], a[148:151], v[116:119], v[80:95]
    ds_read_b64_tr_b16 a[144:145], v12 offset:14336
    ds_read_b64_tr_b16 a[146:147], v12 offset:14848
    buffer_load_dwordx4 a[172:175], v50, s[28:31], s65 offen sc1
    s_waitcnt lgkmcnt(8)
    v_mfma_f32_32x32x16_bf16 v[80:95], a[152:155], v[120:123], v[80:95]
    ds_read_b64_tr_b16 a[148:149], v12 offset:16384
    ds_read_b64_tr_b16 a[150:151], v12 offset:16896
    v_cvt_pk_bf16_f32 v192, v96, v97
    buffer_load_dwordx4 v16, s[36:39], s56 offen offset:0 lds
    v_cvt_pk_bf16_f32 v193, v98, v99
    v_mfma_f32_32x32x16_bf16 v[80:95], a[156:159], v[124:127], v[80:95]
    ds_read_b64_tr_b16 a[152:153], v12 offset:18432
    ds_read_b64_tr_b16 a[154:155], v12 offset:18944
    v_cvt_pk_bf16_f32 v194, v100, v101
    v_cvt_pk_bf16_f32 v195, v102, v103
    s_waitcnt lgkmcnt(8)
    v_mfma_f32_32x32x16_bf16 v[80:95], a[160:163], v[128:131], v[80:95]
    ds_read_b64_tr_b16 a[156:157], v12 offset:20480
    ds_read_b64_tr_b16 a[158:159], v12 offset:20992
    s_add_u32 s64, s50, 4
    s_and_b32 s64, s64, 7
    s_lshl_b32 s64, s64, 18
    v_mfma_f32_32x32x16_bf16 v[80:95], a[164:167], v[132:135], v[80:95]
    ds_read_b64_tr_b16 a[160:161], v12 offset:22528
    ds_read_b64_tr_b16 a[162:163], v12 offset:23040
    s_add_u32 s64, s64, s13
    buffer_load_dwordx4 v17, s[36:39], s56 offen offset:1024 lds
    s_waitcnt lgkmcnt(8)
    v_mfma_f32_32x32x16_bf16 v[80:95], a[168:171], v[136:139], v[80:95]
    ds_read_b64_tr_b16 a[164:165], v12 offset:24576
    ds_read_b64_tr_b16 a[166:167], v12 offset:25088
    buffer_store_dwordx4 v[192:195], v2, s[28:31], s64 offen sc1
    v_mfma_f32_32x32x16_bf16 v[80:95], a[144:147], v[140:143], v[80:95]
    ds_read_b64_tr_b16 a[168:169], v12 offset:26624
    ds_read_b64_tr_b16 a[170:171], v12 offset:27136
    v_cvt_pk_bf16_f32 v196, v104, v105
    s_waitcnt lgkmcnt(8)
    v_mfma_f32_32x32x16_bf16 v[80:95], a[148:151], v[144:147], v[80:95]
    ds_read_b64_tr_b16 a[144:145], v12 offset:28672
    ds_read_b64_tr_b16 a[146:147], v12 offset:29184
    v_cvt_pk_bf16_f32 v197, v106, v107
    v_cvt_pk_bf16_f32 v198, v108, v109
    v_cvt_pk_bf16_f32 v199, v110, v111
    v_mfma_f32_32x32x16_bf16 v[80:95], a[152:155], v[148:151], v[80:95]
    ds_read_b64_tr_b16 a[148:149], v12 offset:30720
    ds_read_b64_tr_b16 a[150:151], v12 offset:31232
    buffer_load_dwordx4 v18, s[36:39], s56 offen offset:2048 lds
    s_waitcnt lgkmcnt(8)
    v_mfma_f32_32x32x16_bf16 v[80:95], a[156:159], v[152:155], v[80:95]
    ds_read_b64_tr_b16 a[152:153], v12 offset:32768
    ds_read_b64_tr_b16 a[154:155], v12 offset:33280
    buffer_store_dwordx4 v[196:199], v2, s[28:31], s64 offen offset:1024 sc1
    v_mfma_f32_32x32x16_bf16 v[80:95], a[160:163], v[156:159], v[80:95]
    ds_read_b64_tr_b16 a[156:157], v12 offset:34816
    ds_read_b64_tr_b16 a[158:159], v12 offset:35328
    s_waitcnt lgkmcnt(8)
    v_mfma_f32_32x32x16_bf16 v[80:95], a[164:167], v[160:163], v[80:95]
    ds_read_b64_tr_b16 a[160:161], v13 offset:0
    ds_read_b64_tr_b16 a[162:163], v13 offset:512
    buffer_load_dword v62, v3, s[28:31], 0 offen sc1
    buffer_load_dwordx4 v19, s[36:39], s56 offen offset:3072 lds
    v_mfma_f32_32x32x16_bf16 v[80:95], a[168:171], v[164:167], v[80:95]
    ds_read_b64_tr_b16 a[164:165], v13 offset:2048
    ds_read_b64_tr_b16 a[166:167], v13 offset:2560
    s_waitcnt lgkmcnt(8)
    v_mfma_f32_32x32x16_bf16 v[80:95], a[144:147], v[168:171], v[80:95]
    ds_read_b64_tr_b16 a[168:169], v13 offset:4096
    ds_read_b64_tr_b16 a[170:171], v13 offset:4608
    s_add_u32 m0, s10, 40960
    v_mfma_f32_32x32x16_bf16 v[80:95], a[148:151], v[172:175], v[80:95]
    ds_read_b64_tr_b16 a[144:145], v13 offset:6144
    ds_read_b64_tr_b16 a[146:147], v13 offset:6656
    s_waitcnt lgkmcnt(8)
    v_mfma_f32_32x32x16_bf16 v[80:95], a[152:155], v[176:179], v[80:95]
    ds_read_b64_tr_b16 a[148:149], v13 offset:8192
    ds_read_b64_tr_b16 a[150:151], v13 offset:8704
    s_add_u32 s14, s50, 5
    buffer_load_dwordx4 v20, s[36:39], s57 offen offset:0 lds
    v_mfma_f32_32x32x16_bf16 v[80:95], a[156:159], v[180:183], v[80:95]
    ds_read_b64_tr_b16 a[152:153], v13 offset:10240
    ds_read_b64_tr_b16 a[154:155], v13 offset:10752
    s_waitcnt lgkmcnt(8)
    v_mfma_f32_32x32x16_bf16 v[96:111], a[160:163], v[112:115], 0
    ds_read_b64_tr_b16 a[156:157], v13 offset:12288
    ds_read_b64_tr_b16 a[158:159], v13 offset:12800
    s_and_b32 s14, s14, 7
    v_mfma_f32_32x32x16_bf16 v[96:111], a[164:167], v[116:119], v[96:111]
    ds_read_b64_tr_b16 a[160:161], v13 offset:14336
    ds_read_b64_tr_b16 a[162:163], v13 offset:14848
    buffer_load_dwordx4 v21, s[36:39], s57 offen offset:1024 lds
    s_waitcnt lgkmcnt(8)
    v_mfma_f32_32x32x16_bf16 v[96:111], a[168:171], v[120:123], v[96:111]
    ds_read_b64_tr_b16 a[164:165], v13 offset:16384
    ds_read_b64_tr_b16 a[166:167], v13 offset:16896
    s_lshl_b32 s11, s14, 1
    v_cvt_pk_bf16_f32 v184, v80, v81
    v_cvt_pk_bf16_f32 v185, v82, v83
    v_mfma_f32_32x32x16_bf16 v[96:111], a[144:147], v[124:127], v[96:111]
    ds_read_b64_tr_b16 a[168:169], v13 offset:18432
    ds_read_b64_tr_b16 a[170:171], v13 offset:18944
    s_lshl_b32 s11, 3, s11
    v_cvt_pk_bf16_f32 v186, v84, v85
    v_cvt_pk_bf16_f32 v187, v86, v87
    s_waitcnt lgkmcnt(8)
    v_mfma_f32_32x32x16_bf16 v[96:111], a[148:151], v[128:131], v[96:111]
    ds_read_b64_tr_b16 a[144:145], v13 offset:20480
    ds_read_b64_tr_b16 a[146:147], v13 offset:20992
    s_add_u32 s64, s50, 5
    s_add_u32 s15, s50, 4
    s_and_b32 s64, s64, 7
    s_lshl_b32 s64, s64, 18
    v_mfma_f32_32x32x16_bf16 v[96:111], a[152:155], v[132:135], v[96:111]
    ds_read_b64_tr_b16 a[148:149], v13 offset:22528
    ds_read_b64_tr_b16 a[150:151], v13 offset:23040
    s_lshl_b32 s14, s14, 12
    s_add_u32 s64, s64, s12
    buffer_load_dwordx4 v22, s[36:39], s57 offen offset:2048 lds
    s_waitcnt lgkmcnt(8)
    v_mfma_f32_32x32x16_bf16 v[96:111], a[156:159], v[136:139], v[96:111]
    ds_read_b64_tr_b16 a[152:153], v13 offset:24576
    ds_read_b64_tr_b16 a[154:155], v13 offset:25088
    buffer_store_dwordx4 v[184:187], v2, s[28:31], s64 offen sc1
    s_and_b32 s15, s15, 7
    v_mfma_f32_32x32x16_bf16 v[96:111], a[160:163], v[140:143], v[96:111]
    ds_read_b64_tr_b16 a[156:157], v13 offset:26624
    ds_read_b64_tr_b16 a[158:159], v13 offset:27136
    s_xor_b32 s14, s14, s67
    v_cvt_pk_bf16_f32 v188, v88, v89
    s_waitcnt lgkmcnt(8)
    v_mfma_f32_32x32x16_bf16 v[96:111], a[164:167], v[144:147], v[96:111]
    ds_read_b64_tr_b16 a[160:161], v13 offset:28672
    ds_read_b64_tr_b16 a[162:163], v13 offset:29184
    v_cvt_pk_bf16_f32 v189, v90, v91
    s_lshl_b32 s15, s15, 10
    buffer_load_dwordx4 v23, s[36:39], s57 offen offset:3072 lds
    v_cvt_pk_bf16_f32 v190, v92, v93
    v_cvt_pk_bf16_f32 v191, v94, v95
    v_mfma_f32_32x32x16_bf16 v[96:111], a[168:171], v[148:151], v[96:111]
    ds_read_b64_tr_b16 a[164:165], v13 offset:30720
    ds_read_b64_tr_b16 a[166:167], v13 offset:31232
    s_add_u32 s14, s14, s58
    s_waitcnt lgkmcnt(8)
    v_mfma_f32_32x32x16_bf16 v[96:111], a[144:147], v[152:155], v[96:111]
    ds_read_b64_tr_b16 a[168:169], v13 offset:32768
    ds_read_b64_tr_b16 a[170:171], v13 offset:33280
    buffer_store_dwordx4 v[188:191], v2, s[28:31], s64 offen offset:1024 sc1
    s_waitcnt vmcnt(7)
L_fc_42:
    v_cmp_gt_u32 vcc, 1, v62
    s_nop 1
    s_and_b32 s3, vcc_lo, s11
    s_cbranch_scc0 L_fcok_43
    s_add_u32 s61, s61, 1
    s_cmp_gt_u32 s61, 400000
    s_cbranch_scc1 L_fcok_43
    buffer_load_dword v62, v3, s[28:31], 0 offen sc1
    s_waitcnt vmcnt(0)
    s_branch L_fc_42
L_fcok_43:
    s_add_u32 s15, s15, s68
    s_add_u32 m0, s10, 45056
    v_mfma_f32_32x32x16_bf16 v[96:111], a[148:151], v[156:159], v[96:111]
    ds_read_b64_tr_b16 a[144:145], v13 offset:34816
    ds_read_b64_tr_b16 a[146:147], v13 offset:35328
    s_waitcnt lgkmcnt(8)
    v_mfma_f32_32x32x16_bf16 v[96:111], a[152:155], v[160:163], v[96:111]
    buffer_load_dwordx4 v24, s[36:39], s57 offen offset:0 lds
    s_mov_b64 exec, 3
    buffer_store_dword v31, v7, s[28:31], s15 offen sc1
    s_mov_b64 exec, -1
    buffer_load_dwordx4 a[32:35], v2, s[28:31], s14 offen offset:0 sc1
    v_mfma_f32_32x32x16_bf16 v[96:111], a[156:159], v[164:167], v[96:111]
    s_waitcnt lgkmcnt(4)
    v_mfma_f32_32x32x16_bf16 v[96:111], a[160:163], v[168:171], v[96:111]
    s_waitcnt lgkmcnt(0)
    s_barrier
    ds_read_b64_tr_b16 a[148:149], v14 offset:0
    ds_read_b64_tr_b16 a[150:151], v14 offset:512
    ds_read_b64_tr_b16 a[152:153], v14 offset:2048
    ds_read_b64_tr_b16 a[154:155], v14 offset:2560
    ds_read_b64_tr_b16 a[156:157], v14 offset:4096
    ds_read_b64_tr_b16 a[158:159], v14 offset:4608
    buffer_load_dwordx4 a[36:39], v2, s[28:31], s14 offen offset:1024 sc1
    v_mfma_f32_32x32x16_bf16 v[96:111], a[164:167], v[172:175], v[96:111]
    ds_read_b64_tr_b16 a[160:161], v14 offset:6144
    ds_read_b64_tr_b16 a[162:163], v14 offset:6656
    v_mfma_f32_32x32x16_bf16 v[96:111], a[168:171], v[176:179], v[96:111]
    ds_read_b64_tr_b16 a[164:165], v14 offset:8192
    ds_read_b64_tr_b16 a[166:167], v14 offset:8704
    buffer_load_dwordx4 a[40:43], v2, s[28:31], s14 offen offset:2048 sc1
    v_mfma_f32_32x32x16_bf16 v[96:111], a[144:147], v[180:183], v[96:111]
    ds_read_b64_tr_b16 a[168:169], v14 offset:10240
    ds_read_b64_tr_b16 a[170:171], v14 offset:10752
    s_waitcnt lgkmcnt(8)
    v_mfma_f32_32x32x16_bf16 v[80:95], a[148:151], v[112:115], 0
    ds_read_b64_tr_b16 a[144:145], v14 offset:12288
    ds_read_b64_tr_b16 a[146:147], v14 offset:12800
    buffer_load_dwordx4 a[44:47], v2, s[28:31], s14 offen offset:3072 sc1
    v_mfma_f32_32x32x16_bf16 v[80:95], a[152:155], v[116:119], v[80:95]
    ds_read_b64_tr_b16 a[148:149], v14 offset:14336
    ds_read_b64_tr_b16 a[150:151], v14 offset:14848
    s_waitcnt lgkmcnt(8)
    v_mfma_f32_32x32x16_bf16 v[80:95], a[156:159], v[120:123], v[80:95]
    ds_read_b64_tr_b16 a[152:153], v14 offset:16384
    ds_read_b64_tr_b16 a[154:155], v14 offset:16896
    v_cvt_pk_bf16_f32 v192, v96, v97
    v_cvt_pk_bf16_f32 v193, v98, v99
    v_mfma_f32_32x32x16_bf16 v[80:95], a[160:163], v[124:127], v[80:95]
    ds_read_b64_tr_b16 a[156:157], v14 offset:18432
    ds_read_b64_tr_b16 a[158:159], v14 offset:18944
    v_cvt_pk_bf16_f32 v194, v100, v101
    v_cvt_pk_bf16_f32 v195, v102, v103
    s_waitcnt lgkmcnt(8)
    v_mfma_f32_32x32x16_bf16 v[80:95], a[164:167], v[128:131], v[80:95]
    ds_read_b64_tr_b16 a[160:161], v14 offset:20480
    ds_read_b64_tr_b16 a[162:163], v14 offset:20992
    s_add_u32 s64, s50, 5
    v_and_b32 v56, 0x13, v1
    s_and_b32 s64, s64, 7
    s_lshl_b32 s64, s64, 18
    v_mfma_f32_32x32x16_bf16 v[80:95], a[168:171], v[132:135], v[80:95]
    ds_read_b64_tr_b16 a[164:165], v14 offset:22528
    ds_read_b64_tr_b16 a[166:167], v14 offset:23040
    s_add_u32 s64, s64, s13
    v_bfe_u32 v57, v1, 2, 1
    s_waitcnt lgkmcnt(8)
    v_mfma_f32_32x32x16_bf16 v[80:95], a[144:147], v[136:139], v[80:95]
    ds_read_b64_tr_b16 a[168:169], v14 offset:24576
    ds_read_b64_tr_b16 a[170:171], v14 offset:25088
    buffer_store_dwordx4 v[192:195], v2, s[28:31], s64 offen sc1
    v_mfma_f32_32x32x16_bf16 v[80:95], a[148:151], v[140:143], v[80:95]
    ds_read_b64_tr_b16 a[144:145], v14 offset:26624
    ds_read_b64_tr_b16 a[146:147], v14 offset:27136
    v_cvt_pk_bf16_f32 v196, v104, v105
    v_lshl_add_u32 v56, v57, 3, v56
    s_waitcnt lgkmcnt(8)
    v_mfma_f32_32x32x16_bf16 v[80:95], a[152:155], v[144:147], v[80:95]
    ds_read_b64_tr_b16 a[148:149], v14 offset:28672
    ds_read_b64_tr_b16 a[150:151], v14 offset:29184
    v_cvt_pk_bf16_f32 v197, v106, v107
    v_bfe_u32 v57, v1, 3, 1
    v_cvt_pk_bf16_f32 v198, v108, v109
    v_cvt_pk_bf16_f32 v199, v110, v111
    v_mfma_f32_32x32x16_bf16 v[80:95], a[156:159], v[148:151], v[80:95]
    ds_read_b64_tr_b16 a[152:153], v14 offset:30720
    ds_read_b64_tr_b16 a[154:155], v14 offset:31232
    v_lshl_add_u32 v56, v57, 2, v56
    s_waitcnt lgkmcnt(8)
    v_mfma_f32_32x32x16_bf16 v[80:95], a[160:163], v[152:155], v[80:95]
    ds_read_b64_tr_b16 a[156:157], v14 offset:32768
    ds_read_b64_tr_b16 a[158:159], v14 offset:33280
    buffer_store_dwordx4 v[196:199], v2, s[28:31], s64 offen offset:1024 sc1
    v_lshrrev_b32 v58, 5, v1
    v_mfma_f32_32x32x16_bf16 v[80:95], a[164:167], v[156:159], v[80:95]
    ds_read_b64_tr_b16 a[160:161], v14 offset:34816
    ds_read_b64_tr_b16 a[162:163], v14 offset:35328
    s_waitcnt lgkmcnt(8)
    v_mfma_f32_32x32x16_bf16 v[80:95], a[168:171], v[160:163], v[80:95]
    ds_read_b64_tr_b16 a[164:165], v15 offset:0
    ds_read_b64_tr_b16 a[166:167], v15 offset:512
    buffer_load_dword v44, v3, s[28:31], 0 offen sc1
    v_lshlrev_b32 v58, 3, v58
    v_mfma_f32_32x32x16_bf16 v[80:95], a[144:147], v[164:167], v[80:95]
    ds_read_b64_tr_b16 a[168:169], v15 offset:2048
    ds_read_b64_tr_b16 a[170:171], v15 offset:2560
    v_sub_u32 v56, v56, v58
    s_waitcnt lgkmcnt(8)
    v_mfma_f32_32x32x16_bf16 v[80:95], a[148:151], v[168:171], v[80:95]
    ds_read_b64_tr_b16 a[144:145], v15 offset:4096
    ds_read_b64_tr_b16 a[146:147], v15 offset:4608
    v_and_b32 v57, 31, v1
    v_mfma_f32_32x32x16_bf16 v[80:95], a[152:155], v[172:175], v[80:95]
    ds_read_b64_tr_b16 a[148:149], v15 offset:6144
    ds_read_b64_tr_b16 a[150:151], v15 offset:6656
    v_and_b32 v58, 1, v56
    s_waitcnt lgkmcnt(8)
    v_mfma_f32_32x32x16_bf16 v[80:95], a[156:159], v[176:179], v[80:95]
    ds_read_b64_tr_b16 a[152:153], v15 offset:8192
    ds_read_b64_tr_b16 a[154:155], v15 offset:8704
    s_add_u32 s14, s50, 4
    v_mfma_f32_32x32x16_bf16 v[80:95], a[160:163], v[180:183], v[80:95]
    ds_read_b64_tr_b16 a[156:157], v15 offset:10240
    ds_read_b64_tr_b16 a[158:159], v15 offset:10752
    v_lshlrev_b32 v58, 4, v58
    s_waitcnt lgkmcnt(8)
    v_mfma_f32_32x32x16_bf16 v[96:111], a[164:167], v[112:115], 0
    ds_read_b64_tr_b16 a[160:161], v15 offset:12288
    ds_read_b64_tr_b16 a[162:163], v15 offset:12800
    s_and_b32 s14, s14, 7
    v_mov_b32 v59, 0x3f80
    v_mfma_f32_32x32x16_bf16 v[96:111], a[168:171], v[116:119], v[96:111]
    ds_read_b64_tr_b16 a[164:165], v15 offset:14336
    ds_read_b64_tr_b16 a[166:167], v15 offset:14848
    v_lshlrev_b32 v58, v58, v59
    s_waitcnt lgkmcnt(8)
    v_mfma_f32_32x32x16_bf16 v[96:111], a[144:147], v[120:123], v[96:111]
    ds_read_b64_tr_b16 a[168:169], v15 offset:16384
    ds_read_b64_tr_b16 a[170:171], v15 offset:16896
    s_lshl_b32 s11, s14, 1
    v_cvt_pk_bf16_f32 v184, v80, v81
    v_ashrrev_i32 v56, 1, v56
    v_cvt_pk_bf16_f32 v185, v82, v83
    v_mfma_f32_32x32x16_bf16 v[96:111], a[148:151], v[124:127], v[96:111]
    ds_read_b64_tr_b16 a[144:145], v15 offset:18432
    ds_read_b64_tr_b16 a[146:147], v15 offset:18944
    s_lshl_b32 s11, 3, s11
    v_cvt_pk_bf16_f32 v186, v84, v85
    v_cvt_pk_bf16_f32 v187, v86, v87
    s_waitcnt lgkmcnt(8)
    v_mfma_f32_32x32x16_bf16 v[96:111], a[152:155], v[128:131], v[96:111]
    ds_read_b64_tr_b16 a[148:149], v15 offset:20480
    ds_read_b64_tr_b16 a[150:151], v15 offset:20992
    s_add_u32 s64, s50, 6
    s_add_u32 s15, s50, 5
    s_and_b32 s64, s64, 7
    s_lshl_b32 s64, s64, 18
    v_mfma_f32_32x32x16_bf16 v[96:111], a[156:159], v[132:135], v[96:111]
    ds_read_b64_tr_b16 a[152:153], v15 offset:22528
    ds_read_b64_tr_b16 a[154:155], v15 offset:23040
    s_lshl_b32 s14, s14, 12
    s_add_u32 s64, s64, s12
    v_cmp_eq_u32 s[16:17], 0, v56
    s_nop 1
    v_cndmask_b32 v32, 0, v58, s[16:17]
    s_waitcnt lgkmcnt(8)
    v_mfma_f32_32x32x16_bf16 v[96:111], a[160:163], v[136:139], v[96:111]
    ds_read_b64_tr_b16 a[156:157], v15 offset:24576
    ds_read_b64_tr_b16 a[158:159], v15 offset:25088
    buffer_store_dwordx4 v[184:187], v2, s[28:31], s64 offen sc1
    s_and_b32 s15, s15, 7
    v_mfma_f32_32x32x16_bf16 v[96:111], a[164:167], v[140:143], v[96:111]
    ds_read_b64_tr_b16 a[160:161], v15 offset:26624
    ds_read_b64_tr_b16 a[162:163], v15 offset:27136
    s_xor_b32 s14, s14, s67
    v_cvt_pk_bf16_f32 v188, v88, v89
    s_waitcnt lgkmcnt(8)
    v_mfma_f32_32x32x16_bf16 v[96:111], a[168:171], v[144:147], v[96:111]
    ds_read_b64_tr_b16 a[164:165], v15 offset:28672
    ds_read_b64_tr_b16 a[166:167], v15 offset:29184
    v_cvt_pk_bf16_f32 v189, v90, v91
    s_lshl_b32 s15, s15, 10
    v_cvt_pk_bf16_f32 v190, v92, v93
    v_cvt_pk_bf16_f32 v191, v94, v95
    v_mfma_f32_32x32x16_bf16 v[96:111], a[144:147], v[148:151], v[96:111]
    ds_read_b64_tr_b16 a[168:169], v15 offset:30720
    ds_read_b64_tr_b16 a[170:171], v15 offset:31232
    s_add_u32 s14, s14, s58
    v_cmp_eq_u32 s[16:17], 1, v56
    s_nop 1
    v_cndmask_b32 v33, 0, v58, s[16:17]
    s_waitcnt lgkmcnt(8)
    v_mfma_f32_32x32x16_bf16 v[96:111], a[148:151], v[152:155], v[96:111]
    ds_read_b64_tr_b16 a[144:145], v15 offset:32768
    ds_read_b64_tr_b16 a[146:147], v15 offset:33280
    buffer_store_dwordx4 v[188:191], v2, s[28:31], s64 offen offset:1024 sc1
    s_waitcnt vmcnt(2)
L_fc_44:
    v_cmp_gt_u32 vcc, 1, v44
    s_nop 1
    s_and_b32 s3, vcc_lo, s11
    s_cbranch_scc0 L_fcok_45
    s_add_u32 s61, s61, 1
    s_cmp_gt_u32 s61, 400000
    s_cbranch_scc1 L_fcok_45
    buffer_load_dword v44, v3, s[28:31], 0 offen sc1
    s_waitcnt vmcnt(0)
    s_branch L_fc_44
L_fcok_45:
    s_add_u32 s15, s15, s68
    v_mfma_f32_32x32x16_bf16 v[96:111], a[152:155], v[156:159], v[96:111]
    ds_read_b64_tr_b16 a[148:149], v15 offset:34816
    ds_read_b64_tr_b16 a[150:151], v15 offset:35328
    buffer_load_dwordx4 a[48:51], v2, s[28:31], s14 offen offset:0 sc1
    s_waitcnt lgkmcnt(8)
    v_mfma_f32_32x32x16_bf16 v[96:111], a[156:159], v[160:163], v[96:111]
    s_mov_b64 exec, 3
    buffer_store_dword v31, v7, s[28:31], s15 offen sc1
    s_mov_b64 exec, -1
    v_cmp_eq_u32 s[16:17], 2, v56
    s_nop 1
    v_cndmask_b32 v34, 0, v58, s[16:17]
    v_mfma_f32_32x32x16_bf16 v[96:111], a[160:163], v[164:167], v[96:111]
    buffer_load_dwordx4 a[52:55], v2, s[28:31], s14 offen offset:1024 sc1
    s_waitcnt lgkmcnt(4)
    v_mfma_f32_32x32x16_bf16 v[96:111], a[164:167], v[168:171], v[96:111]
    s_waitcnt lgkmcnt(0)
    s_barrier
    ds_read_b64_tr_b16 a[152:153], v8 offset:0
    ds_read_b64_tr_b16 a[154:155], v8 offset:512
    ds_read_b64_tr_b16 a[156:157], v8 offset:2048
    ds_read_b64_tr_b16 a[158:159], v8 offset:2560
    ds_read_b64_tr_b16 a[160:161], v8 offset:4096
    ds_read_b64_tr_b16 a[162:163], v8 offset:4608
    buffer_load_dwordx4 a[56:59], v2, s[28:31], s14 offen offset:2048 sc1
    v_mfma_f32_32x32x16_bf16 v[96:111], a[168:171], v[172:175], v[96:111]
    ds_read_b64_tr_b16 a[164:165], v8 offset:6144
    ds_read_b64_tr_b16 a[166:167], v8 offset:6656
    v_mfma_f32_32x32x16_bf16 v[96:111], a[144:147], v[176:179], v[96:111]
    ds_read_b64_tr_b16 a[168:169], v8 offset:8192
    ds_read_b64_tr_b16 a[170:171], v8 offset:8704
    buffer_load_dwordx4 a[60:63], v2, s[28:31], s14 offen offset:3072 sc1
    v_cmp_eq_u32 s[16:17], 3, v56
    s_nop 1
    v_cndmask_b32 v35, 0, v58, s[16:17]
    v_mfma_f32_32x32x16_bf16 v[96:111], a[148:151], v[180:183], v[96:111]
    ds_read_b64_tr_b16 a[144:145], v8 offset:10240
    ds_read_b64_tr_b16 a[146:147], v8 offset:10752
    v_add_u32 v50, 13, v49
    v_and_b32 v50, 7, v50
    v_xor_b32 v50, s66, v50
    s_waitcnt lgkmcnt(8)
    v_mfma_f32_32x32x16_bf16 v[80:95], a[152:155], v[112:115], 0
    ds_read_b64_tr_b16 a[148:149], v8 offset:12288
    ds_read_b64_tr_b16 a[150:151], v8 offset:12800
    v_lshl_add_u32 v50, v50, 12, v48
    v_mfma_f32_32x32x16_bf16 v[80:95], a[156:159], v[116:119], v[80:95]
    ds_read_b64_tr_b16 a[152:153], v8 offset:14336
    ds_read_b64_tr_b16 a[154:155], v8 offset:14848
    buffer_load_dwordx4 a[176:179], v50, s[28:31], s65 offen sc1
    s_waitcnt lgkmcnt(8)
    v_mfma_f32_32x32x16_bf16 v[80:95], a[160:163], v[120:123], v[80:95]
    ds_read_b64_tr_b16 a[156:157], v8 offset:16384
    ds_read_b64_tr_b16 a[158:159], v8 offset:16896
    v_cvt_pk_bf16_f32 v192, v96, v97
    v_cmp_eq_u32 s[16:17], 8, v56
    s_nop 1
    v_cndmask_b32 v36, 0, v58, s[16:17]
    v_cvt_pk_bf16_f32 v193, v98, v99
    v_mfma_f32_32x32x16_bf16 v[80:95], a[164:167], v[124:127], v[80:95]
    ds_read_b64_tr_b16 a[160:161], v8 offset:18432
    ds_read_b64_tr_b16 a[162:163], v8 offset:18944
    v_cvt_pk_bf16_f32 v194, v100, v101
    v_cvt_pk_bf16_f32 v195, v102, v103
    s_waitcnt lgkmcnt(8)
    v_mfma_f32_32x32x16_bf16 v[80:95], a[168:171], v[128:131], v[80:95]
    ds_read_b64_tr_b16 a[164:165], v8 offset:20480
    ds_read_b64_tr_b16 a[166:167], v8 offset:20992
    s_add_u32 s64, s50, 6
    s_and_b32 s64, s64, 7
    s_lshl_b32 s64, s64, 18
    v_mfma_f32_32x32x16_bf16 v[80:95], a[144:147], v[132:135], v[80:95]
    ds_read_b64_tr_b16 a[168:169], v8 offset:22528
    ds_read_b64_tr_b16 a[170:171], v8 offset:23040
    s_add_u32 s64, s64, s13
    s_waitcnt lgkmcnt(8)
    v_mfma_f32_32x32x16_bf16 v[80:95], a[148:151], v[136:139], v[80:95]
    ds_read_b64_tr_b16 a[144:145], v8 offset:24576
    ds_read_b64_tr_b16 a[146:147], v8 offset:25088
    buffer_store_dwordx4 v[192:195], v2, s[28:31], s64 offen sc1
    v_cmp_eq_u32 s[16:17], 9, v56
    s_nop 1
    v_cndmask_b32 v37, 0, v58, s[16:17]
    v_mfma_f32_32x32x16_bf16 v[80:95], a[152:155], v[140:143], v[80:95]
    ds_read_b64_tr_b16 a[148:149], v8 offset:26624
    ds_read_b64_tr_b16 a[150:151], v8 offset:27136
    v_cvt_pk_bf16_f32 v196, v104, v105
    s_waitcnt lgkmcnt(8)
    v_mfma_f32_32x32x16_bf16 v[80:95], a[156:159], v[144:147], v[80:95]
    ds_read_b64_tr_b16 a[152:153], v8 offset:28672
    ds_read_b64_tr_b16 a[154:155], v8 offset:29184
    v_cvt_pk_bf16_f32 v197, v106, v107
    v_cvt_pk_bf16_f32 v198, v108, v109
    v_cvt_pk_bf16_f32 v199, v110, v111
    v_mfma_f32_32x32x16_bf16 v[80:95], a[160:163], v[148:151], v[80:95]
    ds_read_b64_tr_b16 a[156:157], v8 offset:30720
    ds_read_b64_tr_b16 a[158:159], v8 offset:31232
    s_waitcnt lgkmcnt(8)
    v_mfma_f32_32x32x16_bf16 v[80:95], a[164:167], v[152:155], v[80:95]
    ds_read_b64_tr_b16 a[160:161], v8 offset:32768
    ds_read_b64_tr_b16 a[162:163], v8 offset:33280
    buffer_store_dwordx4 v[196:199], v2, s[28:31], s64 offen offset:1024 sc1
    v_cmp_eq_u32 s[16:17], 10, v56
    s_nop 1
    v_cndmask_b32 v38, 0, v58, s[16:17]
    v_mfma_f32_32x32x16_bf16 v[80:95], a[168:171], v[156:159], v[80:95]
    ds_read_b64_tr_b16 a[164:165], v8 offset:34816
    ds_read_b64_tr_b16 a[166:167], v8 offset:35328
    s_waitcnt lgkmcnt(8)
    v_mfma_f32_32x32x16_bf16 v[80:95], a[144:147], v[160:163], v[80:95]
    ds_read_b64_tr_b16 a[168:169], v9 offset:0
    ds_read_b64_tr_b16 a[170:171], v9 offset:512
    buffer_load_dword v62, v3, s[28:31], 0 offen sc1
    v_mfma_f32_32x32x16_bf16 v[80:95], a[148:151], v[164:167], v[80:95]
    ds_read_b64_tr_b16 a[144:145], v9 offset:2048
    ds_read_b64_tr_b16 a[146:147], v9 offset:2560
    v_cmp_eq_u32 s[16:17], 11, v56
    s_nop 1
    v_cndmask_b32 v39, 0, v58, s[16:17]
    s_waitcnt lgkmcnt(8)
    v_mfma_f32_32x32x16_bf16 v[80:95], a[152:155], v[168:171], v[80:95]
    ds_read_b64_tr_b16 a[148:149], v9 offset:4096
    ds_read_b64_tr_b16 a[150:151], v9 offset:4608
    v_mfma_f32_32x32x16_bf16 v[80:95], a[156:159], v[172:175], v[80:95]
    ds_read_b64_tr_b16 a[152:153], v9 offset:6144
    ds_read_b64_tr_b16 a[154:155], v9 offset:6656
    s_waitcnt lgkmcnt(8)
    v_mfma_f32_32x32x16_bf16 v[80:95], a[160:163], v[176:179], v[80:95]
    ds_read_b64_tr_b16 a[156:157], v9 offset:8192
    ds_read_b64_tr_b16 a[158:159], v9 offset:8704
    s_add_u32 s14, s50, 3
    v_and_b32 v58, 1, v57
    v_mfma_f32_32x32x16_bf16 v[80:95], a[164:167], v[180:183], v[80:95]
    ds_read_b64_tr_b16 a[160:161], v9 offset:10240
    ds_read_b64_tr_b16 a[162:163], v9 offset:10752
    v_lshlrev_b32 v58, 4, v58
    s_waitcnt lgkmcnt(8)
    v_mfma_f32_32x32x16_bf16 v[96:111], a[168:171], v[112:115], 0
    ds_read_b64_tr_b16 a[164:165], v9 offset:12288
    ds_read_b64_tr_b16 a[166:167], v9 offset:12800
    s_and_b32 s14, s14, 7
    v_mov_b32 v59, 0x3f80
    v_mfma_f32_32x32x16_bf16 v[96:111], a[144:147], v[116:119], v[96:111]
    ds_read_b64_tr_b16 a[168:169], v9 offset:14336
    ds_read_b64_tr_b16 a[170:171], v9 offset:14848
    s_waitcnt lgkmcnt(8)
    v_mfma_f32_32x32x16_bf16 v[96:111], a[148:151], v[120:123], v[96:111]
    ds_read_b64_tr_b16 a[144:145], v9 offset:16384
    ds_read_b64_tr_b16 a[146:147], v9 offset:16896
    s_lshl_b32 s11, s14, 1
    v_cvt_pk_bf16_f32 v184, v80, v81
    v_lshlrev_b32 v58, v58, v59
    v_cvt_pk_bf16_f32 v185, v82, v83
    v_mfma_f32_32x32x16_bf16 v[96:111], a[152:155], v[124:127], v[96:111]
    ds_read_b64_tr_b16 a[148:149], v9 offset:18432
    ds_read_b64_tr_b16 a[150:151], v9 offset:18944
    s_lshl_b32 s11, 3, s11
    v_cvt_pk_bf16_f32 v186, v84, v85
    v_ashrrev_i32 v57, 1, v57
    v_cvt_pk_bf16_f32 v187, v86, v87
    v_min_u32 v184, 0xfffffffe, v184
    s_waitcnt lgkmcnt(8)
    v_mfma_f32_32x32x16_bf16 v[96:111], a[156:159], v[128:131], v[96:111]
    ds_read_b64_tr_b16 a[152:153], v9 offset:20480
    ds_read_b64_tr_b16 a[154:155], v9 offset:20992
    s_add_u32 s64, s50, 7
    s_add_u32 s15, s50, 6
    s_and_b32 s64, s64, 7
    v_mfma_f32_32x32x16_bf16 v[96:111], a[160:163], v[132:135], v[96:111]
    ds_read_b64_tr_b16 a[156:157], v9 offset:22528
    ds_read_b64_tr_b16 a[158:159], v9 offset:23040
    s_lshl_b32 s14, s14, 12
    s_lshl_b32 s64, s64, 18
    v_cmp_eq_u32 s[16:17], 0, v57
    s_nop 1
    v_cndmask_b32 v40, 0, v58, s[16:17]
    s_add_u32 s64, s64, s12
    s_waitcnt lgkmcnt(8)
    v_mfma_f32_32x32x16_bf16 v[96:111], a[164:167], v[136:139], v[96:111]
    ds_read_b64_tr_b16 a[160:161], v9 offset:24576
    ds_read_b64_tr_b16 a[162:163], v9 offset:25088
    buffer_store_dwordx4 v[184:187], v2, s[28:31], s64 offen sc1
    s_and_b32 s15, s15, 7
    v_mfma_f32_32x32x16_bf16 v[96:111], a[168:171], v[140:143], v[96:111]
    ds_read_b64_tr_b16 a[164:165], v9 offset:26624
    ds_read_b64_tr_b16 a[166:167], v9 offset:27136
    s_xor_b32 s14, s14, s67
    v_cvt_pk_bf16_f32 v188, v88, v89
    v_cvt_pk_bf16_f32 v189, v90, v91
    s_waitcnt lgkmcnt(8)
    v_mfma_f32_32x32x16_bf16 v[96:111], a[144:147], v[144:147], v[96:111]
    ds_read_b64_tr_b16 a[168:169], v9 offset:28672
    ds_read_b64_tr_b16 a[170:171], v9 offset:29184
    v_cvt_pk_bf16_f32 v190, v92, v93
    s_lshl_b32 s15, s15, 10
    v_cvt_pk_bf16_f32 v191, v94, v95
    v_mfma_f32_32x32x16_bf16 v[96:111], a[148:151], v[148:151], v[96:111]
    ds_read_b64_tr_b16 a[144:145], v9 offset:30720
    ds_read_b64_tr_b16 a[146:147], v9 offset:31232
    s_add_u32 s14, s14, s58
    v_min_u32 v188, 0xfffffffe, v188
    v_cmp_eq_u32 s[16:17], 1, v57
    s_nop 1
    v_cndmask_b32 v41, 0, v58, s[16:17]
    s_waitcnt lgkmcnt(8)
    v_mfma_f32_32x32x16_bf16 v[96:111], a[152:155], v[152:155], v[96:111]
    ds_read_b64_tr_b16 a[148:149], v9 offset:32768
    ds_read_b64_tr_b16 a[150:151], v9 offset:33280
    buffer_store_dwordx4 v[188:191], v2, s[28:31], s64 offen offset:1024 sc1
    s_waitcnt vmcnt(2)
L_fc_46:
    v_cmp_gt_u32 vcc, 1, v62
    s_nop 1
    s_and_b32 s3, vcc_lo, s11
    s_cbranch_scc0 L_fcok_47
    s_add_u32 s61, s61, 1
    s_cmp_gt_u32 s61, 400000
    s_cbranch_scc1 L_fcok_47
    buffer_load_dword v62, v3, s[28:31], 0 offen sc1
    s_waitcnt vmcnt(0)
    s_branch L_fc_46
L_fcok_47:
    s_add_u32 s15, s15, s68
    v_mfma_f32_32x32x16_bf16 v[96:111], a[156:159], v[156:159], v[96:111]
    ds_read_b64_tr_b16 a[152:153], v9 offset:34816
    ds_read_b64_tr_b16 a[154:155], v9 offset:35328
    s_waitcnt lgkmcnt(8)
    v_mfma_f32_32x32x16_bf16 v[96:111], a[160:163], v[160:163], v[96:111]
    s_mov_b64 exec, 3
    buffer_store_dword v31, v7, s[28:31], s15 offen sc1
    s_mov_b64 exec, -1
    buffer_load_dwordx4 a[64:67], v2, s[28:31], s14 offen offset:0 sc1
    v_mfma_f32_32x32x16_bf16 v[96:111], a[164:167], v[164:167], v[96:111]
    v_cmp_eq_u32 s[16:17], 2, v57
    s_nop 1
    v_cndmask_b32 v42, 0, v58, s[16:17]
    s_waitcnt lgkmcnt(4)
    v_mfma_f32_32x32x16_bf16 v[96:111], a[168:171], v[168:171], v[96:111]
    s_waitcnt lgkmcnt(0)
    s_barrier
    ds_read_b64_tr_b16 a[156:157], v10 offset:0
    ds_read_b64_tr_b16 a[158:159], v10 offset:512
    ds_read_b64_tr_b16 a[160:161], v10 offset:2048
    ds_read_b64_tr_b16 a[162:163], v10 offset:2560
    ds_read_b64_tr_b16 a[164:165], v10 offset:4096
    ds_read_b64_tr_b16 a[166:167], v10 offset:4608
    buffer_load_dwordx4 a[68:71], v2, s[28:31], s14 offen offset:1024 sc1
    v_mfma_f32_32x32x16_bf16 v[96:111], a[144:147], v[172:175], v[96:111]
    ds_read_b64_tr_b16 a[168:169], v10 offset:6144
    ds_read_b64_tr_b16 a[170:171], v10 offset:6656
    v_mfma_f32_32x32x16_bf16 v[96:111], a[148:151], v[176:179], v[96:111]
    ds_read_b64_tr_b16 a[144:145], v10 offset:8192
    ds_read_b64_tr_b16 a[146:147], v10 offset:8704
    buffer_load_dwordx4 a[72:75], v2, s[28:31], s14 offen offset:2048 sc1
    v_mfma_f32_32x32x16_bf16 v[96:111], a[152:155], v[180:183], v[96:111]
    ds_read_b64_tr_b16 a[148:149], v10 offset:10240
    ds_read_b64_tr_b16 a[150:151], v10 offset:10752
    v_cmp_eq_u32 s[16:17], 3, v57
    s_nop 1
    v_cndmask_b32 v43, 0, v58, s[16:17]
    s_waitcnt lgkmcnt(8)
    v_mfma_f32_32x32x16_bf16 v[80:95], a[156:159], v[112:115], 0
    ds_read_b64_tr_b16 a[152:153], v10 offset:12288
    ds_read_b64_tr_b16 a[154:155], v10 offset:12800
    buffer_load_dwordx4 a[76:79], v2, s[28:31], s14 offen offset:3072 sc1
    v_mov_b32 v224, v46
    v_mfma_f32_32x32x16_bf16 v[80:95], a[160:163], v[116:119], v[80:95]
    ds_read_b64_tr_b16 a[156:157], v10 offset:14336
    ds_read_b64_tr_b16 a[158:159], v10 offset:14848
    v_mov_b32 v225, v46
    v_mov_b32 v226, v46
    s_waitcnt lgkmcnt(8)
    v_mfma_f32_32x32x16_bf16 v[80:95], a[164:167], v[120:123], v[80:95]
    ds_read_b64_tr_b16 a[160:161], v10 offset:16384
    ds_read_b64_tr_b16 a[162:163], v10 offset:16896
    v_cvt_pk_bf16_f32 v192, v96, v97
    v_mov_b32 v227, v46
    v_cvt_pk_bf16_f32 v193, v98, v99
    v_mfma_f32_32x32x16_bf16 v[80:95], a[168:171], v[124:127], v[80:95]
    ds_read_b64_tr_b16 a[164:165], v10 offset:18432
    ds_read_b64_tr_b16 a[166:167], v10 offset:18944
    v_cvt_pk_bf16_f32 v194, v100, v101
    v_mov_b32 v228, v46
    v_cvt_pk_bf16_f32 v195, v102, v103
    v_min_u32 v192, 0xfffffffe, v192
    s_waitcnt lgkmcnt(8)
    v_mfma_f32_32x32x16_bf16 v[80:95], a[144:147], v[128:131], v[80:95]
    ds_read_b64_tr_b16 a[168:169], v10 offset:20480
    ds_read_b64_tr_b16 a[170:171], v10 offset:20992
    s_add_u32 s64, s50, 7
    v_mov_b32 v229, v46
    s_and_b32 s64, s64, 7
    v_mov_b32 v230, v46
    v_mfma_f32_32x32x16_bf16 v[80:95], a[148:151], v[132:135], v[80:95]
    ds_read_b64_tr_b16 a[144:145], v10 offset:22528
    ds_read_b64_tr_b16 a[146:147], v10 offset:23040
    s_lshl_b32 s64, s64, 18
    v_mov_b32 v231, v46
    s_add_u32 s64, s64, s13
    s_waitcnt lgkmcnt(8)
    v_mfma_f32_32x32x16_bf16 v[80:95], a[152:155], v[136:139], v[80:95]
    ds_read_b64_tr_b16 a[148:149], v10 offset:24576
    ds_read_b64_tr_b16 a[150:151], v10 offset:25088
    buffer_store_dwordx4 v[192:195], v2, s[28:31], s64 offen sc1
    v_mov_b32 v232, v46
    v_mfma_f32_32x32x16_bf16 v[80:95], a[156:159], v[140:143], v[80:95]
    ds_read_b64_tr_b16 a[152:153], v10 offset:26624
    ds_read_b64_tr_b16 a[154:155], v10 offset:27136
    v_cvt_pk_bf16_f32 v196, v104, v105
    v_mov_b32 v233, v46
    v_cvt_pk_bf16_f32 v197, v106, v107
    v_mov_b32 v234, v46
    s_waitcnt lgkmcnt(8)
    v_mfma_f32_32x32x16_bf16 v[80:95], a[160:163], v[144:147], v[80:95]
    ds_read_b64_tr_b16 a[156:157], v10 offset:28672
    ds_read_b64_tr_b16 a[158:159], v10 offset:29184
    v_cvt_pk_bf16_f32 v198, v108, v109
    v_mov_b32 v235, v46
    v_cvt_pk_bf16_f32 v199, v110, v111
    v_mfma_f32_32x32x16_bf16 v[80:95], a[164:167], v[148:151], v[80:95]
    ds_read_b64_tr_b16 a[160:161], v10 offset:30720
    ds_read_b64_tr_b16 a[162:163], v10 offset:31232
    v_min_u32 v196, 0xfffffffe, v196
    v_mov_b32 v236, v46
    s_waitcnt lgkmcnt(8)
    v_mfma_f32_32x32x16_bf16 v[80:95], a[168:171], v[152:155], v[80:95]
    ds_read_b64_tr_b16 a[164:165], v10 offset:32768
    ds_read_b64_tr_b16 a[166:167], v10 offset:33280
    buffer_store_dwordx4 v[196:199], v2, s[28:31], s64 offen offset:1024 sc1
    v_mov_b32 v237, v46
    v_mov_b32 v238, v46
    v_mfma_f32_32x32x16_bf16 v[80:95], a[144:147], v[156:159], v[80:95]
    ds_read_b64_tr_b16 a[168:169], v10 offset:34816
    ds_read_b64_tr_b16 a[170:171], v10 offset:35328
    v_mov_b32 v239, v46
    s_waitcnt lgkmcnt(8)
    v_mfma_f32_32x32x16_bf16 v[80:95], a[148:151], v[160:163], v[80:95]
    ds_read_b64_tr_b16 a[144:145], v11 offset:0
    ds_read_b64_tr_b16 a[146:147], v11 offset:512
    buffer_load_dword v44, v3, s[28:31], 0 offen sc1
    v_mul_f32 v64, 0.5, v68
    v_mfma_f32_32x32x16_bf16 v[80:95], a[152:155], v[164:167], v[80:95]
    ds_read_b64_tr_b16 a[148:149], v11 offset:2048
    ds_read_b64_tr_b16 a[150:151], v11 offset:2560
    v_mul_f32 v65, 0.5, v68
    v_mul_f32 v66, 0.5, v68
    s_waitcnt lgkmcnt(8)
    v_mfma_f32_32x32x16_bf16 v[80:95], a[156:159], v[168:171], v[80:95]
    ds_read_b64_tr_b16 a[152:153], v11 offset:4096
    ds_read_b64_tr_b16 a[154:155], v11 offset:4608
    v_mul_f32 v67, 0.5, v68
    v_mfma_f32_32x32x16_bf16 v[80:95], a[160:163], v[172:175], v[80:95]
    ds_read_b64_tr_b16 a[156:157], v11 offset:6144
    ds_read_b64_tr_b16 a[158:159], v11 offset:6656
    s_waitcnt lgkmcnt(8)
    v_mfma_f32_32x32x16_bf16 v[80:95], a[164:167], v[176:179], v[80:95]
    ds_read_b64_tr_b16 a[160:161], v11 offset:8192
    ds_read_b64_tr_b16 a[162:163], v11 offset:8704
    s_add_u32 s14, s50, 2
    v_mfma_f32_32x32x16_bf16 v[80:95], a[168:171], v[180:183], v[80:95]
    ds_read_b64_tr_b16 a[164:165], v11 offset:10240
    ds_read_b64_tr_b16 a[166:167], v11 offset:10752
    s_waitcnt lgkmcnt(8)
    v_mfma_f32_32x32x16_bf16 v[96:111], a[144:147], v[112:115], v[224:239]
    ds_read_b64_tr_b16 a[168:169], v11 offset:12288
    ds_read_b64_tr_b16 a[170:171], v11 offset:12800
    s_and_b32 s14, s14, 7
    v_mfma_f32_32x32x16_bf16 v[96:111], a[148:151], v[116:119], v[96:111]
    ds_read_b64_tr_b16 a[144:145], v11 offset:14336
    ds_read_b64_tr_b16 a[146:147], v11 offset:14848
    s_waitcnt lgkmcnt(8)
    v_mfma_f32_32x32x16_bf16 v[96:111], a[152:155], v[120:123], v[96:111]
    ds_read_b64_tr_b16 a[148:149], v11 offset:16384
    ds_read_b64_tr_b16 a[150:151], v11 offset:16896
    s_lshl_b32 s11, s14, 1
    v_cvt_pk_bf16_f32 v184, v80, v81
    v_cvt_pk_bf16_f32 v185, v82, v83
    v_mfma_f32_32x32x16_bf16 v[96:111], a[156:159], v[124:127], v[96:111]
    ds_read_b64_tr_b16 a[152:153], v11 offset:18432
    ds_read_b64_tr_b16 a[154:155], v11 offset:18944
    s_lshl_b32 s11, 3, s11
    v_cvt_pk_bf16_f32 v186, v84, v85
    v_cvt_pk_bf16_f32 v187, v86, v87
    v_min_u32 v184, 0xfffffffe, v184
    s_waitcnt lgkmcnt(8)
    v_mfma_f32_32x32x16_bf16 v[96:111], a[160:163], v[128:131], v[96:111]
    ds_read_b64_tr_b16 a[156:157], v11 offset:20480
    ds_read_b64_tr_b16 a[158:159], v11 offset:20992
    s_add_u32 s64, s50, 8
    s_and_b32 s64, s64, 7
    v_mfma_f32_32x32x16_bf16 v[96:111], a[164:167], v[132:135], v[96:111]
    ds_read_b64_tr_b16 a[160:161], v11 offset:22528
    ds_read_b64_tr_b16 a[162:163], v11 offset:23040
    s_lshl_b32 s14, s14, 12
    s_lshl_b32 s64, s64, 18
    s_add_u32 s64, s64, s12
    s_waitcnt lgkmcnt(8)
    v_mfma_f32_32x32x16_bf16 v[96:111], a[168:171], v[136:139], v[96:111]
    ds_read_b64_tr_b16 a[164:165], v11 offset:24576
    ds_read_b64_tr_b16 a[166:167], v11 offset:25088
    buffer_store_dwordx4 v[184:187], v2, s[28:31], s64 offen sc1
    v_mfma_f32_32x32x16_bf16 v[96:111], a[144:147], v[140:143], v[96:111]
    ds_read_b64_tr_b16 a[168:169], v11 offset:26624
    ds_read_b64_tr_b16 a[170:171], v11 offset:27136
    s_xor_b32 s14, s14, s67
    v_cvt_pk_bf16_f32 v188, v88, v89
    v_cvt_pk_bf16_f32 v189, v90, v91
    s_waitcnt lgkmcnt(8)
    v_mfma_f32_32x32x16_bf16 v[96:111], a[148:151], v[144:147], v[96:111]
    ds_read_b64_tr_b16 a[144:145], v11 offset:28672
    ds_read_b64_tr_b16 a[146:147], v11 offset:29184
    v_cvt_pk_bf16_f32 v190, v92, v93
    v_cvt_pk_bf16_f32 v191, v94, v95
    v_mfma_f32_32x32x16_bf16 v[96:111], a[152:155], v[148:151], v[96:111]
    ds_read_b64_tr_b16 a[148:149], v11 offset:30720
    ds_read_b64_tr_b16 a[150:151], v11 offset:31232
    s_add_u32 s14, s14, s58
    v_min_u32 v188, 0xfffffffe, v188
    s_waitcnt lgkmcnt(8)
    v_mfma_f32_32x32x16_bf16 v[96:111], a[156:159], v[152:155], v[96:111]
    ds_read_b64_tr_b16 a[152:153], v11 offset:32768
    ds_read_b64_tr_b16 a[154:155], v11 offset:33280
    buffer_store_dwordx4 v[188:191], v2, s[28:31], s64 offen offset:1024 sc1
    s_waitcnt vmcnt(2)
L_fc_48:
    v_cmp_gt_u32 vcc, 1, v44
    s_nop 1
    s_and_b32 s3, vcc_lo, s11
    s_cbranch_scc0 L_fcok_49
    s_add_u32 s61, s61, 1
    s_cmp_gt_u32 s61, 400000
    s_cbranch_scc1 L_fcok_49
    buffer_load_dword v44, v3, s[28:31], 0 offen sc1
    s_waitcnt vmcnt(0)
    s_branch L_fc_48
L_fcok_49:
    v_mfma_f32_32x32x16_bf16 v[96:111], a[160:163], v[156:159], v[96:111]
    ds_read_b64_tr_b16 a[156:157], v11 offset:34816
    ds_read_b64_tr_b16 a[158:159], v11 offset:35328
    buffer_load_dwordx4 a[80:83], v2, s[28:31], s14 offen offset:0 sc1
    s_waitcnt lgkmcnt(8)
    v_mfma_f32_32x32x16_bf16 v[96:111], a[164:167], v[160:163], v[96:111]
    buffer_load_dwordx4 a[84:87], v2, s[28:31], s14 offen offset:1024 sc1
    v_mfma_f32_32x32x16_bf16 v[96:111], a[168:171], v[164:167], v[96:111]
    buffer_load_dwordx4 a[88:91], v2, s[28:31], s14 offen offset:2048 sc1
    s_waitcnt lgkmcnt(4)
    v_mfma_f32_32x32x16_bf16 v[96:111], a[144:147], v[168:171], v[96:111]
    v_mfma_f32_32x32x16_bf16 v[96:111], a[148:151], v[172:175], v[96:111]
    buffer_load_dwordx4 a[92:95], v2, s[28:31], s14 offen offset:3072 sc1
    v_add_u32 v50, 11, v49
    s_waitcnt lgkmcnt(0)
    v_mfma_f32_32x32x16_bf16 v[96:111], a[152:155], v[176:179], v[96:111]
    v_and_b32 v50, 7, v50
    v_xor_b32 v50, s66, v50
    v_lshl_add_u32 v50, v50, 12, v48
    v_mfma_f32_32x32x16_bf16 v[96:111], a[156:159], v[180:183], v[96:111]
    buffer_load_dwordx4 a[180:183], v50, s[28:31], s65 offen sc1
    s_add_u32 s1, s50, 1
    s_and_b32 s1, s1, 7
    s_lshl_b32 s1, s1, 12
    s_xor_b32 s1, s1, s67
    s_add_u32 s1, s1, s58
    buffer_load_dwordx4 v[208:211], v2, s[28:31], s1 offen offset:0 sc1
    buffer_load_dwordx4 v[212:215], v2, s[28:31], s1 offen offset:1024 sc1
    buffer_load_dwordx4 v[216:219], v2, s[28:31], s1 offen offset:2048 sc1
    buffer_load_dwordx4 v[220:223], v2, s[28:31], s1 offen offset:3072 sc1
    v_mfma_f32_32x32x16_bf16 v[96:111], v[32:35], a[120:123], v[96:111]
    v_mfma_f32_32x32x16_bf16 v[96:111], v[36:39], a[124:127], v[96:111]
    v_mfma_f32_32x32x16_bf16 v[96:111], v[32:35], a[128:131], v[96:111]
    v_mfma_f32_32x32x16_bf16 v[96:111], v[36:39], a[132:135], v[96:111]
    v_mfma_f32_32x32x16_bf16 v[96:111], v[32:35], a[0:3], v[96:111]
    v_mfma_f32_32x32x16_bf16 v[96:111], v[36:39], a[4:7], v[96:111]
    v_mfma_f32_32x32x16_bf16 v[96:111], v[32:35], a[8:11], v[96:111]
    v_mfma_f32_32x32x16_bf16 v[96:111], v[36:39], a[12:15], v[96:111]
    buffer_load_dwordx4 v[200:203], v2, s[28:31], s7 offen offset:0 sc1
    buffer_load_dwordx4 v[204:207], v2, s[28:31], s7 offen offset:1024 sc1
    v_mfma_f32_32x32x16_bf16 v[96:111], v[32:35], a[16:19], v[96:111]
    v_mfma_f32_32x32x16_bf16 v[96:111], v[36:39], a[20:23], v[96:111]
    v_mfma_f32_32x32x16_bf16 v[96:111], v[32:35], a[24:27], v[96:111]
    v_mfma_f32_32x32x16_bf16 v[96:111], v[36:39], a[28:31], v[96:111]
    v_mfma_f32_32x32x16_bf16 v[96:111], v[32:35], a[32:35], v[96:111]
    v_mfma_f32_32x32x16_bf16 v[96:111], v[36:39], a[36:39], v[96:111]
    v_mfma_f32_32x32x16_bf16 v[96:111], v[32:35], a[40:43], v[96:111]
    v_mfma_f32_32x32x16_bf16 v[96:111], v[36:39], a[44:47], v[96:111]
    v_mfma_f32_32x32x16_bf16 v[96:111], v[32:35], a[48:51], v[96:111]
    v_mfma_f32_32x32x16_bf16 v[96:111], v[36:39], a[52:55], v[96:111]
    v_mfma_f32_32x32x16_bf16 v[96:111], v[32:35], a[56:59], v[96:111]
    v_mfma_f32_32x32x16_bf16 v[96:111], v[36:39], a[60:63], v[96:111]
    v_mfma_f32_32x32x16_bf16 v[96:111], v[32:35], a[64:67], v[96:111]
    v_mfma_f32_32x32x16_bf16 v[96:111], v[36:39], a[68:71], v[96:111]
    v_mfma_f32_32x32x16_bf16 v[96:111], v[32:35], a[72:75], v[96:111]
    v_mfma_f32_32x32x16_bf16 v[96:111], v[36:39], a[76:79], v[96:111]
    s_waitcnt vmcnt(10)
    v_mfma_f32_32x32x16_bf16 v[96:111], v[32:35], a[80:83], v[96:111]
    s_waitcnt vmcnt(9)
    v_mfma_f32_32x32x16_bf16 v[96:111], v[36:39], a[84:87], v[96:111]
    s_waitcnt vmcnt(8)
    v_mfma_f32_32x32x16_bf16 v[96:111], v[32:35], a[88:91], v[96:111]
    s_waitcnt vmcnt(7)
    v_mfma_f32_32x32x16_bf16 v[96:111], v[36:39], a[92:95], v[96:111]
    v_mfma_f32_32x32x16_bf16 v[240:255], v[40:43], a[188:191], v[64:79]
    v_mfma_f32_32x32x16_bf16 v[240:255], v[40:43], a[184:187], v[240:255]
    v_mfma_f32_32x32x16_bf16 v[240:255], v[40:43], a[172:175], v[240:255]
    v_mfma_f32_32x32x16_bf16 v[240:255], v[40:43], a[176:179], v[240:255]
    s_waitcnt vmcnt(6)
    v_mfma_f32_32x32x16_bf16 v[240:255], v[40:43], a[180:183], v[240:255]
    s_waitcnt vmcnt(2)
    v_max_u32 v63, v220, v216
    v_max3_u32 v63, v212, v208, v63
    s_waitcnt vmcnt(0)
    v_max3_u32 v63, v204, v200, v63
    v_cmp_eq_u32 vcc, -1, v63
    s_nop 1
    s_cbranch_vccz L_tailok_50
    s_mov_b32 s69, 0
L_pd_51:
    s_add_u32 s1, s50, 1
    s_and_b32 s1, s1, 7
    s_lshl_b32 s1, s1, 12
    s_xor_b32 s1, s1, s67
    s_add_u32 s1, s1, s58
    buffer_load_dwordx4 v[208:211], v2, s[28:31], s1 offen offset:0 sc1
    buffer_load_dwordx4 v[212:215], v2, s[28:31], s1 offen offset:1024 sc1
    buffer_load_dwordx4 v[216:219], v2, s[28:31], s1 offen offset:2048 sc1
    buffer_load_dwordx4 v[220:223], v2, s[28:31], s1 offen offset:3072 sc1
    buffer_load_dwordx4 v[200:203], v2, s[28:31], s7 offen offset:0 sc1
    buffer_load_dwordx4 v[204:207], v2, s[28:31], s7 offen offset:1024 sc1
    s_add_u32 s69, s69, 1
    s_cmp_gt_u32 s69, 400000
    s_waitcnt vmcnt(0)
    s_cbranch_scc1 L_pdout_52
    v_max_u32 v63, v220, v216
    v_max3_u32 v63, v212, v208, v63
    v_max3_u32 v63, v204, v200, v63
    v_cmp_eq_u32 vcc, -1, v63
    s_nop 1
    s_cbranch_vccnz L_pd_51
L_pdout_52:
L_tailok_50:
    v_mfma_f32_32x32x16_bf16 v[96:111], v[32:35], v[216:219], v[96:111]
    v_mfma_f32_32x32x16_bf16 v[96:111], v[36:39], v[220:223], v[96:111]
    v_mfma_f32_32x32x16_bf16 v[96:111], v[32:35], v[208:211], v[96:111]
    v_mfma_f32_32x32x16_bf16 v[96:111], v[36:39], v[212:215], v[96:111]
    v_mov_b32 v56, v240
    v_mov_b32 v57, v241
    v_mov_b32 v58, v242
    v_mov_b32 v59, v243
    v_permlane16_swap_b32 v240, v56
    v_permlane16_swap_b32 v241, v57
    v_permlane16_swap_b32 v242, v58
    v_permlane16_swap_b32 v243, v59
    v_add_f32 v240, v240, v56
    v_add_f32 v241, v241, v57
    v_add_f32 v242, v242, v58
    v_add_f32 v243, v243, v59
    v_mfma_f32_32x32x16_bf16 v[96:111], v[32:35], v[200:203], v[96:111]
    v_mfma_f32_32x32x16_bf16 v[96:111], v[36:39], v[204:207], v[96:111]
    v_cvt_pk_bf16_f32 v240, v240, v241
    v_cvt_pk_bf16_f32 v241, v242, v243
    s_mov_b32 exec_lo, 0xffff
    s_mov_b32 exec_hi, 0xffff
    buffer_store_dwordx2 v[240:241], v52, s[40:43], s4 offen offset:1024
    s_mov_b64 exec, -1
    s_nop 5
    v_cvt_pk_bf16_f32 v184, v96, v97
    v_cvt_pk_bf16_f32 v185, v98, v99
    v_cvt_pk_bf16_f32 v186, v100, v101
    v_cvt_pk_bf16_f32 v187, v102, v103
    buffer_store_dwordx4 v[184:187], v53, s[40:43], s5 offen offset:0
    v_cvt_pk_bf16_f32 v188, v104, v105
    v_cvt_pk_bf16_f32 v189, v106, v107
    v_cvt_pk_bf16_f32 v190, v108, v109
    v_cvt_pk_bf16_f32 v191, v110, v111
    buffer_store_dwordx4 v[188:191], v53, s[40:43], s5 offen offset:32
L_end:
    s_endpgm
.section .rodata,"a"
.p2align 6
.amdhsa_kernel sequential_preLN__sliding_block__mixer_s_mlp__prompt_kernel
  .amdhsa_next_free_vgpr 512
  .amdhsa_next_free_sgpr 102
  .amdhsa_accum_offset 256
  .amdhsa_group_segment_fixed_size 0
  .amdhsa_kernarg_size 88
  .amdhsa_user_sgpr_count 2
  .amdhsa_user_sgpr_kernarg_segment_ptr 1
  .amdhsa_system_sgpr_workgroup_id_x 1
  .amdhsa_float_denorm_mode_32 3
.end_amdhsa_kernel
```
